```python
import torch

def _softmax(x, axis=-1):
    return torch.softmax(x, dim=axis)
def _gelu(x):
    return torch.nn.functional.gelu(x, approximate="tanh")
def _silu(x):
    return torch.nn.functional.silu(x)
def _sigmoid(x):
    return torch.sigmoid(x)
def _layernorm(x, axis=-1, eps=1e-5):
    m = x.mean(dim=axis, keepdim=True)
    v = x.var(dim=axis, keepdim=True, unbiased=False)
    return (x - m) / torch.sqrt(v + eps)
def _scatter_add(tgt, idx, src, axis=0):
    return tgt.clone().index_add_(axis, idx, src)
def _segment_sum(src, seg, n):
    out = torch.zeros((n,) + src.shape[1:], dtype=src.dtype)
    return out.index_add_(0, seg, src)
def _pad(x, pw):
    flat = tuple(v for pair in reversed(pw) for v in pair)
    return torch.nn.functional.pad(x, flat)

kernel_name = 'parallel_sum__ssm_conv_s5__dense_activation_silu__prompt'

def setup_inputs():

    _w = (lambda a: (lambda t: t.to(torch.bfloat16) if t.is_floating_point() else t)(torch.as_tensor(a)))
    def _A_setup():
        B, S, D = 1, 2048, 576
        P = D
        Lambda_re = -0.5 * (lambda _x: torch.exp(torch.as_tensor(_x)))((lambda *s: torch.randn(*s, dtype=torch.bfloat16) * 0.2)(P))
        Lambda_im = (lambda *s: torch.randn(*s, dtype=torch.bfloat16) * 0.8)(P) * 1.0
        B_re = (lambda *s: torch.randn(*s, dtype=torch.bfloat16) * 0.2)(P, D) * (D ** -0.5)
        B_im = (lambda *s: torch.randn(*s, dtype=torch.bfloat16) * 0.2)(P, D) * (D ** -0.5)
        C_re = (lambda *s: torch.randn(*s, dtype=torch.bfloat16) * 0.2)(D, P) * (P ** -0.5)
        C_im = (lambda *s: torch.randn(*s, dtype=torch.bfloat16) * 0.2)(D, P) * (P ** -0.5)
        log_dt = (lambda *s: torch.randn(*s, dtype=torch.bfloat16) * 0.2)(P) * 0.3 - 2.0
        Dskip = (lambda *s: torch.randn(*s, dtype=torch.bfloat16) * 0.05)(D)
        return {
            "x": _w((lambda *s: torch.randn(*s, dtype=torch.bfloat16) * 0.05)(B, S, D)),
            "Lambda_re": _w(Lambda_re),
            "Lambda_im": _w(Lambda_im),
            "B_re": _w(B_re),
            "B_im": _w(B_im),
            "C_re": _w(C_re),
            "C_im": _w(C_im),
            "log_dt": _w(log_dt),
            "Dskip": _w(Dskip),
        }
    _A_in = _A_setup()

    def _B_setup():
        B, S, D, F = 1, 2048, 576, 4608
        return {
            "x": _w((lambda *s: torch.randn(*s, dtype=torch.bfloat16) * 0.05)(B, S, D)),
            "w1": _w((lambda *s: torch.randn(*s, dtype=torch.bfloat16) * 0.8)(D, F) * (D ** -0.5)),
            "w2": _w((lambda *s: torch.randn(*s, dtype=torch.bfloat16) * 0.2)(F, D) * (F ** -0.5)),
        }
    _B_in = _B_setup()

    return {
        "A_x": _A_in["x"],
        "A_Lambda_re": _A_in["Lambda_re"],
        "A_Lambda_im": _A_in["Lambda_im"],
        "A_B_re": _A_in["B_re"],
        "A_B_im": _A_in["B_im"],
        "A_C_re": _A_in["C_re"],
        "A_C_im": _A_in["C_im"],
        "A_log_dt": _A_in["log_dt"],
        "A_Dskip": _A_in["Dskip"],
        "B_x": _B_in["x"],
        "B_w1": _B_in["w1"],
        "B_w2": _B_in["w2"],
    }

def reference(A_x, A_Lambda_re, A_Lambda_im, A_B_re, A_B_im, A_C_re, A_C_im, A_log_dt, A_Dskip, B_x, B_w1, B_w2):
    def _A_ref(x, Lambda_re, Lambda_im, B_re, B_im, C_re, C_im, log_dt, Dskip):
        Bsz, L, H = x.shape
        Lam = Lambda_re + 1j * Lambda_im
        Bmat = B_re + 1j * B_im
        Cmat = C_re + 1j * C_im
        dt = torch.exp(log_dt)
        Lam_bar = torch.exp(dt * Lam)
        B_bar = ((Lam_bar - 1.0) / Lam)[:, None] * Bmat
        Bu = torch.einsum("bld,pd->blp", x + 0j, B_bar)
        h = torch.zeros_like(Bu[:, 0, :])
        hs = []
        for t in range(L):
            h = Lam_bar[None, :] * h + Bu[:, t, :]
            hs.append(h)
        hseq = torch.stack(hs, 1)
        y = 2.0 * torch.einsum("blp,dp->bld", hseq, Cmat).real + x * Dskip[None, None, :]
        return y

    def _B_ref(x, w1, w2):
        h = torch.einsum("bsd,df->bsf", x, w1)
        h = _silu(h)
        out = torch.einsum("bsf,fd->bsd", h, w2)
        return out

    x = A_x
    xn = _layernorm(x, axis=-1)
    return x + _A_ref(xn, A_Lambda_re, A_Lambda_im, A_B_re, A_B_im, A_C_re, A_C_im, A_log_dt, A_Dskip) + _B_ref(xn, B_w1, B_w2)
```

```asm
; @launch grid=(256,1,1) block=(256,1,1) lds=163840
.amdgcn_target "amdgcn-amd-amdhsa--gfx950"
.text
.globl parallel_sum__ssm_conv_s5__dense_activation_silu__prompt_kernel
.p2align 8
.type parallel_sum__ssm_conv_s5__dense_activation_silu__prompt_kernel,@function
parallel_sum__ssm_conv_s5__dense_activation_silu__prompt_kernel:
s_cmp_ge_u32 s2, 256
s_cbranch_scc1 Lend
s_load_dwordx16 s[68:83], s[0:1], 0
s_load_dwordx2 s[84:85], s[0:1], 64
s_load_dwordx8 s[88:95], s[0:1], 80
s_load_dwordx2 s[96:97], s[0:1], 112
v_lshrrev_b32 v1, 6, v0
s_and_b32 s67, s2, 7
v_readfirstlane_b32 s50, v1
s_lshr_b32 s86, s2, 3
s_cmp_lt_u32 s86, 2
s_cbranch_scc1 Lhsel
s_and_b32 s87, s67, 3
s_mul_i32 s87, s87, 30
s_add_u32 s87, s87, s86
s_sub_u32 s87, s87, 2
s_lshr_b32 s48, s87, 3
s_and_b32 s87, s87, 7
s_lshr_b32 s67, s67, 2
s_lshl_b32 s67, s67, 3
s_add_u32 s49, s67, s87
s_mul_i32 s67, s48, 1
s_add_u32 s67, s67, s49
s_mul_i32 s86, s67, 7282
s_lshr_b32 s86, s86, 16
s_mul_i32 s86, s86, 9
s_sub_u32 s67, s67, s86
s_mul_i32 s67, s67, 128
s_mul_i32 s100, s49, 147456
s_cmp_ge_u32 s48, 9
s_cselect_b32 s86, 4608, 0
s_add_u32 s100, s100, s86
s_lshl_b32 s53, s50, 11
v_and_b32 v255, 63, v0
v_lshrrev_b32 v254, 3, v255
v_and_b32 v253, 7, v255
v_lshrrev_b32 v248, 1, v254
v_xor_b32 v248, v253, v248
v_lshlrev_b32 v252, 4, v248
v_xor_b32 v251, 64, v252
v_and_b32 v248, 4, v254
v_add_u32 v248, v254, v248
s_lshl_b32 s86, s50, 5
v_add_u32 v248, s86, v248
v_mul_u32_u24 v248, 1152, v248
v_add_u32 v250, v248, v252
v_add_u32 v248, 17408, v248
v_add_u32 v249, v248, v251
s_add_u32 s86, s67, 0
s_sub_u32 s87, s86, 1152
s_min_u32 s58, s86, s87
s_add_u32 s86, s67, 128
s_sub_u32 s87, s86, 1152
s_min_u32 s59, s86, s87
s_add_u32 s86, s67, 256
s_sub_u32 s87, s86, 1152
s_min_u32 s60, s86, s87
s_add_u32 s86, s67, 384
s_sub_u32 s87, s86, 1152
s_min_u32 s61, s86, s87
s_add_u32 s86, s67, 512
s_sub_u32 s87, s86, 1152
s_min_u32 s62, s86, s87
s_add_u32 s86, s67, 640
s_sub_u32 s87, s86, 1152
s_min_u32 s63, s86, s87
s_add_u32 s86, s67, 768
s_sub_u32 s87, s86, 1152
s_min_u32 s64, s86, s87
s_add_u32 s86, s67, 896
s_sub_u32 s87, s86, 1152
s_min_u32 s65, s86, s87
s_add_u32 s86, s67, 1024
s_sub_u32 s87, s86, 1152
s_min_u32 s66, s86, s87
s_mov_b32 s6, 2359296
s_mov_b32 s7, 0x20000
s_waitcnt lgkmcnt(0)
s_mov_b32 s4, s68
s_mov_b32 s5, s69
s_mov_b32 m0, s53
s_add_u32 s54, s100, s58
buffer_load_dwordx4 v250, s[4:7], s54 offen  lds
buffer_load_dwordx4 v249, s[4:7], s54 offen offset:1024  lds
s_addk_i32 m0, 0x2000
s_add_u32 s54, s100, s59
buffer_load_dwordx4 v250, s[4:7], s54 offen  lds
buffer_load_dwordx4 v249, s[4:7], s54 offen offset:1024  lds
s_addk_i32 m0, 0x2000
s_add_u32 s54, s100, s60
buffer_load_dwordx4 v250, s[4:7], s54 offen  lds
buffer_load_dwordx4 v249, s[4:7], s54 offen offset:1024  lds
s_addk_i32 m0, 0x2000
s_add_u32 s54, s100, s61
buffer_load_dwordx4 v250, s[4:7], s54 offen  lds
buffer_load_dwordx4 v249, s[4:7], s54 offen offset:1024  lds
s_addk_i32 m0, 0x2000
s_add_u32 s54, s100, s62
buffer_load_dwordx4 v250, s[4:7], s54 offen  lds
buffer_load_dwordx4 v249, s[4:7], s54 offen offset:1024  lds
s_mov_b64 exec, 0
s_cmp_ge_u32 s48, 9
s_cbranch_scc1 Ldf
s_cmp_eq_u32 s50, 0
s_cbranch_scc1 LM
s_cmp_eq_u32 s50, 1
s_cbranch_scc1 LM_p1
s_cmp_eq_u32 s50, 2
s_cbranch_scc1 LM_p2
s_branch LM_p3
Ldf:
s_cmp_eq_u32 s50, 0
s_cbranch_scc1 LF
s_cmp_eq_u32 s50, 1
s_cbranch_scc1 LF_p1
s_cmp_eq_u32 s50, 2
s_cbranch_scc1 LF_p2
s_branch LF_p3
Lend:
s_endpgm
Lhsel:

s_lshl_b32 s67, s67, 1
s_add_u32 s49, s67, s86
s_mov_b32 s48, 15
v_mov_b32 v247, 0
s_getpc_b64 s[30:31]
LH_pc:
s_bitcmp1_b32 s49, 0
s_mov_b32 s86, LM-LH_pc
s_cselect_b32 s67, LF-LH_pc, s86
s_add_u32 s30, s30, s67
s_addc_u32 s31, s31, 0
s_sub_u32 s67, Lcode_end-LH_pc, s67
v_mov_b32 v244, s30
v_mov_b32 v245, s31
v_mov_b32 v246, s67
v_lshlrev_b32 v243, 7, v0
v_add_u32 v243, 0, v243
v_min_u32 v243, v246, v243
v_add_co_u32 v240, vcc, v244, v243
s_nop 1
v_addc_co_u32 v241, vcc, 0, v245, vcc
global_load_ubyte v247, v[240:241], off
v_lshlrev_b32 v243, 7, v0
v_add_u32 v243, 32768, v243
v_min_u32 v243, v246, v243
v_add_co_u32 v240, vcc, v244, v243
s_nop 1
v_addc_co_u32 v241, vcc, 0, v245, vcc
global_load_ubyte v247, v[240:241], off
s_branch LH
.p2align 12
LM:
s_mov_b64 exec, -1
s_lshl_b32 s86, s48, 7
v_and_b32 v247, 12, v255
v_add_u32 v247, v255, v247
v_bfe_u32 v248, v255, 4, 1
v_mul_u32_u24 v248, 12, v248
v_sub_u32 v247, v247, v248
v_lshl_add_u32 v247, v247, 1, s86
s_mov_b64 s[40:41], s[70:71]
s_mov_b64 s[42:43], s[72:73]
s_mov_b64 s[44:45], s[82:83]
v_and_b32 v246, 15, v255
v_lshrrev_b32 v245, 4, v255
v_lshrrev_b32 v248, 1, v246
v_xor_b32 v248, v245, v248
v_lshlrev_b32 v248, 4, v248
v_lshl_add_u32 v248, v246, 7, v248
v_add_u32 v244, s53, v248
v_xor_b32 v243, 64, v244
v_add_u32 v242, 49152, v244
v_add_u32 v241, 49152, v243
v_add_u32 v240, 98304, v244
v_add_u32 v239, 98304, v243
v_mov_b32 v248, 0x3f803f80
v_accvgpr_write_b32 a244, v248
v_accvgpr_write_b32 a245, v248
v_accvgpr_write_b32 a246, v248
v_accvgpr_write_b32 a247, v248
s_mov_b64 s[8:9], s[88:89]
s_mov_b32 s10, 5308416
s_mov_b32 s11, 0x20000
s_mov_b64 s[12:13], s[90:91]
s_mov_b64 s[20:21], s[78:79]
s_mov_b64 s[24:25], s[80:81]
s_bitcmp1_b32 s50, 0
s_cselect_b64 s[16:17], s[76:77], s[74:75]
s_mov_b32 s18, 663552
s_mov_b32 s19, 0x20000
s_mov_b64 s[28:29], s[92:93]
s_mov_b64 s[36:37], s[94:95]
s_mov_b64 s[32:33], s[96:97]
s_mov_b32 s97, 0xffff0000
s_add_u32 s86, s48, 1
s_lshr_b32 s51, s86, 1
s_and_b32 s52, s86, 1
s_xor_b32 s3, s52, 1
s_sub_u32 s86, s49, 9
s_min_u32 s101, s49, s86
s_add_u32 s86, s51, 8
s_and_b32 s86, s86, 7
s_add_u32 s86, s86, s101
s_add_u32 s86, s86, 1
s_sub_u32 s87, s86, 9
s_min_u32 s86, s86, s87
s_lshl_b32 s82, s86, 7
s_sub_u32 s86, s82, s58
s_add_u32 s87, s86, 1152
s_min_u32 s86, s86, s87
s_lshl_b32 s86, s86, 6
s_add_u32 s86, s86, s53
v_lshrrev_b32 v248, 1, v246
v_lshrrev_b32 v238, 1, v245
v_xor_b32 v248, v248, v238
s_lshl_b32 s87, s52, 2
v_xor_b32 v248, s87, v248
v_lshlrev_b32 v248, 4, v248
v_lshl_add_u32 v248, v246, 7, v248
v_and_b32 v238, 1, v245
v_lshl_add_u32 v248, v238, 3, v248
v_add_u32 v237, s86, v248
s_lshl_b32 s87, s52, 6
s_add_u32 s87, s87, s82
v_lshl_add_u32 v236, v245, 3, s87
s_lshl_b32 s86, s48, 9
s_mul_i32 s68, s48, 73728
s_mul_i32 s69, s48, 73728
s_add_u32 s69, s69, 36864
s_add_u32 s70, s86, 0
s_add_u32 s71, s86, 128
s_add_u32 s72, s86, 256
s_add_u32 s73, s86, 384
s_lshl_b32 s86, s50, 4
v_add_u32 v235, s86, v254
s_and_b32 s87, s50, 1
s_mul_i32 s87, s87, 12
s_sub_u32 s86, s86, s87
v_and_b32 v238, 4, v254
v_add3_u32 v238, v238, v254, s86
v_mul_u32_u24 v238, 9216, v238
v_and_b32 v248, 6, v254
v_xor_b32 v248, v253, v248
v_lshl_add_u32 v254, v248, 4, v238
v_add_u32 v253, 146432, v254
s_lshl_b32 s86, s3, 2
v_xor_b32 v248, s86, v248
v_lshlrev_b32 v248, 4, v248
v_mul_u32_u24 v238, 1152, v235
v_add_u32 v234, v238, v248
v_add_u32 v233, 8192, v234
s_lshr_b32 s86, s50, 1
s_lshl_b32 s87, s50, 3
s_sub_u32 s86, s87, s86
s_mul_i32 s86, s86, 4608
v_subrev_u32 v232, s86, v250
v_subrev_u32 v231, s86, v249
s_lshl_b32 s86, s3, 5
v_xor_b32 v238, s86, v235
v_mul_u32_u24 v238, 1152, v238
s_lshl_b32 s86, s48, 7
v_add_u32 v238, s86, v238
v_add_u32 v235, v238, v252
v_add_u32 v238, 8192, v238
v_add_u32 v252, v238, v251
v_lshrrev_b32 v248, 2, v246
v_lshl_add_u32 v251, v248, 4, v246
v_lshlrev_b32 v251, 2, v251
v_and_b32 v238, 3, v255
v_cmp_eq_u32 s[88:89], 1, v238
v_cmp_eq_u32 s[90:91], 2, v238
v_cmp_eq_u32 s[92:93], 3, v238
s_waitcnt vmcnt(8)
ds_read_b128 v[4:7], v244 offset:0
ds_read_b128 v[8:11], v243 offset:0
s_addk_i32 m0, 0x2000
s_add_u32 s54, s100, s63
buffer_load_dwordx4 v250, s[4:7], s54 offen  lds
buffer_load_dwordx4 v249, s[4:7], s54 offen offset:1024  lds
s_waitcnt vmcnt(8)
ds_read_b128 v[12:15], v244 offset:8192
ds_read_b128 v[16:19], v243 offset:8192
s_waitcnt lgkmcnt(2)
v_mfma_f32_16x16x32_bf16 a[248:251], a[244:247], v[4:7], 0
v_subrev_u32 v248, s53, v244
v_mfma_f32_16x16x32_bf16 v[20:23], v[4:7], v[4:7], 0
v_mfma_f32_16x16x32_bf16 a[248:251], a[244:247], v[8:11], a[248:251]
v_mfma_f32_16x16x32_bf16 v[20:23], v[8:11], v[8:11], v[20:23]
s_addk_i32 m0, 0x2000
s_add_u32 s54, s100, s64
buffer_load_dwordx4 v250, s[4:7], s54 offen  lds
buffer_load_dwordx4 v249, s[4:7], s54 offen offset:1024  lds
s_waitcnt vmcnt(8)
ds_read_b128 v[24:27], v244 offset:16384
ds_read_b128 v[28:31], v243 offset:16384
s_waitcnt lgkmcnt(2)
v_mfma_f32_16x16x32_bf16 a[248:251], a[244:247], v[12:15], a[248:251]
v_lshlrev_b32 v32, 16, v4
v_and_b32 v4, s97, v4
v_mfma_f32_16x16x32_bf16 v[20:23], v[12:15], v[12:15], v[20:23]
v_lshlrev_b32 v33, 16, v5
v_and_b32 v5, s97, v5
v_mfma_f32_16x16x32_bf16 a[248:251], a[244:247], v[16:19], a[248:251]
v_lshlrev_b32 v34, 16, v6
v_and_b32 v6, s97, v6
v_mfma_f32_16x16x32_bf16 v[20:23], v[16:19], v[16:19], v[20:23]
v_lshlrev_b32 v35, 16, v7
v_and_b32 v7, s97, v7
v_lshlrev_b32 v36, 16, v8
v_and_b32 v8, s97, v8
v_lshlrev_b32 v37, 16, v9
v_and_b32 v9, s97, v9
v_lshlrev_b32 v38, 16, v10
v_and_b32 v10, s97, v10
v_lshlrev_b32 v39, 16, v11
v_and_b32 v11, s97, v11
v_subrev_u32 v230, s53, v243
s_addk_i32 m0, 0x2000
s_add_u32 s54, s100, s65
buffer_load_dwordx4 v250, s[4:7], s54 offen  lds
buffer_load_dwordx4 v249, s[4:7], s54 offen offset:1024  lds
s_waitcnt vmcnt(8)
ds_read_b128 v[40:43], v244 offset:24576
ds_read_b128 v[44:47], v243 offset:24576
s_waitcnt lgkmcnt(2)
v_mfma_f32_16x16x32_bf16 a[248:251], a[244:247], v[24:27], a[248:251]
v_lshlrev_b32 v48, 16, v12
v_and_b32 v12, s97, v12
v_mfma_f32_16x16x32_bf16 v[20:23], v[24:27], v[24:27], v[20:23]
v_lshlrev_b32 v49, 16, v13
v_and_b32 v13, s97, v13
v_mfma_f32_16x16x32_bf16 a[248:251], a[244:247], v[28:31], a[248:251]
v_lshlrev_b32 v50, 16, v14
v_and_b32 v14, s97, v14
v_mfma_f32_16x16x32_bf16 v[20:23], v[28:31], v[28:31], v[20:23]
v_lshlrev_b32 v51, 16, v15
v_and_b32 v15, s97, v15
v_lshlrev_b32 v52, 16, v16
v_and_b32 v16, s97, v16
v_lshlrev_b32 v53, 16, v17
v_and_b32 v17, s97, v17
v_lshlrev_b32 v54, 16, v18
v_and_b32 v18, s97, v18
v_lshlrev_b32 v55, 16, v19
v_and_b32 v19, s97, v19
s_addk_i32 m0, 0x2000
s_add_u32 s54, s100, s66
buffer_load_dwordx4 v250, s[4:7], s54 offen  lds
buffer_load_dwordx4 v249, s[4:7], s54 offen offset:1024  lds
s_waitcnt vmcnt(8)
ds_read_b128 v[56:59], v244 offset:32768
ds_read_b128 v[60:63], v243 offset:32768
s_waitcnt lgkmcnt(2)
v_mfma_f32_16x16x32_bf16 a[248:251], a[244:247], v[40:43], a[248:251]
v_lshlrev_b32 v64, 16, v24
v_and_b32 v24, s97, v24
v_mfma_f32_16x16x32_bf16 v[20:23], v[40:43], v[40:43], v[20:23]
v_lshlrev_b32 v65, 16, v25
v_and_b32 v25, s97, v25
v_mfma_f32_16x16x32_bf16 a[248:251], a[244:247], v[44:47], a[248:251]
v_lshlrev_b32 v66, 16, v26
v_and_b32 v26, s97, v26
v_mfma_f32_16x16x32_bf16 v[20:23], v[44:47], v[44:47], v[20:23]
v_lshlrev_b32 v67, 16, v27
v_and_b32 v27, s97, v27
v_lshlrev_b32 v68, 16, v28
v_and_b32 v28, s97, v28
v_lshlrev_b32 v69, 16, v29
v_and_b32 v29, s97, v29
v_lshlrev_b32 v70, 16, v30
v_and_b32 v30, s97, v30
v_lshlrev_b32 v71, 16, v31
v_and_b32 v31, s97, v31
s_addk_i32 m0, 0x2000
s_add_u32 s100, s100, 4608
s_add_u32 s54, s100, s58
buffer_load_dwordx4 v250, s[4:7], s54 offen  lds
buffer_load_dwordx4 v249, s[4:7], s54 offen offset:1024  lds
s_waitcnt vmcnt(8)
ds_read_b128 v[72:75], v244 offset:40960
ds_read_b128 v[76:79], v243 offset:40960
s_waitcnt lgkmcnt(2)
v_mfma_f32_16x16x32_bf16 a[248:251], a[244:247], v[56:59], a[248:251]
v_lshlrev_b32 v80, 16, v40
v_and_b32 v40, s97, v40
v_mfma_f32_16x16x32_bf16 v[20:23], v[56:59], v[56:59], v[20:23]
v_lshlrev_b32 v81, 16, v41
v_and_b32 v41, s97, v41
v_mfma_f32_16x16x32_bf16 a[248:251], a[244:247], v[60:63], a[248:251]
v_lshlrev_b32 v82, 16, v42
v_and_b32 v42, s97, v42
v_mfma_f32_16x16x32_bf16 v[20:23], v[60:63], v[60:63], v[20:23]
v_lshlrev_b32 v83, 16, v43
v_and_b32 v43, s97, v43
v_lshlrev_b32 v84, 16, v44
v_and_b32 v44, s97, v44
v_lshlrev_b32 v85, 16, v45
v_and_b32 v45, s97, v45
v_lshlrev_b32 v86, 16, v46
v_and_b32 v46, s97, v46
v_lshlrev_b32 v87, 16, v47
v_and_b32 v47, s97, v47
s_addk_i32 m0, 0x2000
s_add_u32 s54, s100, s59
buffer_load_dwordx4 v250, s[4:7], s54 offen  lds
buffer_load_dwordx4 v249, s[4:7], s54 offen offset:1024  lds
s_waitcnt vmcnt(8)
ds_read_b128 v[88:91], v242 offset:0
ds_read_b128 v[92:95], v241 offset:0
s_mov_b64 exec, 0
s_cmp_eq_u32 s50, 0
s_cbranch_scc1 LM_p4
s_cmp_eq_u32 s50, 1
s_cbranch_scc1 LM_p5
s_cmp_eq_u32 s50, 2
s_cbranch_scc1 LM_p6
s_branch LM_p7
LM_v105:
s_mov_b64 exec, -1
s_waitcnt lgkmcnt(2)
v_mfma_f32_16x16x32_bf16 a[248:251], a[244:247], v[72:75], a[248:251]
v_lshlrev_b32 v96, 16, v56
v_and_b32 v56, s97, v56
v_mfma_f32_16x16x32_bf16 v[20:23], v[72:75], v[72:75], v[20:23]
v_lshlrev_b32 v97, 16, v57
v_and_b32 v57, s97, v57
v_mfma_f32_16x16x32_bf16 a[248:251], a[244:247], v[76:79], a[248:251]
v_lshlrev_b32 v98, 16, v58
v_and_b32 v58, s97, v58
v_mfma_f32_16x16x32_bf16 v[20:23], v[76:79], v[76:79], v[20:23]
v_lshlrev_b32 v99, 16, v59
v_and_b32 v59, s97, v59
v_lshlrev_b32 v100, 16, v60
v_and_b32 v60, s97, v60
v_lshlrev_b32 v101, 16, v61
v_and_b32 v61, s97, v61
v_lshlrev_b32 v102, 16, v62
v_and_b32 v62, s97, v62
v_lshlrev_b32 v103, 16, v63
v_and_b32 v63, s97, v63
s_addk_i32 m0, 0x2000
s_add_u32 s54, s100, s60
buffer_load_dwordx4 v250, s[4:7], s54 offen  lds
buffer_load_dwordx4 v249, s[4:7], s54 offen offset:1024  lds
s_waitcnt vmcnt(8)
ds_read_b128 v[104:107], v242 offset:8192
ds_read_b128 v[108:111], v241 offset:8192
s_waitcnt lgkmcnt(2)
v_mfma_f32_16x16x32_bf16 a[248:251], a[244:247], v[88:91], a[248:251]
v_lshlrev_b32 v112, 16, v72
v_and_b32 v72, s97, v72
v_mfma_f32_16x16x32_bf16 v[20:23], v[88:91], v[88:91], v[20:23]
v_lshlrev_b32 v113, 16, v73
v_and_b32 v73, s97, v73
v_mfma_f32_16x16x32_bf16 a[248:251], a[244:247], v[92:95], a[248:251]
v_lshlrev_b32 v114, 16, v74
v_and_b32 v74, s97, v74
v_mfma_f32_16x16x32_bf16 v[20:23], v[92:95], v[92:95], v[20:23]
v_lshlrev_b32 v115, 16, v75
v_and_b32 v75, s97, v75
v_lshlrev_b32 v116, 16, v76
v_and_b32 v76, s97, v76
v_lshlrev_b32 v117, 16, v77
v_and_b32 v77, s97, v77
v_lshlrev_b32 v118, 16, v78
v_and_b32 v78, s97, v78
v_lshlrev_b32 v119, 16, v79
v_and_b32 v79, s97, v79
s_addk_i32 m0, 0x2000
s_add_u32 s54, s100, s61
buffer_load_dwordx4 v250, s[4:7], s54 offen  lds
buffer_load_dwordx4 v249, s[4:7], s54 offen offset:1024  lds
s_waitcnt vmcnt(8)
ds_read_b128 v[120:123], v242 offset:16384
ds_read_b128 v[124:127], v241 offset:16384
v_xor_b32 v238, 32, v237
ds_read_b64 a[232:233], v237
ds_read_b64 a[236:237], v238
s_waitcnt lgkmcnt(4)
v_mfma_f32_16x16x32_bf16 a[248:251], a[244:247], v[104:107], a[248:251]
v_lshlrev_b32 v128, 16, v88
v_and_b32 v88, s97, v88
v_mfma_f32_16x16x32_bf16 v[20:23], v[104:107], v[104:107], v[20:23]
v_lshlrev_b32 v129, 16, v89
v_and_b32 v89, s97, v89
v_mfma_f32_16x16x32_bf16 a[248:251], a[244:247], v[108:111], a[248:251]
v_lshlrev_b32 v130, 16, v90
v_and_b32 v90, s97, v90
v_mfma_f32_16x16x32_bf16 v[20:23], v[108:111], v[108:111], v[20:23]
v_lshlrev_b32 v131, 16, v91
v_and_b32 v91, s97, v91
v_lshlrev_b32 v132, 16, v92
v_and_b32 v92, s97, v92
v_lshlrev_b32 v133, 16, v93
v_and_b32 v93, s97, v93
v_lshlrev_b32 v134, 16, v94
v_and_b32 v94, s97, v94
v_lshlrev_b32 v135, 16, v95
v_and_b32 v95, s97, v95
s_addk_i32 m0, 0x2000
s_add_u32 s54, s100, s62
buffer_load_dwordx4 v250, s[4:7], s54 offen  lds
buffer_load_dwordx4 v249, s[4:7], s54 offen offset:1024  lds
s_waitcnt vmcnt(8)
ds_read_b128 v[136:139], v242 offset:24576
ds_read_b128 v[140:143], v241 offset:24576
s_waitcnt lgkmcnt(4)
v_mfma_f32_16x16x32_bf16 a[248:251], a[244:247], v[120:123], a[248:251]
v_lshlrev_b32 v144, 16, v104
v_and_b32 v104, s97, v104
v_mfma_f32_16x16x32_bf16 v[20:23], v[120:123], v[120:123], v[20:23]
v_lshlrev_b32 v145, 16, v105
v_and_b32 v105, s97, v105
v_mfma_f32_16x16x32_bf16 a[248:251], a[244:247], v[124:127], a[248:251]
v_lshlrev_b32 v146, 16, v106
v_and_b32 v106, s97, v106
v_mfma_f32_16x16x32_bf16 v[20:23], v[124:127], v[124:127], v[20:23]
v_lshlrev_b32 v147, 16, v107
v_and_b32 v107, s97, v107
v_lshlrev_b32 v148, 16, v108
v_and_b32 v108, s97, v108
v_lshlrev_b32 v149, 16, v109
v_and_b32 v109, s97, v109
v_lshlrev_b32 v150, 16, v110
v_and_b32 v110, s97, v110
v_lshlrev_b32 v151, 16, v111
v_and_b32 v111, s97, v111
v_cndmask_b32 v244, v20, v21, s[88:89]
v_cndmask_b32 v244, v244, v22, s[90:91]
v_cndmask_b32 v244, v244, v23, s[92:93]
ds_bpermute_b32 v244, v251, v244
v_accvgpr_read_b32 v243, a248
v_mul_f32 v243, 0x3ae38e39, v243
v_cvt_pk_bf16_f32 v229, 0, v243
v_mul_f32 v243, v243, v243
s_addk_i32 m0, 0x2000
s_add_u32 s54, s100, s63
buffer_load_dwordx4 v250, s[4:7], s54 offen  lds
buffer_load_dwordx4 v249, s[4:7], s54 offen offset:1024  lds
s_waitcnt vmcnt(8)
ds_read_b128 v[20:23], v242 offset:32768
ds_read_b128 v[152:155], v241 offset:32768
s_waitcnt lgkmcnt(3)
v_mfma_f32_16x16x32_bf16 a[252:255], a[244:247], v[136:139], 0
v_lshlrev_b32 v156, 16, v120
v_and_b32 v120, s97, v120
v_mfma_f32_16x16x32_bf16 v[160:163], v[136:139], v[136:139], 0
v_lshlrev_b32 v157, 16, v121
v_and_b32 v121, s97, v121
v_mfma_f32_16x16x32_bf16 a[252:255], a[244:247], v[140:143], a[252:255]
v_lshlrev_b32 v158, 16, v122
v_and_b32 v122, s97, v122
v_mfma_f32_16x16x32_bf16 v[160:163], v[140:143], v[140:143], v[160:163]
v_lshlrev_b32 v159, 16, v123
v_and_b32 v123, s97, v123
v_lshlrev_b32 v164, 16, v124
v_and_b32 v124, s97, v124
v_lshlrev_b32 v165, 16, v125
v_and_b32 v125, s97, v125
v_lshlrev_b32 v166, 16, v126
v_and_b32 v126, s97, v126
v_lshlrev_b32 v167, 16, v127
v_and_b32 v127, s97, v127
s_waitcnt lgkmcnt(2)
v_mul_f32 v244, 0x3ae38e39, v244
v_sub_f32 v244, v244, v243
v_max_f32 v244, 0, v244
v_cvt_pk_bf16_f32 v244, 0, v244
v_add_f32 v244, 0x3727c5ac, v244
v_cvt_pk_bf16_f32 v244, 0, v244
v_sqrt_f32 v244, v244
s_nop 0
v_cvt_pk_bf16_f32 v244, 0, v244
v_rcp_f32 v243, v244
s_nop 0
v_mul_f32 v226, 0xbfb8aa3b, v243
v_mul_f32 v227, v229, v226
s_addk_i32 m0, 0x2000
s_add_u32 s54, s100, s64
buffer_load_dwordx4 v250, s[4:7], s54 offen  lds
buffer_load_dwordx4 v249, s[4:7], s54 offen offset:1024  lds
s_waitcnt vmcnt(8)
ds_read_b128 v[168:171], v242 offset:40960
ds_read_b128 v[172:175], v241 offset:40960
s_waitcnt lgkmcnt(2)
v_mfma_f32_16x16x32_bf16 a[252:255], a[244:247], v[20:23], a[252:255]
v_mfma_f32_16x16x32_bf16 v[160:163], v[20:23], v[20:23], v[160:163]
v_mfma_f32_16x16x32_bf16 a[252:255], a[244:247], v[152:155], a[252:255]
v_mfma_f32_16x16x32_bf16 v[160:163], v[152:155], v[152:155], v[160:163]
v_pk_fma_f32 v[32:33], v[32:33], v[226:227], v[226:227] op_sel:[0,0,1] op_sel_hi:[1,0,1] neg_lo:[0,0,1] neg_hi:[0,0,1]
v_pk_fma_f32 v[34:35], v[34:35], v[226:227], v[226:227] op_sel:[0,0,1] op_sel_hi:[1,0,1] neg_lo:[0,0,1] neg_hi:[0,0,1]
v_pk_fma_f32 v[4:5], v[4:5], v[226:227], v[226:227] op_sel:[0,0,1] op_sel_hi:[1,0,1] neg_lo:[0,0,1] neg_hi:[0,0,1]
v_pk_fma_f32 v[6:7], v[6:7], v[226:227], v[226:227] op_sel:[0,0,1] op_sel_hi:[1,0,1] neg_lo:[0,0,1] neg_hi:[0,0,1]
v_pk_fma_f32 v[36:37], v[36:37], v[226:227], v[226:227] op_sel:[0,0,1] op_sel_hi:[1,0,1] neg_lo:[0,0,1] neg_hi:[0,0,1]
v_pk_fma_f32 v[38:39], v[38:39], v[226:227], v[226:227] op_sel:[0,0,1] op_sel_hi:[1,0,1] neg_lo:[0,0,1] neg_hi:[0,0,1]
v_pk_fma_f32 v[8:9], v[8:9], v[226:227], v[226:227] op_sel:[0,0,1] op_sel_hi:[1,0,1] neg_lo:[0,0,1] neg_hi:[0,0,1]
v_pk_fma_f32 v[10:11], v[10:11], v[226:227], v[226:227] op_sel:[0,0,1] op_sel_hi:[1,0,1] neg_lo:[0,0,1] neg_hi:[0,0,1]
v_cvt_pk_bf16_f32 v4, v32, v4
v_cvt_pk_bf16_f32 v5, v33, v5
v_cvt_pk_bf16_f32 v6, v34, v6
v_cvt_pk_bf16_f32 v7, v35, v7
v_cvt_pk_bf16_f32 v8, v36, v8
v_cvt_pk_bf16_f32 v9, v37, v9
v_cvt_pk_bf16_f32 v10, v38, v10
v_cvt_pk_bf16_f32 v11, v39, v11
s_addk_i32 m0, 0x2000
s_add_u32 s54, s100, s65
buffer_load_dwordx4 v250, s[4:7], s54 offen  lds
buffer_load_dwordx4 v249, s[4:7], s54 offen offset:1024  lds
s_waitcnt vmcnt(8)
ds_read_b128 v[32:35], v240 offset:0
ds_read_b128 v[36:39], v239 offset:0
s_waitcnt lgkmcnt(2)
v_mfma_f32_16x16x32_bf16 a[252:255], a[244:247], v[168:171], a[252:255]
v_lshlrev_b32 v176, 16, v136
v_and_b32 v136, s97, v136
v_mfma_f32_16x16x32_bf16 v[160:163], v[168:171], v[168:171], v[160:163]
v_lshlrev_b32 v177, 16, v137
v_and_b32 v137, s97, v137
v_mfma_f32_16x16x32_bf16 a[252:255], a[244:247], v[172:175], a[252:255]
v_lshlrev_b32 v178, 16, v138
v_and_b32 v138, s97, v138
v_mfma_f32_16x16x32_bf16 v[160:163], v[172:175], v[172:175], v[160:163]
v_lshlrev_b32 v179, 16, v139
v_and_b32 v139, s97, v139
v_lshlrev_b32 v180, 16, v140
v_and_b32 v140, s97, v140
v_lshlrev_b32 v181, 16, v141
v_and_b32 v141, s97, v141
v_lshlrev_b32 v182, 16, v142
v_and_b32 v142, s97, v142
v_lshlrev_b32 v183, 16, v143
v_and_b32 v143, s97, v143
v_pk_fma_f32 v[48:49], v[48:49], v[226:227], v[226:227] op_sel:[0,0,1] op_sel_hi:[1,0,1] neg_lo:[0,0,1] neg_hi:[0,0,1]
v_pk_fma_f32 v[50:51], v[50:51], v[226:227], v[226:227] op_sel:[0,0,1] op_sel_hi:[1,0,1] neg_lo:[0,0,1] neg_hi:[0,0,1]
v_pk_fma_f32 v[12:13], v[12:13], v[226:227], v[226:227] op_sel:[0,0,1] op_sel_hi:[1,0,1] neg_lo:[0,0,1] neg_hi:[0,0,1]
v_pk_fma_f32 v[14:15], v[14:15], v[226:227], v[226:227] op_sel:[0,0,1] op_sel_hi:[1,0,1] neg_lo:[0,0,1] neg_hi:[0,0,1]
v_pk_fma_f32 v[52:53], v[52:53], v[226:227], v[226:227] op_sel:[0,0,1] op_sel_hi:[1,0,1] neg_lo:[0,0,1] neg_hi:[0,0,1]
v_pk_fma_f32 v[54:55], v[54:55], v[226:227], v[226:227] op_sel:[0,0,1] op_sel_hi:[1,0,1] neg_lo:[0,0,1] neg_hi:[0,0,1]
v_pk_fma_f32 v[16:17], v[16:17], v[226:227], v[226:227] op_sel:[0,0,1] op_sel_hi:[1,0,1] neg_lo:[0,0,1] neg_hi:[0,0,1]
v_pk_fma_f32 v[18:19], v[18:19], v[226:227], v[226:227] op_sel:[0,0,1] op_sel_hi:[1,0,1] neg_lo:[0,0,1] neg_hi:[0,0,1]
v_cvt_pk_bf16_f32 v12, v48, v12
v_cvt_pk_bf16_f32 v13, v49, v13
v_cvt_pk_bf16_f32 v14, v50, v14
v_cvt_pk_bf16_f32 v15, v51, v15
v_cvt_pk_bf16_f32 v16, v52, v16
v_cvt_pk_bf16_f32 v17, v53, v17
v_cvt_pk_bf16_f32 v18, v54, v18
v_cvt_pk_bf16_f32 v19, v55, v19
s_addk_i32 m0, 0x2000
s_add_u32 s54, s100, s66
buffer_load_dwordx4 v250, s[4:7], s54 offen  lds
buffer_load_dwordx4 v249, s[4:7], s54 offen offset:1024  lds
s_waitcnt vmcnt(8)
ds_read_b128 v[48:51], v240 offset:8192
ds_read_b128 v[52:55], v239 offset:8192
s_waitcnt lgkmcnt(2)
v_mfma_f32_16x16x32_bf16 a[252:255], a[244:247], v[32:35], a[252:255]
v_lshlrev_b32 v184, 16, v20
v_and_b32 v20, s97, v20
v_mfma_f32_16x16x32_bf16 v[160:163], v[32:35], v[32:35], v[160:163]
v_lshlrev_b32 v185, 16, v21
v_and_b32 v21, s97, v21
v_mfma_f32_16x16x32_bf16 a[252:255], a[244:247], v[36:39], a[252:255]
v_lshlrev_b32 v186, 16, v22
v_and_b32 v22, s97, v22
v_mfma_f32_16x16x32_bf16 v[160:163], v[36:39], v[36:39], v[160:163]
v_lshlrev_b32 v187, 16, v23
v_and_b32 v23, s97, v23
v_lshlrev_b32 v188, 16, v152
v_and_b32 v152, s97, v152
v_lshlrev_b32 v189, 16, v153
v_and_b32 v153, s97, v153
v_lshlrev_b32 v190, 16, v154
v_and_b32 v154, s97, v154
v_lshlrev_b32 v191, 16, v155
v_and_b32 v155, s97, v155
v_pk_fma_f32 v[64:65], v[64:65], v[226:227], v[226:227] op_sel:[0,0,1] op_sel_hi:[1,0,1] neg_lo:[0,0,1] neg_hi:[0,0,1]
v_pk_fma_f32 v[66:67], v[66:67], v[226:227], v[226:227] op_sel:[0,0,1] op_sel_hi:[1,0,1] neg_lo:[0,0,1] neg_hi:[0,0,1]
v_pk_fma_f32 v[24:25], v[24:25], v[226:227], v[226:227] op_sel:[0,0,1] op_sel_hi:[1,0,1] neg_lo:[0,0,1] neg_hi:[0,0,1]
v_pk_fma_f32 v[26:27], v[26:27], v[226:227], v[226:227] op_sel:[0,0,1] op_sel_hi:[1,0,1] neg_lo:[0,0,1] neg_hi:[0,0,1]
v_pk_fma_f32 v[68:69], v[68:69], v[226:227], v[226:227] op_sel:[0,0,1] op_sel_hi:[1,0,1] neg_lo:[0,0,1] neg_hi:[0,0,1]
v_pk_fma_f32 v[70:71], v[70:71], v[226:227], v[226:227] op_sel:[0,0,1] op_sel_hi:[1,0,1] neg_lo:[0,0,1] neg_hi:[0,0,1]
v_pk_fma_f32 v[28:29], v[28:29], v[226:227], v[226:227] op_sel:[0,0,1] op_sel_hi:[1,0,1] neg_lo:[0,0,1] neg_hi:[0,0,1]
v_pk_fma_f32 v[30:31], v[30:31], v[226:227], v[226:227] op_sel:[0,0,1] op_sel_hi:[1,0,1] neg_lo:[0,0,1] neg_hi:[0,0,1]
v_cvt_pk_bf16_f32 v24, v64, v24
v_cvt_pk_bf16_f32 v25, v65, v25
v_cvt_pk_bf16_f32 v26, v66, v26
v_cvt_pk_bf16_f32 v27, v67, v27
v_cvt_pk_bf16_f32 v28, v68, v28
v_cvt_pk_bf16_f32 v29, v69, v29
v_cvt_pk_bf16_f32 v30, v70, v30
v_cvt_pk_bf16_f32 v31, v71, v31
s_add_u32 s54, s68, s58
s_mov_b32 m0, s53
s_nop 0
buffer_load_dwordx4 v232, s[16:19], s54 offen  lds
buffer_load_dwordx4 v231, s[16:19], s54 offen offset:1024  lds
s_waitcnt vmcnt(8)
ds_read_b128 v[64:67], v240 offset:16384
ds_read_b128 v[68:71], v239 offset:16384
s_waitcnt lgkmcnt(2)
v_mfma_f32_16x16x32_bf16 a[252:255], a[244:247], v[48:51], a[252:255]
v_lshlrev_b32 v192, 16, v168
v_and_b32 v168, s97, v168
v_mfma_f32_16x16x32_bf16 v[160:163], v[48:51], v[48:51], v[160:163]
v_lshlrev_b32 v193, 16, v169
v_and_b32 v169, s97, v169
v_mfma_f32_16x16x32_bf16 a[252:255], a[244:247], v[52:55], a[252:255]
v_lshlrev_b32 v194, 16, v170
v_and_b32 v170, s97, v170
v_mfma_f32_16x16x32_bf16 v[160:163], v[52:55], v[52:55], v[160:163]
v_lshlrev_b32 v195, 16, v171
v_and_b32 v171, s97, v171
v_lshlrev_b32 v196, 16, v172
v_and_b32 v172, s97, v172
v_lshlrev_b32 v197, 16, v173
v_and_b32 v173, s97, v173
v_lshlrev_b32 v198, 16, v174
v_and_b32 v174, s97, v174
v_lshlrev_b32 v199, 16, v175
v_and_b32_e64 v175, s97, v175
v_pk_fma_f32 v[80:81], v[80:81], v[226:227], v[226:227] op_sel:[0,0,1] op_sel_hi:[1,0,1] neg_lo:[0,0,1] neg_hi:[0,0,1]
v_pk_fma_f32 v[82:83], v[82:83], v[226:227], v[226:227] op_sel:[0,0,1] op_sel_hi:[1,0,1] neg_lo:[0,0,1] neg_hi:[0,0,1]
v_pk_fma_f32 v[40:41], v[40:41], v[226:227], v[226:227] op_sel:[0,0,1] op_sel_hi:[1,0,1] neg_lo:[0,0,1] neg_hi:[0,0,1]
v_pk_fma_f32 v[42:43], v[42:43], v[226:227], v[226:227] op_sel:[0,0,1] op_sel_hi:[1,0,1] neg_lo:[0,0,1] neg_hi:[0,0,1]
v_pk_fma_f32 v[84:85], v[84:85], v[226:227], v[226:227] op_sel:[0,0,1] op_sel_hi:[1,0,1] neg_lo:[0,0,1] neg_hi:[0,0,1]
v_pk_fma_f32 v[86:87], v[86:87], v[226:227], v[226:227] op_sel:[0,0,1] op_sel_hi:[1,0,1] neg_lo:[0,0,1] neg_hi:[0,0,1]
v_pk_fma_f32 v[44:45], v[44:45], v[226:227], v[226:227] op_sel:[0,0,1] op_sel_hi:[1,0,1] neg_lo:[0,0,1] neg_hi:[0,0,1]
v_pk_fma_f32 v[46:47], v[46:47], v[226:227], v[226:227] op_sel:[0,0,1] op_sel_hi:[1,0,1] neg_lo:[0,0,1] neg_hi:[0,0,1]
v_cvt_pk_bf16_f32 v40, v80, v40
v_cvt_pk_bf16_f32 v41, v81, v41
v_cvt_pk_bf16_f32 v42, v82, v42
v_cvt_pk_bf16_f32 v43, v83, v43
v_cvt_pk_bf16_f32 v44, v84, v44
v_cvt_pk_bf16_f32 v45, v85, v45
v_cvt_pk_bf16_f32 v46, v86, v46
v_cvt_pk_bf16_f32 v47, v87, v47
s_add_u32 s55, s68, s59
s_addk_i32 m0, 0x2000
s_nop 0
buffer_load_dwordx4 v232, s[16:19], s55 offen  lds
buffer_load_dwordx4 v231, s[16:19], s55 offen offset:1024  lds
s_waitcnt vmcnt(8)
ds_read_b128 v[80:83], v240 offset:24576
ds_read_b128 v[84:87], v239 offset:24576
s_waitcnt lgkmcnt(2)
v_mfma_f32_16x16x32_bf16 a[252:255], a[244:247], v[64:67], a[252:255]
v_lshlrev_b32 v200, 16, v32
v_and_b32 v32, s97, v32
v_mfma_f32_16x16x32_bf16 v[160:163], v[64:67], v[64:67], v[160:163]
v_lshlrev_b32 v201, 16, v33
v_and_b32 v33, s97, v33
v_mfma_f32_16x16x32_bf16 a[252:255], a[244:247], v[68:71], a[252:255]
v_lshlrev_b32 v202, 16, v34
v_and_b32 v34, s97, v34
v_mfma_f32_16x16x32_bf16 v[160:163], v[68:71], v[68:71], v[160:163]
v_lshlrev_b32 v203, 16, v35
v_and_b32 v35, s97, v35
v_lshlrev_b32 v204, 16, v36
v_and_b32 v36, s97, v36
v_lshlrev_b32 v205, 16, v37
v_and_b32 v37, s97, v37
v_lshlrev_b32 v206, 16, v38
v_and_b32 v38, s97, v38
v_lshlrev_b32 v207, 16, v39
v_and_b32_e64 v39, s97, v39
v_pk_fma_f32 v[96:97], v[96:97], v[226:227], v[226:227] op_sel:[0,0,1] op_sel_hi:[1,0,1] neg_lo:[0,0,1] neg_hi:[0,0,1]
v_pk_fma_f32 v[98:99], v[98:99], v[226:227], v[226:227] op_sel:[0,0,1] op_sel_hi:[1,0,1] neg_lo:[0,0,1] neg_hi:[0,0,1]
v_pk_fma_f32 v[56:57], v[56:57], v[226:227], v[226:227] op_sel:[0,0,1] op_sel_hi:[1,0,1] neg_lo:[0,0,1] neg_hi:[0,0,1]
v_pk_fma_f32 v[58:59], v[58:59], v[226:227], v[226:227] op_sel:[0,0,1] op_sel_hi:[1,0,1] neg_lo:[0,0,1] neg_hi:[0,0,1]
v_pk_fma_f32 v[100:101], v[100:101], v[226:227], v[226:227] op_sel:[0,0,1] op_sel_hi:[1,0,1] neg_lo:[0,0,1] neg_hi:[0,0,1]
v_pk_fma_f32 v[102:103], v[102:103], v[226:227], v[226:227] op_sel:[0,0,1] op_sel_hi:[1,0,1] neg_lo:[0,0,1] neg_hi:[0,0,1]
v_pk_fma_f32 v[60:61], v[60:61], v[226:227], v[226:227] op_sel:[0,0,1] op_sel_hi:[1,0,1] neg_lo:[0,0,1] neg_hi:[0,0,1]
v_pk_fma_f32 v[62:63], v[62:63], v[226:227], v[226:227] op_sel:[0,0,1] op_sel_hi:[1,0,1] neg_lo:[0,0,1] neg_hi:[0,0,1]
v_cvt_pk_bf16_f32 v56, v96, v56
v_cvt_pk_bf16_f32 v57, v97, v57
v_cvt_pk_bf16_f32 v58, v98, v58
v_cvt_pk_bf16_f32 v59, v99, v59
v_cvt_pk_bf16_f32 v60, v100, v60
v_cvt_pk_bf16_f32 v61, v101, v61
v_cvt_pk_bf16_f32 v62, v102, v62
v_cvt_pk_bf16_f32 v63, v103, v63
s_add_u32 s54, s68, s60
s_addk_i32 m0, 0x2000
s_nop 0
buffer_load_dwordx4 v232, s[16:19], s54 offen  lds
buffer_load_dwordx4 v231, s[16:19], s54 offen offset:1024  lds
s_waitcnt vmcnt(8)
ds_read_b128 v[96:99], v240 offset:32768
ds_read_b128 v[100:103], v239 offset:32768
s_waitcnt lgkmcnt(2)
v_mfma_f32_16x16x32_bf16 a[252:255], a[244:247], v[80:83], a[252:255]
v_lshlrev_b32 v208, 16, v48
v_and_b32 v48, s97, v48
v_mfma_f32_16x16x32_bf16 v[160:163], v[80:83], v[80:83], v[160:163]
v_lshlrev_b32 v209, 16, v49
v_and_b32 v49, s97, v49
v_mfma_f32_16x16x32_bf16 a[252:255], a[244:247], v[84:87], a[252:255]
v_lshlrev_b32 v210, 16, v50
v_and_b32 v50, s97, v50
v_mfma_f32_16x16x32_bf16 v[160:163], v[84:87], v[84:87], v[160:163]
v_lshlrev_b32 v211, 16, v51
v_and_b32 v51, s97, v51
v_lshlrev_b32 v212, 16, v52
v_and_b32 v52, s97, v52
v_lshlrev_b32 v213, 16, v53
v_and_b32 v53, s97, v53
v_lshlrev_b32 v214, 16, v54
v_and_b32 v54, s97, v54
v_lshlrev_b32 v215, 16, v55
v_and_b32_e64 v55, s97, v55
v_pk_fma_f32 v[112:113], v[112:113], v[226:227], v[226:227] op_sel:[0,0,1] op_sel_hi:[1,0,1] neg_lo:[0,0,1] neg_hi:[0,0,1]
v_pk_fma_f32 v[114:115], v[114:115], v[226:227], v[226:227] op_sel:[0,0,1] op_sel_hi:[1,0,1] neg_lo:[0,0,1] neg_hi:[0,0,1]
v_pk_fma_f32 v[72:73], v[72:73], v[226:227], v[226:227] op_sel:[0,0,1] op_sel_hi:[1,0,1] neg_lo:[0,0,1] neg_hi:[0,0,1]
v_pk_fma_f32 v[74:75], v[74:75], v[226:227], v[226:227] op_sel:[0,0,1] op_sel_hi:[1,0,1] neg_lo:[0,0,1] neg_hi:[0,0,1]
v_pk_fma_f32 v[116:117], v[116:117], v[226:227], v[226:227] op_sel:[0,0,1] op_sel_hi:[1,0,1] neg_lo:[0,0,1] neg_hi:[0,0,1]
v_pk_fma_f32 v[118:119], v[118:119], v[226:227], v[226:227] op_sel:[0,0,1] op_sel_hi:[1,0,1] neg_lo:[0,0,1] neg_hi:[0,0,1]
v_pk_fma_f32 v[76:77], v[76:77], v[226:227], v[226:227] op_sel:[0,0,1] op_sel_hi:[1,0,1] neg_lo:[0,0,1] neg_hi:[0,0,1]
v_pk_fma_f32 v[78:79], v[78:79], v[226:227], v[226:227] op_sel:[0,0,1] op_sel_hi:[1,0,1] neg_lo:[0,0,1] neg_hi:[0,0,1]
v_cvt_pk_bf16_f32 v72, v112, v72
v_cvt_pk_bf16_f32 v73, v113, v73
v_cvt_pk_bf16_f32 v74, v114, v74
v_cvt_pk_bf16_f32 v75, v115, v75
v_cvt_pk_bf16_f32 v76, v116, v76
v_cvt_pk_bf16_f32 v77, v117, v77
v_cvt_pk_bf16_f32 v78, v118, v78
v_cvt_pk_bf16_f32 v79, v119, v79
s_add_u32 s55, s68, s61
s_addk_i32 m0, 0x2000
s_nop 0
buffer_load_dwordx4 v232, s[16:19], s55 offen  lds
buffer_load_dwordx4 v231, s[16:19], s55 offen offset:1024  lds
s_waitcnt vmcnt(8)
ds_read_b128 v[112:115], v240 offset:40960
ds_read_b128 v[116:119], v239 offset:40960
global_load_ushort v250, v247, s[40:41]
global_load_ushort v249, v247, s[42:43]
global_load_ushort v244, v247, s[44:45]
global_load_dwordx2 a[240:241], v236, s[84:85]
global_load_dwordx2 a[242:243], v236, s[84:85] offset:32
v_add_u32 v237, 73728, v237
v_xor_b32 v238, 32, v237
ds_read_b64 a[234:235], v237
ds_read_b64 a[238:239], v238
s_waitcnt lgkmcnt(4)
v_mfma_f32_16x16x32_bf16 a[252:255], a[244:247], v[96:99], a[252:255]
v_lshlrev_b32 v216, 16, v64
v_and_b32 v64, s97, v64
v_mfma_f32_16x16x32_bf16 v[160:163], v[96:99], v[96:99], v[160:163]
v_lshlrev_b32 v217, 16, v65
v_and_b32 v65, s97, v65
v_mfma_f32_16x16x32_bf16 a[252:255], a[244:247], v[100:103], a[252:255]
v_lshlrev_b32 v218, 16, v66
v_and_b32 v66, s97, v66
v_mfma_f32_16x16x32_bf16 v[160:163], v[100:103], v[100:103], v[160:163]
v_lshlrev_b32 v219, 16, v67
v_and_b32 v67, s97, v67
v_lshlrev_b32 v220, 16, v68
v_and_b32 v68, s97, v68
v_lshlrev_b32 v221, 16, v69
v_and_b32 v69, s97, v69
v_lshlrev_b32 v222, 16, v70
v_and_b32 v70, s97, v70
v_lshlrev_b32 v223, 16, v71
v_and_b32 v71, s97, v71
v_pk_fma_f32 v[128:129], v[128:129], v[226:227], v[226:227] op_sel:[0,0,1] op_sel_hi:[1,0,1] neg_lo:[0,0,1] neg_hi:[0,0,1]
v_pk_fma_f32 v[130:131], v[130:131], v[226:227], v[226:227] op_sel:[0,0,1] op_sel_hi:[1,0,1] neg_lo:[0,0,1] neg_hi:[0,0,1]
v_pk_fma_f32 v[88:89], v[88:89], v[226:227], v[226:227] op_sel:[0,0,1] op_sel_hi:[1,0,1] neg_lo:[0,0,1] neg_hi:[0,0,1]
v_pk_fma_f32 v[90:91], v[90:91], v[226:227], v[226:227] op_sel:[0,0,1] op_sel_hi:[1,0,1] neg_lo:[0,0,1] neg_hi:[0,0,1]
v_pk_fma_f32 v[132:133], v[132:133], v[226:227], v[226:227] op_sel:[0,0,1] op_sel_hi:[1,0,1] neg_lo:[0,0,1] neg_hi:[0,0,1]
LM_p1:
s_cbranch_execz LM
s_nop 0
v_pk_fma_f32 v[134:135], v[134:135], v[226:227], v[226:227] op_sel:[0,0,1] op_sel_hi:[1,0,1] neg_lo:[0,0,1] neg_hi:[0,0,1]
v_pk_fma_f32 v[92:93], v[92:93], v[226:227], v[226:227] op_sel:[0,0,1] op_sel_hi:[1,0,1] neg_lo:[0,0,1] neg_hi:[0,0,1]
v_pk_fma_f32 v[94:95], v[94:95], v[226:227], v[226:227] op_sel:[0,0,1] op_sel_hi:[1,0,1] neg_lo:[0,0,1] neg_hi:[0,0,1]
v_cvt_pk_bf16_f32 v88, v128, v88
v_cvt_pk_bf16_f32 v89, v129, v89
v_cvt_pk_bf16_f32 v90, v130, v90
v_cvt_pk_bf16_f32 v91, v131, v91
v_cvt_pk_bf16_f32 v92, v132, v92
v_cvt_pk_bf16_f32 v93, v133, v93
v_cvt_pk_bf16_f32 v94, v134, v94
v_cvt_pk_bf16_f32 v95, v135, v95
s_add_u32 s54, s68, s62
s_addk_i32 m0, 0x2000
s_nop 0
buffer_load_dwordx4 v232, s[16:19], s54 offen  lds
buffer_load_dwordx4 v231, s[16:19], s54 offen offset:1024  lds
s_waitcnt lgkmcnt(2)
v_mfma_f32_16x16x32_bf16 a[252:255], a[244:247], v[112:115], a[252:255]
v_lshlrev_b32 v128, 16, v80
v_and_b32 v80, s97, v80
v_mfma_f32_16x16x32_bf16 v[160:163], v[112:115], v[112:115], v[160:163]
v_lshlrev_b32 v129, 16, v81
v_and_b32 v81, s97, v81
v_mfma_f32_16x16x32_bf16 a[252:255], a[244:247], v[116:119], a[252:255]
v_lshlrev_b32 v130, 16, v82
v_and_b32 v82, s97, v82
v_mfma_f32_16x16x32_bf16 v[160:163], v[116:119], v[116:119], v[160:163]
v_lshlrev_b32 v131, 16, v83
v_and_b32 v83, s97, v83
v_lshlrev_b32 v132, 16, v84
v_and_b32 v84, s97, v84
v_lshlrev_b32 v133, 16, v85
v_and_b32 v85, s97, v85
v_lshlrev_b32 v134, 16, v86
v_and_b32 v86, s97, v86
v_lshlrev_b32 v135, 16, v87
v_and_b32 v87, s97, v87
v_pk_fma_f32 v[144:145], v[144:145], v[226:227], v[226:227] op_sel:[0,0,1] op_sel_hi:[1,0,1] neg_lo:[0,0,1] neg_hi:[0,0,1]
v_pk_fma_f32 v[146:147], v[146:147], v[226:227], v[226:227] op_sel:[0,0,1] op_sel_hi:[1,0,1] neg_lo:[0,0,1] neg_hi:[0,0,1]
v_pk_fma_f32 v[104:105], v[104:105], v[226:227], v[226:227] op_sel:[0,0,1] op_sel_hi:[1,0,1] neg_lo:[0,0,1] neg_hi:[0,0,1]
v_pk_fma_f32 v[106:107], v[106:107], v[226:227], v[226:227] op_sel:[0,0,1] op_sel_hi:[1,0,1] neg_lo:[0,0,1] neg_hi:[0,0,1]
v_pk_fma_f32 v[148:149], v[148:149], v[226:227], v[226:227] op_sel:[0,0,1] op_sel_hi:[1,0,1] neg_lo:[0,0,1] neg_hi:[0,0,1]
v_pk_fma_f32 v[150:151], v[150:151], v[226:227], v[226:227] op_sel:[0,0,1] op_sel_hi:[1,0,1] neg_lo:[0,0,1] neg_hi:[0,0,1]
v_pk_fma_f32 v[108:109], v[108:109], v[226:227], v[226:227] op_sel:[0,0,1] op_sel_hi:[1,0,1] neg_lo:[0,0,1] neg_hi:[0,0,1]
v_pk_fma_f32 v[110:111], v[110:111], v[226:227], v[226:227] op_sel:[0,0,1] op_sel_hi:[1,0,1] neg_lo:[0,0,1] neg_hi:[0,0,1]
v_cvt_pk_bf16_f32 v104, v144, v104
v_cvt_pk_bf16_f32 v105, v145, v105
v_cvt_pk_bf16_f32 v106, v146, v106
v_cvt_pk_bf16_f32 v107, v147, v107
v_cvt_pk_bf16_f32 v108, v148, v108
v_cvt_pk_bf16_f32 v109, v149, v109
v_cvt_pk_bf16_f32 v110, v150, v110
v_cvt_pk_bf16_f32 v111, v151, v111
v_cndmask_b32 v247, v160, v161, s[88:89]
v_cndmask_b32 v247, v247, v162, s[90:91]
v_cndmask_b32 v247, v247, v163, s[92:93]
ds_bpermute_b32 v247, v251, v247
v_accvgpr_read_b32 v251, a252
v_mul_f32 v251, 0x3ae38e39, v251
v_cvt_pk_bf16_f32 v242, 0, v251
v_mul_f32_e64 v251, v251, v251
v_pk_fma_f32 v[156:157], v[156:157], v[226:227], v[226:227] op_sel:[0,0,1] op_sel_hi:[1,0,1] neg_lo:[0,0,1] neg_hi:[0,0,1]
v_pk_fma_f32 v[158:159], v[158:159], v[226:227], v[226:227] op_sel:[0,0,1] op_sel_hi:[1,0,1] neg_lo:[0,0,1] neg_hi:[0,0,1]
v_pk_fma_f32 v[120:121], v[120:121], v[226:227], v[226:227] op_sel:[0,0,1] op_sel_hi:[1,0,1] neg_lo:[0,0,1] neg_hi:[0,0,1]
v_pk_fma_f32 v[122:123], v[122:123], v[226:227], v[226:227] op_sel:[0,0,1] op_sel_hi:[1,0,1] neg_lo:[0,0,1] neg_hi:[0,0,1]
v_pk_fma_f32 v[164:165], v[164:165], v[226:227], v[226:227] op_sel:[0,0,1] op_sel_hi:[1,0,1] neg_lo:[0,0,1] neg_hi:[0,0,1]
v_pk_fma_f32 v[166:167], v[166:167], v[226:227], v[226:227] op_sel:[0,0,1] op_sel_hi:[1,0,1] neg_lo:[0,0,1] neg_hi:[0,0,1]
v_pk_fma_f32 v[124:125], v[124:125], v[226:227], v[226:227] op_sel:[0,0,1] op_sel_hi:[1,0,1] neg_lo:[0,0,1] neg_hi:[0,0,1]
v_pk_fma_f32 v[126:127], v[126:127], v[226:227], v[226:227] op_sel:[0,0,1] op_sel_hi:[1,0,1] neg_lo:[0,0,1] neg_hi:[0,0,1]
v_cvt_pk_bf16_f32 v120, v156, v120
v_cvt_pk_bf16_f32 v121, v157, v121
v_cvt_pk_bf16_f32 v122, v158, v122
v_cvt_pk_bf16_f32 v123, v159, v123
v_cvt_pk_bf16_f32 v124, v164, v124
v_cvt_pk_bf16_f32 v125, v165, v125
v_cvt_pk_bf16_f32 v126, v166, v126
v_cvt_pk_bf16_f32 v127, v167, v127
v_lshlrev_b32 v144, 16, v96
v_and_b32 v96, s97, v96
v_lshlrev_b32 v145, 16, v97
v_and_b32 v97, s97, v97
v_lshlrev_b32 v146, 16, v98
v_and_b32 v98, s97, v98
v_lshlrev_b32 v147, 16, v99
v_and_b32 v99, s97, v99
v_lshlrev_b32 v148, 16, v100
v_and_b32 v100, s97, v100
v_lshlrev_b32 v149, 16, v101
v_and_b32 v101, s97, v101
v_lshlrev_b32 v150, 16, v102
v_and_b32 v102, s97, v102
v_lshlrev_b32 v151, 16, v103
v_and_b32 v103, s97, v103
s_waitcnt lgkmcnt(0)
v_mul_f32 v247, 0x3ae38e39, v247
v_sub_f32 v247, v247, v251
v_max_f32 v247, 0, v247
v_cvt_pk_bf16_f32 v247, 0, v247
v_add_f32 v247, 0x3727c5ac, v247
v_cvt_pk_bf16_f32 v247, 0, v247
v_sqrt_f32 v247, v247
s_nop 0
v_cvt_pk_bf16_f32 v247, 0, v247
v_rcp_f32 v251, v247
s_nop 0
v_mul_f32 v240, 0xbfb8aa3b, v251
v_mul_f32 v241, v242, v240
s_add_u32 s55, s68, s63
s_addk_i32 m0, 0x2000
s_nop 0
buffer_load_dwordx4 v232, s[16:19], s55 offen  lds
buffer_load_dwordx4 v231, s[16:19], s55 offen offset:1024  lds
s_nop 0
v_pk_fma_f32 v[176:177], v[176:177], v[240:241], v[240:241] op_sel:[0,0,1] op_sel_hi:[1,0,1] neg_lo:[0,0,1] neg_hi:[0,0,1]
v_pk_fma_f32 v[178:179], v[178:179], v[240:241], v[240:241] op_sel:[0,0,1] op_sel_hi:[1,0,1] neg_lo:[0,0,1] neg_hi:[0,0,1]
v_pk_fma_f32 v[136:137], v[136:137], v[240:241], v[240:241] op_sel:[0,0,1] op_sel_hi:[1,0,1] neg_lo:[0,0,1] neg_hi:[0,0,1]
v_pk_fma_f32 v[138:139], v[138:139], v[240:241], v[240:241] op_sel:[0,0,1] op_sel_hi:[1,0,1] neg_lo:[0,0,1] neg_hi:[0,0,1]
v_pk_fma_f32 v[180:181], v[180:181], v[240:241], v[240:241] op_sel:[0,0,1] op_sel_hi:[1,0,1] neg_lo:[0,0,1] neg_hi:[0,0,1]
v_pk_fma_f32 v[182:183], v[182:183], v[240:241], v[240:241] op_sel:[0,0,1] op_sel_hi:[1,0,1] neg_lo:[0,0,1] neg_hi:[0,0,1]
v_pk_fma_f32 v[140:141], v[140:141], v[240:241], v[240:241] op_sel:[0,0,1] op_sel_hi:[1,0,1] neg_lo:[0,0,1] neg_hi:[0,0,1]
v_pk_fma_f32 v[142:143], v[142:143], v[240:241], v[240:241] op_sel:[0,0,1] op_sel_hi:[1,0,1] neg_lo:[0,0,1] neg_hi:[0,0,1]
v_cvt_pk_bf16_f32 v136, v176, v136
v_cvt_pk_bf16_f32 v137, v177, v137
v_cvt_pk_bf16_f32 v138, v178, v138
v_cvt_pk_bf16_f32 v139, v179, v139
v_cvt_pk_bf16_f32 v140, v180, v140
v_cvt_pk_bf16_f32 v141, v181, v141
v_cvt_pk_bf16_f32 v142, v182, v142
v_cvt_pk_bf16_f32 v143, v183, v143
s_add_u32 s54, s68, s64
s_addk_i32 m0, 0x2000
s_nop 0
buffer_load_dwordx4 v232, s[16:19], s54 offen  lds
buffer_load_dwordx4 v231, s[16:19], s54 offen offset:1024  lds
s_nop 0
v_pk_fma_f32 v[184:185], v[184:185], v[240:241], v[240:241] op_sel:[0,0,1] op_sel_hi:[1,0,1] neg_lo:[0,0,1] neg_hi:[0,0,1]
v_pk_fma_f32 v[186:187], v[186:187], v[240:241], v[240:241] op_sel:[0,0,1] op_sel_hi:[1,0,1] neg_lo:[0,0,1] neg_hi:[0,0,1]
v_pk_fma_f32 v[20:21], v[20:21], v[240:241], v[240:241] op_sel:[0,0,1] op_sel_hi:[1,0,1] neg_lo:[0,0,1] neg_hi:[0,0,1]
v_pk_fma_f32 v[22:23], v[22:23], v[240:241], v[240:241] op_sel:[0,0,1] op_sel_hi:[1,0,1] neg_lo:[0,0,1] neg_hi:[0,0,1]
v_pk_fma_f32 v[188:189], v[188:189], v[240:241], v[240:241] op_sel:[0,0,1] op_sel_hi:[1,0,1] neg_lo:[0,0,1] neg_hi:[0,0,1]
v_pk_fma_f32 v[190:191], v[190:191], v[240:241], v[240:241] op_sel:[0,0,1] op_sel_hi:[1,0,1] neg_lo:[0,0,1] neg_hi:[0,0,1]
v_pk_fma_f32 v[152:153], v[152:153], v[240:241], v[240:241] op_sel:[0,0,1] op_sel_hi:[1,0,1] neg_lo:[0,0,1] neg_hi:[0,0,1]
v_pk_fma_f32 v[154:155], v[154:155], v[240:241], v[240:241] op_sel:[0,0,1] op_sel_hi:[1,0,1] neg_lo:[0,0,1] neg_hi:[0,0,1]
v_cvt_pk_bf16_f32 v20, v184, v20
v_cvt_pk_bf16_f32 v21, v185, v21
v_cvt_pk_bf16_f32 v22, v186, v22
v_cvt_pk_bf16_f32 v23, v187, v23
v_cvt_pk_bf16_f32 v152, v188, v152
v_cvt_pk_bf16_f32 v153, v189, v153
v_cvt_pk_bf16_f32 v154, v190, v154
v_cvt_pk_bf16_f32 v155, v191, v155
s_add_u32 s55, s68, s65
s_addk_i32 m0, 0x2000
s_nop 0
buffer_load_dwordx4 v232, s[16:19], s55 offen  lds
buffer_load_dwordx4 v231, s[16:19], s55 offen offset:1024  lds
s_nop 0
v_pk_fma_f32 v[192:193], v[192:193], v[240:241], v[240:241] op_sel:[0,0,1] op_sel_hi:[1,0,1] neg_lo:[0,0,1] neg_hi:[0,0,1]
v_pk_fma_f32 v[194:195], v[194:195], v[240:241], v[240:241] op_sel:[0,0,1] op_sel_hi:[1,0,1] neg_lo:[0,0,1] neg_hi:[0,0,1]
v_pk_fma_f32 v[168:169], v[168:169], v[240:241], v[240:241] op_sel:[0,0,1] op_sel_hi:[1,0,1] neg_lo:[0,0,1] neg_hi:[0,0,1]
v_pk_fma_f32 v[170:171], v[170:171], v[240:241], v[240:241] op_sel:[0,0,1] op_sel_hi:[1,0,1] neg_lo:[0,0,1] neg_hi:[0,0,1]
v_pk_fma_f32 v[196:197], v[196:197], v[240:241], v[240:241] op_sel:[0,0,1] op_sel_hi:[1,0,1] neg_lo:[0,0,1] neg_hi:[0,0,1]
v_pk_fma_f32 v[198:199], v[198:199], v[240:241], v[240:241] op_sel:[0,0,1] op_sel_hi:[1,0,1] neg_lo:[0,0,1] neg_hi:[0,0,1]
v_pk_fma_f32 v[172:173], v[172:173], v[240:241], v[240:241] op_sel:[0,0,1] op_sel_hi:[1,0,1] neg_lo:[0,0,1] neg_hi:[0,0,1]
v_pk_fma_f32 v[174:175], v[174:175], v[240:241], v[240:241] op_sel:[0,0,1] op_sel_hi:[1,0,1] neg_lo:[0,0,1] neg_hi:[0,0,1]
v_cvt_pk_bf16_f32 v168, v192, v168
v_cvt_pk_bf16_f32 v169, v193, v169
v_cvt_pk_bf16_f32 v170, v194, v170
v_cvt_pk_bf16_f32 v171, v195, v171
v_cvt_pk_bf16_f32 v172, v196, v172
v_cvt_pk_bf16_f32 v173, v197, v173
v_cvt_pk_bf16_f32 v174, v198, v174
v_cvt_pk_bf16_f32 v175, v199, v175
v_pk_fma_f32 v[200:201], v[200:201], v[240:241], v[240:241] op_sel:[0,0,1] op_sel_hi:[1,0,1] neg_lo:[0,0,1] neg_hi:[0,0,1]
v_pk_fma_f32 v[202:203], v[202:203], v[240:241], v[240:241] op_sel:[0,0,1] op_sel_hi:[1,0,1] neg_lo:[0,0,1] neg_hi:[0,0,1]
v_pk_fma_f32 v[32:33], v[32:33], v[240:241], v[240:241] op_sel:[0,0,1] op_sel_hi:[1,0,1] neg_lo:[0,0,1] neg_hi:[0,0,1]
v_pk_fma_f32 v[34:35], v[34:35], v[240:241], v[240:241] op_sel:[0,0,1] op_sel_hi:[1,0,1] neg_lo:[0,0,1] neg_hi:[0,0,1]
v_pk_fma_f32 v[204:205], v[204:205], v[240:241], v[240:241] op_sel:[0,0,1] op_sel_hi:[1,0,1] neg_lo:[0,0,1] neg_hi:[0,0,1]
v_pk_fma_f32 v[206:207], v[206:207], v[240:241], v[240:241] op_sel:[0,0,1] op_sel_hi:[1,0,1] neg_lo:[0,0,1] neg_hi:[0,0,1]
v_pk_fma_f32 v[36:37], v[36:37], v[240:241], v[240:241] op_sel:[0,0,1] op_sel_hi:[1,0,1] neg_lo:[0,0,1] neg_hi:[0,0,1]
v_pk_fma_f32 v[38:39], v[38:39], v[240:241], v[240:241] op_sel:[0,0,1] op_sel_hi:[1,0,1] neg_lo:[0,0,1] neg_hi:[0,0,1]
v_cvt_pk_bf16_f32 v32, v200, v32
v_cvt_pk_bf16_f32 v33, v201, v33
v_cvt_pk_bf16_f32 v34, v202, v34
v_cvt_pk_bf16_f32 v35, v203, v35
v_cvt_pk_bf16_f32 v36, v204, v36
v_cvt_pk_bf16_f32 v37, v205, v37
v_cvt_pk_bf16_f32 v38, v206, v38
v_cvt_pk_bf16_f32 v39, v207, v39
v_pk_fma_f32 v[208:209], v[208:209], v[240:241], v[240:241] op_sel:[0,0,1] op_sel_hi:[1,0,1] neg_lo:[0,0,1] neg_hi:[0,0,1]
v_pk_fma_f32 v[210:211], v[210:211], v[240:241], v[240:241] op_sel:[0,0,1] op_sel_hi:[1,0,1] neg_lo:[0,0,1] neg_hi:[0,0,1]
v_pk_fma_f32 v[48:49], v[48:49], v[240:241], v[240:241] op_sel:[0,0,1] op_sel_hi:[1,0,1] neg_lo:[0,0,1] neg_hi:[0,0,1]
v_pk_fma_f32 v[50:51], v[50:51], v[240:241], v[240:241] op_sel:[0,0,1] op_sel_hi:[1,0,1] neg_lo:[0,0,1] neg_hi:[0,0,1]
v_pk_fma_f32 v[212:213], v[212:213], v[240:241], v[240:241] op_sel:[0,0,1] op_sel_hi:[1,0,1] neg_lo:[0,0,1] neg_hi:[0,0,1]
v_pk_fma_f32 v[214:215], v[214:215], v[240:241], v[240:241] op_sel:[0,0,1] op_sel_hi:[1,0,1] neg_lo:[0,0,1] neg_hi:[0,0,1]
v_pk_fma_f32 v[52:53], v[52:53], v[240:241], v[240:241] op_sel:[0,0,1] op_sel_hi:[1,0,1] neg_lo:[0,0,1] neg_hi:[0,0,1]
v_pk_fma_f32 v[54:55], v[54:55], v[240:241], v[240:241] op_sel:[0,0,1] op_sel_hi:[1,0,1] neg_lo:[0,0,1] neg_hi:[0,0,1]
v_cvt_pk_bf16_f32 v48, v208, v48
v_cvt_pk_bf16_f32 v49, v209, v49
v_cvt_pk_bf16_f32 v50, v210, v50
v_cvt_pk_bf16_f32 v51, v211, v51
v_cvt_pk_bf16_f32 v52, v212, v52
v_cvt_pk_bf16_f32 v53, v213, v53
v_cvt_pk_bf16_f32 v54, v214, v54
v_cvt_pk_bf16_f32 v55, v215, v55
s_mov_b64 exec, 0
s_cmp_eq_u32 s50, 0
s_cbranch_scc1 LM_p8
s_cmp_eq_u32 s50, 1
s_cbranch_scc1 LM_p9
s_cmp_eq_u32 s50, 2
s_cbranch_scc1 LM_p10
s_branch LM_p11
LM_v0:
s_mov_b64 exec, -1
s_waitcnt vmcnt(4)
s_barrier
ds_read_b128 a[144:147], v248 offset:0
ds_read_b128 a[148:151], v230 offset:0
ds_read_b128 a[152:155], v248 offset:8192
ds_read_b128 a[156:159], v230 offset:8192
ds_read_b128 a[160:163], v248 offset:16384
ds_read_b128 a[164:167], v230 offset:16384
s_nop 0
v_pk_fma_f32 v[216:217], v[216:217], v[240:241], v[240:241] op_sel:[0,0,1] op_sel_hi:[1,0,1] neg_lo:[0,0,1] neg_hi:[0,0,1]
v_pk_fma_f32 v[218:219], v[218:219], v[240:241], v[240:241] op_sel:[0,0,1] op_sel_hi:[1,0,1] neg_lo:[0,0,1] neg_hi:[0,0,1]
v_pk_fma_f32 v[64:65], v[64:65], v[240:241], v[240:241] op_sel:[0,0,1] op_sel_hi:[1,0,1] neg_lo:[0,0,1] neg_hi:[0,0,1]
v_pk_fma_f32 v[66:67], v[66:67], v[240:241], v[240:241] op_sel:[0,0,1] op_sel_hi:[1,0,1] neg_lo:[0,0,1] neg_hi:[0,0,1]
v_pk_fma_f32 v[220:221], v[220:221], v[240:241], v[240:241] op_sel:[0,0,1] op_sel_hi:[1,0,1] neg_lo:[0,0,1] neg_hi:[0,0,1]
v_pk_fma_f32 v[222:223], v[222:223], v[240:241], v[240:241] op_sel:[0,0,1] op_sel_hi:[1,0,1] neg_lo:[0,0,1] neg_hi:[0,0,1]
v_pk_fma_f32 v[68:69], v[68:69], v[240:241], v[240:241] op_sel:[0,0,1] op_sel_hi:[1,0,1] neg_lo:[0,0,1] neg_hi:[0,0,1]
v_pk_fma_f32 v[70:71], v[70:71], v[240:241], v[240:241] op_sel:[0,0,1] op_sel_hi:[1,0,1] neg_lo:[0,0,1] neg_hi:[0,0,1]
v_cvt_pk_bf16_f32 v64, v216, v64
v_cvt_pk_bf16_f32 v65, v217, v65
v_cvt_pk_bf16_f32 v66, v218, v66
v_cvt_pk_bf16_f32 v67, v219, v67
v_cvt_pk_bf16_f32 v68, v220, v68
v_cvt_pk_bf16_f32 v69, v221, v69
v_cvt_pk_bf16_f32 v70, v222, v70
v_cvt_pk_bf16_f32 v71, v223, v71
v_pk_fma_f32 v[128:129], v[128:129], v[240:241], v[240:241] op_sel:[0,0,1] op_sel_hi:[1,0,1] neg_lo:[0,0,1] neg_hi:[0,0,1]
v_pk_fma_f32 v[130:131], v[130:131], v[240:241], v[240:241] op_sel:[0,0,1] op_sel_hi:[1,0,1] neg_lo:[0,0,1] neg_hi:[0,0,1]
v_pk_fma_f32 v[80:81], v[80:81], v[240:241], v[240:241] op_sel:[0,0,1] op_sel_hi:[1,0,1] neg_lo:[0,0,1] neg_hi:[0,0,1]
v_pk_fma_f32 v[82:83], v[82:83], v[240:241], v[240:241] op_sel:[0,0,1] op_sel_hi:[1,0,1] neg_lo:[0,0,1] neg_hi:[0,0,1]
v_pk_fma_f32 v[132:133], v[132:133], v[240:241], v[240:241] op_sel:[0,0,1] op_sel_hi:[1,0,1] neg_lo:[0,0,1] neg_hi:[0,0,1]
v_pk_fma_f32 v[134:135], v[134:135], v[240:241], v[240:241] op_sel:[0,0,1] op_sel_hi:[1,0,1] neg_lo:[0,0,1] neg_hi:[0,0,1]
v_pk_fma_f32 v[84:85], v[84:85], v[240:241], v[240:241] op_sel:[0,0,1] op_sel_hi:[1,0,1] neg_lo:[0,0,1] neg_hi:[0,0,1]
v_pk_fma_f32 v[86:87], v[86:87], v[240:241], v[240:241] op_sel:[0,0,1] op_sel_hi:[1,0,1] neg_lo:[0,0,1] neg_hi:[0,0,1]
v_cvt_pk_bf16_f32 v80, v128, v80
v_cvt_pk_bf16_f32 v81, v129, v81
v_cvt_pk_bf16_f32 v82, v130, v82
v_cvt_pk_bf16_f32 v83, v131, v83
v_cvt_pk_bf16_f32 v84, v132, v84
v_cvt_pk_bf16_f32 v85, v133, v85
v_cvt_pk_bf16_f32 v86, v134, v86
v_cvt_pk_bf16_f32 v87, v135, v87
v_pk_fma_f32 v[144:145], v[144:145], v[240:241], v[240:241] op_sel:[0,0,1] op_sel_hi:[1,0,1] neg_lo:[0,0,1] neg_hi:[0,0,1]
v_pk_fma_f32 v[146:147], v[146:147], v[240:241], v[240:241] op_sel:[0,0,1] op_sel_hi:[1,0,1] neg_lo:[0,0,1] neg_hi:[0,0,1]
v_pk_fma_f32 v[96:97], v[96:97], v[240:241], v[240:241] op_sel:[0,0,1] op_sel_hi:[1,0,1] neg_lo:[0,0,1] neg_hi:[0,0,1]
v_pk_fma_f32 v[98:99], v[98:99], v[240:241], v[240:241] op_sel:[0,0,1] op_sel_hi:[1,0,1] neg_lo:[0,0,1] neg_hi:[0,0,1]
v_pk_fma_f32 v[148:149], v[148:149], v[240:241], v[240:241] op_sel:[0,0,1] op_sel_hi:[1,0,1] neg_lo:[0,0,1] neg_hi:[0,0,1]
v_pk_fma_f32 v[150:151], v[150:151], v[240:241], v[240:241] op_sel:[0,0,1] op_sel_hi:[1,0,1] neg_lo:[0,0,1] neg_hi:[0,0,1]
v_pk_fma_f32 v[100:101], v[100:101], v[240:241], v[240:241] op_sel:[0,0,1] op_sel_hi:[1,0,1] neg_lo:[0,0,1] neg_hi:[0,0,1]
v_pk_fma_f32 v[102:103], v[102:103], v[240:241], v[240:241] op_sel:[0,0,1] op_sel_hi:[1,0,1] neg_lo:[0,0,1] neg_hi:[0,0,1]
v_cvt_pk_bf16_f32 v96, v144, v96
v_cvt_pk_bf16_f32 v97, v145, v97
v_cvt_pk_bf16_f32 v98, v146, v98
v_cvt_pk_bf16_f32 v99, v147, v99
v_cvt_pk_bf16_f32 v100, v148, v100
v_cvt_pk_bf16_f32 v101, v149, v101
v_cvt_pk_bf16_f32 v102, v150, v102
v_cvt_pk_bf16_f32 v103, v151, v103
v_lshlrev_b32 v128, 16, v112
v_and_b32 v112, s97, v112
v_lshlrev_b32 v129, 16, v113
v_and_b32 v113, s97, v113
v_lshlrev_b32 v130, 16, v114
v_and_b32 v114, s97, v114
v_lshlrev_b32 v131, 16, v115
v_and_b32 v115, s97, v115
v_lshlrev_b32 v132, 16, v116
v_and_b32 v116, s97, v116
v_lshlrev_b32 v133, 16, v117
v_and_b32 v117, s97, v117
v_lshlrev_b32 v134, 16, v118
v_and_b32 v118, s97, v118
v_lshlrev_b32 v135, 16, v119
v_and_b32 v119, s97, v119
v_pk_fma_f32 v[128:129], v[128:129], v[240:241], v[240:241] op_sel:[0,0,1] op_sel_hi:[1,0,1] neg_lo:[0,0,1] neg_hi:[0,0,1]
v_pk_fma_f32 v[130:131], v[130:131], v[240:241], v[240:241] op_sel:[0,0,1] op_sel_hi:[1,0,1] neg_lo:[0,0,1] neg_hi:[0,0,1]
v_pk_fma_f32 v[112:113], v[112:113], v[240:241], v[240:241] op_sel:[0,0,1] op_sel_hi:[1,0,1] neg_lo:[0,0,1] neg_hi:[0,0,1]
v_pk_fma_f32 v[114:115], v[114:115], v[240:241], v[240:241] op_sel:[0,0,1] op_sel_hi:[1,0,1] neg_lo:[0,0,1] neg_hi:[0,0,1]
v_pk_fma_f32 v[132:133], v[132:133], v[240:241], v[240:241] op_sel:[0,0,1] op_sel_hi:[1,0,1] neg_lo:[0,0,1] neg_hi:[0,0,1]
v_pk_fma_f32 v[134:135], v[134:135], v[240:241], v[240:241] op_sel:[0,0,1] op_sel_hi:[1,0,1] neg_lo:[0,0,1] neg_hi:[0,0,1]
v_pk_fma_f32 v[116:117], v[116:117], v[240:241], v[240:241] op_sel:[0,0,1] op_sel_hi:[1,0,1] neg_lo:[0,0,1] neg_hi:[0,0,1]
v_pk_fma_f32 v[118:119], v[118:119], v[240:241], v[240:241] op_sel:[0,0,1] op_sel_hi:[1,0,1] neg_lo:[0,0,1] neg_hi:[0,0,1]
v_cvt_pk_bf16_f32 v112, v128, v112
v_cvt_pk_bf16_f32 v113, v129, v113
v_cvt_pk_bf16_f32 v114, v130, v114
v_cvt_pk_bf16_f32 v115, v131, v115
v_cvt_pk_bf16_f32 v116, v132, v116
v_cvt_pk_bf16_f32 v117, v133, v117
v_cvt_pk_bf16_f32 v118, v134, v118
v_cvt_pk_bf16_f32 v119, v135, v119
s_waitcnt lgkmcnt(5)
v_mfma_f32_16x16x32_bf16 v[128:131], v[4:7], a[144:147], 0
s_add_u32 s54, s68, s66
ds_read_b128 a[168:171], v248 offset:24576
v_add_u32 v247, 49152, v248
s_waitcnt lgkmcnt(5)
v_mfma_f32_16x16x32_bf16 v[128:131], v[8:11], a[148:151], v[128:131]
s_addk_i32 m0, 0x2000
v_add_u32 v241, 49152, v230
v_accvgpr_write_b32 a0, v4
v_mfma_f32_16x16x32_bf16 v[132:135], v[140:143], a[148:151], 0
s_lshl_b32 s86, s50, 12
ds_read_b128 a[172:175], v230 offset:24576
buffer_load_dwordx4 v232, s[16:19], s54 offen  lds
v_mfma_f32_16x16x32_bf16 v[132:135], v[136:139], a[144:147], v[132:135]
s_waitcnt lgkmcnt(4)
v_accvgpr_write_b32 a1, v5
v_accvgpr_write_b32 a2, v6
v_mfma_f32_16x16x32_bf16 v[132:135], v[20:23], a[152:155], v[132:135]
s_add_u32 s86, s86, 147456
ds_read_b128 a[176:179], v248 offset:32768
v_lshl_add_u32 v240, v255, 3, s86
v_mfma_f32_16x16x32_bf16 v[132:135], v[152:155], a[156:159], v[132:135]
v_lshlrev_b32 v250, 16, v250
v_lshlrev_b32 v249, 16, v249
v_mfma_f32_16x16x32_bf16 v[128:131], v[16:19], a[156:159], v[128:131]
ds_read_b128 a[180:183], v230 offset:32768
buffer_load_dwordx4 v231, s[16:19], s54 offen offset:1024  lds
v_mfma_f32_16x16x32_bf16 v[128:131], v[12:15], a[152:155], v[128:131]
s_waitcnt lgkmcnt(4)
v_lshlrev_b32 v244, 16, v244
v_mul_f32 v244, 0x3fb8aa3b, v244
v_mfma_f32_16x16x32_bf16 v[128:131], v[24:27], a[160:163], v[128:131]
s_add_u32 s55, s69, s58
ds_read_b128 a[184:187], v248 offset:40960
v_exp_f32 v244, v244
v_mfma_f32_16x16x32_bf16 v[128:131], v[28:31], a[164:167], v[128:131]
s_addk_i32 m0, 0x2000
v_cvt_pk_bf16_f32 v244, v244, v244
v_and_b32 v244, s97, v244
v_mfma_f32_16x16x32_bf16 v[132:135], v[172:175], a[164:167], v[132:135]
ds_read_b128 a[188:191], v230 offset:40960
buffer_load_dwordx4 v232, s[16:19], s55 offen  lds
v_mfma_f32_16x16x32_bf16 v[132:135], v[168:171], a[160:163], v[132:135]
s_waitcnt lgkmcnt(4)
v_mul_f32 v239, v244, v250
v_mul_f32 v238, v244, v249
v_mfma_f32_16x16x32_bf16 v[132:135], v[32:35], a[168:171], v[132:135]
ds_read_b128 a[144:147], v248 offset:2048
v_mul_f32 v239, 0x3fb8aa3b, v239
v_mfma_f32_16x16x32_bf16 v[132:135], v[36:39], a[172:175], v[132:135]
v_exp_f32 v239, v239
v_mfma_f32_16x16x32_bf16 v[128:131], v[44:47], a[172:175], v[128:131]
ds_read_b128 a[148:151], v230 offset:2048
buffer_load_dwordx4 v231, s[16:19], s55 offen offset:1024  lds
v_mfma_f32_16x16x32_bf16 v[128:131], v[40:43], a[168:171], v[128:131]
s_waitcnt lgkmcnt(4)
v_mul_f32 v238, 0x3e22f983, v238
v_rndne_f32 v244, v238
v_mfma_f32_16x16x32_bf16 v[128:131], v[56:59], a[176:179], v[128:131]
s_add_u32 s54, s69, s59
ds_read_b128 a[152:155], v248 offset:10240
v_sub_f32 v238, v238, v244
v_mfma_f32_16x16x32_bf16 v[128:131], v[60:63], a[180:183], v[128:131]
s_addk_i32 m0, 0x2000
v_cos_f32 v244, v238
v_mfma_f32_16x16x32_bf16 v[132:135], v[52:55], a[180:183], v[132:135]
ds_read_b128 a[156:159], v230 offset:10240
buffer_load_dwordx4 v232, s[16:19], s54 offen  lds
v_mfma_f32_16x16x32_bf16 v[132:135], v[48:51], a[176:179], v[132:135]
s_waitcnt lgkmcnt(4)
v_sin_f32 v237, v238
v_mfma_f32_16x16x32_bf16 v[132:135], v[64:67], a[184:187], v[132:135]
ds_read_b128 a[160:163], v248 offset:18432
v_mul_f32 v144, v239, v244
v_mfma_f32_16x16x32_bf16 v[132:135], v[68:71], a[188:191], v[132:135]
v_mul_f32 v145, v239, v237
v_mul_f32 v244, v250, v250
v_mfma_f32_16x16x32_bf16 v[128:131], v[76:79], a[188:191], v[128:131]
ds_read_b128 a[164:167], v230 offset:18432
buffer_load_dwordx4 v231, s[16:19], s54 offen offset:1024  lds
v_mfma_f32_16x16x32_bf16 v[128:131], v[72:75], a[184:187], v[128:131]
s_waitcnt lgkmcnt(4)
v_fmac_f32 v244, v249, v249
v_rcp_f32 v244, v244
v_mfma_f32_16x16x32_bf16 v[148:151], v[4:7], a[144:147], 0
s_add_u32 s55, s69, s60
ds_read_b128 a[168:171], v248 offset:26624
v_add_f32 v239, -1.0, v144
v_mfma_f32_16x16x32_bf16 v[148:151], v[8:11], a[148:151], v[148:151]
s_addk_i32 m0, 0x2000
v_add_f32 v244, v244, v244
v_mul_f32 v237, v239, v250
v_mfma_f32_16x16x32_bf16 v[156:159], v[140:143], a[148:151], 0
ds_read_b128 a[172:175], v230 offset:26624
buffer_load_dwordx4 v232, s[16:19], s55 offen  lds
v_mfma_f32_16x16x32_bf16 v[156:159], v[136:139], a[144:147], v[156:159]
s_waitcnt lgkmcnt(4)
v_fmac_f32 v237, v145, v249
v_mul_f32 v146, v237, v244
v_mfma_f32_16x16x32_bf16 v[156:159], v[20:23], a[152:155], v[156:159]
ds_read_b128 a[176:179], v248 offset:34816
v_mul_f32 v237, v145, v250
v_mfma_f32_16x16x32_bf16 v[156:159], v[152:155], a[156:159], v[156:159]
v_fma_f32 v237, -v239, v249, v237
v_mul_f32 v147, v237, v244
v_mfma_f32_16x16x32_bf16 v[148:151], v[16:19], a[156:159], v[148:151]
ds_read_b128 a[180:183], v230 offset:34816
buffer_load_dwordx4 v231, s[16:19], s55 offen offset:1024  lds
v_mfma_f32_16x16x32_bf16 v[148:151], v[12:15], a[152:155], v[148:151]
s_waitcnt lgkmcnt(4)
v_lshlrev_b32 v244, 3, v255
v_add_u32 v250, v240, v244
v_mfma_f32_16x16x32_bf16 v[148:151], v[24:27], a[160:163], v[148:151]
s_add_u32 s54, s69, s61
ds_read_b128 a[184:187], v248 offset:43008
v_lshlrev_b32 v244, 8, v245
v_mfma_f32_16x16x32_bf16 v[148:151], v[28:31], a[164:167], v[148:151]
s_addk_i32 m0, 0x2000
v_sub_u32 v249, v250, v244
v_accvgpr_write_b32 a3, v7
v_mfma_f32_16x16x32_bf16 v[156:159], v[172:175], a[164:167], v[156:159]
ds_read_b128 a[188:191], v230 offset:43008
buffer_load_dwordx4 v232, s[16:19], s54 offen  lds
v_mfma_f32_16x16x32_bf16 v[156:159], v[168:171], a[160:163], v[156:159]
s_waitcnt lgkmcnt(4)
ds_write_b128 v250, v[144:147]
v_accvgpr_write_b32 a4, v136
v_mfma_f32_16x16x32_bf16 v[156:159], v[32:35], a[168:171], v[156:159]
s_mov_b32 s14, 5308416
ds_read_b128 a[144:147], v248 offset:4096
v_accvgpr_write_b32 a5, v137
v_mfma_f32_16x16x32_bf16 v[156:159], v[36:39], a[172:175], v[156:159]
s_mov_b32 s15, 0x20000
v_accvgpr_write_b32 a6, v138
v_accvgpr_write_b32 a7, v139
v_mfma_f32_16x16x32_bf16 v[148:151], v[44:47], a[172:175], v[148:151]
s_mov_b32 s22, 663552
ds_read_b128 a[148:151], v230 offset:4096
buffer_load_dwordx4 v231, s[16:19], s54 offen offset:1024  lds
v_mfma_f32_16x16x32_bf16 v[148:151], v[40:43], a[168:171], v[148:151]
s_waitcnt lgkmcnt(5)
v_accvgpr_write_b32 a8, v8
v_accvgpr_write_b32 a9, v9
v_mfma_f32_16x16x32_bf16 v[148:151], v[56:59], a[176:179], v[148:151]
s_add_u32 s55, s69, s62
ds_read_b128 a[152:155], v248 offset:12288
v_accvgpr_write_b32 a10, v10
v_mfma_f32_16x16x32_bf16 v[148:151], v[60:63], a[180:183], v[148:151]
s_addk_i32 m0, 0x2000
v_accvgpr_write_b32 a11, v11
v_accvgpr_write_b32 a12, v140
v_mfma_f32_16x16x32_bf16 v[156:159], v[52:55], a[180:183], v[156:159]
s_mov_b32 s23, 0x20000
ds_read_b128 a[156:159], v230 offset:12288
buffer_load_dwordx4 v232, s[16:19], s55 offen  lds
v_mfma_f32_16x16x32_bf16 v[156:159], v[48:51], a[176:179], v[156:159]
s_waitcnt lgkmcnt(5)
v_accvgpr_write_b32 a13, v141
v_accvgpr_write_b32 a14, v142
v_mfma_f32_16x16x32_bf16 v[156:159], v[64:67], a[184:187], v[156:159]
s_mov_b32 s26, 663552
ds_read_b128 a[160:163], v248 offset:20480
v_accvgpr_write_b32 a15, v143
v_mfma_f32_16x16x32_bf16 v[156:159], v[68:71], a[188:191], v[156:159]
s_mov_b32 s27, 0x20000
v_accvgpr_write_b32 a16, v12
v_accvgpr_write_b32 a17, v13
v_mfma_f32_16x16x32_bf16 v[148:151], v[76:79], a[188:191], v[148:151]
s_mov_b32 s30, 4718592
ds_read_b128 a[164:167], v230 offset:20480
buffer_load_dwordx4 v231, s[16:19], s55 offen offset:1024  lds
v_mfma_f32_16x16x32_bf16 v[148:151], v[72:75], a[184:187], v[148:151]
s_waitcnt lgkmcnt(4)
v_accvgpr_write_b32 a18, v14
v_accvgpr_write_b32 a19, v15
v_mfma_f32_16x16x32_bf16 v[160:163], v[4:7], a[144:147], 0
s_add_u32 s54, s69, s63
ds_read_b128 a[168:171], v248 offset:28672
v_accvgpr_write_b32 a20, v20
v_mfma_f32_16x16x32_bf16 v[160:163], v[8:11], a[148:151], v[160:163]
s_addk_i32 m0, 0x2000
v_accvgpr_write_b32 a21, v21
v_accvgpr_write_b32 a22, v22
v_mfma_f32_16x16x32_bf16 v[164:167], v[140:143], a[148:151], 0
s_mov_b32 s31, 0x20000
ds_read_b128 a[172:175], v230 offset:28672
buffer_load_dwordx4 v232, s[16:19], s54 offen  lds
v_mfma_f32_16x16x32_bf16 v[164:167], v[136:139], a[144:147], v[164:167]
s_waitcnt lgkmcnt(4)
v_accvgpr_write_b32 a23, v23
v_accvgpr_write_b32 a24, v16
v_mfma_f32_16x16x32_bf16 v[164:167], v[20:23], a[152:155], v[164:167]
s_mov_b32 s38, 256
ds_read_b128 a[176:179], v248 offset:36864
v_accvgpr_write_b32 a25, v17
v_mfma_f32_16x16x32_bf16 v[164:167], v[152:155], a[156:159], v[164:167]
s_mov_b32 s39, 0x20000
v_accvgpr_write_b32 a26, v18
v_accvgpr_write_b32 a27, v19
v_mfma_f32_16x16x32_bf16 v[160:163], v[16:19], a[156:159], v[160:163]
s_mov_b32 s34, 134217728
ds_read_b128 a[180:183], v230 offset:36864
buffer_load_dwordx4 v231, s[16:19], s54 offen offset:1024  lds
v_mfma_f32_16x16x32_bf16 v[160:163], v[12:15], a[152:155], v[160:163]
s_waitcnt lgkmcnt(4)
v_accvgpr_write_b32 a28, v152
v_accvgpr_write_b32 a29, v153
v_mfma_f32_16x16x32_bf16 v[160:163], v[24:27], a[160:163], v[160:163]
s_add_u32 s55, s69, s64
ds_read_b128 a[184:187], v248 offset:45056
v_accvgpr_write_b32 a30, v154
v_mfma_f32_16x16x32_bf16 v[160:163], v[28:31], a[164:167], v[160:163]
s_addk_i32 m0, 0x2000
v_accvgpr_write_b32 a31, v155
v_accvgpr_write_b32 a32, v24
v_mfma_f32_16x16x32_bf16 v[164:167], v[172:175], a[164:167], v[164:167]
s_mov_b32 s35, 0x20000
ds_read_b128 a[188:191], v230 offset:45056
buffer_load_dwordx4 v232, s[16:19], s55 offen  lds
v_mfma_f32_16x16x32_bf16 v[164:167], v[168:171], a[160:163], v[164:167]
s_waitcnt lgkmcnt(4)
v_accvgpr_write_b32 a33, v25
v_accvgpr_write_b32 a34, v26
v_mfma_f32_16x16x32_bf16 v[164:167], v[32:35], a[168:171], v[164:167]
s_mov_b32 s46, 245760
ds_read_b128 a[144:147], v248 offset:6144
v_accvgpr_write_b32 a35, v27
v_mfma_f32_16x16x32_bf16 v[164:167], v[36:39], a[172:175], v[164:167]
s_mov_b32 s47, 0x20000
v_accvgpr_write_b32 a36, v168
v_accvgpr_write_b32 a37, v169
v_mfma_f32_16x16x32_bf16 v[160:163], v[44:47], a[172:175], v[160:163]
s_mov_b32 s98, 0x7fff
ds_read_b128 a[148:151], v230 offset:6144
buffer_load_dwordx4 v231, s[16:19], s55 offen offset:1024  lds
v_mfma_f32_16x16x32_bf16 v[160:163], v[40:43], a[168:171], v[160:163]
s_waitcnt lgkmcnt(4)
v_accvgpr_write_b32 a38, v170
v_accvgpr_write_b32 a39, v171
v_mfma_f32_16x16x32_bf16 v[160:163], v[56:59], a[176:179], v[160:163]
s_add_u32 s54, s69, s65
ds_read_b128 a[152:155], v248 offset:14336
v_accvgpr_write_b32 a40, v28
v_mfma_f32_16x16x32_bf16 v[160:163], v[60:63], a[180:183], v[160:163]
s_addk_i32 m0, 0x2000
v_accvgpr_write_b32 a41, v29
v_accvgpr_write_b32 a42, v30
v_mfma_f32_16x16x32_bf16 v[164:167], v[52:55], a[180:183], v[164:167]
s_mov_b32 s99, 0
ds_read_b128 a[156:159], v230 offset:14336
buffer_load_dwordx4 v232, s[16:19], s54 offen  lds
v_mfma_f32_16x16x32_bf16 v[164:167], v[48:51], a[176:179], v[164:167]
s_waitcnt lgkmcnt(4)
v_accvgpr_write_b32 a43, v31
v_accvgpr_write_b32 a44, v172
v_mfma_f32_16x16x32_bf16 v[164:167], v[64:67], a[184:187], v[164:167]
s_lshl_b32 s86, s48, 13
ds_read_b128 a[160:163], v248 offset:22528
v_accvgpr_write_b32 a45, v173
v_mfma_f32_16x16x32_bf16 v[164:167], v[68:71], a[188:191], v[164:167]
s_add_u32 s40, s32, s86
s_addc_u32 s41, s33, 0
v_accvgpr_write_b32 a46, v174
v_accvgpr_write_b32 a47, v175
v_mfma_f32_16x16x32_bf16 v[160:163], v[76:79], a[188:191], v[160:163]
s_mov_b32 s42, 8192
ds_read_b128 a[164:167], v230 offset:22528
buffer_load_dwordx4 v231, s[16:19], s54 offen offset:1024  lds
v_mfma_f32_16x16x32_bf16 v[160:163], v[72:75], a[184:187], v[160:163]
s_waitcnt lgkmcnt(4)
v_accvgpr_write_b32 a48, v40
v_accvgpr_write_b32 a49, v41
v_mfma_f32_16x16x32_bf16 v[176:179], v[4:7], a[144:147], 0
s_add_u32 s55, s69, s66
ds_read_b128 a[168:171], v248 offset:30720
v_accvgpr_write_b32 a50, v42
v_mfma_f32_16x16x32_bf16 v[176:179], v[8:11], a[148:151], v[176:179]
s_addk_i32 m0, 0x2000
v_accvgpr_write_b32 a51, v43
v_accvgpr_write_b32 a52, v32
v_mfma_f32_16x16x32_bf16 v[4:7], v[140:143], a[148:151], 0
s_mov_b32 s43, 0x20000
ds_read_b128 a[172:175], v230 offset:30720
buffer_load_dwordx4 v232, s[16:19], s55 offen  lds
v_mfma_f32_16x16x32_bf16 v[4:7], v[136:139], a[144:147], v[4:7]
s_waitcnt lgkmcnt(4)
v_accvgpr_write_b32 a53, v33
LM_p2:
s_cbranch_execz LM
v_accvgpr_write_b32 a54, v34
v_mfma_f32_16x16x32_bf16 v[4:7], v[20:23], a[152:155], v[4:7]
s_lshl_b32 s74, s101, 7
ds_read_b128 a[176:179], v248 offset:38912
v_accvgpr_write_b32 a55, v35
v_mfma_f32_16x16x32_bf16 v[4:7], v[152:155], a[156:159], v[4:7]
s_add_u32 s86, s51, 1
v_accvgpr_write_b32 a56, v44
v_accvgpr_write_b32 a57, v45
v_mfma_f32_16x16x32_bf16 v[176:179], v[16:19], a[156:159], v[176:179]
s_and_b32 s86, s86, 7
ds_read_b128 a[180:183], v230 offset:38912
buffer_load_dwordx4 v231, s[16:19], s55 offen offset:1024  lds
v_mfma_f32_16x16x32_bf16 v[176:179], v[12:15], a[152:155], v[176:179]
s_waitcnt lgkmcnt(4)
v_accvgpr_write_b32 a58, v46
v_accvgpr_write_b32 a59, v47
v_mfma_f32_16x16x32_bf16 v[176:179], v[24:27], a[160:163], v[176:179]
s_add_u32 s86, s86, s101
ds_read_b128 a[184:187], v248 offset:47104
v_accvgpr_write_b32 a60, v36
v_mfma_f32_16x16x32_bf16 v[176:179], v[28:31], a[164:167], v[176:179]
s_add_u32 s86, s86, 1
v_accvgpr_write_b32 a61, v37
v_accvgpr_write_b32 a62, v38
v_mfma_f32_16x16x32_bf16 v[4:7], v[172:175], a[164:167], v[4:7]
s_waitcnt vmcnt(12)
ds_read_b128 a[188:191], v230 offset:47104
v_accvgpr_write_b32 a63, v39
v_mfma_f32_16x16x32_bf16 v[4:7], v[168:171], a[160:163], v[4:7]
s_waitcnt lgkmcnt(4)
v_accvgpr_write_b32 a64, v56
v_accvgpr_write_b32 a65, v57
v_mfma_f32_16x16x32_bf16 v[4:7], v[32:35], a[168:171], v[4:7]
s_barrier
ds_read_b128 a[144:147], v247 offset:0
v_accvgpr_write_b32 a66, v58
v_mfma_f32_16x16x32_bf16 v[4:7], v[36:39], a[172:175], v[4:7]
s_sub_u32 s87, s86, 9
v_accvgpr_write_b32 a67, v59
v_accvgpr_write_b32 a68, v48
v_mfma_f32_16x16x32_bf16 v[176:179], v[44:47], a[172:175], v[176:179]
s_min_u32 s86, s86, s87
ds_read_b128 a[148:151], v241 offset:0
v_accvgpr_write_b32 a69, v49
v_mfma_f32_16x16x32_bf16 v[176:179], v[40:43], a[168:171], v[176:179]
s_waitcnt lgkmcnt(4)
v_accvgpr_write_b32 a70, v50
v_accvgpr_write_b32 a71, v51
v_mfma_f32_16x16x32_bf16 v[176:179], v[56:59], a[176:179], v[176:179]
s_lshl_b32 s75, s86, 7
ds_read_b128 a[152:155], v247 offset:8192
v_accvgpr_write_b32 a72, v60
v_mfma_f32_16x16x32_bf16 v[176:179], v[60:63], a[180:183], v[176:179]
s_add_u32 s86, s51, 2
v_accvgpr_write_b32 a73, v61
v_accvgpr_write_b32 a74, v62
v_mfma_f32_16x16x32_bf16 v[4:7], v[52:55], a[180:183], v[4:7]
s_and_b32 s86, s86, 7
ds_read_b128 a[156:159], v241 offset:8192
v_accvgpr_write_b32 a75, v63
v_mfma_f32_16x16x32_bf16 v[4:7], v[48:51], a[176:179], v[4:7]
s_waitcnt lgkmcnt(4)
v_accvgpr_write_b32 a76, v52
v_accvgpr_write_b32 a77, v53
v_mfma_f32_16x16x32_bf16 v[4:7], v[64:67], a[184:187], v[4:7]
s_add_u32 s86, s86, s101
ds_read_b128 a[160:163], v247 offset:16384
v_accvgpr_write_b32 a78, v54
v_mfma_f32_16x16x32_bf16 v[4:7], v[68:71], a[188:191], v[4:7]
s_add_u32 s86, s86, 1
v_accvgpr_write_b32 a79, v55
v_accvgpr_write_b32 a80, v72
v_mfma_f32_16x16x32_bf16 v[176:179], v[76:79], a[188:191], v[176:179]
s_sub_u32 s87, s86, 9
ds_read_b128 a[164:167], v241 offset:16384
v_accvgpr_write_b32 a81, v73
v_mfma_f32_16x16x32_bf16 v[176:179], v[72:75], a[184:187], v[176:179]
s_waitcnt lgkmcnt(4)
v_accvgpr_write_b32 a82, v74
v_accvgpr_write_b32 a83, v75
v_mfma_f32_16x16x32_bf16 v[128:131], v[88:91], a[144:147], v[128:131]
s_mul_i32 s54, s58, 4608
ds_read_b128 a[168:171], v247 offset:2048
v_accvgpr_write_b32 a84, v64
v_mfma_f32_16x16x32_bf16 v[128:131], v[92:95], a[148:151], v[128:131]
s_add_u32 s54, s54, s70
v_accvgpr_write_b32 a85, v65
v_accvgpr_write_b32 a86, v66
v_mfma_f32_16x16x32_bf16 v[132:135], v[84:87], a[148:151], v[132:135]
s_mov_b32 m0, s53
ds_read_b128 a[172:175], v241 offset:2048
v_accvgpr_write_b32 a87, v67
v_mfma_f32_16x16x32_bf16 v[132:135], v[80:83], a[144:147], v[132:135]
s_waitcnt lgkmcnt(4)
buffer_load_dwordx4 v254, s[8:11], s54 offen  lds
v_accvgpr_write_b32 a88, v76
v_mfma_f32_16x16x32_bf16 v[132:135], v[96:99], a[152:155], v[132:135]
s_min_u32 s86, s86, s87
ds_read_b128 a[176:179], v247 offset:10240
v_accvgpr_write_b32 a89, v77
v_mfma_f32_16x16x32_bf16 v[132:135], v[100:103], a[156:159], v[132:135]
s_lshl_b32 s76, s86, 7
v_accvgpr_write_b32 a90, v78
v_accvgpr_write_b32 a91, v79
v_mfma_f32_16x16x32_bf16 v[128:131], v[108:111], a[156:159], v[128:131]
s_add_u32 s86, s51, 3
ds_read_b128 a[180:183], v241 offset:10240
v_accvgpr_write_b32 a92, v68
v_mfma_f32_16x16x32_bf16 v[128:131], v[104:107], a[152:155], v[128:131]
s_waitcnt lgkmcnt(4)
v_accvgpr_write_b32 a93, v69
v_accvgpr_write_b32 a94, v70
v_mfma_f32_16x16x32_bf16 v[128:131], v[120:123], a[160:163], v[128:131]
s_and_b32 s86, s86, 7
ds_read_b128 a[184:187], v247 offset:18432
v_accvgpr_write_b32 a95, v71
v_mfma_f32_16x16x32_bf16 v[128:131], v[124:127], a[164:167], v[128:131]
s_add_u32 s86, s86, s101
v_accvgpr_write_b32 a96, v88
v_accvgpr_write_b32 a97, v89
v_mfma_f32_16x16x32_bf16 v[132:135], v[116:119], a[164:167], v[132:135]
s_add_u32 s86, s86, 1
ds_read_b128 a[188:191], v241 offset:18432
v_accvgpr_write_b32 a98, v90
v_mfma_f32_16x16x32_bf16 v[132:135], v[112:115], a[160:163], v[132:135]
s_waitcnt lgkmcnt(4)
buffer_load_dwordx4 v253, s[8:11], s54 offen offset:1024  lds
v_accvgpr_write_b32 a99, v91
v_mfma_f32_16x16x32_bf16 v[148:151], v[88:91], a[168:171], v[148:151]
s_sub_u32 s87, s86, 9
ds_read_b128 a[144:147], v247 offset:4096
v_accvgpr_write_b32 a100, v80
v_mfma_f32_16x16x32_bf16 v[148:151], v[92:95], a[172:175], v[148:151]
s_min_u32 s86, s86, s87
v_accvgpr_write_b32 a101, v81
v_accvgpr_write_b32 a102, v82
v_mfma_f32_16x16x32_bf16 v[156:159], v[84:87], a[172:175], v[156:159]
s_lshl_b32 s77, s86, 7
ds_read_b128 a[148:151], v241 offset:4096
v_accvgpr_write_b32 a103, v83
v_mfma_f32_16x16x32_bf16 v[156:159], v[80:83], a[168:171], v[156:159]
s_waitcnt lgkmcnt(4)
v_accvgpr_write_b32 a104, v92
v_accvgpr_write_b32 a105, v93
v_mfma_f32_16x16x32_bf16 v[156:159], v[96:99], a[176:179], v[156:159]
s_mul_i32 s55, s59, 4608
ds_read_b128 a[152:155], v247 offset:12288
v_accvgpr_write_b32 a106, v94
v_mfma_f32_16x16x32_bf16 v[156:159], v[100:103], a[180:183], v[156:159]
s_add_u32 s55, s55, s70
v_accvgpr_write_b32 a107, v95
v_accvgpr_write_b32 a108, v84
v_mfma_f32_16x16x32_bf16 v[148:151], v[108:111], a[180:183], v[148:151]
s_addk_i32 m0, 0x2000
ds_read_b128 a[156:159], v241 offset:12288
v_accvgpr_write_b32 a109, v85
v_mfma_f32_16x16x32_bf16 v[148:151], v[104:107], a[176:179], v[148:151]
s_waitcnt lgkmcnt(4)
buffer_load_dwordx4 v254, s[8:11], s55 offen  lds
v_accvgpr_write_b32 a110, v86
v_mfma_f32_16x16x32_bf16 v[148:151], v[120:123], a[184:187], v[148:151]
s_add_u32 s86, s51, 4
ds_read_b128 a[160:163], v247 offset:20480
v_accvgpr_write_b32 a111, v87
v_mfma_f32_16x16x32_bf16 v[148:151], v[124:127], a[188:191], v[148:151]
s_and_b32 s86, s86, 7
v_add_u32 v250, 98304, v248
v_add_u32 v244, 98304, v230
v_mfma_f32_16x16x32_bf16 v[156:159], v[116:119], a[188:191], v[156:159]
s_add_u32 s86, s86, s101
ds_read_b128 a[164:167], v241 offset:20480
v_lshrrev_b32 v239, 2, v255
v_mfma_f32_16x16x32_bf16 v[156:159], v[112:115], a[184:187], v[156:159]
s_waitcnt lgkmcnt(4)
v_lshlrev_b32 v239, 7, v239
v_bfe_u32 v238, v255, 3, 2
v_mfma_f32_16x16x32_bf16 v[160:163], v[88:91], a[144:147], v[160:163]
s_add_u32 s86, s86, 1
ds_read_b128 a[168:171], v247 offset:6144
v_lshl_add_u32 v239, v238, 5, v239
v_mfma_f32_16x16x32_bf16 v[160:163], v[92:95], a[148:151], v[160:163]
s_sub_u32 s87, s86, 9
v_and_b32 v238, 3, v255
v_lshl_add_u32 v237, v238, 3, v239
v_mfma_f32_16x16x32_bf16 v[164:167], v[84:87], a[148:151], v[164:167]
s_min_u32 s86, s86, s87
ds_read_b128 a[172:175], v241 offset:6144
v_xor_b32 v239, 32, v237
v_mfma_f32_16x16x32_bf16 v[164:167], v[80:83], a[144:147], v[164:167]
s_waitcnt lgkmcnt(4)
buffer_load_dwordx4 v253, s[8:11], s55 offen offset:1024  lds
v_xor_b32 v238, 64, v237
v_mfma_f32_16x16x32_bf16 v[164:167], v[96:99], a[152:155], v[164:167]
s_lshl_b32 s78, s86, 7
ds_read_b128 a[176:179], v247 offset:14336
v_xor_b32 v236, 96, v237
v_mfma_f32_16x16x32_bf16 v[164:167], v[100:103], a[156:159], v[164:167]
s_add_u32 s86, s51, 5
ds_read_b128 v[8:11], v249 offset:0
ds_read_b128 v[12:15], v249 offset:256
v_mfma_f32_16x16x32_bf16 v[160:163], v[108:111], a[156:159], v[160:163]
s_and_b32 s86, s86, 7
ds_read_b128 a[180:183], v241 offset:14336
ds_read_b128 v[16:19], v249 offset:512
v_mfma_f32_16x16x32_bf16 v[160:163], v[104:107], a[152:155], v[160:163]
s_waitcnt lgkmcnt(7)
ds_read_b128 v[20:23], v249 offset:768
s_waitcnt lgkmcnt(4)
v_mul_f32 v24, v10, v128
v_mfma_f32_16x16x32_bf16 v[160:163], v[120:123], a[160:163], v[160:163]
s_mul_i32 s54, s60, 4608
ds_read_b128 a[184:187], v247 offset:22528
v_mul_f32 v25, v10, v148
v_mfma_f32_16x16x32_bf16 v[160:163], v[124:127], a[164:167], v[160:163]
s_add_u32 s54, s54, s70
v_fma_f32 v24, -v11, v148, v24
v_fmac_f32 v25, v11, v128
v_mfma_f32_16x16x32_bf16 v[164:167], v[116:119], a[164:167], v[164:167]
s_addk_i32 m0, 0x2000
ds_read_b128 a[188:191], v241 offset:22528
v_mul_f32 v26, v10, v129
v_mfma_f32_16x16x32_bf16 v[164:167], v[112:115], a[160:163], v[164:167]
buffer_load_dwordx4 v254, s[8:11], s54 offen  lds
v_mul_f32 v27, v10, v149
v_mfma_f32_16x16x32_bf16 v[176:179], v[88:91], a[168:171], v[176:179]
s_add_u32 s86, s86, s101
ds_read_b128 a[144:147], v247 offset:24576
v_fma_f32 v26, -v11, v149, v26
v_mfma_f32_16x16x32_bf16 v[176:179], v[92:95], a[172:175], v[176:179]
s_add_u32 s86, s86, 1
v_fmac_f32 v27, v11, v129
v_fma_f32 v226, v8, v24, v26
v_mfma_f32_16x16x32_bf16 v[4:7], v[84:87], a[172:175], v[4:7]
s_sub_u32 s87, s86, 9
ds_read_b128 a[148:151], v241 offset:24576
v_fma_f32 v227, v8, v25, v27
v_mfma_f32_16x16x32_bf16 v[4:7], v[80:83], a[168:171], v[4:7]
s_waitcnt lgkmcnt(6)
v_fma_f32 v226, -v9, v25, v226
v_fmac_f32 v227, v9, v24
v_mfma_f32_16x16x32_bf16 v[4:7], v[96:99], a[176:179], v[4:7]
s_min_u32 s86, s86, s87
ds_read_b128 a[152:155], v247 offset:32768
v_mul_f32 v28, v10, v130
v_mfma_f32_16x16x32_bf16 v[4:7], v[100:103], a[180:183], v[4:7]
s_lshl_b32 s79, s86, 7
v_mul_f32 v29, v10, v150
v_fma_f32 v28, -v11, v150, v28
v_mfma_f32_16x16x32_bf16 v[176:179], v[108:111], a[180:183], v[176:179]
s_add_u32 s86, s51, 6
ds_read_b128 a[156:159], v241 offset:32768
v_fmac_f32 v29, v11, v130
v_mfma_f32_16x16x32_bf16 v[176:179], v[104:107], a[176:179], v[176:179]
s_waitcnt lgkmcnt(4)
buffer_load_dwordx4 v253, s[8:11], s54 offen offset:1024  lds
v_fma_f32 v224, v8, v226, v28
v_mfma_f32_16x16x32_bf16 v[176:179], v[120:123], a[184:187], v[176:179]
s_and_b32 s86, s86, 7
ds_read_b128 a[160:163], v247 offset:40960
v_fma_f32 v225, v8, v227, v29
v_mfma_f32_16x16x32_bf16 v[176:179], v[124:127], a[188:191], v[176:179]
s_add_u32 s86, s86, s101
v_fma_f32 v224, -v9, v227, v224
v_fmac_f32 v225, v9, v226
v_mfma_f32_16x16x32_bf16 v[4:7], v[116:119], a[188:191], v[4:7]
s_add_u32 s86, s86, 1
ds_read_b128 a[164:167], v241 offset:40960
v_mul_f32 v30, v10, v131
v_mfma_f32_16x16x32_bf16 v[4:7], v[112:115], a[184:187], v[4:7]
s_waitcnt lgkmcnt(4)
v_mul_f32 v31, v10, v151
v_fma_f32 v30, -v11, v151, v30
v_mfma_f32_16x16x32_bf16 v[32:35], a[0:3], a[144:147], 0
s_mul_i32 s55, s61, 4608
ds_read_b128 a[168:171], v247 offset:26624
v_fmac_f32 v31, v11, v131
v_mfma_f32_16x16x32_bf16 v[32:35], a[8:11], a[148:151], v[32:35]
s_add_u32 s55, s55, s70
v_fma_f32 v226, v8, v224, v30
v_fma_f32 v227, v8, v225, v31
v_mfma_f32_16x16x32_bf16 v[36:39], a[12:15], a[148:151], 0
s_addk_i32 m0, 0x2000
ds_read_b128 a[172:175], v241 offset:26624
v_fma_f32 v226, -v9, v225, v226
v_mfma_f32_16x16x32_bf16 v[36:39], a[4:7], a[144:147], v[36:39]
s_waitcnt lgkmcnt(4)
buffer_load_dwordx4 v254, s[8:11], s55 offen  lds
v_fmac_f32 v227, v9, v224
v_mfma_f32_16x16x32_bf16 v[36:39], a[20:23], a[152:155], v[36:39]
s_sub_u32 s87, s86, 9
ds_read_b128 a[176:179], v247 offset:34816
v_mul_f32 v40, v10, v132
v_mfma_f32_16x16x32_bf16 v[36:39], a[28:31], a[156:159], v[36:39]
s_min_u32 s86, s86, s87
v_mul_f32 v41, v10, v156
v_fma_f32 v40, -v11, v156, v40
v_mfma_f32_16x16x32_bf16 v[32:35], a[24:27], a[156:159], v[32:35]
s_lshl_b32 s80, s86, 7
ds_read_b128 a[180:183], v241 offset:34816
v_fmac_f32 v41, v11, v132
v_mfma_f32_16x16x32_bf16 v[32:35], a[16:19], a[152:155], v[32:35]
s_waitcnt lgkmcnt(4)
v_fma_f32 v224, v8, v226, v40
v_fma_f32 v225, v8, v227, v41
v_mfma_f32_16x16x32_bf16 v[32:35], a[32:35], a[160:163], v[32:35]
s_add_u32 s86, s51, 7
ds_read_b128 a[184:187], v247 offset:43008
v_fma_f32 v224, -v9, v227, v224
v_mfma_f32_16x16x32_bf16 v[32:35], a[40:43], a[164:167], v[32:35]
s_and_b32 s86, s86, 7
v_fmac_f32 v225, v9, v226
v_mul_f32 v42, v10, v133
v_mfma_f32_16x16x32_bf16 v[36:39], a[44:47], a[164:167], v[36:39]
s_add_u32 s86, s86, s101
ds_read_b128 a[188:191], v241 offset:43008
v_mul_f32 v43, v10, v157
v_mfma_f32_16x16x32_bf16 v[36:39], a[36:39], a[160:163], v[36:39]
s_waitcnt lgkmcnt(4)
buffer_load_dwordx4 v253, s[8:11], s55 offen offset:1024  lds
v_fma_f32 v42, -v11, v157, v42
v_mfma_f32_16x16x32_bf16 v[44:47], a[0:3], a[168:171], 0
s_add_u32 s86, s86, 1
ds_read_b128 a[144:147], v247 offset:28672
v_fmac_f32 v43, v11, v133
v_mfma_f32_16x16x32_bf16 v[44:47], a[8:11], a[172:175], v[44:47]
s_sub_u32 s87, s86, 9
v_fma_f32 v226, v8, v224, v42
v_fma_f32 v227, v8, v225, v43
v_mfma_f32_16x16x32_bf16 v[48:51], a[12:15], a[172:175], 0
s_min_u32 s86, s86, s87
ds_read_b128 a[148:151], v241 offset:28672
v_fma_f32 v226, -v9, v225, v226
v_mfma_f32_16x16x32_bf16 v[48:51], a[4:7], a[168:171], v[48:51]
s_waitcnt lgkmcnt(4)
v_fmac_f32 v227, v9, v224
v_mul_f32 v52, v10, v134
v_mfma_f32_16x16x32_bf16 v[48:51], a[20:23], a[176:179], v[48:51]
s_mul_i32 s54, s62, 4608
ds_read_b128 a[152:155], v247 offset:36864
v_mul_f32 v53, v10, v158
v_mfma_f32_16x16x32_bf16 v[48:51], a[28:31], a[180:183], v[48:51]
s_add_u32 s54, s54, s70
v_fma_f32 v52, -v11, v158, v52
v_fmac_f32 v53, v11, v134
v_mfma_f32_16x16x32_bf16 v[44:47], a[24:27], a[180:183], v[44:47]
s_addk_i32 m0, 0x2000
ds_read_b128 a[156:159], v241 offset:36864
v_fma_f32 v224, v8, v226, v52
v_mfma_f32_16x16x32_bf16 v[44:47], a[16:19], a[176:179], v[44:47]
s_waitcnt lgkmcnt(4)
buffer_load_dwordx4 v254, s[8:11], s54 offen  lds
v_fma_f32 v225, v8, v227, v53
v_mfma_f32_16x16x32_bf16 v[44:47], a[32:35], a[184:187], v[44:47]
s_lshl_b32 s81, s86, 7
ds_read_b128 a[160:163], v247 offset:45056
v_fma_f32 v224, -v9, v227, v224
v_mfma_f32_16x16x32_bf16 v[44:47], a[40:43], a[188:191], v[44:47]
s_mul_i32 s86, s49, 6291456
v_fmac_f32 v225, v9, v226
v_mul_f32 v54, v10, v135
v_mfma_f32_16x16x32_bf16 v[48:51], a[44:47], a[188:191], v[48:51]
s_add_u32 s86, s86, 2097152
ds_read_b128 a[164:167], v241 offset:45056
v_mul_f32 v55, v10, v159
v_mfma_f32_16x16x32_bf16 v[48:51], a[36:39], a[184:187], v[48:51]
s_waitcnt lgkmcnt(4)
v_fma_f32 v54, -v11, v159, v54
v_fmac_f32 v55, v11, v135
v_mfma_f32_16x16x32_bf16 v[56:59], a[0:3], a[144:147], 0
s_lshl_b32 s87, s48, 14
ds_read_b128 a[168:171], v247 offset:30720
v_fma_f32 v226, v8, v224, v54
v_mfma_f32_16x16x32_bf16 v[56:59], a[8:11], a[148:151], v[56:59]
s_sub_u32 s83, s86, s87
v_fma_f32 v227, v8, v225, v55
v_fma_f32 v226, -v9, v225, v226
v_mfma_f32_16x16x32_bf16 v[60:63], a[12:15], a[148:151], 0
s_add_u32 s83, s83, 229376
ds_read_b128 a[172:175], v241 offset:30720
v_fmac_f32 v227, v9, v224
v_mfma_f32_16x16x32_bf16 v[60:63], a[4:7], a[144:147], v[60:63]
s_waitcnt lgkmcnt(4)
buffer_load_dwordx4 v253, s[8:11], s54 offen offset:1024  lds
v_mul_f32 v64, v14, v160
v_mfma_f32_16x16x32_bf16 v[60:63], a[20:23], a[152:155], v[60:63]
s_add_u32 s87, s48, 3
ds_read_b128 a[176:179], v247 offset:38912
v_mul_f32 v65, v14, v176
v_mfma_f32_16x16x32_bf16 v[60:63], a[28:31], a[156:159], v[60:63]
s_lshl_b32 s87, s87, 18
v_fma_f32 v64, -v15, v176, v64
v_fmac_f32 v65, v15, v160
v_mfma_f32_16x16x32_bf16 v[56:59], a[24:27], a[156:159], v[56:59]
s_add_u32 s86, s86, s87
ds_read_b128 a[180:183], v241 offset:38912
v_mul_f32 v66, v14, v161
v_mfma_f32_16x16x32_bf16 v[56:59], a[16:19], a[152:155], v[56:59]
s_waitcnt lgkmcnt(4)
v_mul_f32 v67, v14, v177
v_fma_f32 v66, -v15, v177, v66
v_mfma_f32_16x16x32_bf16 v[56:59], a[32:35], a[160:163], v[56:59]
s_mul_i32 s55, s63, 4608
ds_read_b128 a[184:187], v247 offset:47104
v_fmac_f32 v67, v15, v161
v_mfma_f32_16x16x32_bf16 v[56:59], a[40:43], a[164:167], v[56:59]
s_add_u32 s55, s55, s70
v_fma_f32 v224, v12, v64, v66
v_fma_f32 v225, v12, v65, v67
v_mfma_f32_16x16x32_bf16 v[60:63], a[44:47], a[164:167], v[60:63]
s_waitcnt vmcnt(10)
ds_read_b128 a[188:191], v241 offset:47104
v_fma_f32 v224, -v13, v65, v224
v_mfma_f32_16x16x32_bf16 v[60:63], a[36:39], a[160:163], v[60:63]
s_waitcnt lgkmcnt(4)
v_fmac_f32 v225, v13, v64
v_mul_f32 v68, v14, v162
v_mfma_f32_16x16x32_bf16 v[72:75], a[0:3], a[168:171], 0
s_barrier
ds_read_b128 a[144:147], v250 offset:0
v_mul_f32 v69, v14, v178
v_mfma_f32_16x16x32_bf16 v[72:75], a[8:11], a[172:175], v[72:75]
s_addk_i32 m0, 0x2000
v_fma_f32 v68, -v15, v178, v68
v_fmac_f32 v69, v15, v162
v_mfma_f32_16x16x32_bf16 v[76:79], a[12:15], a[172:175], 0
s_add_u32 s44, s32, s86
s_addc_u32 s45, s33, 0
ds_read_b128 a[148:151], v244 offset:0
buffer_load_dwordx4 v254, s[8:11], s55 offen  lds
v_mfma_f32_16x16x32_bf16 v[76:79], a[4:7], a[168:171], v[76:79]
s_waitcnt lgkmcnt(4)
v_mul_f32 v249, v145, v145
v_mul_f32 v223, v144, v145
v_mfma_f32_16x16x32_bf16 v[76:79], a[20:23], a[176:179], v[76:79]
ds_read_b128 a[152:155], v250 offset:8192
v_add_f32 v223, v223, v223
v_mfma_f32_16x16x32_bf16 v[76:79], a[28:31], a[180:183], v[76:79]
v_fma_f32 v222, v144, v144, -v249
v_mul_f32 v249, v223, v223
v_mfma_f32_16x16x32_bf16 v[72:75], a[24:27], a[180:183], v[72:75]
ds_read_b128 a[156:159], v244 offset:8192
v_mul_f32 v223, v222, v223
v_mfma_f32_16x16x32_bf16 v[72:75], a[16:19], a[176:179], v[72:75]
s_waitcnt lgkmcnt(4)
v_add_f32 v223, v223, v223
v_fma_f32 v222, v222, v222, -v249
v_mfma_f32_16x16x32_bf16 v[72:75], a[32:35], a[184:187], v[72:75]
ds_read_b128 a[160:163], v250 offset:16384
v_mul_f32 v249, v223, v223
v_mfma_f32_16x16x32_bf16 v[72:75], a[40:43], a[188:191], v[72:75]
v_mul_f32 v223, v222, v223
v_add_f32 v223, v223, v223
v_mfma_f32_16x16x32_bf16 v[76:79], a[44:47], a[188:191], v[76:79]
ds_read_b128 a[164:167], v244 offset:16384
buffer_load_dwordx4 v253, s[8:11], s55 offen offset:1024  lds
v_mfma_f32_16x16x32_bf16 v[76:79], a[36:39], a[184:187], v[76:79]
s_waitcnt lgkmcnt(4)
v_fma_f32 v222, v222, v222, -v249
v_mul_f32 v249, v223, v223
v_mfma_f32_16x16x32_bf16 v[32:35], a[48:51], a[144:147], v[32:35]
s_mul_i32 s54, s64, 4608
ds_read_b128 a[168:171], v250 offset:24576
v_mul_f32 v221, v222, v223
v_mfma_f32_16x16x32_bf16 v[32:35], a[56:59], a[148:151], v[32:35]
s_add_u32 s54, s54, s70
v_add_f32 v221, v221, v221
v_fma_f32 v220, v222, v222, -v249
v_mfma_f32_16x16x32_bf16 v[36:39], a[60:63], a[148:151], v[36:39]
s_addk_i32 m0, 0x2000
ds_read_b128 a[172:175], v244 offset:24576
v_mul_f32 v249, v221, v221
v_mfma_f32_16x16x32_bf16 v[36:39], a[52:55], a[144:147], v[36:39]
s_waitcnt lgkmcnt(4)
buffer_load_dwordx4 v254, s[8:11], s54 offen  lds
v_mul_f32 v221, v220, v221
v_mfma_f32_16x16x32_bf16 v[36:39], a[68:71], a[152:155], v[36:39]
ds_read_b128 a[176:179], v250 offset:32768
v_add_f32 v221, v221, v221
v_mfma_f32_16x16x32_bf16 v[36:39], a[76:79], a[156:159], v[36:39]
v_fma_f32 v220, v220, v220, -v249
v_mul_f32 v249, v221, v221
v_mfma_f32_16x16x32_bf16 v[32:35], a[72:75], a[156:159], v[32:35]
ds_read_b128 a[180:183], v244 offset:32768
v_mul_f32 v219, v220, v221
v_mfma_f32_16x16x32_bf16 v[32:35], a[64:67], a[152:155], v[32:35]
s_waitcnt lgkmcnt(4)
v_add_f32 v219, v219, v219
v_fma_f32 v218, v220, v220, -v249
v_mfma_f32_16x16x32_bf16 v[32:35], a[80:83], a[160:163], v[32:35]
ds_read_b128 a[184:187], v250 offset:40960
v_mul_f32 v249, v219, v219
v_mfma_f32_16x16x32_bf16 v[32:35], a[88:91], a[164:167], v[32:35]
v_mul_f32 v217, v218, v219
v_add_f32 v217, v217, v217
v_mfma_f32_16x16x32_bf16 v[36:39], a[92:95], a[164:167], v[36:39]
ds_read_b128 a[188:191], v244 offset:40960
v_fma_f32 v216, v218, v218, -v249
v_mfma_f32_16x16x32_bf16 v[36:39], a[84:87], a[160:163], v[36:39]
s_waitcnt lgkmcnt(4)
buffer_load_dwordx4 v253, s[8:11], s54 offen offset:1024  lds
v_mul_f32 v249, v217, v217
v_mfma_f32_16x16x32_bf16 v[36:39], a[100:103], a[168:171], v[36:39]
ds_read_b128 a[144:147], v250 offset:2048
v_mul_f32 v215, v216, v217
v_mfma_f32_16x16x32_bf16 v[36:39], a[108:111], a[172:175], v[36:39]
v_add_f32 v215, v215, v215
v_fma_f32 v214, v216, v216, -v249
v_mfma_f32_16x16x32_bf16 v[32:35], a[104:107], a[172:175], v[32:35]
ds_read_b128 a[148:151], v244 offset:2048
v_mul_f32 v249, v215, v215
v_mfma_f32_16x16x32_bf16 v[32:35], a[96:99], a[168:171], v[32:35]
s_waitcnt lgkmcnt(4)
v_mul_f32 v215, v214, v215
v_add_f32 v215, v215, v215
v_mfma_f32_16x16x32_bf16 v[32:35], v[104:107], a[176:179], v[32:35]
s_mul_i32 s55, s65, 4608
ds_read_b128 a[152:155], v250 offset:10240
v_fma_f32 v214, v214, v214, -v249
v_mfma_f32_16x16x32_bf16 v[32:35], v[108:111], a[180:183], v[32:35]
s_add_u32 s55, s55, s70
v_fma_f32 v212, v12, v224, v68
v_fma_f32 v213, v12, v225, v69
v_mfma_f32_16x16x32_bf16 v[36:39], v[100:103], a[180:183], v[36:39]
s_addk_i32 m0, 0x2000
ds_read_b128 a[156:159], v244 offset:10240
v_fma_f32 v212, -v13, v225, v212
v_mfma_f32_16x16x32_bf16 v[36:39], v[96:99], a[176:179], v[36:39]
s_waitcnt lgkmcnt(4)
buffer_load_dwordx4 v254, s[8:11], s55 offen  lds
v_fmac_f32 v213, v13, v224
v_mfma_f32_16x16x32_bf16 v[36:39], v[112:115], a[184:187], v[36:39]
s_bitcmp1_b32 s50, 0
s_cselect_b64 vcc, -1, 0
ds_read_b128 a[160:163], v250 offset:18432
v_mfma_f32_16x16x32_bf16 v[36:39], v[116:119], a[188:191], v[36:39]
v_cndmask_b32 v249, 1.0, v220, vcc
v_cndmask_b32 v232, 0, v221, vcc
v_mfma_f32_16x16x32_bf16 v[32:35], v[124:127], a[188:191], v[32:35]
s_bitcmp1_b32 s50, 1
s_cselect_b64 vcc, -1, 0
ds_read_b128 a[164:167], v244 offset:18432
v_mfma_f32_16x16x32_bf16 v[32:35], v[120:123], a[184:187], v[32:35]
s_waitcnt lgkmcnt(4)
v_cndmask_b32 v218, 1.0, v218, vcc
v_cndmask_b32 v219, 0, v219, vcc
v_mfma_f32_16x16x32_bf16 v[44:47], a[48:51], a[144:147], v[44:47]
ds_read_b128 a[168:171], v250 offset:26624
v_mul_f32 v210, v249, v218
v_mfma_f32_16x16x32_bf16 v[44:47], a[56:59], a[148:151], v[44:47]
v_fma_f32 v210, -v232, v219, v210
v_mul_f32 v211, v249, v219
v_mfma_f32_16x16x32_bf16 v[48:51], a[60:63], a[148:151], v[48:51]
ds_read_b128 a[172:175], v244 offset:26624
v_fmac_f32 v211, v232, v218
v_mfma_f32_16x16x32_bf16 v[48:51], a[52:55], a[144:147], v[48:51]
s_waitcnt lgkmcnt(4)
buffer_load_dwordx4 v253, s[8:11], s55 offen offset:1024  lds
v_lshlrev_b32 v249, 2, v246
v_mfma_f32_16x16x32_bf16 v[48:51], a[68:71], a[152:155], v[48:51]
buffer_load_dword v232, v249, s[36:39], 0 offen
ds_read_b128 a[176:179], v250 offset:34816
v_mfma_f32_16x16x32_bf16 v[48:51], a[76:79], a[156:159], v[48:51]
v_mul_f32 v70, v14, v163
v_mul_f32 v71, v14, v179
v_mfma_f32_16x16x32_bf16 v[44:47], a[72:75], a[156:159], v[44:47]
ds_read_b128 a[180:183], v244 offset:34816
v_fma_f32 v70, -v15, v179, v70
v_mfma_f32_16x16x32_bf16 v[44:47], a[64:67], a[152:155], v[44:47]
s_waitcnt lgkmcnt(4)
v_fmac_f32 v71, v15, v163
v_fma_f32 v224, v12, v212, v70
v_fma_f32 v225, v12, v213, v71
v_mfma_f32_16x16x32_bf16 v[44:47], a[80:83], a[160:163], v[44:47]
s_mul_i32 s54, s66, 4608
ds_read_b128 a[184:187], v250 offset:43008
v_fma_f32 v224, -v13, v213, v224
v_mfma_f32_16x16x32_bf16 v[44:47], a[88:91], a[164:167], v[44:47]
s_add_u32 s54, s54, s70
v_fmac_f32 v225, v13, v212
v_mul_f32 v80, v14, v164
v_mfma_f32_16x16x32_bf16 v[48:51], a[92:95], a[164:167], v[48:51]
s_addk_i32 m0, 0x2000
ds_read_b128 a[188:191], v244 offset:43008
v_mul_f32 v81, v14, v4
v_mfma_f32_16x16x32_bf16 v[48:51], a[84:87], a[160:163], v[48:51]
s_waitcnt lgkmcnt(4)
buffer_load_dwordx4 v254, s[8:11], s54 offen  lds
v_fma_f32 v80, -v15, v4, v80
v_mfma_f32_16x16x32_bf16 v[48:51], a[100:103], a[168:171], v[48:51]
ds_read_b128 a[144:147], v250 offset:4096
v_fmac_f32 v81, v15, v164
v_mfma_f32_16x16x32_bf16 v[48:51], a[108:111], a[172:175], v[48:51]
v_fma_f32 v212, v12, v224, v80
v_fma_f32 v213, v12, v225, v81
v_mfma_f32_16x16x32_bf16 v[44:47], a[104:107], a[172:175], v[44:47]
ds_read_b128 a[148:151], v244 offset:4096
v_fma_f32 v212, -v13, v225, v212
v_mfma_f32_16x16x32_bf16 v[44:47], a[96:99], a[168:171], v[44:47]
s_waitcnt lgkmcnt(4)
v_fmac_f32 v213, v13, v224
v_mul_f32 v82, v14, v165
v_mfma_f32_16x16x32_bf16 v[44:47], v[104:107], a[176:179], v[44:47]
ds_read_b128 a[152:155], v250 offset:12288
v_mul_f32 v83, v14, v5
v_mfma_f32_16x16x32_bf16 v[44:47], v[108:111], a[180:183], v[44:47]
v_fma_f32 v82, -v15, v5, v82
v_fmac_f32 v83, v15, v165
v_mfma_f32_16x16x32_bf16 v[48:51], v[100:103], a[180:183], v[48:51]
ds_read_b128 a[156:159], v244 offset:12288
v_fma_f32 v224, v12, v212, v82
v_mfma_f32_16x16x32_bf16 v[48:51], v[96:99], a[176:179], v[48:51]
s_waitcnt lgkmcnt(4)
buffer_load_dwordx4 v253, s[8:11], s54 offen offset:1024  lds
v_fma_f32 v225, v12, v213, v83
v_mfma_f32_16x16x32_bf16 v[48:51], v[112:115], a[184:187], v[48:51]
ds_read_b128 a[160:163], v250 offset:20480
v_fma_f32 v224, -v13, v213, v224
v_mfma_f32_16x16x32_bf16 v[48:51], v[116:119], a[188:191], v[48:51]
LM_p3:
s_cbranch_execz LM
v_fmac_f32 v225, v13, v212
v_mul_f32 v84, v14, v166
v_mfma_f32_16x16x32_bf16 v[44:47], v[124:127], a[188:191], v[44:47]
ds_read_b128 a[164:167], v244 offset:20480
v_mul_f32 v85, v14, v6
v_mfma_f32_16x16x32_bf16 v[44:47], v[120:123], a[184:187], v[44:47]
s_waitcnt lgkmcnt(4)
v_fma_f32 v84, -v15, v6, v84
v_fmac_f32 v85, v15, v166
v_mfma_f32_16x16x32_bf16 v[56:59], a[48:51], a[144:147], v[56:59]
s_mul_i32 s55, s58, 4608
ds_read_b128 a[168:171], v250 offset:28672
v_fma_f32 v212, v12, v224, v84
v_mfma_f32_16x16x32_bf16 v[56:59], a[56:59], a[148:151], v[56:59]
s_add_u32 s55, s55, s71
v_fma_f32 v213, v12, v225, v85
v_fma_f32 v212, -v13, v225, v212
v_mfma_f32_16x16x32_bf16 v[60:63], a[60:63], a[148:151], v[60:63]
s_addk_i32 m0, 0x2000
ds_read_b128 a[172:175], v244 offset:28672
v_fmac_f32 v213, v13, v224
v_mfma_f32_16x16x32_bf16 v[60:63], a[52:55], a[144:147], v[60:63]
s_waitcnt lgkmcnt(4)
buffer_load_dwordx4 v254, s[8:11], s55 offen  lds
v_mul_f32 v86, v14, v167
v_mfma_f32_16x16x32_bf16 v[60:63], a[68:71], a[152:155], v[60:63]
ds_read_b128 a[176:179], v250 offset:36864
v_mul_f32 v87, v14, v7
v_mfma_f32_16x16x32_bf16 v[60:63], a[76:79], a[156:159], v[60:63]
v_fma_f32 v86, -v15, v7, v86
v_fmac_f32 v87, v15, v167
v_mfma_f32_16x16x32_bf16 v[56:59], a[72:75], a[156:159], v[56:59]
ds_read_b128 a[180:183], v244 offset:36864
v_fma_f32 v224, v12, v212, v86
v_mfma_f32_16x16x32_bf16 v[56:59], a[64:67], a[152:155], v[56:59]
s_waitcnt lgkmcnt(4)
v_fma_f32 v225, v12, v213, v87
v_fma_f32 v224, -v13, v213, v224
v_mfma_f32_16x16x32_bf16 v[56:59], a[80:83], a[160:163], v[56:59]
ds_read_b128 a[184:187], v250 offset:45056
v_fmac_f32 v225, v13, v212
v_mfma_f32_16x16x32_bf16 v[56:59], a[88:91], a[164:167], v[56:59]
v_mul_f32 v4, v18, v32
v_mul_f32 v5, v18, v44
v_mfma_f32_16x16x32_bf16 v[60:63], a[92:95], a[164:167], v[60:63]
ds_read_b128 a[188:191], v244 offset:45056
v_fma_f32 v4, -v19, v44, v4
v_mfma_f32_16x16x32_bf16 v[60:63], a[84:87], a[160:163], v[60:63]
s_waitcnt lgkmcnt(4)
buffer_load_dwordx4 v253, s[8:11], s55 offen offset:1024  lds
v_fmac_f32 v5, v19, v32
v_mfma_f32_16x16x32_bf16 v[60:63], a[100:103], a[168:171], v[60:63]
ds_read_b128 a[144:147], v250 offset:6144
v_mul_f32 v6, v18, v33
v_mfma_f32_16x16x32_bf16 v[60:63], a[108:111], a[172:175], v[60:63]
v_mul_f32 v7, v18, v45
v_fma_f32 v6, -v19, v45, v6
v_mfma_f32_16x16x32_bf16 v[56:59], a[104:107], a[172:175], v[56:59]
ds_read_b128 a[148:151], v244 offset:6144
v_fmac_f32 v7, v19, v33
v_mfma_f32_16x16x32_bf16 v[56:59], a[96:99], a[168:171], v[56:59]
s_waitcnt lgkmcnt(4)
v_fma_f32 v218, v16, v4, v6
v_fma_f32 v219, v16, v5, v7
v_mfma_f32_16x16x32_bf16 v[56:59], v[104:107], a[176:179], v[56:59]
s_mul_i32 s54, s59, 4608
ds_read_b128 a[152:155], v250 offset:14336
v_fma_f32 v218, -v17, v5, v218
v_mfma_f32_16x16x32_bf16 v[56:59], v[108:111], a[180:183], v[56:59]
s_add_u32 s54, s54, s71
v_fmac_f32 v219, v17, v4
v_mul_f32 v88, v18, v34
v_mfma_f32_16x16x32_bf16 v[60:63], v[100:103], a[180:183], v[60:63]
s_addk_i32 m0, 0x2000
ds_read_b128 a[156:159], v244 offset:14336
v_mul_f32 v89, v18, v46
v_mfma_f32_16x16x32_bf16 v[60:63], v[96:99], a[176:179], v[60:63]
s_waitcnt lgkmcnt(4)
buffer_load_dwordx4 v254, s[8:11], s54 offen  lds
v_fma_f32 v88, -v19, v46, v88
v_mfma_f32_16x16x32_bf16 v[60:63], v[112:115], a[184:187], v[60:63]
ds_read_b128 a[160:163], v250 offset:22528
v_fmac_f32 v89, v19, v34
v_mfma_f32_16x16x32_bf16 v[60:63], v[116:119], a[188:191], v[60:63]
v_fma_f32 v212, v16, v218, v88
v_fma_f32 v213, v16, v219, v89
v_mfma_f32_16x16x32_bf16 v[56:59], v[124:127], a[188:191], v[56:59]
ds_read_b128 a[164:167], v244 offset:22528
v_fma_f32 v212, -v17, v219, v212
v_mfma_f32_16x16x32_bf16 v[56:59], v[120:123], a[184:187], v[56:59]
s_waitcnt lgkmcnt(4)
v_fmac_f32 v213, v17, v218
v_mul_f32 v90, v18, v35
v_mfma_f32_16x16x32_bf16 v[72:75], a[48:51], a[144:147], v[72:75]
ds_read_b128 a[168:171], v250 offset:30720
v_mul_f32 v91, v18, v47
v_mfma_f32_16x16x32_bf16 v[72:75], a[56:59], a[148:151], v[72:75]
v_fma_f32 v90, -v19, v47, v90
v_fmac_f32 v91, v19, v35
v_mfma_f32_16x16x32_bf16 v[76:79], a[60:63], a[148:151], v[76:79]
ds_read_b128 a[172:175], v244 offset:30720
v_fma_f32 v218, v16, v212, v90
v_mfma_f32_16x16x32_bf16 v[76:79], a[52:55], a[144:147], v[76:79]
s_waitcnt lgkmcnt(4)
buffer_load_dwordx4 v253, s[8:11], s54 offen offset:1024  lds
v_fma_f32 v219, v16, v213, v91
v_mfma_f32_16x16x32_bf16 v[76:79], a[68:71], a[152:155], v[76:79]
ds_read_b128 a[176:179], v250 offset:38912
v_fma_f32 v218, -v17, v213, v218
v_mfma_f32_16x16x32_bf16 v[76:79], a[76:79], a[156:159], v[76:79]
v_fmac_f32 v219, v17, v212
v_mul_f32 v32, v18, v36
v_mfma_f32_16x16x32_bf16 v[72:75], a[72:75], a[156:159], v[72:75]
ds_read_b128 a[180:183], v244 offset:38912
v_mul_f32 v33, v18, v48
v_mfma_f32_16x16x32_bf16 v[72:75], a[64:67], a[152:155], v[72:75]
s_waitcnt lgkmcnt(4)
v_fma_f32 v32, -v19, v48, v32
v_fmac_f32 v33, v19, v36
v_mfma_f32_16x16x32_bf16 v[72:75], a[80:83], a[160:163], v[72:75]
s_mul_i32 s55, s60, 4608
ds_read_b128 a[184:187], v250 offset:47104
v_fma_f32 v212, v16, v218, v32
v_mfma_f32_16x16x32_bf16 v[72:75], a[88:91], a[164:167], v[72:75]
s_add_u32 s55, s55, s71
v_fma_f32 v213, v16, v219, v33
v_fma_f32 v212, -v17, v219, v212
v_mfma_f32_16x16x32_bf16 v[76:79], a[92:95], a[164:167], v[76:79]
s_waitcnt vmcnt(11)
ds_read_b128 a[188:191], v244 offset:47104
v_fmac_f32 v213, v17, v218
v_mfma_f32_16x16x32_bf16 v[76:79], a[84:87], a[160:163], v[76:79]
s_waitcnt lgkmcnt(4)
v_mul_f32 v34, v18, v37
v_mul_f32 v35, v18, v49
v_mfma_f32_16x16x32_bf16 v[76:79], a[100:103], a[168:171], v[76:79]
s_barrier
ds_read_b64_tr_b16 a[144:145], v237 offset:0
v_fma_f32 v34, -v19, v49, v34
v_mfma_f32_16x16x32_bf16 v[76:79], a[108:111], a[172:175], v[76:79]
s_addk_i32 m0, 0x2000
ds_read_b64_tr_b16 a[146:147], v237 offset:2048
v_fmac_f32 v35, v19, v37
v_mfma_f32_16x16x32_bf16 v[72:75], a[104:107], a[172:175], v[72:75]
ds_read_b64_tr_b16 a[148:149], v237 offset:4096
buffer_load_dwordx4 v254, s[8:11], s55 offen  lds
v_mfma_f32_16x16x32_bf16 v[72:75], a[96:99], a[168:171], v[72:75]
s_waitcnt lgkmcnt(5)
ds_read_b64_tr_b16 a[150:151], v237 offset:6144
v_fma_f32 v218, v16, v212, v34
v_mfma_f32_16x16x32_bf16 v[72:75], v[104:107], a[176:179], v[72:75]
ds_read_b64_tr_b16 a[152:153], v237 offset:8192
s_waitcnt vmcnt(7)
v_cmp_gt_u32 vcc, 1, v232
v_mfma_f32_16x16x32_bf16 v[72:75], v[108:111], a[180:183], v[72:75]
s_cbranch_vccnz LM_go
LM_go_b:
ds_read_b64_tr_b16 a[154:155], v237 offset:10240
v_fma_f32 v219, v16, v213, v35
v_fma_f32 v218, -v17, v213, v218
v_mfma_f32_16x16x32_bf16 v[76:79], v[100:103], a[180:183], v[76:79]
s_lshl_b32 s86, s49, 9
ds_read_b64_tr_b16 a[156:157], v237 offset:12288
v_fmac_f32 v219, v17, v212
v_mfma_f32_16x16x32_bf16 v[76:79], v[96:99], a[176:179], v[76:79]
s_waitcnt lgkmcnt(7)
ds_read_b64_tr_b16 a[158:159], v237 offset:14336
v_mul_f32 v44, v18, v38
v_mfma_f32_16x16x32_bf16 v[76:79], v[112:115], a[184:187], v[76:79]
s_sub_u32 s86, 7680, s86
ds_read_b64_tr_b16 a[160:161], v237 offset:16384
v_mul_f32 v45, v18, v50
v_mfma_f32_16x16x32_bf16 v[76:79], v[116:119], a[188:191], v[76:79]
s_lshl_b32 s87, s50, 13
ds_read_b64_tr_b16 a[162:163], v237 offset:18432
v_fma_f32 v44, -v19, v50, v44
v_mfma_f32_16x16x32_bf16 v[72:75], v[124:127], a[188:191], v[72:75]
s_add_u32 s86, s86, s87
ds_read_b64_tr_b16 a[164:165], v237 offset:20480
buffer_load_dwordx4 v253, s[8:11], s55 offen offset:1024  lds
v_mfma_f32_16x16x32_bf16 v[72:75], v[120:123], a[184:187], v[72:75]
s_waitcnt lgkmcnt(7)
ds_read_b64_tr_b16 a[166:167], v237 offset:22528
v_lshl_add_u32 v249, v255, 3, s86
v_mfma_f32_16x16x32_bf16 v[92:95], a[144:147], a[0:3], 0
s_mul_i32 s54, s61, 4608
ds_read_b64_tr_b16 a[168:169], v237 offset:24576
v_fmac_f32 v45, v19, v38
v_mfma_f32_16x16x32_bf16 v[92:95], a[148:151], a[8:11], v[92:95]
s_add_u32 s54, s54, s71
ds_read_b64_tr_b16 a[170:171], v237 offset:26624
v_fma_f32 v212, v16, v218, v44
v_mfma_f32_16x16x32_bf16 v[128:131], a[148:151], a[12:15], 0
s_addk_i32 m0, 0x2000
ds_read_b64_tr_b16 a[172:173], v237 offset:28672
v_fma_f32 v213, v16, v219, v45
v_mfma_f32_16x16x32_bf16 v[128:131], a[144:147], a[4:7], v[128:131]
s_waitcnt lgkmcnt(7)
ds_read_b64_tr_b16 a[174:175], v237 offset:30720
buffer_load_dwordx4 v254, s[8:11], s54 offen  lds
v_mfma_f32_16x16x32_bf16 v[128:131], a[152:155], a[20:23], v[128:131]
ds_read_b64_tr_b16 a[176:177], v237 offset:32768
v_fma_f32 v212, -v17, v219, v212
v_mfma_f32_16x16x32_bf16 v[128:131], a[156:159], a[28:31], v[128:131]
ds_read_b64_tr_b16 a[178:179], v237 offset:34816
v_fmac_f32 v213, v17, v218
v_mfma_f32_16x16x32_bf16 v[92:95], a[156:159], a[24:27], v[92:95]
ds_read_b64_tr_b16 a[180:181], v237 offset:36864
v_mul_f32 v46, v18, v39
v_mfma_f32_16x16x32_bf16 v[92:95], a[152:155], a[16:19], v[92:95]
s_waitcnt lgkmcnt(7)
ds_read_b64_tr_b16 a[182:183], v237 offset:38912
v_mul_f32 v47, v18, v51
v_mfma_f32_16x16x32_bf16 v[92:95], a[160:163], a[32:35], v[92:95]
ds_read_b64_tr_b16 a[184:185], v237 offset:40960
v_fma_f32 v46, -v19, v51, v46
v_mfma_f32_16x16x32_bf16 v[92:95], a[164:167], a[40:43], v[92:95]
ds_read_b64_tr_b16 a[186:187], v237 offset:43008
v_fmac_f32 v47, v19, v39
v_mfma_f32_16x16x32_bf16 v[128:131], a[164:167], a[44:47], v[128:131]
ds_read_b64_tr_b16 a[188:189], v237 offset:45056
v_fma_f32 v218, v16, v212, v46
v_mfma_f32_16x16x32_bf16 v[128:131], a[160:163], a[36:39], v[128:131]
s_waitcnt lgkmcnt(7)
ds_read_b64_tr_b16 a[190:191], v237 offset:47104
buffer_load_dwordx4 v253, s[8:11], s54 offen offset:1024  lds
v_mfma_f32_16x16x32_bf16 v[128:131], a[168:171], a[52:55], v[128:131]
ds_read_b64_tr_b16 a[144:145], v239 offset:0
v_fma_f32 v219, v16, v213, v47
v_mfma_f32_16x16x32_bf16 v[128:131], a[172:175], a[60:63], v[128:131]
ds_read_b64_tr_b16 a[146:147], v239 offset:2048
v_fma_f32 v218, -v17, v213, v218
v_mfma_f32_16x16x32_bf16 v[92:95], a[172:175], a[56:59], v[92:95]
ds_read_b64_tr_b16 a[148:149], v239 offset:4096
v_fmac_f32 v219, v17, v212
v_mfma_f32_16x16x32_bf16 v[92:95], a[168:171], a[48:51], v[92:95]
s_waitcnt lgkmcnt(7)
ds_read_b64_tr_b16 a[150:151], v239 offset:6144
v_mul_f32 v36, v22, v56
v_mfma_f32_16x16x32_bf16 v[92:95], a[176:179], a[64:67], v[92:95]
s_mul_i32 s55, s62, 4608
ds_read_b64_tr_b16 a[152:153], v239 offset:8192
v_mul_f32 v37, v22, v72
v_mfma_f32_16x16x32_bf16 v[92:95], a[180:183], a[72:75], v[92:95]
s_add_u32 s55, s55, s71
ds_read_b64_tr_b16 a[154:155], v239 offset:10240
v_fma_f32 v36, -v23, v72, v36
v_mfma_f32_16x16x32_bf16 v[128:131], a[180:183], a[76:79], v[128:131]
s_addk_i32 m0, 0x2000
ds_read_b64_tr_b16 a[156:157], v239 offset:12288
v_fmac_f32 v37, v23, v56
v_mfma_f32_16x16x32_bf16 v[128:131], a[176:179], a[68:71], v[128:131]
s_waitcnt lgkmcnt(7)
ds_read_b64_tr_b16 a[158:159], v239 offset:14336
buffer_load_dwordx4 v254, s[8:11], s55 offen  lds
v_mfma_f32_16x16x32_bf16 v[128:131], a[184:187], a[84:87], v[128:131]
ds_read_b64_tr_b16 a[160:161], v239 offset:16384
v_mul_f32 v38, v22, v57
v_mfma_f32_16x16x32_bf16 v[128:131], a[188:191], a[92:95], v[128:131]
ds_read_b64_tr_b16 a[162:163], v239 offset:18432
v_mul_f32 v39, v22, v73
v_mfma_f32_16x16x32_bf16 v[92:95], a[188:191], a[88:91], v[92:95]
ds_read_b64_tr_b16 a[164:165], v239 offset:20480
v_fma_f32 v38, -v23, v73, v38
v_mfma_f32_16x16x32_bf16 v[92:95], a[184:187], a[80:83], v[92:95]
s_waitcnt lgkmcnt(7)
ds_read_b64_tr_b16 a[166:167], v239 offset:22528
v_fmac_f32 v39, v23, v57
v_mfma_f32_16x16x32_bf16 v[48:51], a[144:147], a[0:3], 0
ds_read_b64_tr_b16 a[168:169], v239 offset:24576
v_mul_f32 v132, v22, v58
v_mfma_f32_16x16x32_bf16 v[48:51], a[148:151], a[8:11], v[48:51]
ds_read_b64_tr_b16 a[170:171], v239 offset:26624
v_mul_f32 v133, v22, v74
v_mfma_f32_16x16x32_bf16 v[136:139], a[148:151], a[12:15], 0
ds_read_b64_tr_b16 a[172:173], v239 offset:28672
v_fma_f32 v132, -v23, v74, v132
v_mfma_f32_16x16x32_bf16 v[136:139], a[144:147], a[4:7], v[136:139]
s_waitcnt lgkmcnt(7)
ds_read_b64_tr_b16 a[174:175], v239 offset:30720
buffer_load_dwordx4 v253, s[8:11], s55 offen offset:1024  lds
v_mfma_f32_16x16x32_bf16 v[136:139], a[152:155], a[20:23], v[136:139]
ds_read_b64_tr_b16 a[176:177], v239 offset:32768
v_fmac_f32 v133, v23, v58
v_mfma_f32_16x16x32_bf16 v[136:139], a[156:159], a[28:31], v[136:139]
ds_read_b64_tr_b16 a[178:179], v239 offset:34816
v_mul_f32 v134, v22, v59
v_mfma_f32_16x16x32_bf16 v[48:51], a[156:159], a[24:27], v[48:51]
ds_read_b64_tr_b16 a[180:181], v239 offset:36864
v_mul_f32 v135, v22, v75
v_mfma_f32_16x16x32_bf16 v[48:51], a[152:155], a[16:19], v[48:51]
s_waitcnt lgkmcnt(7)
ds_read_b64_tr_b16 a[182:183], v239 offset:38912
v_fma_f32 v134, -v23, v75, v134
v_mfma_f32_16x16x32_bf16 v[48:51], a[160:163], a[32:35], v[48:51]
s_mul_i32 s54, s63, 4608
ds_read_b64_tr_b16 a[184:185], v239 offset:40960
v_fmac_f32 v135, v23, v59
v_mfma_f32_16x16x32_bf16 v[48:51], a[164:167], a[40:43], v[48:51]
s_add_u32 s54, s54, s71
ds_read_b64_tr_b16 a[186:187], v239 offset:43008
v_mul_f32 v56, v22, v60
v_mfma_f32_16x16x32_bf16 v[136:139], a[164:167], a[44:47], v[136:139]
s_addk_i32 m0, 0x2000
ds_read_b64_tr_b16 a[188:189], v239 offset:45056
v_mul_f32 v57, v22, v76
v_mfma_f32_16x16x32_bf16 v[136:139], a[160:163], a[36:39], v[136:139]
s_waitcnt lgkmcnt(7)
ds_read_b64_tr_b16 a[190:191], v239 offset:47104
buffer_load_dwordx4 v254, s[8:11], s54 offen  lds
v_mfma_f32_16x16x32_bf16 v[136:139], a[168:171], a[52:55], v[136:139]
ds_read_b64_tr_b16 a[144:145], v238 offset:0
v_fma_f32 v56, -v23, v76, v56
v_mfma_f32_16x16x32_bf16 v[136:139], a[172:175], a[60:63], v[136:139]
ds_read_b64_tr_b16 a[146:147], v238 offset:2048
v_fmac_f32 v57, v23, v60
v_mfma_f32_16x16x32_bf16 v[48:51], a[172:175], a[56:59], v[48:51]
ds_read_b64_tr_b16 a[148:149], v238 offset:4096
v_mul_f32 v58, v22, v61
v_mfma_f32_16x16x32_bf16 v[48:51], a[168:171], a[48:51], v[48:51]
s_waitcnt lgkmcnt(7)
ds_read_b64_tr_b16 a[150:151], v238 offset:6144
v_mul_f32 v59, v22, v77
v_mfma_f32_16x16x32_bf16 v[48:51], a[176:179], a[64:67], v[48:51]
ds_read_b64_tr_b16 a[152:153], v238 offset:8192
v_fma_f32 v58, -v23, v77, v58
v_mfma_f32_16x16x32_bf16 v[48:51], a[180:183], a[72:75], v[48:51]
ds_read_b64_tr_b16 a[154:155], v238 offset:10240
v_fmac_f32 v59, v23, v61
v_mfma_f32_16x16x32_bf16 v[136:139], a[180:183], a[76:79], v[136:139]
ds_read_b64_tr_b16 a[156:157], v238 offset:12288
v_mul_f32 v72, v22, v62
v_mfma_f32_16x16x32_bf16 v[136:139], a[176:179], a[68:71], v[136:139]
s_waitcnt lgkmcnt(7)
ds_read_b64_tr_b16 a[158:159], v238 offset:14336
buffer_load_dwordx4 v253, s[8:11], s54 offen offset:1024  lds
v_mfma_f32_16x16x32_bf16 v[136:139], a[184:187], a[84:87], v[136:139]
ds_read_b64_tr_b16 a[160:161], v238 offset:16384
v_mul_f32 v73, v22, v78
v_mfma_f32_16x16x32_bf16 v[136:139], a[188:191], a[92:95], v[136:139]
ds_read_b64_tr_b16 a[162:163], v238 offset:18432
v_fma_f32 v72, -v23, v78, v72
v_mfma_f32_16x16x32_bf16 v[48:51], a[188:191], a[88:91], v[48:51]
ds_read_b64_tr_b16 a[164:165], v238 offset:20480
v_fmac_f32 v73, v23, v62
v_mfma_f32_16x16x32_bf16 v[48:51], a[184:187], a[80:83], v[48:51]
s_waitcnt lgkmcnt(7)
ds_read_b64_tr_b16 a[166:167], v238 offset:22528
v_mul_f32 v74, v22, v63
v_mfma_f32_16x16x32_bf16 v[140:143], a[144:147], a[0:3], 0
s_mul_i32 s55, s64, 4608
ds_read_b64_tr_b16 a[168:169], v238 offset:24576
v_mul_f32 v75, v22, v79
v_mfma_f32_16x16x32_bf16 v[140:143], a[148:151], a[8:11], v[140:143]
s_add_u32 s55, s55, s71
ds_read_b64_tr_b16 a[170:171], v238 offset:26624
v_fma_f32 v74, -v23, v79, v74
v_fmac_f32 v75, v23, v63
v_mfma_f32_16x16x32_bf16 v[60:63], a[148:151], a[12:15], 0
s_addk_i32 m0, 0x2000
ds_read_b64_tr_b16 a[172:173], v238 offset:28672
v_pk_fma_f32 v[212:213], v[20:21], v[36:37], v[38:39] op_sel_hi:[0,1,1]
v_pk_fma_f32 v[212:213], v[20:21], v[36:37], v[212:213] op_sel:[1,1,0] op_sel_hi:[1,0,1] neg_lo:[1,0,0]
v_pk_fma_f32 v[208:209], v[20:21], v[212:213], v[132:133] op_sel_hi:[0,1,1]
v_pk_fma_f32 v[208:209], v[20:21], v[212:213], v[208:209] op_sel:[1,1,0] op_sel_hi:[1,0,1] neg_lo:[1,0,0]
v_pk_fma_f32 v[212:213], v[20:21], v[208:209], v[134:135] op_sel_hi:[0,1,1]
v_pk_fma_f32 v[212:213], v[20:21], v[208:209], v[212:213] op_sel:[1,1,0] op_sel_hi:[1,0,1] neg_lo:[1,0,0]
v_pk_fma_f32 v[208:209], v[20:21], v[212:213], v[56:57] op_sel_hi:[0,1,1]
v_pk_fma_f32 v[208:209], v[20:21], v[212:213], v[208:209] op_sel:[1,1,0] op_sel_hi:[1,0,1] neg_lo:[1,0,0]
v_pk_fma_f32 v[212:213], v[20:21], v[208:209], v[58:59] op_sel_hi:[0,1,1]
v_pk_fma_f32 v[212:213], v[20:21], v[208:209], v[212:213] op_sel:[1,1,0] op_sel_hi:[1,0,1] neg_lo:[1,0,0]
v_pk_fma_f32 v[208:209], v[20:21], v[212:213], v[72:73] op_sel_hi:[0,1,1]
v_pk_fma_f32 v[208:209], v[20:21], v[212:213], v[208:209] op_sel:[1,1,0] op_sel_hi:[1,0,1] neg_lo:[1,0,0]
v_pk_fma_f32 v[212:213], v[20:21], v[208:209], v[74:75] op_sel_hi:[0,1,1]
v_pk_fma_f32 v[212:213], v[20:21], v[208:209], v[212:213] op_sel:[1,1,0] op_sel_hi:[1,0,1] neg_lo:[1,0,0]
v_mfma_f32_16x16x32_bf16 v[60:63], a[144:147], a[4:7], v[60:63]
s_waitcnt lgkmcnt(7)
ds_read_b64_tr_b16 a[174:175], v238 offset:30720
buffer_load_dwordx4 v254, s[8:11], s55 offen  lds
v_mfma_f32_16x16x32_bf16 v[60:63], a[152:155], a[20:23], v[60:63]
ds_read_b64_tr_b16 a[176:177], v238 offset:32768
v_permlane32_swap_b32 v226, v218
v_mfma_f32_16x16x32_bf16 v[60:63], a[156:159], a[28:31], v[60:63]
ds_read_b64_tr_b16 a[178:179], v238 offset:34816
v_permlane32_swap_b32 v224, v212
v_mfma_f32_16x16x32_bf16 v[140:143], a[156:159], a[24:27], v[140:143]
ds_read_b64_tr_b16 a[180:181], v238 offset:36864
v_permlane32_swap_b32 v227, v219
v_mfma_f32_16x16x32_bf16 v[140:143], a[152:155], a[16:19], v[140:143]
s_waitcnt lgkmcnt(7)
ds_read_b64_tr_b16 a[182:183], v238 offset:38912
v_permlane32_swap_b32 v225, v213
v_mfma_f32_16x16x32_bf16 v[140:143], a[160:163], a[32:35], v[140:143]
ds_read_b64_tr_b16 a[184:185], v238 offset:40960
v_permlane16_swap_b32 v226, v224
v_mfma_f32_16x16x32_bf16 v[140:143], a[164:167], a[40:43], v[140:143]
ds_read_b64_tr_b16 a[186:187], v238 offset:43008
v_permlane16_swap_b32 v218, v212
v_mfma_f32_16x16x32_bf16 v[60:63], a[164:167], a[44:47], v[60:63]
ds_read_b64_tr_b16 a[188:189], v238 offset:45056
v_permlane16_swap_b32 v227, v225
v_mfma_f32_16x16x32_bf16 v[60:63], a[160:163], a[36:39], v[60:63]
s_waitcnt lgkmcnt(7)
ds_read_b64_tr_b16 a[190:191], v238 offset:47104
buffer_load_dwordx4 v253, s[8:11], s55 offen offset:1024  lds
v_mfma_f32_16x16x32_bf16 v[60:63], a[168:171], a[52:55], v[60:63]
ds_read_b64_tr_b16 a[144:145], v236 offset:0
v_permlane16_swap_b32 v219, v213
v_mfma_f32_16x16x32_bf16 v[60:63], a[172:175], a[60:63], v[60:63]
ds_read_b64_tr_b16 a[146:147], v236 offset:2048
v_fma_f32 v208, v222, v226, v224
v_mfma_f32_16x16x32_bf16 v[140:143], a[172:175], a[56:59], v[140:143]
ds_read_b64_tr_b16 a[148:149], v236 offset:4096
v_fma_f32 v209, v222, v227, v225
v_mfma_f32_16x16x32_bf16 v[140:143], a[168:171], a[48:51], v[140:143]
s_waitcnt lgkmcnt(7)
ds_read_b64_tr_b16 a[150:151], v236 offset:6144
v_fma_f32 v208, -v223, v227, v208
v_mfma_f32_16x16x32_bf16 v[140:143], a[176:179], a[64:67], v[140:143]
s_mul_i32 s54, s65, 4608
ds_read_b64_tr_b16 a[152:153], v236 offset:8192
v_fmac_f32 v209, v223, v226
v_mfma_f32_16x16x32_bf16 v[140:143], a[180:183], a[72:75], v[140:143]
s_add_u32 s54, s54, s71
ds_read_b64_tr_b16 a[154:155], v236 offset:10240
v_fma_f32 v206, v222, v208, v218
v_mfma_f32_16x16x32_bf16 v[60:63], a[180:183], a[76:79], v[60:63]
s_addk_i32 m0, 0x2000
ds_read_b64_tr_b16 a[156:157], v236 offset:12288
v_fma_f32 v207, v222, v209, v219
v_mfma_f32_16x16x32_bf16 v[60:63], a[176:179], a[68:71], v[60:63]
s_waitcnt lgkmcnt(7)
ds_read_b64_tr_b16 a[158:159], v236 offset:14336
buffer_load_dwordx4 v254, s[8:11], s54 offen  lds
v_mfma_f32_16x16x32_bf16 v[60:63], a[184:187], a[84:87], v[60:63]
ds_read_b64_tr_b16 a[160:161], v236 offset:16384
v_fma_f32 v206, -v223, v209, v206
v_mfma_f32_16x16x32_bf16 v[60:63], a[188:191], a[92:95], v[60:63]
ds_read_b64_tr_b16 a[162:163], v236 offset:18432
v_fmac_f32 v207, v223, v208
v_mfma_f32_16x16x32_bf16 v[140:143], a[188:191], a[88:91], v[140:143]
ds_read_b64_tr_b16 a[164:165], v236 offset:20480
v_fma_f32 v208, v222, v206, v212
v_mfma_f32_16x16x32_bf16 v[140:143], a[184:187], a[80:83], v[140:143]
s_waitcnt lgkmcnt(7)
ds_read_b64_tr_b16 a[166:167], v236 offset:22528
v_fma_f32 v209, v222, v207, v213
v_mfma_f32_16x16x32_bf16 v[76:79], a[144:147], a[0:3], 0
ds_read_b64_tr_b16 a[168:169], v236 offset:24576
v_fma_f32 v208, -v223, v207, v208
v_mfma_f32_16x16x32_bf16 v[76:79], a[148:151], a[8:11], v[76:79]
ds_read_b64_tr_b16 a[170:171], v236 offset:26624
v_fmac_f32 v209, v223, v206
v_mfma_f32_16x16x32_bf16 v[144:147], a[148:151], a[12:15], 0
ds_read_b64_tr_b16 a[172:173], v236 offset:28672
ds_write_b64 v240, v[208:209] offset:2048
v_mfma_f32_16x16x32_bf16 v[144:147], a[144:147], a[4:7], v[144:147]
s_waitcnt lgkmcnt(8)
ds_read_b64_tr_b16 a[174:175], v236 offset:30720
buffer_load_dwordx4 v253, s[8:11], s54 offen offset:1024  lds
v_mfma_f32_16x16x32_bf16 v[144:147], a[152:155], a[20:23], v[144:147]
ds_read_b64_tr_b16 a[176:177], v236 offset:32768
v_lshlrev_b32 v232, 3, v255
v_mfma_f32_16x16x32_bf16 v[144:147], a[156:159], a[28:31], v[144:147]
ds_read_b64_tr_b16 a[178:179], v236 offset:34816
v_add_u32 v232, 149504, v232
v_mfma_f32_16x16x32_bf16 v[76:79], a[156:159], a[24:27], v[76:79]
ds_read_b64_tr_b16 a[180:181], v236 offset:36864
v_add_u32 v231, 49152, v237
v_mfma_f32_16x16x32_bf16 v[76:79], a[152:155], a[16:19], v[76:79]
s_waitcnt lgkmcnt(8)
ds_read_b64_tr_b16 a[182:183], v236 offset:38912
v_add_u32 v228, 49152, v239
v_mfma_f32_16x16x32_bf16 v[76:79], a[160:163], a[32:35], v[76:79]
s_mul_i32 s55, s66, 4608
ds_read_b64_tr_b16 a[184:185], v236 offset:40960
v_add_u32 v213, 49152, v238
v_mfma_f32_16x16x32_bf16 v[76:79], a[164:167], a[40:43], v[76:79]
s_add_u32 s55, s55, s71
ds_read_b64_tr_b16 a[186:187], v236 offset:43008
v_add_u32 v212, 49152, v236
v_mfma_f32_16x16x32_bf16 v[144:147], a[164:167], a[44:47], v[144:147]
s_waitcnt vmcnt(10)
ds_read_b64_tr_b16 a[188:189], v236 offset:45056
v_add_u32 v209, 98304, v237
v_mfma_f32_16x16x32_bf16 v[144:147], a[160:163], a[36:39], v[144:147]
s_waitcnt lgkmcnt(7)
ds_read_b64_tr_b16 a[190:191], v236 offset:47104
v_mfma_f32_16x16x32_bf16 v[144:147], a[168:171], a[52:55], v[144:147]
s_barrier
ds_read_b64_tr_b16 a[144:145], v231 offset:0
v_add_u32 v208, 98304, v239
v_mfma_f32_16x16x32_bf16 v[144:147], a[172:175], a[60:63], v[144:147]
s_addk_i32 m0, 0x2000
ds_read_b64_tr_b16 a[146:147], v231 offset:2048
ds_read2st64_b64 v[148:151], v232 offset0:0 offset1:8
v_mfma_f32_16x16x32_bf16 v[76:79], a[172:175], a[56:59], v[76:79]
ds_read_b64_tr_b16 a[148:149], v231 offset:4096
buffer_load_dwordx4 v254, s[8:11], s55 offen  lds
v_mfma_f32_16x16x32_bf16 v[76:79], a[168:171], a[48:51], v[76:79]
s_waitcnt lgkmcnt(8)
ds_read_b64_tr_b16 a[150:151], v231 offset:6144
ds_read2st64_b64 v[152:155], v232 offset0:16 offset1:24
v_mfma_f32_16x16x32_bf16 v[76:79], a[176:179], a[64:67], v[76:79]
ds_read_b64_tr_b16 a[152:153], v231 offset:8192
v_add_u32 v207, 98304, v238
v_mfma_f32_16x16x32_bf16 v[76:79], a[180:183], a[72:75], v[76:79]
ds_read_b64_tr_b16 a[154:155], v231 offset:10240
v_add_u32 v206, 98304, v236
v_mfma_f32_16x16x32_bf16 v[144:147], a[180:183], a[76:79], v[144:147]
ds_read_b64_tr_b16 a[156:157], v231 offset:12288
v_lshrrev_b32 v205, 2, v246
v_mfma_f32_16x16x32_bf16 v[144:147], a[176:179], a[68:71], v[144:147]
s_waitcnt lgkmcnt(9)
ds_read_b64_tr_b16 a[158:159], v231 offset:14336
v_cmp_eq_u32 s[90:91], v205, v245
v_mfma_f32_16x16x32_bf16 v[144:147], a[184:187], a[84:87], v[144:147]
ds_read_b64_tr_b16 a[160:161], v231 offset:16384
v_and_b32 v205, 1, v255
v_mfma_f32_16x16x32_bf16 v[144:147], a[188:191], a[92:95], v[144:147]
ds_read_b64_tr_b16 a[162:163], v231 offset:18432
v_lshlrev_b32 v205, 4, v205
v_mfma_f32_16x16x32_bf16 v[76:79], a[188:191], a[88:91], v[76:79]
ds_read_b64_tr_b16 a[164:165], v231 offset:20480
buffer_load_dwordx4 v253, s[8:11], s55 offen offset:1024  lds
v_mfma_f32_16x16x32_bf16 v[76:79], a[184:187], a[80:83], v[76:79]
s_waitcnt lgkmcnt(8)
ds_read_b64_tr_b16 a[166:167], v231 offset:22528
v_fma_f32 v202, v220, v148, v150
v_mfma_f32_16x16x32_bf16 v[92:95], a[144:147], a[96:99], v[92:95]
s_mul_i32 s54, s58, 4608
ds_read_b64_tr_b16 a[168:169], v228 offset:0
v_fma_f32 v203, v220, v149, v151
v_mfma_f32_16x16x32_bf16 v[92:95], a[148:151], a[104:107], v[92:95]
s_add_u32 s54, s54, s72
ds_read_b64_tr_b16 a[170:171], v228 offset:2048
v_fma_f32 v202, -v221, v149, v202
v_mfma_f32_16x16x32_bf16 v[128:131], a[148:151], a[108:111], v[128:131]
s_mov_b32 m0, s53
ds_read_b64_tr_b16 a[172:173], v228 offset:4096
v_fmac_f32 v203, v221, v148
v_mfma_f32_16x16x32_bf16 v[128:131], a[144:147], a[100:103], v[128:131]
s_waitcnt lgkmcnt(7)
ds_read_b64_tr_b16 a[174:175], v228 offset:6144
buffer_load_dwordx4 v254, s[8:11], s54 offen  lds
v_mfma_f32_16x16x32_bf16 v[128:131], a[152:155], v[96:99], v[128:131]
ds_read_b64_tr_b16 a[176:177], v228 offset:8192
v_fma_f32 v200, v220, v202, v152
v_mfma_f32_16x16x32_bf16 v[128:131], a[156:159], v[100:103], v[128:131]
ds_read_b64_tr_b16 a[178:179], v228 offset:10240
v_fma_f32 v201, v220, v203, v153
v_mfma_f32_16x16x32_bf16 v[92:95], a[156:159], v[108:111], v[92:95]
ds_read_b64_tr_b16 a[180:181], v228 offset:12288
v_fma_f32 v200, -v221, v203, v200
v_mfma_f32_16x16x32_bf16 v[92:95], a[152:155], v[104:107], v[92:95]
s_waitcnt lgkmcnt(7)
ds_read_b64_tr_b16 a[182:183], v228 offset:14336
v_fmac_f32 v201, v221, v202
v_mfma_f32_16x16x32_bf16 v[92:95], a[160:163], v[120:123], v[92:95]
ds_read_b64_tr_b16 a[184:185], v228 offset:16384
v_fma_f32 v198, v220, v200, v154
v_mfma_f32_16x16x32_bf16 v[92:95], a[164:167], v[124:127], v[92:95]
ds_read_b64_tr_b16 a[186:187], v228 offset:18432
v_fma_f32 v199, v220, v201, v155
v_mfma_f32_16x16x32_bf16 v[128:131], a[164:167], v[116:119], v[128:131]
ds_read_b64_tr_b16 a[188:189], v228 offset:20480
v_fma_f32 v198, -v221, v201, v198
v_mfma_f32_16x16x32_bf16 v[128:131], a[160:163], v[112:115], v[128:131]
s_waitcnt lgkmcnt(7)
ds_read_b64_tr_b16 a[190:191], v228 offset:22528
buffer_load_dwordx4 v253, s[8:11], s54 offen offset:1024  lds
v_mfma_f32_16x16x32_bf16 v[48:51], a[168:171], a[96:99], v[48:51]
ds_read_b64_tr_b16 a[144:145], v213 offset:0
v_fmac_f32 v199, v221, v200
v_mfma_f32_16x16x32_bf16 v[48:51], a[172:175], a[104:107], v[48:51]
buffer_store_dwordx2 v[198:199], v249, s[40:43], 0 offen sc1
ds_read_b64_tr_b16 a[146:147], v213 offset:2048
v_mfma_f32_16x16x32_bf16 v[136:139], a[172:175], a[108:111], v[136:139]
s_cmp_eq_u32 s50, 1
s_cselect_b64 s[88:89], -1, 0
ds_read_b64_tr_b16 a[148:149], v213 offset:4096
v_mfma_f32_16x16x32_bf16 v[136:139], a[168:171], a[100:103], v[136:139]
s_waitcnt lgkmcnt(7)
ds_read_b64_tr_b16 a[150:151], v213 offset:6144
v_cndmask_b32 v220, 0, v148, s[88:89]
v_mfma_f32_16x16x32_bf16 v[136:139], a[176:179], v[96:99], v[136:139]
s_mul_i32 s55, s59, 4608
ds_read_b64_tr_b16 a[152:153], v213 offset:8192
v_cndmask_b32 v221, 0, v149, s[88:89]
v_mfma_f32_16x16x32_bf16 v[136:139], a[180:183], v[100:103], v[136:139]
LM_p4:
s_cbranch_execz LM_v105
s_add_u32 s55, s55, s72
ds_read_b64_tr_b16 a[154:155], v213 offset:10240
v_mov_b32 v249, 0x3f80
v_mfma_f32_16x16x32_bf16 v[48:51], a[180:183], v[108:111], v[48:51]
s_addk_i32 m0, 0x2000
ds_read_b64_tr_b16 a[156:157], v213 offset:12288
v_lshlrev_b32 v249, v205, v249
v_mfma_f32_16x16x32_bf16 v[48:51], a[176:179], v[104:107], v[48:51]
s_waitcnt lgkmcnt(7)
ds_read_b64_tr_b16 a[158:159], v213 offset:14336
buffer_load_dwordx4 v254, s[8:11], s55 offen  lds
v_mfma_f32_16x16x32_bf16 v[48:51], a[184:187], v[120:123], v[48:51]
s_cmp_eq_u32 s50, 2
s_cselect_b64 s[88:89], -1, 0
ds_read_b64_tr_b16 a[160:161], v213 offset:16384
v_mfma_f32_16x16x32_bf16 v[48:51], a[188:191], v[124:127], v[48:51]
ds_read_b64_tr_b16 a[162:163], v213 offset:18432
v_cndmask_b32 v220, v220, v202, s[88:89]
v_mfma_f32_16x16x32_bf16 v[136:139], a[188:191], v[116:119], v[136:139]
ds_read_b64_tr_b16 a[164:165], v213 offset:20480
v_cndmask_b32 v221, v221, v203, s[88:89]
v_mfma_f32_16x16x32_bf16 v[136:139], a[184:187], v[112:115], v[136:139]
s_waitcnt lgkmcnt(7)
ds_read_b64_tr_b16 a[166:167], v213 offset:22528
v_cndmask_b32 v249, 0, v249, s[90:91]
v_mfma_f32_16x16x32_bf16 v[140:143], a[144:147], a[96:99], v[140:143]
s_cmp_eq_u32 s50, 3
s_cselect_b64 s[88:89], -1, 0
ds_read_b64_tr_b16 a[168:169], v212 offset:0
v_mfma_f32_16x16x32_bf16 v[140:143], a[148:151], a[104:107], v[140:143]
ds_read_b64_tr_b16 a[170:171], v212 offset:2048
v_cndmask_b32 v220, v220, v200, s[88:89]
v_mfma_f32_16x16x32_bf16 v[60:63], a[148:151], a[108:111], v[60:63]
ds_read_b64_tr_b16 a[172:173], v212 offset:4096
v_cndmask_b32 v221, v221, v201, s[88:89]
v_mfma_f32_16x16x32_bf16 v[60:63], a[144:147], a[100:103], v[60:63]
s_waitcnt lgkmcnt(7)
ds_read_b64_tr_b16 a[174:175], v212 offset:6144
buffer_load_dwordx4 v253, s[8:11], s55 offen offset:1024  lds
v_mfma_f32_16x16x32_bf16 v[60:63], a[152:155], v[96:99], v[60:63]
s_lshl_b32 s67, s49, 9
ds_read_b64_tr_b16 a[176:177], v212 offset:8192
v_and_b32 v205, 2, v255
v_mfma_f32_16x16x32_bf16 v[60:63], a[156:159], v[100:103], v[60:63]
s_sub_u32 s67, 8192, s67
ds_read_b64_tr_b16 a[178:179], v212 offset:10240
v_cmp_eq_u32 s[90:91], 0, v205
v_mfma_f32_16x16x32_bf16 v[140:143], a[156:159], v[108:111], v[140:143]
s_add_u32 s67, s67, s53
ds_read_b64_tr_b16 a[180:181], v212 offset:12288
v_lshl_add_u32 v204, v255, 3, s67
v_mfma_f32_16x16x32_bf16 v[140:143], a[152:155], v[104:107], v[140:143]
s_waitcnt lgkmcnt(7)
ds_read_b64_tr_b16 a[182:183], v212 offset:14336
v_cndmask_b32 v205, 0, v249, s[90:91]
v_mfma_f32_16x16x32_bf16 v[140:143], a[160:163], v[120:123], v[140:143]
s_mul_i32 s54, s60, 4608
ds_read_b64_tr_b16 a[184:185], v212 offset:16384
v_cndmask_b32 v249, v249, 0, s[90:91]
v_mfma_f32_16x16x32_bf16 v[140:143], a[164:167], v[124:127], v[140:143]
s_add_u32 s54, s54, s72
ds_read_b64_tr_b16 a[186:187], v212 offset:18432
v_accvgpr_write_b32 a224, v205
v_mfma_f32_16x16x32_bf16 v[60:63], a[164:167], v[116:119], v[60:63]
s_addk_i32 m0, 0x2000
ds_read_b64_tr_b16 a[188:189], v212 offset:20480
v_accvgpr_write_b32 a225, v249
v_mfma_f32_16x16x32_bf16 v[60:63], a[160:163], v[112:115], v[60:63]
s_waitcnt lgkmcnt(7)
ds_read_b64_tr_b16 a[190:191], v212 offset:22528
buffer_load_dwordx4 v254, s[8:11], s54 offen  lds
v_mfma_f32_16x16x32_bf16 v[76:79], a[168:171], a[96:99], v[76:79]
ds_read_b64_tr_b16 a[144:145], v231 offset:24576
v_accvgpr_write_b32 a226, v205
v_mfma_f32_16x16x32_bf16 v[76:79], a[172:175], a[104:107], v[76:79]
ds_read_b64_tr_b16 a[146:147], v231 offset:26624
v_accvgpr_write_b32 a227, v249
v_mfma_f32_16x16x32_bf16 v[144:147], a[172:175], a[108:111], v[144:147]
ds_read_b64_tr_b16 a[148:149], v231 offset:28672
v_accvgpr_write_b32 a222, 0
v_mfma_f32_16x16x32_bf16 v[144:147], a[168:171], a[100:103], v[144:147]
s_waitcnt lgkmcnt(7)
ds_read_b64_tr_b16 a[150:151], v231 offset:30720
v_accvgpr_write_b32 a223, 0
v_mfma_f32_16x16x32_bf16 v[144:147], a[176:179], v[96:99], v[144:147]
ds_read_b64_tr_b16 a[152:153], v231 offset:32768
v_accvgpr_write_b32 a228, 0
v_mfma_f32_16x16x32_bf16 v[144:147], a[180:183], v[100:103], v[144:147]
ds_read_b64_tr_b16 a[154:155], v231 offset:34816
v_accvgpr_write_b32 a229, 0
v_mfma_f32_16x16x32_bf16 v[76:79], a[180:183], v[108:111], v[76:79]
ds_read_b64_tr_b16 a[156:157], v231 offset:36864
v_exp_f32 v249, v92
v_mfma_f32_16x16x32_bf16 v[76:79], a[176:179], v[104:107], v[76:79]
s_waitcnt lgkmcnt(7)
ds_read_b64_tr_b16 a[158:159], v231 offset:38912
buffer_load_dwordx4 v253, s[8:11], s54 offen offset:1024  lds
v_mfma_f32_16x16x32_bf16 v[76:79], a[184:187], v[120:123], v[76:79]
ds_read_b64_tr_b16 a[160:161], v231 offset:40960
v_exp_f32 v205, v93
v_mfma_f32_16x16x32_bf16 v[76:79], a[188:191], v[124:127], v[76:79]
ds_read_b64_tr_b16 a[162:163], v231 offset:43008
v_add_f32 v249, 1.0, v249
v_mfma_f32_16x16x32_bf16 v[144:147], a[188:191], v[116:119], v[144:147]
ds_read_b64_tr_b16 a[164:165], v231 offset:45056
v_exp_f32 v203, v94
v_mfma_f32_16x16x32_bf16 v[144:147], a[184:187], v[112:115], v[144:147]
s_waitcnt lgkmcnt(7)
ds_read_b64_tr_b16 a[166:167], v231 offset:47104
v_rcp_f32 v249, v249
v_mfma_f32_16x16x32_bf16 v[148:151], a[144:147], a[0:3], 0
s_mul_i32 s55, s61, 4608
ds_read_b64_tr_b16 a[168:169], v228 offset:24576
v_add_f32 v205, 1.0, v205
v_mfma_f32_16x16x32_bf16 v[148:151], a[148:151], a[8:11], v[148:151]
s_add_u32 s55, s55, s72
ds_read_b64_tr_b16 a[170:171], v228 offset:26624
v_exp_f32 v202, v95
v_mfma_f32_16x16x32_bf16 v[152:155], a[148:151], a[12:15], 0
s_addk_i32 m0, 0x2000
ds_read_b64_tr_b16 a[172:173], v228 offset:28672
v_mul_f32 v249, v249, v92
v_mfma_f32_16x16x32_bf16 v[152:155], a[144:147], a[4:7], v[152:155]
s_waitcnt lgkmcnt(7)
ds_read_b64_tr_b16 a[174:175], v228 offset:30720
buffer_load_dwordx4 v254, s[8:11], s55 offen  lds
v_mfma_f32_16x16x32_bf16 v[152:155], a[152:155], a[20:23], v[152:155]
ds_read_b64_tr_b16 a[176:177], v228 offset:32768
v_rcp_f32 v205, v205
v_mfma_f32_16x16x32_bf16 v[152:155], a[156:159], a[28:31], v[152:155]
ds_read_b64_tr_b16 a[178:179], v228 offset:34816
v_add_f32 v203, 1.0, v203
v_mfma_f32_16x16x32_bf16 v[148:151], a[156:159], a[24:27], v[148:151]
ds_read_b64_tr_b16 a[180:181], v228 offset:36864
v_exp_f32 v201, v128
v_mfma_f32_16x16x32_bf16 v[148:151], a[152:155], a[16:19], v[148:151]
s_waitcnt lgkmcnt(7)
ds_read_b64_tr_b16 a[182:183], v228 offset:38912
v_mul_f32 v205, v205, v93
v_mfma_f32_16x16x32_bf16 v[148:151], a[160:163], a[32:35], v[148:151]
ds_read_b64_tr_b16 a[184:185], v228 offset:40960
v_rcp_f32 v203, v203
v_mfma_f32_16x16x32_bf16 v[148:151], a[164:167], a[40:43], v[148:151]
ds_read_b64_tr_b16 a[186:187], v228 offset:43008
v_add_f32 v202, 1.0, v202
v_mfma_f32_16x16x32_bf16 v[152:155], a[164:167], a[44:47], v[152:155]
ds_read_b64_tr_b16 a[188:189], v228 offset:45056
v_cvt_pk_bf16_f32 v156, v249, v205
v_mfma_f32_16x16x32_bf16 v[152:155], a[160:163], a[36:39], v[152:155]
s_waitcnt lgkmcnt(7)
ds_read_b64_tr_b16 a[190:191], v228 offset:47104
buffer_load_dwordx4 v253, s[8:11], s55 offen offset:1024  lds
v_mfma_f32_16x16x32_bf16 v[160:163], a[168:171], a[0:3], 0
ds_read_b64_tr_b16 a[144:145], v213 offset:24576
v_exp_f32 v249, v129
v_mfma_f32_16x16x32_bf16 v[160:163], a[172:175], a[8:11], v[160:163]
ds_read_b64_tr_b16 a[146:147], v213 offset:26624
v_mul_f32 v203, v203, v94
v_mfma_f32_16x16x32_bf16 v[164:167], a[172:175], a[12:15], 0
ds_read_b64_tr_b16 a[148:149], v213 offset:28672
v_rcp_f32 v202, v202
v_mfma_f32_16x16x32_bf16 v[164:167], a[168:171], a[4:7], v[164:167]
s_waitcnt lgkmcnt(7)
ds_read_b64_tr_b16 a[150:151], v213 offset:30720
v_add_f32 v201, 1.0, v201
v_mfma_f32_16x16x32_bf16 v[164:167], a[176:179], a[20:23], v[164:167]
s_mul_i32 s54, s62, 4608
ds_read_b64_tr_b16 a[152:153], v213 offset:32768
v_exp_f32 v205, v130
v_mfma_f32_16x16x32_bf16 v[164:167], a[180:183], a[28:31], v[164:167]
s_add_u32 s54, s54, s72
ds_read_b64_tr_b16 a[154:155], v213 offset:34816
v_mul_f32 v202, v202, v95
v_mfma_f32_16x16x32_bf16 v[160:163], a[180:183], a[24:27], v[160:163]
s_addk_i32 m0, 0x2000
ds_read_b64_tr_b16 a[156:157], v213 offset:36864
v_rcp_f32 v201, v201
v_mfma_f32_16x16x32_bf16 v[160:163], a[176:179], a[16:19], v[160:163]
s_waitcnt lgkmcnt(7)
ds_read_b64_tr_b16 a[158:159], v213 offset:38912
buffer_load_dwordx4 v254, s[8:11], s54 offen  lds
v_mfma_f32_16x16x32_bf16 v[160:163], a[184:187], a[32:35], v[160:163]
ds_read_b64_tr_b16 a[160:161], v213 offset:40960
v_add_f32 v249, 1.0, v249
v_mfma_f32_16x16x32_bf16 v[160:163], a[188:191], a[40:43], v[160:163]
ds_read_b64_tr_b16 a[162:163], v213 offset:43008
v_cvt_pk_bf16_f32 v157, v203, v202
v_mfma_f32_16x16x32_bf16 v[164:167], a[188:191], a[44:47], v[164:167]
ds_read_b64_tr_b16 a[164:165], v213 offset:45056
v_exp_f32 v203, v131
v_mfma_f32_16x16x32_bf16 v[164:167], a[184:187], a[36:39], v[164:167]
s_waitcnt lgkmcnt(7)
ds_read_b64_tr_b16 a[166:167], v213 offset:47104
v_mul_f32 v201, v201, v128
v_mfma_f32_16x16x32_bf16 v[92:95], a[144:147], a[0:3], 0
ds_read_b64_tr_b16 a[168:169], v212 offset:24576
v_rcp_f32 v249, v249
v_mfma_f32_16x16x32_bf16 v[92:95], a[148:151], a[8:11], v[92:95]
ds_read_b64_tr_b16 a[170:171], v212 offset:26624
v_add_f32 v205, 1.0, v205
v_mfma_f32_16x16x32_bf16 v[168:171], a[148:151], a[12:15], 0
ds_read_b64_tr_b16 a[172:173], v212 offset:28672
v_exp_f32 v202, v48
v_mfma_f32_16x16x32_bf16 v[168:171], a[144:147], a[4:7], v[168:171]
s_waitcnt lgkmcnt(7)
ds_read_b64_tr_b16 a[174:175], v212 offset:30720
buffer_load_dwordx4 v253, s[8:11], s54 offen offset:1024  lds
v_mfma_f32_16x16x32_bf16 v[168:171], a[152:155], a[20:23], v[168:171]
ds_read_b64_tr_b16 a[176:177], v212 offset:32768
v_mul_f32 v249, v249, v129
v_mfma_f32_16x16x32_bf16 v[168:171], a[156:159], a[28:31], v[168:171]
ds_read_b64_tr_b16 a[178:179], v212 offset:34816
v_rcp_f32 v205, v205
v_mfma_f32_16x16x32_bf16 v[92:95], a[156:159], a[24:27], v[92:95]
ds_read_b64_tr_b16 a[180:181], v212 offset:36864
v_add_f32 v203, 1.0, v203
v_mfma_f32_16x16x32_bf16 v[92:95], a[152:155], a[16:19], v[92:95]
s_waitcnt lgkmcnt(7)
ds_read_b64_tr_b16 a[182:183], v212 offset:38912
v_cvt_pk_bf16_f32 v172, v201, v249
v_mfma_f32_16x16x32_bf16 v[92:95], a[160:163], a[32:35], v[92:95]
s_mul_i32 s55, s63, 4608
ds_read_b64_tr_b16 a[184:185], v212 offset:40960
v_exp_f32 v249, v49
v_mfma_f32_16x16x32_bf16 v[92:95], a[164:167], a[40:43], v[92:95]
s_add_u32 s55, s55, s72
ds_read_b64_tr_b16 a[186:187], v212 offset:43008
v_mul_f32 v205, v205, v130
v_mfma_f32_16x16x32_bf16 v[168:171], a[164:167], a[44:47], v[168:171]
s_waitcnt vmcnt(11)
ds_read_b64_tr_b16 a[188:189], v212 offset:45056
v_rcp_f32 v203, v203
v_mfma_f32_16x16x32_bf16 v[168:171], a[160:163], a[36:39], v[168:171]
s_waitcnt lgkmcnt(7)
ds_read_b64_tr_b16 a[190:191], v212 offset:47104
v_add_f32 v202, 1.0, v202
v_mfma_f32_16x16x32_bf16 v[176:179], a[168:171], a[0:3], 0
s_barrier
ds_read_b64_tr_b16 a[144:145], v209 offset:0
v_exp_f32 v201, v50
v_mfma_f32_16x16x32_bf16 v[176:179], a[172:175], a[8:11], v[176:179]
s_addk_i32 m0, 0x2000
ds_read_b64_tr_b16 a[146:147], v209 offset:2048
v_mul_f32 v203, v203, v131
v_mfma_f32_16x16x32_bf16 v[128:131], a[172:175], a[12:15], 0
ds_read_b64_tr_b16 a[148:149], v209 offset:4096
buffer_load_dwordx4 v254, s[8:11], s55 offen  lds
v_mfma_f32_16x16x32_bf16 v[128:131], a[168:171], a[4:7], v[128:131]
s_waitcnt lgkmcnt(7)
ds_read_b64_tr_b16 a[150:151], v209 offset:6144
v_rcp_f32 v202, v202
v_mfma_f32_16x16x32_bf16 v[128:131], a[176:179], a[20:23], v[128:131]
ds_read_b64_tr_b16 a[152:153], v209 offset:8192
v_add_f32 v249, 1.0, v249
v_mfma_f32_16x16x32_bf16 v[128:131], a[180:183], a[28:31], v[128:131]
ds_read_b64_tr_b16 a[154:155], v209 offset:10240
v_cvt_pk_bf16_f32 v173, v205, v203
v_mfma_f32_16x16x32_bf16 v[176:179], a[180:183], a[24:27], v[176:179]
buffer_load_dwordx2 v[198:199], v204, s[40:43], 0 offen offset:1536 sc1
ds_read_b64_tr_b16 a[156:157], v209 offset:12288
v_mfma_f32_16x16x32_bf16 v[176:179], a[176:179], a[16:19], v[176:179]
s_waitcnt lgkmcnt(7)
buffer_load_dwordx2 v[196:197], v204, s[40:43], 0 offen offset:1024 sc1
ds_read_b64_tr_b16 a[158:159], v209 offset:14336
v_mfma_f32_16x16x32_bf16 v[176:179], a[184:187], a[32:35], v[176:179]
buffer_load_dwordx2 v[194:195], v204, s[40:43], 0 offen offset:512 sc1
ds_read_b64_tr_b16 a[160:161], v209 offset:16384
v_mfma_f32_16x16x32_bf16 v[176:179], a[188:191], a[40:43], v[176:179]
buffer_load_dwordx2 v[192:193], v204, s[40:43], 0 offen offset:0 sc1
ds_read_b64_tr_b16 a[162:163], v209 offset:18432
v_mfma_f32_16x16x32_bf16 v[128:131], a[188:191], a[44:47], v[128:131]
ds_read_b64_tr_b16 a[164:165], v209 offset:20480
buffer_load_dwordx4 v253, s[8:11], s55 offen offset:1024  lds
v_mfma_f32_16x16x32_bf16 v[128:131], a[184:187], a[36:39], v[128:131]
s_waitcnt lgkmcnt(7)
ds_read_b64_tr_b16 a[166:167], v209 offset:22528
v_exp_f32 v205, v51
v_mfma_f32_16x16x32_bf16 v[148:151], a[144:147], a[48:51], v[148:151]
s_mul_i32 s54, s64, 4608
ds_read_b64_tr_b16 a[168:169], v209 offset:24576
v_mul_f32 v202, v202, v48
v_mfma_f32_16x16x32_bf16 v[148:151], a[148:151], a[56:59], v[148:151]
s_add_u32 s54, s54, s72
ds_read_b64_tr_b16 a[170:171], v209 offset:26624
v_rcp_f32 v249, v249
v_mfma_f32_16x16x32_bf16 v[152:155], a[148:151], a[60:63], v[152:155]
s_addk_i32 m0, 0x2000
ds_read_b64_tr_b16 a[172:173], v209 offset:28672
v_add_f32 v201, 1.0, v201
v_mfma_f32_16x16x32_bf16 v[152:155], a[144:147], a[52:55], v[152:155]
s_waitcnt lgkmcnt(7)
ds_read_b64_tr_b16 a[174:175], v209 offset:30720
buffer_load_dwordx4 v254, s[8:11], s54 offen  lds
v_mfma_f32_16x16x32_bf16 v[152:155], a[152:155], a[68:71], v[152:155]
ds_read_b64_tr_b16 a[176:177], v209 offset:32768
v_exp_f32 v203, v136
v_mfma_f32_16x16x32_bf16 v[152:155], a[156:159], a[76:79], v[152:155]
ds_read_b64_tr_b16 a[178:179], v209 offset:34816
v_mul_f32 v249, v249, v49
v_mfma_f32_16x16x32_bf16 v[148:151], a[156:159], a[72:75], v[148:151]
ds_read_b64_tr_b16 a[180:181], v209 offset:36864
v_rcp_f32 v201, v201
v_mfma_f32_16x16x32_bf16 v[148:151], a[152:155], a[64:67], v[148:151]
s_waitcnt lgkmcnt(7)
ds_read_b64_tr_b16 a[182:183], v209 offset:38912
v_add_f32 v205, 1.0, v205
v_mfma_f32_16x16x32_bf16 v[148:151], a[160:163], a[80:83], v[148:151]
ds_read_b64_tr_b16 a[184:185], v209 offset:40960
v_cvt_pk_bf16_f32 v158, v202, v249
v_mfma_f32_16x16x32_bf16 v[148:151], a[164:167], a[88:91], v[148:151]
ds_read_b64_tr_b16 a[186:187], v209 offset:43008
v_exp_f32 v249, v137
v_mfma_f32_16x16x32_bf16 v[152:155], a[164:167], a[92:95], v[152:155]
ds_read_b64_tr_b16 a[188:189], v209 offset:45056
v_mul_f32 v201, v201, v50
v_mfma_f32_16x16x32_bf16 v[152:155], a[160:163], a[84:87], v[152:155]
s_waitcnt lgkmcnt(7)
ds_read_b64_tr_b16 a[190:191], v209 offset:47104
buffer_load_dwordx4 v253, s[8:11], s54 offen offset:1024  lds
v_mfma_f32_16x16x32_bf16 v[152:155], a[168:171], a[100:103], v[152:155]
ds_read_b64_tr_b16 a[144:145], v208 offset:0
v_rcp_f32 v205, v205
v_mfma_f32_16x16x32_bf16 v[152:155], a[172:175], a[108:111], v[152:155]
ds_read_b64_tr_b16 a[146:147], v208 offset:2048
v_add_f32 v203, 1.0, v203
v_mfma_f32_16x16x32_bf16 v[148:151], a[172:175], a[104:107], v[148:151]
ds_read_b64_tr_b16 a[148:149], v208 offset:4096
v_exp_f32 v202, v138
v_mfma_f32_16x16x32_bf16 v[148:151], a[168:171], a[96:99], v[148:151]
s_waitcnt lgkmcnt(7)
ds_read_b64_tr_b16 a[150:151], v208 offset:6144
v_mul_f32 v205, v205, v51
v_mfma_f32_16x16x32_bf16 v[148:151], a[176:179], v[104:107], v[148:151]
s_mul_i32 s55, s65, 4608
ds_read_b64_tr_b16 a[152:153], v208 offset:8192
v_rcp_f32 v203, v203
v_mfma_f32_16x16x32_bf16 v[148:151], a[180:183], v[108:111], v[148:151]
s_add_u32 s55, s55, s72
ds_read_b64_tr_b16 a[154:155], v208 offset:10240
v_add_f32 v249, 1.0, v249
v_mfma_f32_16x16x32_bf16 v[152:155], a[180:183], v[100:103], v[152:155]
s_addk_i32 m0, 0x2000
ds_read_b64_tr_b16 a[156:157], v208 offset:12288
v_cvt_pk_bf16_f32 v159, v201, v205
v_mfma_f32_16x16x32_bf16 v[152:155], a[176:179], v[96:99], v[152:155]
s_waitcnt lgkmcnt(7)
ds_read_b64_tr_b16 a[158:159], v208 offset:14336
buffer_load_dwordx4 v254, s[8:11], s55 offen  lds
v_mfma_f32_16x16x32_bf16 v[152:155], a[184:187], v[112:115], v[152:155]
ds_read_b64_tr_b16 a[160:161], v208 offset:16384
v_exp_f32 v205, v139
v_mfma_f32_16x16x32_bf16 v[152:155], a[188:191], v[116:119], v[152:155]
ds_read_b64_tr_b16 a[162:163], v208 offset:18432
v_mul_f32 v203, v203, v136
v_mfma_f32_16x16x32_bf16 v[148:151], a[188:191], v[124:127], v[148:151]
ds_read_b64_tr_b16 a[164:165], v208 offset:20480
v_rcp_f32 v249, v249
v_mfma_f32_16x16x32_bf16 v[148:151], a[184:187], v[120:123], v[148:151]
s_waitcnt lgkmcnt(7)
ds_read_b64_tr_b16 a[166:167], v208 offset:22528
v_add_f32 v202, 1.0, v202
v_mfma_f32_16x16x32_bf16 v[160:163], a[144:147], a[48:51], v[160:163]
ds_read_b64_tr_b16 a[168:169], v208 offset:24576
v_exp_f32 v201, v140
v_mfma_f32_16x16x32_bf16 v[160:163], a[148:151], a[56:59], v[160:163]
ds_read_b64_tr_b16 a[170:171], v208 offset:26624
v_mul_f32 v249, v249, v137
v_mfma_f32_16x16x32_bf16 v[164:167], a[148:151], a[60:63], v[164:167]
ds_read_b64_tr_b16 a[172:173], v208 offset:28672
v_rcp_f32 v202, v202
v_mfma_f32_16x16x32_bf16 v[164:167], a[144:147], a[52:55], v[164:167]
s_waitcnt lgkmcnt(7)
ds_read_b64_tr_b16 a[174:175], v208 offset:30720
buffer_load_dwordx4 v253, s[8:11], s55 offen offset:1024  lds
v_mfma_f32_16x16x32_bf16 v[164:167], a[152:155], a[68:71], v[164:167]
ds_read_b64_tr_b16 a[176:177], v208 offset:32768
v_add_f32 v205, 1.0, v205
v_mfma_f32_16x16x32_bf16 v[164:167], a[156:159], a[76:79], v[164:167]
ds_read_b64_tr_b16 a[178:179], v208 offset:34816
v_cvt_pk_bf16_f32 v174, v203, v249
v_mfma_f32_16x16x32_bf16 v[160:163], a[156:159], a[72:75], v[160:163]
ds_read_b64_tr_b16 a[180:181], v208 offset:36864
v_exp_f32 v249, v141
v_mfma_f32_16x16x32_bf16 v[160:163], a[152:155], a[64:67], v[160:163]
s_waitcnt lgkmcnt(7)
ds_read_b64_tr_b16 a[182:183], v208 offset:38912
v_mul_f32 v202, v202, v138
v_mfma_f32_16x16x32_bf16 v[160:163], a[160:163], a[80:83], v[160:163]
s_mul_i32 s54, s66, 4608
ds_read_b64_tr_b16 a[184:185], v208 offset:40960
v_rcp_f32 v205, v205
v_mfma_f32_16x16x32_bf16 v[160:163], a[164:167], a[88:91], v[160:163]
s_add_u32 s54, s54, s72
ds_read_b64_tr_b16 a[186:187], v208 offset:43008
v_add_f32 v201, 1.0, v201
v_mfma_f32_16x16x32_bf16 v[164:167], a[164:167], a[92:95], v[164:167]
s_addk_i32 m0, 0x2000
ds_read_b64_tr_b16 a[188:189], v208 offset:45056
v_exp_f32 v203, v142
v_mfma_f32_16x16x32_bf16 v[164:167], a[160:163], a[84:87], v[164:167]
s_waitcnt lgkmcnt(7)
ds_read_b64_tr_b16 a[190:191], v208 offset:47104
buffer_load_dwordx4 v254, s[8:11], s54 offen  lds
v_mfma_f32_16x16x32_bf16 v[164:167], a[168:171], a[100:103], v[164:167]
ds_read_b64_tr_b16 a[144:145], v207 offset:0
v_mul_f32 v205, v205, v139
v_mfma_f32_16x16x32_bf16 v[164:167], a[172:175], a[108:111], v[164:167]
ds_read_b64_tr_b16 a[146:147], v207 offset:2048
v_rcp_f32 v201, v201
v_mfma_f32_16x16x32_bf16 v[160:163], a[172:175], a[104:107], v[160:163]
ds_read_b64_tr_b16 a[148:149], v207 offset:4096
v_add_f32 v249, 1.0, v249
v_mfma_f32_16x16x32_bf16 v[160:163], a[168:171], a[96:99], v[160:163]
s_waitcnt lgkmcnt(7)
ds_read_b64_tr_b16 a[150:151], v207 offset:6144
v_cvt_pk_bf16_f32 v175, v202, v205
v_mfma_f32_16x16x32_bf16 v[160:163], a[176:179], v[104:107], v[160:163]
ds_read_b64_tr_b16 a[152:153], v207 offset:8192
v_exp_f32 v205, v143
v_mfma_f32_16x16x32_bf16 v[160:163], a[180:183], v[108:111], v[160:163]
ds_read_b64_tr_b16 a[154:155], v207 offset:10240
v_mul_f32 v201, v201, v140
v_mfma_f32_16x16x32_bf16 v[164:167], a[180:183], v[100:103], v[164:167]
ds_read_b64_tr_b16 a[156:157], v207 offset:12288
v_rcp_f32 v249, v249
v_mfma_f32_16x16x32_bf16 v[164:167], a[176:179], v[96:99], v[164:167]
s_waitcnt lgkmcnt(7)
ds_read_b64_tr_b16 a[158:159], v207 offset:14336
buffer_load_dwordx4 v253, s[8:11], s54 offen offset:1024  lds
v_mfma_f32_16x16x32_bf16 v[164:167], a[184:187], v[112:115], v[164:167]
ds_read_b64_tr_b16 a[160:161], v207 offset:16384
v_add_f32 v203, 1.0, v203
v_mfma_f32_16x16x32_bf16 v[164:167], a[188:191], v[116:119], v[164:167]
ds_read_b64_tr_b16 a[162:163], v207 offset:18432
v_exp_f32 v202, v60
v_mfma_f32_16x16x32_bf16 v[160:163], a[188:191], v[124:127], v[160:163]
ds_read_b64_tr_b16 a[164:165], v207 offset:20480
v_mul_f32 v249, v249, v141
v_mfma_f32_16x16x32_bf16 v[160:163], a[184:187], v[120:123], v[160:163]
s_waitcnt lgkmcnt(7)
ds_read_b64_tr_b16 a[166:167], v207 offset:22528
v_rcp_f32 v203, v203
v_mfma_f32_16x16x32_bf16 v[92:95], a[144:147], a[48:51], v[92:95]
s_mul_i32 s55, s58, 4608
ds_read_b64_tr_b16 a[168:169], v207 offset:24576
v_add_f32 v205, 1.0, v205
v_mfma_f32_16x16x32_bf16 v[92:95], a[148:151], a[56:59], v[92:95]
s_add_u32 s55, s55, s73
ds_read_b64_tr_b16 a[170:171], v207 offset:26624
v_cvt_pk_bf16_f32 v48, v201, v249
v_mfma_f32_16x16x32_bf16 v[168:171], a[148:151], a[60:63], v[168:171]
s_addk_i32 m0, 0x2000
ds_read_b64_tr_b16 a[172:173], v207 offset:28672
v_exp_f32 v249, v61
v_mfma_f32_16x16x32_bf16 v[168:171], a[144:147], a[52:55], v[168:171]
s_waitcnt lgkmcnt(7)
ds_read_b64_tr_b16 a[174:175], v207 offset:30720
buffer_load_dwordx4 v254, s[8:11], s55 offen  lds
v_mfma_f32_16x16x32_bf16 v[168:171], a[152:155], a[68:71], v[168:171]
ds_read_b64_tr_b16 a[176:177], v207 offset:32768
v_mul_f32 v203, v203, v142
v_mfma_f32_16x16x32_bf16 v[168:171], a[156:159], a[76:79], v[168:171]
ds_read_b64_tr_b16 a[178:179], v207 offset:34816
v_rcp_f32 v205, v205
v_mfma_f32_16x16x32_bf16 v[92:95], a[156:159], a[72:75], v[92:95]
ds_read_b64_tr_b16 a[180:181], v207 offset:36864
v_add_f32 v202, 1.0, v202
v_mfma_f32_16x16x32_bf16 v[92:95], a[152:155], a[64:67], v[92:95]
s_waitcnt lgkmcnt(7)
ds_read_b64_tr_b16 a[182:183], v207 offset:38912
v_exp_f32 v201, v62
v_mfma_f32_16x16x32_bf16 v[92:95], a[160:163], a[80:83], v[92:95]
ds_read_b64_tr_b16 a[184:185], v207 offset:40960
v_mul_f32 v205, v205, v143
v_mfma_f32_16x16x32_bf16 v[92:95], a[164:167], a[88:91], v[92:95]
ds_read_b64_tr_b16 a[186:187], v207 offset:43008
v_rcp_f32 v202, v202
v_mfma_f32_16x16x32_bf16 v[168:171], a[164:167], a[92:95], v[168:171]
ds_read_b64_tr_b16 a[188:189], v207 offset:45056
v_add_f32 v249, 1.0, v249
v_mfma_f32_16x16x32_bf16 v[168:171], a[160:163], a[84:87], v[168:171]
s_waitcnt lgkmcnt(7)
ds_read_b64_tr_b16 a[190:191], v207 offset:47104
buffer_load_dwordx4 v253, s[8:11], s55 offen offset:1024  lds
v_mfma_f32_16x16x32_bf16 v[168:171], a[168:171], a[100:103], v[168:171]
ds_read_b64_tr_b16 a[144:145], v206 offset:0
v_cvt_pk_bf16_f32 v49, v203, v205
v_mfma_f32_16x16x32_bf16 v[168:171], a[172:175], a[108:111], v[168:171]
ds_read_b64_tr_b16 a[146:147], v206 offset:2048
v_exp_f32 v205, v63
v_mfma_f32_16x16x32_bf16 v[92:95], a[172:175], a[104:107], v[92:95]
ds_read_b64_tr_b16 a[148:149], v206 offset:4096
v_mul_f32 v202, v202, v60
v_mfma_f32_16x16x32_bf16 v[92:95], a[168:171], a[96:99], v[92:95]
s_waitcnt lgkmcnt(7)
ds_read_b64_tr_b16 a[150:151], v206 offset:6144
v_rcp_f32 v249, v249
v_mfma_f32_16x16x32_bf16 v[92:95], a[176:179], v[104:107], v[92:95]
s_mul_i32 s54, s59, 4608
ds_read_b64_tr_b16 a[152:153], v206 offset:8192
v_add_f32 v201, 1.0, v201
v_mfma_f32_16x16x32_bf16 v[92:95], a[180:183], v[108:111], v[92:95]
s_add_u32 s54, s54, s73
ds_read_b64_tr_b16 a[154:155], v206 offset:10240
v_exp_f32 v203, v76
v_mfma_f32_16x16x32_bf16 v[168:171], a[180:183], v[100:103], v[168:171]
s_addk_i32 m0, 0x2000
ds_read_b64_tr_b16 a[156:157], v206 offset:12288
v_mul_f32 v249, v249, v61
v_mfma_f32_16x16x32_bf16 v[168:171], a[176:179], v[96:99], v[168:171]
s_waitcnt lgkmcnt(7)
ds_read_b64_tr_b16 a[158:159], v206 offset:14336
buffer_load_dwordx4 v254, s[8:11], s54 offen  lds
v_mfma_f32_16x16x32_bf16 v[168:171], a[184:187], v[112:115], v[168:171]
ds_read_b64_tr_b16 a[160:161], v206 offset:16384
v_rcp_f32 v201, v201
v_mfma_f32_16x16x32_bf16 v[168:171], a[188:191], v[116:119], v[168:171]
ds_read_b64_tr_b16 a[162:163], v206 offset:18432
v_add_f32 v205, 1.0, v205
v_mfma_f32_16x16x32_bf16 v[92:95], a[188:191], v[124:127], v[92:95]
ds_read_b64_tr_b16 a[164:165], v206 offset:20480
s_waitcnt vmcnt(12)
v_pk_fma_f32 v[190:191], v[216:217], v[198:199], v[196:197] op_sel_hi:[0,1,1]
v_pk_fma_f32 v[190:191], v[216:217], v[198:199], v[190:191] op_sel:[1,1,0] op_sel_hi:[1,0,1] neg_lo:[1,0,0]
s_waitcnt vmcnt(11)
v_pk_fma_f32 v[188:189], v[216:217], v[190:191], v[194:195] op_sel_hi:[0,1,1]
v_pk_fma_f32 v[188:189], v[216:217], v[190:191], v[188:189] op_sel:[1,1,0] op_sel_hi:[1,0,1] neg_lo:[1,0,0]
s_waitcnt vmcnt(10)
v_pk_fma_f32 v[190:191], v[216:217], v[188:189], v[192:193] op_sel_hi:[0,1,1]
v_pk_fma_f32 v[190:191], v[216:217], v[188:189], v[190:191] op_sel:[1,1,0] op_sel_hi:[1,0,1] neg_lo:[1,0,0]
v_cmp_u_f32 vcc, v190, v191
v_mfma_f32_16x16x32_bf16 v[92:95], a[184:187], v[120:123], v[92:95]
s_waitcnt lgkmcnt(7)
ds_read_b64_tr_b16 a[166:167], v206 offset:22528
v_cvt_pk_bf16_f32 v136, v202, v249
v_mfma_f32_16x16x32_bf16 v[176:179], a[144:147], a[48:51], v[176:179]
s_cbranch_vccnz LM_g
LM_g_b:
ds_read_b64_tr_b16 a[168:169], v206 offset:24576
ds_write_b64 v240, v[190:191] offset:2560
v_mfma_f32_16x16x32_bf16 v[176:179], a[148:151], a[56:59], v[176:179]
ds_read_b64_tr_b16 a[170:171], v206 offset:26624
v_exp_f32 v249, v77
v_mfma_f32_16x16x32_bf16 v[128:131], a[148:151], a[60:63], v[128:131]
ds_read_b64_tr_b16 a[172:173], v206 offset:28672
v_mul_f32 v201, v201, v62
v_mfma_f32_16x16x32_bf16 v[128:131], a[144:147], a[52:55], v[128:131]
s_waitcnt lgkmcnt(8)
ds_read_b64_tr_b16 a[174:175], v206 offset:30720
buffer_load_dwordx4 v253, s[8:11], s54 offen offset:1024  lds
v_mfma_f32_16x16x32_bf16 v[128:131], a[152:155], a[68:71], v[128:131]
s_waitcnt lgkmcnt(3)
ds_read_b64_tr_b16 a[176:177], v206 offset:32768
v_rcp_f32 v205, v205
v_mfma_f32_16x16x32_bf16 v[128:131], a[156:159], a[76:79], v[128:131]
ds_read_b64_tr_b16 a[178:179], v206 offset:34816
v_add_f32 v203, 1.0, v203
v_mfma_f32_16x16x32_bf16 v[176:179], a[156:159], a[72:75], v[176:179]
ds_read_b64_tr_b16 a[180:181], v206 offset:36864
v_exp_f32 v240, v78
v_mfma_f32_16x16x32_bf16 v[176:179], a[152:155], a[64:67], v[176:179]
ds_read_b64_tr_b16 a[182:183], v206 offset:38912
v_mul_f32 v205, v205, v63
v_mfma_f32_16x16x32_bf16 v[176:179], a[160:163], a[80:83], v[176:179]
s_mul_i32 s55, s60, 4608
ds_read_b64_tr_b16 a[184:185], v206 offset:40960
v_rcp_f32 v203, v203
v_mfma_f32_16x16x32_bf16 v[176:179], a[164:167], a[88:91], v[176:179]
s_add_u32 s55, s55, s73
ds_read_b64_tr_b16 a[186:187], v206 offset:43008
v_add_f32 v249, 1.0, v249
v_mfma_f32_16x16x32_bf16 v[128:131], a[164:167], a[92:95], v[128:131]
s_waitcnt vmcnt(10)
ds_read_b64_tr_b16 a[188:189], v206 offset:45056
v_cvt_pk_bf16_f32 v137, v201, v205
v_mfma_f32_16x16x32_bf16 v[128:131], a[160:163], a[84:87], v[128:131]
s_waitcnt lgkmcnt(7)
ds_read_b64_tr_b16 a[190:191], v206 offset:47104
v_exp_f32 v217, v79
v_mfma_f32_16x16x32_bf16 v[128:131], a[168:171], a[100:103], v[128:131]
s_barrier
ds_read_b64_tr_b16 a[144:145], v237 offset:0
v_mul_f32 v203, v203, v76
v_mfma_f32_16x16x32_bf16 v[128:131], a[172:175], a[108:111], v[128:131]
s_addk_i32 m0, 0x2000
ds_read_b64_tr_b16 a[146:147], v237 offset:2048
ds_read2st64_b64 v[60:63], v232 offset0:1 offset1:9
v_mfma_f32_16x16x32_bf16 v[176:179], a[172:175], a[104:107], v[176:179]
ds_read_b64_tr_b16 a[148:149], v237 offset:4096
buffer_load_dwordx4 v254, s[8:11], s55 offen  lds
v_mfma_f32_16x16x32_bf16 v[176:179], a[168:171], a[96:99], v[176:179]
s_waitcnt lgkmcnt(8)
ds_read_b64_tr_b16 a[150:151], v237 offset:6144
ds_read2st64_b64 v[140:143], v232 offset0:17 offset1:25
v_mfma_f32_16x16x32_bf16 v[176:179], a[176:179], v[104:107], v[176:179]
ds_read_b64_tr_b16 a[152:153], v237 offset:8192
v_rcp_f32 v249, v249
v_mfma_f32_16x16x32_bf16 v[176:179], a[180:183], v[108:111], v[176:179]
ds_read_b64_tr_b16 a[154:155], v237 offset:10240
v_add_f32 v240, 1.0, v240
v_mfma_f32_16x16x32_bf16 v[128:131], a[180:183], v[100:103], v[128:131]
ds_read_b64_tr_b16 a[156:157], v237 offset:12288
v_exp_f32 v232, v144
v_mfma_f32_16x16x32_bf16 v[128:131], a[176:179], v[96:99], v[128:131]
s_waitcnt lgkmcnt(9)
ds_read_b64_tr_b16 a[158:159], v237 offset:14336
v_mul_f32 v249, v249, v77
v_mfma_f32_16x16x32_bf16 v[128:131], a[184:187], v[112:115], v[128:131]
LM_p5:
s_cbranch_execz LM_v105
ds_read_b64_tr_b16 a[160:161], v237 offset:16384
v_rcp_f32 v240, v240
v_mfma_f32_16x16x32_bf16 v[128:131], a[188:191], v[116:119], v[128:131]
ds_read_b64_tr_b16 a[162:163], v237 offset:18432
v_add_f32 v217, 1.0, v217
v_mfma_f32_16x16x32_bf16 v[176:179], a[188:191], v[124:127], v[176:179]
ds_read_b64_tr_b16 a[164:165], v237 offset:20480
buffer_load_dwordx4 v253, s[8:11], s55 offen offset:1024  lds
v_mfma_f32_16x16x32_bf16 v[176:179], a[184:187], v[120:123], v[176:179]
s_waitcnt lgkmcnt(8)
ds_read_b64_tr_b16 a[166:167], v237 offset:22528
s_waitcnt lgkmcnt(8)
v_pk_fma_f32 v[190:191], v[214:215], v[142:143], v[140:141] op_sel_hi:[0,1,1]
v_pk_fma_f32 v[190:191], v[214:215], v[142:143], v[190:191] op_sel:[1,1,0] op_sel_hi:[1,0,1] neg_lo:[1,0,0]
v_pk_fma_f32 v[188:189], v[214:215], v[190:191], v[62:63] op_sel_hi:[0,1,1]
v_pk_fma_f32 v[188:189], v[214:215], v[190:191], v[188:189] op_sel:[1,1,0] op_sel_hi:[1,0,1] neg_lo:[1,0,0]
v_pk_fma_f32 v[190:191], v[214:215], v[188:189], v[60:61] op_sel_hi:[0,1,1]
v_pk_fma_f32 v[190:191], v[214:215], v[188:189], v[190:191] op_sel:[1,1,0] op_sel_hi:[1,0,1] neg_lo:[1,0,0]
v_pk_fma_f32 v[214:215], v[210:211], v[190:191], v[220:221] op_sel_hi:[0,1,1]
v_pk_fma_f32 v[214:215], v[210:211], v[190:191], v[214:215] op_sel:[1,1,0] op_sel_hi:[1,0,1] neg_lo:[1,0,0]
v_pk_fma_f32 v[220:221], v[222:223], v[214:215], v[226:227] op_sel_hi:[0,1,1]
v_pk_fma_f32 v[220:221], v[222:223], v[214:215], v[220:221] op_sel:[1,1,0] op_sel_hi:[1,0,1] neg_lo:[1,0,0]
v_pk_fma_f32 v[226:227], v[222:223], v[220:221], v[224:225] op_sel_hi:[0,1,1]
v_pk_fma_f32 v[226:227], v[222:223], v[220:221], v[226:227] op_sel:[1,1,0] op_sel_hi:[1,0,1] neg_lo:[1,0,0]
v_pk_fma_f32 v[224:225], v[222:223], v[226:227], v[218:219] op_sel_hi:[0,1,1]
v_pk_fma_f32 v[224:225], v[222:223], v[226:227], v[224:225] op_sel:[1,1,0] op_sel_hi:[1,0,1] neg_lo:[1,0,0]
v_permlane32_swap_b32 v214, v226
s_nop 0
v_permlane32_swap_b32 v220, v224
v_permlane32_swap_b32 v215, v227
v_permlane32_swap_b32 v221, v225
v_permlane16_swap_b32 v214, v220
v_permlane16_swap_b32 v226, v224
v_permlane16_swap_b32 v215, v221
v_permlane16_swap_b32 v227, v225
s_nop 0
v_pk_fma_f32 v[24:25], v[8:9], v[214:215], v[24:25] op_sel_hi:[0,1,1]
v_pk_fma_f32 v[64:65], v[12:13], v[220:221], v[64:65] op_sel_hi:[0,1,1]
v_pk_fma_f32 v[4:5], v[16:17], v[226:227], v[4:5] op_sel_hi:[0,1,1]
v_pk_fma_f32 v[36:37], v[20:21], v[224:225], v[36:37] op_sel_hi:[0,1,1]
v_pk_fma_f32 v[24:25], v[8:9], v[214:215], v[24:25] op_sel:[1,1,0] op_sel_hi:[1,0,1] neg_lo:[1,0,0]
v_pk_fma_f32 v[64:65], v[12:13], v[220:221], v[64:65] op_sel:[1,1,0] op_sel_hi:[1,0,1] neg_lo:[1,0,0]
v_pk_fma_f32 v[4:5], v[16:17], v[226:227], v[4:5] op_sel:[1,1,0] op_sel_hi:[1,0,1] neg_lo:[1,0,0]
v_pk_fma_f32 v[36:37], v[20:21], v[224:225], v[36:37] op_sel:[1,1,0] op_sel_hi:[1,0,1] neg_lo:[1,0,0]
v_pk_fma_f32 v[26:27], v[8:9], v[24:25], v[26:27] op_sel_hi:[0,1,1]
v_pk_fma_f32 v[66:67], v[12:13], v[64:65], v[66:67] op_sel_hi:[0,1,1]
v_pk_fma_f32 v[6:7], v[16:17], v[4:5], v[6:7] op_sel_hi:[0,1,1]
v_pk_fma_f32 v[38:39], v[20:21], v[36:37], v[38:39] op_sel_hi:[0,1,1]
v_pk_fma_f32 v[26:27], v[8:9], v[24:25], v[26:27] op_sel:[1,1,0] op_sel_hi:[1,0,1] neg_lo:[1,0,0]
v_pk_fma_f32 v[66:67], v[12:13], v[64:65], v[66:67] op_sel:[1,1,0] op_sel_hi:[1,0,1] neg_lo:[1,0,0]
v_pk_fma_f32 v[6:7], v[16:17], v[4:5], v[6:7] op_sel:[1,1,0] op_sel_hi:[1,0,1] neg_lo:[1,0,0]
v_pk_fma_f32 v[38:39], v[20:21], v[36:37], v[38:39] op_sel:[1,1,0] op_sel_hi:[1,0,1] neg_lo:[1,0,0]
v_pk_fma_f32 v[28:29], v[8:9], v[26:27], v[28:29] op_sel_hi:[0,1,1]
v_pk_fma_f32 v[68:69], v[12:13], v[66:67], v[68:69] op_sel_hi:[0,1,1]
v_pk_fma_f32 v[88:89], v[16:17], v[6:7], v[88:89] op_sel_hi:[0,1,1]
v_pk_fma_f32 v[132:133], v[20:21], v[38:39], v[132:133] op_sel_hi:[0,1,1]
v_pk_fma_f32 v[28:29], v[8:9], v[26:27], v[28:29] op_sel:[1,1,0] op_sel_hi:[1,0,1] neg_lo:[1,0,0]
v_pk_fma_f32 v[68:69], v[12:13], v[66:67], v[68:69] op_sel:[1,1,0] op_sel_hi:[1,0,1] neg_lo:[1,0,0]
v_pk_fma_f32 v[88:89], v[16:17], v[6:7], v[88:89] op_sel:[1,1,0] op_sel_hi:[1,0,1] neg_lo:[1,0,0]
v_pk_fma_f32 v[132:133], v[20:21], v[38:39], v[132:133] op_sel:[1,1,0] op_sel_hi:[1,0,1] neg_lo:[1,0,0]
v_pk_fma_f32 v[30:31], v[8:9], v[28:29], v[30:31] op_sel_hi:[0,1,1]
v_pk_fma_f32 v[70:71], v[12:13], v[68:69], v[70:71] op_sel_hi:[0,1,1]
v_pk_fma_f32 v[90:91], v[16:17], v[88:89], v[90:91] op_sel_hi:[0,1,1]
v_pk_fma_f32 v[134:135], v[20:21], v[132:133], v[134:135] op_sel_hi:[0,1,1]
v_pk_fma_f32 v[30:31], v[8:9], v[28:29], v[30:31] op_sel:[1,1,0] op_sel_hi:[1,0,1] neg_lo:[1,0,0]
v_pk_fma_f32 v[70:71], v[12:13], v[68:69], v[70:71] op_sel:[1,1,0] op_sel_hi:[1,0,1] neg_lo:[1,0,0]
v_pk_fma_f32 v[90:91], v[16:17], v[88:89], v[90:91] op_sel:[1,1,0] op_sel_hi:[1,0,1] neg_lo:[1,0,0]
v_pk_fma_f32 v[134:135], v[20:21], v[132:133], v[134:135] op_sel:[1,1,0] op_sel_hi:[1,0,1] neg_lo:[1,0,0]
v_pk_fma_f32 v[40:41], v[8:9], v[30:31], v[40:41] op_sel_hi:[0,1,1]
v_pk_fma_f32 v[80:81], v[12:13], v[70:71], v[80:81] op_sel_hi:[0,1,1]
v_pk_fma_f32 v[32:33], v[16:17], v[90:91], v[32:33] op_sel_hi:[0,1,1]
v_pk_fma_f32 v[56:57], v[20:21], v[134:135], v[56:57] op_sel_hi:[0,1,1]
v_pk_fma_f32 v[40:41], v[8:9], v[30:31], v[40:41] op_sel:[1,1,0] op_sel_hi:[1,0,1] neg_lo:[1,0,0]
v_pk_fma_f32 v[80:81], v[12:13], v[70:71], v[80:81] op_sel:[1,1,0] op_sel_hi:[1,0,1] neg_lo:[1,0,0]
v_pk_fma_f32 v[32:33], v[16:17], v[90:91], v[32:33] op_sel:[1,1,0] op_sel_hi:[1,0,1] neg_lo:[1,0,0]
v_pk_fma_f32 v[56:57], v[20:21], v[134:135], v[56:57] op_sel:[1,1,0] op_sel_hi:[1,0,1] neg_lo:[1,0,0]
v_pk_fma_f32 v[42:43], v[8:9], v[40:41], v[42:43] op_sel_hi:[0,1,1]
v_pk_fma_f32 v[82:83], v[12:13], v[80:81], v[82:83] op_sel_hi:[0,1,1]
v_pk_fma_f32 v[34:35], v[16:17], v[32:33], v[34:35] op_sel_hi:[0,1,1]
v_pk_fma_f32 v[58:59], v[20:21], v[56:57], v[58:59] op_sel_hi:[0,1,1]
v_pk_fma_f32 v[42:43], v[8:9], v[40:41], v[42:43] op_sel:[1,1,0] op_sel_hi:[1,0,1] neg_lo:[1,0,0]
v_pk_fma_f32 v[82:83], v[12:13], v[80:81], v[82:83] op_sel:[1,1,0] op_sel_hi:[1,0,1] neg_lo:[1,0,0]
v_pk_fma_f32 v[34:35], v[16:17], v[32:33], v[34:35] op_sel:[1,1,0] op_sel_hi:[1,0,1] neg_lo:[1,0,0]
v_pk_fma_f32 v[58:59], v[20:21], v[56:57], v[58:59] op_sel:[1,1,0] op_sel_hi:[1,0,1] neg_lo:[1,0,0]
v_pk_fma_f32 v[52:53], v[8:9], v[42:43], v[52:53] op_sel_hi:[0,1,1]
v_pk_fma_f32 v[84:85], v[12:13], v[82:83], v[84:85] op_sel_hi:[0,1,1]
v_pk_fma_f32 v[44:45], v[16:17], v[34:35], v[44:45] op_sel_hi:[0,1,1]
v_pk_fma_f32 v[72:73], v[20:21], v[58:59], v[72:73] op_sel_hi:[0,1,1]
v_pk_fma_f32 v[52:53], v[8:9], v[42:43], v[52:53] op_sel:[1,1,0] op_sel_hi:[1,0,1] neg_lo:[1,0,0]
v_pk_fma_f32 v[84:85], v[12:13], v[82:83], v[84:85] op_sel:[1,1,0] op_sel_hi:[1,0,1] neg_lo:[1,0,0]
v_pk_fma_f32 v[44:45], v[16:17], v[34:35], v[44:45] op_sel:[1,1,0] op_sel_hi:[1,0,1] neg_lo:[1,0,0]
v_pk_fma_f32 v[72:73], v[20:21], v[58:59], v[72:73] op_sel:[1,1,0] op_sel_hi:[1,0,1] neg_lo:[1,0,0]
v_pk_fma_f32 v[54:55], v[8:9], v[52:53], v[54:55] op_sel_hi:[0,1,1]
v_pk_fma_f32 v[86:87], v[12:13], v[84:85], v[86:87] op_sel_hi:[0,1,1]
v_pk_fma_f32 v[46:47], v[16:17], v[44:45], v[46:47] op_sel_hi:[0,1,1]
v_pk_fma_f32 v[74:75], v[20:21], v[72:73], v[74:75] op_sel_hi:[0,1,1]
v_pk_fma_f32 v[54:55], v[8:9], v[52:53], v[54:55] op_sel:[1,1,0] op_sel_hi:[1,0,1] neg_lo:[1,0,0]
v_pk_fma_f32 v[86:87], v[12:13], v[84:85], v[86:87] op_sel:[1,1,0] op_sel_hi:[1,0,1] neg_lo:[1,0,0]
v_pk_fma_f32 v[46:47], v[16:17], v[44:45], v[46:47] op_sel:[1,1,0] op_sel_hi:[1,0,1] neg_lo:[1,0,0]
v_pk_fma_f32 v[74:75], v[20:21], v[72:73], v[74:75] op_sel:[1,1,0] op_sel_hi:[1,0,1] neg_lo:[1,0,0]
v_mfma_f32_16x16x32_bf16 v[8:11], a[144:147], a[0:3], 0
s_mul_i32 s54, s61, 4608
ds_read_b64_tr_b16 a[168:169], v237 offset:24576
v_cvt_pk_bf16_f32 v50, v203, v249
v_mfma_f32_16x16x32_bf16 v[8:11], a[148:151], a[8:11], v[8:11]
s_add_u32 s54, s54, s73
ds_read_b64_tr_b16 a[170:171], v237 offset:26624
v_exp_f32 v249, v145
v_mfma_f32_16x16x32_bf16 v[12:15], a[148:151], a[12:15], 0
s_addk_i32 m0, 0x2000
ds_read_b64_tr_b16 a[172:173], v237 offset:28672
v_mul_f32 v240, v240, v78
v_mfma_f32_16x16x32_bf16 v[12:15], a[144:147], a[4:7], v[12:15]
s_waitcnt lgkmcnt(7)
ds_read_b64_tr_b16 a[174:175], v237 offset:30720
buffer_load_dwordx4 v254, s[8:11], s54 offen  lds
v_mfma_f32_16x16x32_bf16 v[12:15], a[152:155], a[20:23], v[12:15]
ds_read_b64_tr_b16 a[176:177], v237 offset:32768
v_rcp_f32 v217, v217
v_mfma_f32_16x16x32_bf16 v[12:15], a[156:159], a[28:31], v[12:15]
ds_read_b64_tr_b16 a[178:179], v237 offset:34816
v_add_f32 v232, 1.0, v232
v_mfma_f32_16x16x32_bf16 v[8:11], a[156:159], a[24:27], v[8:11]
ds_read_b64_tr_b16 a[180:181], v237 offset:36864
v_exp_f32 v227, v146
v_mfma_f32_16x16x32_bf16 v[8:11], a[152:155], a[16:19], v[8:11]
s_waitcnt lgkmcnt(7)
ds_read_b64_tr_b16 a[182:183], v237 offset:38912
v_mul_f32 v217, v217, v79
v_mfma_f32_16x16x32_bf16 v[8:11], a[160:163], a[32:35], v[8:11]
ds_read_b64_tr_b16 a[184:185], v237 offset:40960
v_rcp_f32 v232, v232
v_mfma_f32_16x16x32_bf16 v[8:11], a[164:167], a[40:43], v[8:11]
ds_read_b64_tr_b16 a[186:187], v237 offset:43008
v_add_f32 v249, 1.0, v249
v_mfma_f32_16x16x32_bf16 v[12:15], a[164:167], a[44:47], v[12:15]
ds_read_b64_tr_b16 a[188:189], v237 offset:45056
v_cvt_pk_bf16_f32 v51, v240, v217
v_mfma_f32_16x16x32_bf16 v[12:15], a[160:163], a[36:39], v[12:15]
s_waitcnt lgkmcnt(7)
ds_read_b64_tr_b16 a[190:191], v237 offset:47104
buffer_load_dwordx4 v253, s[8:11], s54 offen offset:1024  lds
v_mfma_f32_16x16x32_bf16 v[12:15], a[168:171], a[52:55], v[12:15]
ds_read_b64_tr_b16 a[144:145], v239 offset:0
v_exp_f32 v240, v147
v_mfma_f32_16x16x32_bf16 v[12:15], a[172:175], a[60:63], v[12:15]
ds_read_b64_tr_b16 a[146:147], v239 offset:2048
v_mul_f32 v232, v232, v144
v_mfma_f32_16x16x32_bf16 v[8:11], a[172:175], a[56:59], v[8:11]
ds_read_b64_tr_b16 a[148:149], v239 offset:4096
v_rcp_f32 v249, v249
v_mfma_f32_16x16x32_bf16 v[8:11], a[168:171], a[48:51], v[8:11]
s_waitcnt lgkmcnt(7)
ds_read_b64_tr_b16 a[150:151], v239 offset:6144
v_add_f32 v227, 1.0, v227
v_mfma_f32_16x16x32_bf16 v[8:11], a[176:179], a[64:67], v[8:11]
s_mul_i32 s55, s62, 4608
ds_read_b64_tr_b16 a[152:153], v239 offset:8192
v_mul_f32 v249, v249, v145
v_mfma_f32_16x16x32_bf16 v[8:11], a[180:183], a[72:75], v[8:11]
s_add_u32 s55, s55, s73
ds_read_b64_tr_b16 a[154:155], v239 offset:10240
v_rcp_f32 v227, v227
v_mfma_f32_16x16x32_bf16 v[12:15], a[180:183], a[76:79], v[12:15]
s_addk_i32 m0, 0x2000
ds_read_b64_tr_b16 a[156:157], v239 offset:12288
v_add_f32 v240, 1.0, v240
v_mfma_f32_16x16x32_bf16 v[12:15], a[176:179], a[68:71], v[12:15]
s_waitcnt lgkmcnt(7)
ds_read_b64_tr_b16 a[158:159], v239 offset:14336
buffer_load_dwordx4 v254, s[8:11], s55 offen  lds
v_mfma_f32_16x16x32_bf16 v[12:15], a[184:187], a[84:87], v[12:15]
ds_read_b64_tr_b16 a[160:161], v239 offset:16384
v_cvt_pk_bf16_f32 v138, v232, v249
v_mfma_f32_16x16x32_bf16 v[12:15], a[188:191], a[92:95], v[12:15]
ds_read_b64_tr_b16 a[162:163], v239 offset:18432
v_mul_f32 v227, v227, v146
v_mfma_f32_16x16x32_bf16 v[8:11], a[188:191], a[88:91], v[8:11]
ds_read_b64_tr_b16 a[164:165], v239 offset:20480
v_rcp_f32 v240, v240
v_mfma_f32_16x16x32_bf16 v[8:11], a[184:187], a[80:83], v[8:11]
s_waitcnt lgkmcnt(7)
ds_read_b64_tr_b16 a[166:167], v239 offset:22528
v_mul_f32 v240, v240, v147
v_mfma_f32_16x16x32_bf16 v[16:19], a[144:147], a[0:3], 0
ds_read_b64_tr_b16 a[168:169], v239 offset:24576
v_cvt_pk_bf16_f32 v139, v227, v240
v_mfma_f32_16x16x32_bf16 v[16:19], a[148:151], a[8:11], v[16:19]
ds_read_b64_tr_b16 a[170:171], v239 offset:26624
v_mov_b32 v226, 1.0
v_mfma_f32_16x16x32_bf16 v[20:23], a[148:151], a[12:15], 0
ds_read_b64_tr_b16 a[172:173], v239 offset:28672
v_exp_f32 v60, v152
v_mfma_f32_16x16x32_bf16 v[20:23], a[144:147], a[4:7], v[20:23]
s_waitcnt lgkmcnt(7)
ds_read_b64_tr_b16 a[174:175], v239 offset:30720
buffer_load_dwordx4 v253, s[8:11], s55 offen offset:1024  lds
v_mfma_f32_16x16x32_bf16 v[20:23], a[152:155], a[20:23], v[20:23]
ds_read_b64_tr_b16 a[176:177], v239 offset:32768
v_exp_f32 v61, v153
v_mfma_f32_16x16x32_bf16 v[20:23], a[156:159], a[28:31], v[20:23]
ds_read_b64_tr_b16 a[178:179], v239 offset:34816
v_exp_f32 v62, v154
v_mfma_f32_16x16x32_bf16 v[16:19], a[156:159], a[24:27], v[16:19]
ds_read_b64_tr_b16 a[180:181], v239 offset:36864
v_exp_f32 v63, v155
v_mfma_f32_16x16x32_bf16 v[16:19], a[152:155], a[16:19], v[16:19]
s_waitcnt lgkmcnt(7)
ds_read_b64_tr_b16 a[182:183], v239 offset:38912
v_exp_f32 v76, v148
v_mfma_f32_16x16x32_bf16 v[16:19], a[160:163], a[32:35], v[16:19]
s_mul_i32 s54, s63, 4608
ds_read_b64_tr_b16 a[184:185], v239 offset:40960
v_exp_f32 v77, v149
v_mfma_f32_16x16x32_bf16 v[16:19], a[164:167], a[40:43], v[16:19]
s_add_u32 s54, s54, s73
ds_read_b64_tr_b16 a[186:187], v239 offset:43008
v_exp_f32 v78, v150
v_mfma_f32_16x16x32_bf16 v[20:23], a[164:167], a[44:47], v[20:23]
s_addk_i32 m0, 0x2000
ds_read_b64_tr_b16 a[188:189], v239 offset:45056
v_exp_f32 v79, v151
v_mfma_f32_16x16x32_bf16 v[20:23], a[160:163], a[36:39], v[20:23]
s_waitcnt lgkmcnt(7)
ds_read_b64_tr_b16 a[190:191], v239 offset:47104
buffer_load_dwordx4 v254, s[8:11], s54 offen  lds
v_mfma_f32_16x16x32_bf16 v[20:23], a[168:171], a[52:55], v[20:23]
ds_read_b64_tr_b16 a[144:145], v238 offset:0
v_exp_f32 v140, v164
v_mfma_f32_16x16x32_bf16 v[20:23], a[172:175], a[60:63], v[20:23]
ds_read_b64_tr_b16 a[146:147], v238 offset:2048
v_exp_f32 v141, v165
v_mfma_f32_16x16x32_bf16 v[16:19], a[172:175], a[56:59], v[16:19]
ds_read_b64_tr_b16 a[148:149], v238 offset:4096
v_exp_f32 v142, v166
v_mfma_f32_16x16x32_bf16 v[16:19], a[168:171], a[48:51], v[16:19]
s_waitcnt lgkmcnt(7)
ds_read_b64_tr_b16 a[150:151], v238 offset:6144
v_exp_f32 v143, v167
v_mfma_f32_16x16x32_bf16 v[16:19], a[176:179], a[64:67], v[16:19]
ds_read_b64_tr_b16 a[152:153], v238 offset:8192
v_exp_f32 v144, v160
v_mfma_f32_16x16x32_bf16 v[16:19], a[180:183], a[72:75], v[16:19]
ds_read_b64_tr_b16 a[154:155], v238 offset:10240
v_exp_f32 v145, v161
v_mfma_f32_16x16x32_bf16 v[20:23], a[180:183], a[76:79], v[20:23]
ds_read_b64_tr_b16 a[156:157], v238 offset:12288
v_exp_f32 v146, v162
v_mfma_f32_16x16x32_bf16 v[20:23], a[176:179], a[68:71], v[20:23]
s_waitcnt lgkmcnt(7)
ds_read_b64_tr_b16 a[158:159], v238 offset:14336
buffer_load_dwordx4 v253, s[8:11], s54 offen offset:1024  lds
v_mfma_f32_16x16x32_bf16 v[20:23], a[184:187], a[84:87], v[20:23]
ds_read_b64_tr_b16 a[160:161], v238 offset:16384
v_exp_f32 v147, v163
v_mfma_f32_16x16x32_bf16 v[20:23], a[188:191], a[92:95], v[20:23]
ds_read_b64_tr_b16 a[162:163], v238 offset:18432
v_exp_f32 v180, v168
v_mfma_f32_16x16x32_bf16 v[16:19], a[188:191], a[88:91], v[16:19]
ds_read_b64_tr_b16 a[164:165], v238 offset:20480
v_exp_f32 v181, v169
v_mfma_f32_16x16x32_bf16 v[16:19], a[184:187], a[80:83], v[16:19]
s_waitcnt lgkmcnt(7)
ds_read_b64_tr_b16 a[166:167], v238 offset:22528
v_exp_f32 v182, v170
v_mfma_f32_16x16x32_bf16 v[184:187], a[144:147], a[0:3], 0
s_mul_i32 s55, s64, 4608
ds_read_b64_tr_b16 a[168:169], v238 offset:24576
v_exp_f32 v183, v171
v_mfma_f32_16x16x32_bf16 v[184:187], a[148:151], a[8:11], v[184:187]
s_add_u32 s55, s55, s73
ds_read_b64_tr_b16 a[170:171], v238 offset:26624
v_exp_f32 v188, v92
v_mfma_f32_16x16x32_bf16 v[192:195], a[148:151], a[12:15], 0
s_addk_i32 m0, 0x2000
ds_read_b64_tr_b16 a[172:173], v238 offset:28672
v_exp_f32 v189, v93
v_mfma_f32_16x16x32_bf16 v[192:195], a[144:147], a[4:7], v[192:195]
s_waitcnt lgkmcnt(7)
ds_read_b64_tr_b16 a[174:175], v238 offset:30720
buffer_load_dwordx4 v254, s[8:11], s55 offen  lds
v_mfma_f32_16x16x32_bf16 v[192:195], a[152:155], a[20:23], v[192:195]
ds_read_b64_tr_b16 a[176:177], v238 offset:32768
v_exp_f32 v190, v94
v_mfma_f32_16x16x32_bf16 v[192:195], a[156:159], a[28:31], v[192:195]
ds_read_b64_tr_b16 a[178:179], v238 offset:34816
v_exp_f32 v191, v95
v_mfma_f32_16x16x32_bf16 v[184:187], a[156:159], a[24:27], v[184:187]
ds_read_b64_tr_b16 a[180:181], v238 offset:36864
v_exp_f32 v196, v128
v_mfma_f32_16x16x32_bf16 v[184:187], a[152:155], a[16:19], v[184:187]
s_waitcnt lgkmcnt(7)
ds_read_b64_tr_b16 a[182:183], v238 offset:38912
v_exp_f32 v197, v129
v_mfma_f32_16x16x32_bf16 v[184:187], a[160:163], a[32:35], v[184:187]
ds_read_b64_tr_b16 a[184:185], v238 offset:40960
v_exp_f32 v198, v130
v_mfma_f32_16x16x32_bf16 v[184:187], a[164:167], a[40:43], v[184:187]
ds_read_b64_tr_b16 a[186:187], v238 offset:43008
v_exp_f32 v199, v131
v_mfma_f32_16x16x32_bf16 v[192:195], a[164:167], a[44:47], v[192:195]
ds_read_b64_tr_b16 a[188:189], v238 offset:45056
v_exp_f32 v200, v176
v_mfma_f32_16x16x32_bf16 v[192:195], a[160:163], a[36:39], v[192:195]
s_waitcnt lgkmcnt(7)
ds_read_b64_tr_b16 a[190:191], v238 offset:47104
buffer_load_dwordx4 v253, s[8:11], s55 offen offset:1024  lds
v_mfma_f32_16x16x32_bf16 v[192:195], a[168:171], a[52:55], v[192:195]
ds_read_b64_tr_b16 a[144:145], v236 offset:0
v_exp_f32 v201, v177
v_mfma_f32_16x16x32_bf16 v[192:195], a[172:175], a[60:63], v[192:195]
ds_read_b64_tr_b16 a[146:147], v236 offset:2048
v_exp_f32 v202, v178
v_mfma_f32_16x16x32_bf16 v[184:187], a[172:175], a[56:59], v[184:187]
ds_read_b64_tr_b16 a[148:149], v236 offset:4096
v_exp_f32 v203, v179
v_mfma_f32_16x16x32_bf16 v[184:187], a[168:171], a[48:51], v[184:187]
s_waitcnt lgkmcnt(7)
ds_read_b64_tr_b16 a[150:151], v236 offset:6144
s_nop 0
v_pk_add_f32 v[60:61], v[60:61], v[226:227] op_sel_hi:[1,0]
v_pk_add_f32 v[62:63], v[62:63], v[226:227] op_sel_hi:[1,0]
v_pk_add_f32 v[76:77], v[76:77], v[226:227] op_sel_hi:[1,0]
v_pk_add_f32 v[78:79], v[78:79], v[226:227] op_sel_hi:[1,0]
v_pk_add_f32 v[140:141], v[140:141], v[226:227] op_sel_hi:[1,0]
v_pk_add_f32 v[142:143], v[142:143], v[226:227] op_sel_hi:[1,0]
v_pk_add_f32 v[144:145], v[144:145], v[226:227] op_sel_hi:[1,0]
v_pk_add_f32 v[146:147], v[146:147], v[226:227] op_sel_hi:[1,0]
v_pk_add_f32 v[180:181], v[180:181], v[226:227] op_sel_hi:[1,0]
v_pk_add_f32 v[182:183], v[182:183], v[226:227] op_sel_hi:[1,0]
v_pk_add_f32 v[188:189], v[188:189], v[226:227] op_sel_hi:[1,0]
v_pk_add_f32 v[190:191], v[190:191], v[226:227] op_sel_hi:[1,0]
v_pk_add_f32 v[196:197], v[196:197], v[226:227] op_sel_hi:[1,0]
v_pk_add_f32 v[198:199], v[198:199], v[226:227] op_sel_hi:[1,0]
v_pk_add_f32 v[200:201], v[200:201], v[226:227] op_sel_hi:[1,0]
v_pk_add_f32 v[202:203], v[202:203], v[226:227] op_sel_hi:[1,0]
v_mfma_f32_16x16x32_bf16 v[184:187], a[176:179], a[64:67], v[184:187]
s_mul_i32 s54, s65, 4608
ds_read_b64_tr_b16 a[152:153], v236 offset:8192
v_rcp_f32 v60, v60
v_mfma_f32_16x16x32_bf16 v[184:187], a[180:183], a[72:75], v[184:187]
s_add_u32 s54, s54, s73
ds_read_b64_tr_b16 a[154:155], v236 offset:10240
v_rcp_f32 v61, v61
v_mfma_f32_16x16x32_bf16 v[192:195], a[180:183], a[76:79], v[192:195]
s_addk_i32 m0, 0x2000
ds_read_b64_tr_b16 a[156:157], v236 offset:12288
v_rcp_f32 v62, v62
v_mfma_f32_16x16x32_bf16 v[192:195], a[176:179], a[68:71], v[192:195]
s_waitcnt lgkmcnt(7)
ds_read_b64_tr_b16 a[158:159], v236 offset:14336
buffer_load_dwordx4 v254, s[8:11], s54 offen  lds
v_mfma_f32_16x16x32_bf16 v[192:195], a[184:187], a[84:87], v[192:195]
ds_read_b64_tr_b16 a[160:161], v236 offset:16384
v_rcp_f32 v63, v63
v_mfma_f32_16x16x32_bf16 v[192:195], a[188:191], a[92:95], v[192:195]
ds_read_b64_tr_b16 a[162:163], v236 offset:18432
v_rcp_f32 v76, v76
v_mfma_f32_16x16x32_bf16 v[184:187], a[188:191], a[88:91], v[184:187]
ds_read_b64_tr_b16 a[164:165], v236 offset:20480
v_rcp_f32 v77, v77
v_mfma_f32_16x16x32_bf16 v[184:187], a[184:187], a[80:83], v[184:187]
s_waitcnt lgkmcnt(7)
ds_read_b64_tr_b16 a[166:167], v236 offset:22528
v_rcp_f32 v78, v78
v_mfma_f32_16x16x32_bf16 v[216:219], a[144:147], a[0:3], 0
ds_read_b64_tr_b16 a[168:169], v236 offset:24576
v_rcp_f32 v79, v79
v_mfma_f32_16x16x32_bf16 v[216:219], a[148:151], a[8:11], v[216:219]
ds_read_b64_tr_b16 a[170:171], v236 offset:26624
v_rcp_f32 v140, v140
v_mfma_f32_16x16x32_bf16 v[220:223], a[148:151], a[12:15], 0
ds_read_b64_tr_b16 a[172:173], v236 offset:28672
v_rcp_f32 v141, v141
v_mfma_f32_16x16x32_bf16 v[220:223], a[144:147], a[4:7], v[220:223]
s_waitcnt lgkmcnt(7)
ds_read_b64_tr_b16 a[174:175], v236 offset:30720
buffer_load_dwordx4 v253, s[8:11], s54 offen offset:1024  lds
v_mfma_f32_16x16x32_bf16 v[220:223], a[152:155], a[20:23], v[220:223]
ds_read_b64_tr_b16 a[176:177], v236 offset:32768
v_rcp_f32 v142, v142
v_mfma_f32_16x16x32_bf16 v[220:223], a[156:159], a[28:31], v[220:223]
ds_read_b64_tr_b16 a[178:179], v236 offset:34816
v_rcp_f32 v143, v143
v_mfma_f32_16x16x32_bf16 v[216:219], a[156:159], a[24:27], v[216:219]
ds_read_b64_tr_b16 a[180:181], v236 offset:36864
v_rcp_f32 v144, v144
v_mfma_f32_16x16x32_bf16 v[216:219], a[152:155], a[16:19], v[216:219]
s_waitcnt lgkmcnt(7)
ds_read_b64_tr_b16 a[182:183], v236 offset:38912
v_rcp_f32 v145, v145
v_mfma_f32_16x16x32_bf16 v[216:219], a[160:163], a[32:35], v[216:219]
s_mul_i32 s55, s66, 4608
ds_read_b64_tr_b16 a[184:185], v236 offset:40960
v_rcp_f32 v146, v146
v_mfma_f32_16x16x32_bf16 v[216:219], a[164:167], a[40:43], v[216:219]
s_add_u32 s55, s55, s73
ds_read_b64_tr_b16 a[186:187], v236 offset:43008
v_rcp_f32 v147, v147
v_mfma_f32_16x16x32_bf16 v[220:223], a[164:167], a[44:47], v[220:223]
s_waitcnt vmcnt(10)
ds_read_b64_tr_b16 a[188:189], v236 offset:45056
v_rcp_f32 v180, v180
v_mfma_f32_16x16x32_bf16 v[220:223], a[160:163], a[36:39], v[220:223]
s_waitcnt lgkmcnt(7)
ds_read_b64_tr_b16 a[190:191], v236 offset:47104
v_rcp_f32 v181, v181
v_mfma_f32_16x16x32_bf16 v[220:223], a[168:171], a[52:55], v[220:223]
s_barrier
ds_read_b64_tr_b16 a[144:145], v231 offset:0
v_rcp_f32 v182, v182
v_mfma_f32_16x16x32_bf16 v[220:223], a[172:175], a[60:63], v[220:223]
s_addk_i32 m0, 0x2000
ds_read_b64_tr_b16 a[146:147], v231 offset:2048
v_rcp_f32 v183, v183
v_mfma_f32_16x16x32_bf16 v[216:219], a[172:175], a[56:59], v[216:219]
ds_read_b64_tr_b16 a[148:149], v231 offset:4096
buffer_load_dwordx4 v254, s[8:11], s55 offen  lds
v_mfma_f32_16x16x32_bf16 v[216:219], a[168:171], a[48:51], v[216:219]
s_waitcnt lgkmcnt(7)
ds_read_b64_tr_b16 a[150:151], v231 offset:6144
v_rcp_f32 v188, v188
v_mfma_f32_16x16x32_bf16 v[216:219], a[176:179], a[64:67], v[216:219]
ds_read_b64_tr_b16 a[152:153], v231 offset:8192
v_rcp_f32 v189, v189
v_mfma_f32_16x16x32_bf16 v[216:219], a[180:183], a[72:75], v[216:219]
ds_read_b64_tr_b16 a[154:155], v231 offset:10240
v_rcp_f32 v190, v190
v_mfma_f32_16x16x32_bf16 v[220:223], a[180:183], a[76:79], v[220:223]
ds_read_b64_tr_b16 a[156:157], v231 offset:12288
v_rcp_f32 v191, v191
v_mfma_f32_16x16x32_bf16 v[220:223], a[176:179], a[68:71], v[220:223]
s_waitcnt lgkmcnt(7)
ds_read_b64_tr_b16 a[158:159], v231 offset:14336
v_rcp_f32 v196, v196
v_mfma_f32_16x16x32_bf16 v[220:223], a[184:187], a[84:87], v[220:223]
ds_read_b64_tr_b16 a[160:161], v231 offset:16384
v_rcp_f32 v197, v197
v_mfma_f32_16x16x32_bf16 v[220:223], a[188:191], a[92:95], v[220:223]
ds_read_b64_tr_b16 a[162:163], v231 offset:18432
v_rcp_f32 v198, v198
v_mfma_f32_16x16x32_bf16 v[216:219], a[188:191], a[88:91], v[216:219]
ds_read_b64_tr_b16 a[164:165], v231 offset:20480
buffer_load_dwordx4 v253, s[8:11], s55 offen offset:1024  lds
v_mfma_f32_16x16x32_bf16 v[216:219], a[184:187], a[80:83], v[216:219]
s_waitcnt lgkmcnt(7)
ds_read_b64_tr_b16 a[166:167], v231 offset:22528
v_rcp_f32 v199, v199
v_mfma_f32_16x16x32_bf16 v[8:11], a[144:147], a[96:99], v[8:11]
s_mul_i32 s54, s70, 576
ds_read_b64_tr_b16 a[168:169], v228 offset:0
v_rcp_f32 v200, v200
v_mfma_f32_16x16x32_bf16 v[8:11], a[148:151], a[104:107], v[8:11]
s_add_u32 s54, s54, s74
ds_read_b64_tr_b16 a[170:171], v228 offset:2048
v_rcp_f32 v201, v201
v_mfma_f32_16x16x32_bf16 v[12:15], a[148:151], a[108:111], v[12:15]
s_mov_b32 m0, s53
ds_read_b64_tr_b16 a[172:173], v228 offset:4096
v_rcp_f32 v202, v202
v_mfma_f32_16x16x32_bf16 v[12:15], a[144:147], a[100:103], v[12:15]
s_waitcnt lgkmcnt(7)
ds_read_b64_tr_b16 a[174:175], v228 offset:6144
buffer_load_dwordx4 v234, s[12:15], s54 offen  lds
v_mfma_f32_16x16x32_bf16 v[12:15], a[152:155], v[96:99], v[12:15]
ds_read_b64_tr_b16 a[176:177], v228 offset:8192
v_rcp_f32 v203, v203
v_mfma_f32_16x16x32_bf16 v[12:15], a[156:159], v[100:103], v[12:15]
ds_read_b64_tr_b16 a[178:179], v228 offset:10240
s_nop 0
v_pk_mul_f32 v[60:61], v[60:61], v[152:153]
v_pk_mul_f32 v[62:63], v[62:63], v[154:155]
v_pk_mul_f32 v[76:77], v[76:77], v[148:149]
v_pk_mul_f32 v[78:79], v[78:79], v[150:151]
v_pk_mul_f32 v[140:141], v[140:141], v[164:165]
v_pk_mul_f32 v[142:143], v[142:143], v[166:167]
v_pk_mul_f32 v[144:145], v[144:145], v[160:161]
v_pk_mul_f32 v[146:147], v[146:147], v[162:163]
v_pk_mul_f32 v[180:181], v[180:181], v[168:169]
v_pk_mul_f32 v[182:183], v[182:183], v[170:171]
v_pk_mul_f32 v[188:189], v[188:189], v[92:93]
v_pk_mul_f32 v[190:191], v[190:191], v[94:95]
v_pk_mul_f32 v[196:197], v[196:197], v[128:129]
v_pk_mul_f32 v[198:199], v[198:199], v[130:131]
v_pk_mul_f32 v[200:201], v[200:201], v[176:177]
v_pk_mul_f32 v[202:203], v[202:203], v[178:179]
v_mfma_f32_16x16x32_bf16 v[8:11], a[156:159], v[108:111], v[8:11]
ds_read_b64_tr_b16 a[180:181], v228 offset:12288
v_cvt_pk_bf16_f32 v92, v60, v61
v_mfma_f32_16x16x32_bf16 v[8:11], a[152:155], v[104:107], v[8:11]
s_waitcnt lgkmcnt(7)
ds_read_b64_tr_b16 a[182:183], v228 offset:14336
v_cvt_pk_bf16_f32 v93, v62, v63
v_mfma_f32_16x16x32_bf16 v[8:11], a[160:163], v[120:123], v[8:11]
ds_read_b64_tr_b16 a[184:185], v228 offset:16384
v_cvt_pk_bf16_f32 v60, v76, v77
v_mfma_f32_16x16x32_bf16 v[8:11], a[164:167], v[124:127], v[8:11]
ds_read_b64_tr_b16 a[186:187], v228 offset:18432
v_cvt_pk_bf16_f32 v61, v78, v79
v_mfma_f32_16x16x32_bf16 v[12:15], a[164:167], v[116:119], v[12:15]
ds_read_b64_tr_b16 a[188:189], v228 offset:20480
v_cvt_pk_bf16_f32 v94, v140, v141
v_mfma_f32_16x16x32_bf16 v[12:15], a[160:163], v[112:115], v[12:15]
s_waitcnt lgkmcnt(7)
ds_read_b64_tr_b16 a[190:191], v228 offset:22528
buffer_load_dwordx4 v233, s[12:15], s54 offen offset:1024  lds
v_mfma_f32_16x16x32_bf16 v[16:19], a[168:171], a[96:99], v[16:19]
ds_read_b64_tr_b16 a[144:145], v213 offset:0
v_cvt_pk_bf16_f32 v95, v142, v143
v_mfma_f32_16x16x32_bf16 v[16:19], a[172:175], a[104:107], v[16:19]
ds_read_b64_tr_b16 a[146:147], v213 offset:2048
v_cvt_pk_bf16_f32 v62, v144, v145
v_mfma_f32_16x16x32_bf16 v[20:23], a[172:175], a[108:111], v[20:23]
ds_read_b64_tr_b16 a[148:149], v213 offset:4096
v_cvt_pk_bf16_f32 v63, v146, v147
v_mfma_f32_16x16x32_bf16 v[20:23], a[168:171], a[100:103], v[20:23]
s_waitcnt lgkmcnt(7)
ds_read_b64_tr_b16 a[150:151], v213 offset:6144
v_cvt_pk_bf16_f32 v76, v180, v181
v_mfma_f32_16x16x32_bf16 v[20:23], a[176:179], v[96:99], v[20:23]
s_mul_i32 s55, s71, 576
ds_read_b64_tr_b16 a[152:153], v213 offset:8192
v_cvt_pk_bf16_f32 v77, v182, v183
v_mfma_f32_16x16x32_bf16 v[20:23], a[180:183], v[100:103], v[20:23]
s_add_u32 s55, s55, s74
ds_read_b64_tr_b16 a[154:155], v213 offset:10240
v_cvt_pk_bf16_f32 v128, v188, v189
v_mfma_f32_16x16x32_bf16 v[16:19], a[180:183], v[108:111], v[16:19]
s_addk_i32 m0, 0x2000
ds_read_b64_tr_b16 a[156:157], v213 offset:12288
v_cvt_pk_bf16_f32 v129, v190, v191
v_mfma_f32_16x16x32_bf16 v[16:19], a[176:179], v[104:107], v[16:19]
s_waitcnt lgkmcnt(7)
ds_read_b64_tr_b16 a[158:159], v213 offset:14336
buffer_load_dwordx4 v234, s[12:15], s55 offen  lds
v_mfma_f32_16x16x32_bf16 v[16:19], a[184:187], v[120:123], v[16:19]
ds_read_b64_tr_b16 a[160:161], v213 offset:16384
v_cvt_pk_bf16_f32 v78, v196, v197
v_mfma_f32_16x16x32_bf16 v[16:19], a[188:191], v[124:127], v[16:19]
ds_read_b64_tr_b16 a[162:163], v213 offset:18432
v_cvt_pk_bf16_f32 v79, v198, v199
v_mfma_f32_16x16x32_bf16 v[20:23], a[188:191], v[116:119], v[20:23]
ds_read_b64_tr_b16 a[164:165], v213 offset:20480
v_cvt_pk_bf16_f32 v130, v200, v201
v_mfma_f32_16x16x32_bf16 v[20:23], a[184:187], v[112:115], v[20:23]
s_waitcnt lgkmcnt(7)
ds_read_b64_tr_b16 a[166:167], v213 offset:22528
v_cvt_pk_bf16_f32 v131, v202, v203
v_mfma_f32_16x16x32_bf16 v[184:187], a[144:147], a[96:99], v[184:187]
ds_read_b64_tr_b16 a[168:169], v212 offset:0
v_cvt_pk_bf16_f32 v140, v24, v26
v_mfma_f32_16x16x32_bf16 v[184:187], a[148:151], a[104:107], v[184:187]
ds_read_b64_tr_b16 a[170:171], v212 offset:2048
v_cvt_pk_bf16_f32 v141, v28, v30
v_mfma_f32_16x16x32_bf16 v[192:195], a[148:151], a[108:111], v[192:195]
ds_read_b64_tr_b16 a[172:173], v212 offset:4096
v_cvt_pk_bf16_f32 v142, v40, v42
v_mfma_f32_16x16x32_bf16 v[192:195], a[144:147], a[100:103], v[192:195]
s_waitcnt lgkmcnt(7)
ds_read_b64_tr_b16 a[174:175], v212 offset:6144
buffer_load_dwordx4 v233, s[12:15], s55 offen offset:1024  lds
v_mfma_f32_16x16x32_bf16 v[192:195], a[152:155], v[96:99], v[192:195]
ds_read_b64_tr_b16 a[176:177], v212 offset:8192
v_cvt_pk_bf16_f32 v143, v52, v54
v_mfma_f32_16x16x32_bf16 v[192:195], a[156:159], v[100:103], v[192:195]
ds_read_b64_tr_b16 a[178:179], v212 offset:10240
v_mov_b32 v226, 1.0
v_mfma_f32_16x16x32_bf16 v[184:187], a[156:159], v[108:111], v[184:187]
ds_read_b64_tr_b16 a[180:181], v212 offset:12288
v_mfma_f32_16x16x32_bf16 v[144:147], v[140:143], a[226:229], 0
v_mfma_f32_16x16x32_bf16 v[184:187], a[152:155], v[104:107], v[184:187]
s_waitcnt lgkmcnt(7)
ds_read_b64_tr_b16 a[182:183], v212 offset:14336
v_exp_f32 v148, v8
v_mfma_f32_16x16x32_bf16 v[184:187], a[160:163], v[120:123], v[184:187]
s_mul_i32 s54, s72, 576
ds_read_b64_tr_b16 a[184:185], v212 offset:16384
v_mfma_f32_16x16x32_bf16 v[152:155], v[140:143], a[222:225], 0
v_mfma_f32_16x16x32_bf16 v[184:187], a[164:167], v[124:127], v[184:187]
s_add_u32 s54, s54, s74
ds_read_b64_tr_b16 a[186:187], v212 offset:18432
v_cvt_pk_bf16_f32 v140, -v25, -v27
v_mfma_f32_16x16x32_bf16 v[192:195], a[164:167], v[116:119], v[192:195]
s_addk_i32 m0, 0x2000
ds_read_b64_tr_b16 a[188:189], v212 offset:20480
v_cvt_pk_bf16_f32 v141, -v29, -v31
v_mfma_f32_16x16x32_bf16 v[192:195], a[160:163], v[112:115], v[192:195]
s_waitcnt lgkmcnt(7)
ds_read_b64_tr_b16 a[190:191], v212 offset:22528
buffer_load_dwordx4 v234, s[12:15], s54 offen  lds
v_mfma_f32_16x16x32_bf16 v[216:219], a[168:171], a[96:99], v[216:219]
LM_p6:
s_cbranch_execz LM_v105
ds_read_b64_tr_b16 a[144:145], v231 offset:24576
v_cvt_pk_bf16_f32 v142, -v41, -v43
v_mfma_f32_16x16x32_bf16 v[216:219], a[172:175], a[104:107], v[216:219]
ds_read_b64_tr_b16 a[146:147], v231 offset:26624
v_cvt_pk_bf16_f32 v143, -v53, -v55
v_mfma_f32_16x16x32_bf16 v[220:223], a[172:175], a[108:111], v[220:223]
ds_read_b64_tr_b16 a[148:149], v231 offset:28672
v_exp_f32 v149, v9
v_mfma_f32_16x16x32_bf16 v[220:223], a[168:171], a[100:103], v[220:223]
s_waitcnt lgkmcnt(7)
ds_read_b64_tr_b16 a[150:151], v231 offset:30720
v_mfma_f32_16x16x32_bf16 v[24:27], v[140:143], a[226:229], 0
v_cvt_pk_bf16_f32 v28, v144, v145
v_cvt_pk_bf16_f32 v29, v146, v147
v_mfma_f32_16x16x32_bf16 v[220:223], a[176:179], v[96:99], v[220:223]
ds_read_b64_tr_b16 a[152:153], v231 offset:32768
v_exp_f32 v150, v10
v_mfma_f32_16x16x32_bf16 v[220:223], a[180:183], v[100:103], v[220:223]
ds_read_b64_tr_b16 a[154:155], v231 offset:34816
v_mfma_f32_16x16x32_bf16 v[40:43], v[140:143], a[222:225], 0
v_cvt_pk_bf16_f32 v52, v152, v153
v_cvt_pk_bf16_f32 v53, v154, v155
v_mfma_f32_16x16x32_bf16 v[216:219], a[180:183], v[108:111], v[216:219]
ds_read_b64_tr_b16 a[156:157], v231 offset:36864
v_cvt_pk_bf16_f32 v140, v64, v66
v_mfma_f32_16x16x32_bf16 v[216:219], a[176:179], v[104:107], v[216:219]
s_waitcnt lgkmcnt(7)
ds_read_b64_tr_b16 a[158:159], v231 offset:38912
buffer_load_dwordx4 v233, s[12:15], s54 offen offset:1024  lds
v_mfma_f32_16x16x32_bf16 v[216:219], a[184:187], v[120:123], v[216:219]
ds_read_b64_tr_b16 a[160:161], v231 offset:40960
v_cvt_pk_bf16_f32 v141, v68, v70
v_mfma_f32_16x16x32_bf16 v[216:219], a[188:191], v[124:127], v[216:219]
ds_read_b64_tr_b16 a[162:163], v231 offset:43008
v_cvt_pk_bf16_f32 v142, v80, v82
v_mfma_f32_16x16x32_bf16 v[220:223], a[188:191], v[116:119], v[220:223]
ds_read_b64_tr_b16 a[164:165], v231 offset:45056
v_cvt_pk_bf16_f32 v143, v84, v86
v_mfma_f32_16x16x32_bf16 v[220:223], a[184:187], v[112:115], v[220:223]
s_waitcnt lgkmcnt(7)
ds_read_b64_tr_b16 a[166:167], v231 offset:47104
v_exp_f32 v151, v11
v_mfma_f32_16x16x32_bf16 v[144:147], a[144:147], a[0:3], 0
s_mul_i32 s55, s74, 576
ds_read_b64_tr_b16 a[168:169], v228 offset:24576
v_mfma_f32_16x16x32_bf16 v[152:155], v[140:143], a[226:229], 0
v_cvt_pk_bf16_f32 v160, v24, v25
v_cvt_pk_bf16_f32 v161, v26, v27
v_mfma_f32_16x16x32_bf16 v[144:147], a[148:151], a[8:11], v[144:147]
s_addk_i32 m0, 0x2000
ds_read_b64_tr_b16 a[170:171], v228 offset:26624
v_exp_f32 v24, v12
v_mfma_f32_16x16x32_bf16 v[164:167], a[148:151], a[12:15], 0
ds_read_b64_tr_b16 a[172:173], v228 offset:28672
buffer_load_dwordx4 v235, s[20:23], s55 offen  lds
v_mfma_f32_16x16x32_bf16 v[164:167], a[144:147], a[4:7], v[164:167]
s_waitcnt lgkmcnt(7)
ds_read_b64_tr_b16 a[174:175], v228 offset:30720
v_mfma_f32_16x16x32_bf16 v[168:171], v[140:143], a[222:225], 0
v_cvt_pk_bf16_f32 v140, v40, v41
v_cvt_pk_bf16_f32 v141, v42, v43
v_mfma_f32_16x16x32_bf16 v[164:167], a[152:155], a[20:23], v[164:167]
ds_read_b64_tr_b16 a[176:177], v228 offset:32768
v_cvt_pk_bf16_f32 v40, -v65, -v67
v_mfma_f32_16x16x32_bf16 v[164:167], a[156:159], a[28:31], v[164:167]
ds_read_b64_tr_b16 a[178:179], v228 offset:34816
v_cvt_pk_bf16_f32 v41, -v69, -v71
v_mfma_f32_16x16x32_bf16 v[144:147], a[156:159], a[24:27], v[144:147]
ds_read_b64_tr_b16 a[180:181], v228 offset:36864
v_cvt_pk_bf16_f32 v42, -v81, -v83
v_mfma_f32_16x16x32_bf16 v[144:147], a[152:155], a[16:19], v[144:147]
s_waitcnt lgkmcnt(7)
ds_read_b64_tr_b16 a[182:183], v228 offset:38912
v_cvt_pk_bf16_f32 v43, -v85, -v87
v_mfma_f32_16x16x32_bf16 v[144:147], a[160:163], a[32:35], v[144:147]
ds_read_b64_tr_b16 a[184:185], v228 offset:40960
v_exp_f32 v25, v13
v_mfma_f32_16x16x32_bf16 v[144:147], a[164:167], a[40:43], v[144:147]
ds_read_b64_tr_b16 a[186:187], v228 offset:43008
v_mfma_f32_16x16x32_bf16 v[64:67], v[40:43], a[226:229], 0
v_cvt_pk_bf16_f32 v30, v152, v153
v_cvt_pk_bf16_f32 v31, v154, v155
v_mfma_f32_16x16x32_bf16 v[164:167], a[164:167], a[44:47], v[164:167]
ds_read_b64_tr_b16 a[188:189], v228 offset:45056
buffer_load_dwordx4 v252, s[20:23], s55 offen offset:1024  lds
v_mfma_f32_16x16x32_bf16 v[164:167], a[160:163], a[36:39], v[164:167]
s_waitcnt lgkmcnt(7)
ds_read_b64_tr_b16 a[190:191], v228 offset:47104
v_mfma_f32_16x16x32_bf16 v[68:71], v[40:43], a[222:225], 0
v_cvt_pk_bf16_f32 v54, v168, v169
v_cvt_pk_bf16_f32 v55, v170, v171
v_mfma_f32_16x16x32_bf16 v[40:43], a[168:171], a[0:3], 0
ds_read_b64_tr_b16 a[144:145], v213 offset:24576
v_cvt_pk_bf16_f32 v80, v4, v6
v_mfma_f32_16x16x32_bf16 v[40:43], a[172:175], a[8:11], v[40:43]
ds_read_b64_tr_b16 a[146:147], v213 offset:26624
v_cvt_pk_bf16_f32 v81, v88, v90
v_mfma_f32_16x16x32_bf16 v[84:87], a[172:175], a[12:15], 0
ds_read_b64_tr_b16 a[148:149], v213 offset:28672
v_cvt_pk_bf16_f32 v82, v32, v34
v_mfma_f32_16x16x32_bf16 v[84:87], a[168:171], a[4:7], v[84:87]
s_waitcnt lgkmcnt(7)
ds_read_b64_tr_b16 a[150:151], v213 offset:30720
v_cvt_pk_bf16_f32 v83, v44, v46
v_mfma_f32_16x16x32_bf16 v[84:87], a[176:179], a[20:23], v[84:87]
s_mul_i32 s54, s74, 576
ds_read_b64_tr_b16 a[152:153], v213 offset:32768
v_exp_f32 v26, v14
v_mfma_f32_16x16x32_bf16 v[84:87], a[180:183], a[28:31], v[84:87]
s_addk_i32 m0, 0x2000
ds_read_b64_tr_b16 a[154:155], v213 offset:34816
v_mfma_f32_16x16x32_bf16 v[152:155], v[80:83], a[226:229], 0
v_cvt_pk_bf16_f32 v162, v64, v65
v_cvt_pk_bf16_f32 v163, v66, v67
v_mfma_f32_16x16x32_bf16 v[40:43], a[180:183], a[24:27], v[40:43]
ds_read_b64_tr_b16 a[156:157], v213 offset:36864
buffer_load_dwordx4 v235, s[24:27], s54 offen  lds
v_mfma_f32_16x16x32_bf16 v[40:43], a[176:179], a[16:19], v[40:43]
s_waitcnt lgkmcnt(7)
ds_read_b64_tr_b16 a[158:159], v213 offset:38912
v_mfma_f32_16x16x32_bf16 v[64:67], v[80:83], a[222:225], 0
v_cvt_pk_bf16_f32 v142, v68, v69
v_cvt_pk_bf16_f32 v143, v70, v71
v_mfma_f32_16x16x32_bf16 v[40:43], a[184:187], a[32:35], v[40:43]
ds_read_b64_tr_b16 a[160:161], v213 offset:40960
v_cvt_pk_bf16_f32 v68, -v5, -v7
v_mfma_f32_16x16x32_bf16 v[40:43], a[188:191], a[40:43], v[40:43]
ds_read_b64_tr_b16 a[162:163], v213 offset:43008
v_cvt_pk_bf16_f32 v69, -v89, -v91
v_mfma_f32_16x16x32_bf16 v[84:87], a[188:191], a[44:47], v[84:87]
ds_read_b64_tr_b16 a[164:165], v213 offset:45056
v_cvt_pk_bf16_f32 v70, -v33, -v35
v_mfma_f32_16x16x32_bf16 v[84:87], a[184:187], a[36:39], v[84:87]
s_waitcnt lgkmcnt(7)
ds_read_b64_tr_b16 a[166:167], v213 offset:47104
v_cvt_pk_bf16_f32 v71, -v45, -v47
v_mfma_f32_16x16x32_bf16 v[4:7], a[144:147], a[0:3], 0
ds_read_b64_tr_b16 a[168:169], v212 offset:24576
v_exp_f32 v27, v15
v_mfma_f32_16x16x32_bf16 v[4:7], a[148:151], a[8:11], v[4:7]
ds_read_b64_tr_b16 a[170:171], v212 offset:26624
v_mfma_f32_16x16x32_bf16 v[32:35], v[68:71], a[226:229], 0
v_cvt_pk_bf16_f32 v44, v152, v153
v_cvt_pk_bf16_f32 v45, v154, v155
v_mfma_f32_16x16x32_bf16 v[80:83], a[148:151], a[12:15], 0
ds_read_b64_tr_b16 a[172:173], v212 offset:28672
buffer_load_dwordx4 v252, s[24:27], s54 offen offset:1024  lds
v_mfma_f32_16x16x32_bf16 v[80:83], a[144:147], a[4:7], v[80:83]
s_waitcnt lgkmcnt(7)
ds_read_b64_tr_b16 a[174:175], v212 offset:30720
v_mfma_f32_16x16x32_bf16 v[88:91], v[68:71], a[222:225], 0
v_cvt_pk_bf16_f32 v68, v64, v65
v_cvt_pk_bf16_f32 v69, v66, v67
v_mfma_f32_16x16x32_bf16 v[80:83], a[152:155], a[20:23], v[80:83]
ds_read_b64_tr_b16 a[176:177], v212 offset:32768
v_exp_f32 v64, v16
v_mfma_f32_16x16x32_bf16 v[80:83], a[156:159], a[28:31], v[80:83]
ds_read_b64_tr_b16 a[178:179], v212 offset:34816
v_exp_f32 v65, v17
v_mfma_f32_16x16x32_bf16 v[4:7], a[156:159], a[24:27], v[4:7]
ds_read_b64_tr_b16 a[180:181], v212 offset:36864
v_exp_f32 v66, v18
v_mfma_f32_16x16x32_bf16 v[4:7], a[152:155], a[16:19], v[4:7]
s_waitcnt lgkmcnt(7)
ds_read_b64_tr_b16 a[182:183], v212 offset:38912
v_exp_f32 v67, v19
v_mfma_f32_16x16x32_bf16 v[4:7], a[160:163], a[32:35], v[4:7]
s_mul_i32 s55, s73, 576
ds_read_b64_tr_b16 a[184:185], v212 offset:40960
v_exp_f32 v152, v20
v_mfma_f32_16x16x32_bf16 v[4:7], a[164:167], a[40:43], v[4:7]
s_add_u32 s55, s55, s74
ds_read_b64_tr_b16 a[186:187], v212 offset:43008
v_exp_f32 v153, v21
v_mfma_f32_16x16x32_bf16 v[80:83], a[164:167], a[44:47], v[80:83]
s_waitcnt vmcnt(10)
ds_read_b64_tr_b16 a[188:189], v212 offset:45056
v_exp_f32 v154, v22
v_mfma_f32_16x16x32_bf16 v[80:83], a[160:163], a[36:39], v[80:83]
s_waitcnt lgkmcnt(7)
ds_read_b64_tr_b16 a[190:191], v212 offset:47104
v_exp_f32 v155, v23
v_mfma_f32_16x16x32_bf16 v[168:171], a[168:171], a[0:3], 0
s_barrier
ds_read_b64_tr_b16 a[144:145], v209 offset:0
v_exp_f32 v176, v184
v_mfma_f32_16x16x32_bf16 v[168:171], a[172:175], a[8:11], v[168:171]
s_addk_i32 m0, 0x2000
ds_read_b64_tr_b16 a[146:147], v209 offset:2048
v_exp_f32 v177, v185
v_mfma_f32_16x16x32_bf16 v[180:183], a[172:175], a[12:15], 0
ds_read_b64_tr_b16 a[148:149], v209 offset:4096
buffer_load_dwordx4 v234, s[12:15], s55 offen  lds
v_mfma_f32_16x16x32_bf16 v[180:183], a[168:171], a[4:7], v[180:183]
s_waitcnt lgkmcnt(7)
ds_read_b64_tr_b16 a[150:151], v209 offset:6144
v_exp_f32 v178, v186
v_mfma_f32_16x16x32_bf16 v[180:183], a[176:179], a[20:23], v[180:183]
ds_read_b64_tr_b16 a[152:153], v209 offset:8192
v_exp_f32 v179, v187
v_mfma_f32_16x16x32_bf16 v[180:183], a[180:183], a[28:31], v[180:183]
ds_read_b64_tr_b16 a[154:155], v209 offset:10240
v_exp_f32 v188, v192
v_mfma_f32_16x16x32_bf16 v[168:171], a[180:183], a[24:27], v[168:171]
ds_read_b64_tr_b16 a[156:157], v209 offset:12288
v_exp_f32 v189, v193
v_mfma_f32_16x16x32_bf16 v[168:171], a[176:179], a[16:19], v[168:171]
s_waitcnt lgkmcnt(7)
ds_read_b64_tr_b16 a[158:159], v209 offset:14336
v_exp_f32 v190, v194
v_mfma_f32_16x16x32_bf16 v[168:171], a[184:187], a[32:35], v[168:171]
ds_read_b64_tr_b16 a[160:161], v209 offset:16384
v_exp_f32 v191, v195
v_mfma_f32_16x16x32_bf16 v[168:171], a[188:191], a[40:43], v[168:171]
ds_read_b64_tr_b16 a[162:163], v209 offset:18432
v_exp_f32 v196, v216
v_mfma_f32_16x16x32_bf16 v[180:183], a[188:191], a[44:47], v[180:183]
ds_read_b64_tr_b16 a[164:165], v209 offset:20480
buffer_load_dwordx4 v233, s[12:15], s55 offen offset:1024  lds
v_mfma_f32_16x16x32_bf16 v[180:183], a[184:187], a[36:39], v[180:183]
s_waitcnt lgkmcnt(7)
ds_read_b64_tr_b16 a[166:167], v209 offset:22528
v_exp_f32 v197, v217
v_mfma_f32_16x16x32_bf16 v[144:147], a[144:147], a[48:51], v[144:147]
s_mul_i32 s54, s70, 576
ds_read_b64_tr_b16 a[168:169], v209 offset:24576
v_exp_f32 v198, v218
v_mfma_f32_16x16x32_bf16 v[144:147], a[148:151], a[56:59], v[144:147]
s_add_u32 s54, s54, s75
ds_read_b64_tr_b16 a[170:171], v209 offset:26624
v_exp_f32 v199, v219
v_mfma_f32_16x16x32_bf16 v[164:167], a[148:151], a[60:63], v[164:167]
s_addk_i32 m0, 0x2000
ds_read_b64_tr_b16 a[172:173], v209 offset:28672
v_exp_f32 v200, v220
v_mfma_f32_16x16x32_bf16 v[164:167], a[144:147], a[52:55], v[164:167]
s_waitcnt lgkmcnt(7)
ds_read_b64_tr_b16 a[174:175], v209 offset:30720
buffer_load_dwordx4 v234, s[12:15], s54 offen  lds
v_mfma_f32_16x16x32_bf16 v[164:167], a[152:155], a[68:71], v[164:167]
ds_read_b64_tr_b16 a[176:177], v209 offset:32768
v_exp_f32 v201, v221
v_mfma_f32_16x16x32_bf16 v[164:167], a[156:159], a[76:79], v[164:167]
ds_read_b64_tr_b16 a[178:179], v209 offset:34816
v_exp_f32 v202, v222
v_mfma_f32_16x16x32_bf16 v[144:147], a[156:159], a[72:75], v[144:147]
ds_read_b64_tr_b16 a[180:181], v209 offset:36864
v_exp_f32 v203, v223
v_mfma_f32_16x16x32_bf16 v[144:147], a[152:155], a[64:67], v[144:147]
s_waitcnt lgkmcnt(7)
ds_read_b64_tr_b16 a[182:183], v209 offset:38912
s_nop 0
v_pk_add_f32 v[148:149], v[148:149], v[226:227] op_sel_hi:[1,0]
v_pk_add_f32 v[150:151], v[150:151], v[226:227] op_sel_hi:[1,0]
v_pk_add_f32 v[24:25], v[24:25], v[226:227] op_sel_hi:[1,0]
v_pk_add_f32 v[26:27], v[26:27], v[226:227] op_sel_hi:[1,0]
v_pk_add_f32 v[64:65], v[64:65], v[226:227] op_sel_hi:[1,0]
v_pk_add_f32 v[66:67], v[66:67], v[226:227] op_sel_hi:[1,0]
v_pk_add_f32 v[152:153], v[152:153], v[226:227] op_sel_hi:[1,0]
v_pk_add_f32 v[154:155], v[154:155], v[226:227] op_sel_hi:[1,0]
v_pk_add_f32 v[176:177], v[176:177], v[226:227] op_sel_hi:[1,0]
v_pk_add_f32 v[178:179], v[178:179], v[226:227] op_sel_hi:[1,0]
v_pk_add_f32 v[188:189], v[188:189], v[226:227] op_sel_hi:[1,0]
v_pk_add_f32 v[190:191], v[190:191], v[226:227] op_sel_hi:[1,0]
v_pk_add_f32 v[196:197], v[196:197], v[226:227] op_sel_hi:[1,0]
v_pk_add_f32 v[198:199], v[198:199], v[226:227] op_sel_hi:[1,0]
v_pk_add_f32 v[200:201], v[200:201], v[226:227] op_sel_hi:[1,0]
v_pk_add_f32 v[202:203], v[202:203], v[226:227] op_sel_hi:[1,0]
v_mfma_f32_16x16x32_bf16 v[144:147], a[160:163], a[80:83], v[144:147]
ds_read_b64_tr_b16 a[184:185], v209 offset:40960
v_rcp_f32 v148, v148
v_mfma_f32_16x16x32_bf16 v[144:147], a[164:167], a[88:91], v[144:147]
ds_read_b64_tr_b16 a[186:187], v209 offset:43008
v_rcp_f32 v149, v149
v_mfma_f32_16x16x32_bf16 v[164:167], a[164:167], a[92:95], v[164:167]
ds_read_b64_tr_b16 a[188:189], v209 offset:45056
v_rcp_f32 v150, v150
v_mfma_f32_16x16x32_bf16 v[164:167], a[160:163], a[84:87], v[164:167]
s_waitcnt lgkmcnt(7)
ds_read_b64_tr_b16 a[190:191], v209 offset:47104
buffer_load_dwordx4 v233, s[12:15], s54 offen offset:1024  lds
v_mfma_f32_16x16x32_bf16 v[164:167], a[168:171], a[100:103], v[164:167]
ds_read_b64_tr_b16 a[144:145], v208 offset:0
v_rcp_f32 v151, v151
v_mfma_f32_16x16x32_bf16 v[164:167], a[172:175], a[108:111], v[164:167]
ds_read_b64_tr_b16 a[146:147], v208 offset:2048
v_rcp_f32 v24, v24
v_mfma_f32_16x16x32_bf16 v[144:147], a[172:175], a[104:107], v[144:147]
ds_read_b64_tr_b16 a[148:149], v208 offset:4096
v_rcp_f32 v25, v25
v_mfma_f32_16x16x32_bf16 v[144:147], a[168:171], a[96:99], v[144:147]
s_waitcnt lgkmcnt(7)
ds_read_b64_tr_b16 a[150:151], v208 offset:6144
v_rcp_f32 v26, v26
v_mfma_f32_16x16x32_bf16 v[144:147], a[176:179], v[104:107], v[144:147]
s_mul_i32 s55, s71, 576
ds_read_b64_tr_b16 a[152:153], v208 offset:8192
v_rcp_f32 v27, v27
v_mfma_f32_16x16x32_bf16 v[144:147], a[180:183], v[108:111], v[144:147]
s_add_u32 s55, s55, s75
ds_read_b64_tr_b16 a[154:155], v208 offset:10240
v_rcp_f32 v64, v64
v_mfma_f32_16x16x32_bf16 v[164:167], a[180:183], v[100:103], v[164:167]
s_addk_i32 m0, 0x2000
ds_read_b64_tr_b16 a[156:157], v208 offset:12288
v_rcp_f32 v65, v65
v_mfma_f32_16x16x32_bf16 v[164:167], a[176:179], v[96:99], v[164:167]
s_waitcnt lgkmcnt(7)
ds_read_b64_tr_b16 a[158:159], v208 offset:14336
buffer_load_dwordx4 v234, s[12:15], s55 offen  lds
v_mfma_f32_16x16x32_bf16 v[164:167], a[184:187], v[112:115], v[164:167]
ds_read_b64_tr_b16 a[160:161], v208 offset:16384
v_rcp_f32 v66, v66
v_mfma_f32_16x16x32_bf16 v[164:167], a[188:191], v[116:119], v[164:167]
ds_read_b64_tr_b16 a[162:163], v208 offset:18432
v_rcp_f32 v67, v67
v_mfma_f32_16x16x32_bf16 v[144:147], a[188:191], v[124:127], v[144:147]
ds_read_b64_tr_b16 a[164:165], v208 offset:20480
v_rcp_f32 v152, v152
v_mfma_f32_16x16x32_bf16 v[144:147], a[184:187], v[120:123], v[144:147]
s_waitcnt lgkmcnt(7)
ds_read_b64_tr_b16 a[166:167], v208 offset:22528
v_rcp_f32 v153, v153
v_mfma_f32_16x16x32_bf16 v[40:43], a[144:147], a[48:51], v[40:43]
ds_read_b64_tr_b16 a[168:169], v208 offset:24576
v_rcp_f32 v154, v154
v_mfma_f32_16x16x32_bf16 v[40:43], a[148:151], a[56:59], v[40:43]
ds_read_b64_tr_b16 a[170:171], v208 offset:26624
v_rcp_f32 v155, v155
v_mfma_f32_16x16x32_bf16 v[84:87], a[148:151], a[60:63], v[84:87]
ds_read_b64_tr_b16 a[172:173], v208 offset:28672
v_rcp_f32 v176, v176
v_mfma_f32_16x16x32_bf16 v[84:87], a[144:147], a[52:55], v[84:87]
s_waitcnt lgkmcnt(7)
ds_read_b64_tr_b16 a[174:175], v208 offset:30720
buffer_load_dwordx4 v233, s[12:15], s55 offen offset:1024  lds
v_mfma_f32_16x16x32_bf16 v[84:87], a[152:155], a[68:71], v[84:87]
ds_read_b64_tr_b16 a[176:177], v208 offset:32768
v_rcp_f32 v177, v177
v_mfma_f32_16x16x32_bf16 v[84:87], a[156:159], a[76:79], v[84:87]
ds_read_b64_tr_b16 a[178:179], v208 offset:34816
v_rcp_f32 v178, v178
v_mfma_f32_16x16x32_bf16 v[40:43], a[156:159], a[72:75], v[40:43]
ds_read_b64_tr_b16 a[180:181], v208 offset:36864
v_rcp_f32 v179, v179
v_mfma_f32_16x16x32_bf16 v[40:43], a[152:155], a[64:67], v[40:43]
s_waitcnt lgkmcnt(7)
ds_read_b64_tr_b16 a[182:183], v208 offset:38912
v_rcp_f32 v188, v188
v_mfma_f32_16x16x32_bf16 v[40:43], a[160:163], a[80:83], v[40:43]
s_mul_i32 s54, s72, 576
ds_read_b64_tr_b16 a[184:185], v208 offset:40960
v_rcp_f32 v189, v189
v_mfma_f32_16x16x32_bf16 v[40:43], a[164:167], a[88:91], v[40:43]
s_add_u32 s54, s54, s75
ds_read_b64_tr_b16 a[186:187], v208 offset:43008
v_rcp_f32 v190, v190
v_mfma_f32_16x16x32_bf16 v[84:87], a[164:167], a[92:95], v[84:87]
s_addk_i32 m0, 0x2000
ds_read_b64_tr_b16 a[188:189], v208 offset:45056
v_rcp_f32 v191, v191
v_mfma_f32_16x16x32_bf16 v[84:87], a[160:163], a[84:87], v[84:87]
s_waitcnt lgkmcnt(7)
ds_read_b64_tr_b16 a[190:191], v208 offset:47104
buffer_load_dwordx4 v234, s[12:15], s54 offen  lds
v_mfma_f32_16x16x32_bf16 v[84:87], a[168:171], a[100:103], v[84:87]
s_lshl_b32 s86, s49, 2
ds_read_b64_tr_b16 a[144:145], v207 offset:0
v_rcp_f32 v196, v196
v_mfma_f32_16x16x32_bf16 v[84:87], a[172:175], a[108:111], v[84:87]
s_add_u32 s86, s86, 128
ds_read_b64_tr_b16 a[146:147], v207 offset:2048
v_mov_b32 v254, s86
v_mfma_f32_16x16x32_bf16 v[40:43], a[172:175], a[104:107], v[40:43]
buffer_load_dword v253, v254, s[36:39], 0 offen
ds_read_b64_tr_b16 a[148:149], v207 offset:4096
v_mfma_f32_16x16x32_bf16 v[40:43], a[168:171], a[96:99], v[40:43]
s_waitcnt lgkmcnt(7)
ds_read_b64_tr_b16 a[150:151], v207 offset:6144
v_rcp_f32 v197, v197
v_mfma_f32_16x16x32_bf16 v[40:43], a[176:179], v[104:107], v[40:43]
ds_read_b64_tr_b16 a[152:153], v207 offset:8192
v_rcp_f32 v198, v198
v_mfma_f32_16x16x32_bf16 v[40:43], a[180:183], v[108:111], v[40:43]
ds_read_b64_tr_b16 a[154:155], v207 offset:10240
v_rcp_f32 v199, v199
v_mfma_f32_16x16x32_bf16 v[84:87], a[180:183], v[100:103], v[84:87]
ds_read_b64_tr_b16 a[156:157], v207 offset:12288
v_rcp_f32 v200, v200
v_mfma_f32_16x16x32_bf16 v[84:87], a[176:179], v[96:99], v[84:87]
s_waitcnt lgkmcnt(7)
ds_read_b64_tr_b16 a[158:159], v207 offset:14336
buffer_load_dwordx4 v233, s[12:15], s54 offen offset:1024  lds
v_mfma_f32_16x16x32_bf16 v[84:87], a[184:187], v[112:115], v[84:87]
ds_read_b64_tr_b16 a[160:161], v207 offset:16384
v_rcp_f32 v201, v201
v_mfma_f32_16x16x32_bf16 v[84:87], a[188:191], v[116:119], v[84:87]
ds_read_b64_tr_b16 a[162:163], v207 offset:18432
v_rcp_f32 v202, v202
v_mfma_f32_16x16x32_bf16 v[40:43], a[188:191], v[124:127], v[40:43]
ds_read_b64_tr_b16 a[164:165], v207 offset:20480
v_rcp_f32 v203, v203
v_mfma_f32_16x16x32_bf16 v[40:43], a[184:187], v[120:123], v[40:43]
s_waitcnt lgkmcnt(7)
ds_read_b64_tr_b16 a[166:167], v207 offset:22528
v_pk_mul_f32 v[148:149], v[148:149], v[8:9]
v_pk_mul_f32 v[150:151], v[150:151], v[10:11]
v_pk_mul_f32 v[24:25], v[24:25], v[12:13]
v_pk_mul_f32 v[26:27], v[26:27], v[14:15]
v_pk_mul_f32 v[64:65], v[64:65], v[16:17]
v_pk_mul_f32 v[66:67], v[66:67], v[18:19]
v_pk_mul_f32 v[152:153], v[152:153], v[20:21]
v_pk_mul_f32 v[154:155], v[154:155], v[22:23]
v_pk_mul_f32 v[176:177], v[176:177], v[184:185]
v_pk_mul_f32 v[178:179], v[178:179], v[186:187]
v_pk_mul_f32 v[188:189], v[188:189], v[192:193]
v_pk_mul_f32 v[190:191], v[190:191], v[194:195]
v_pk_mul_f32 v[196:197], v[196:197], v[216:217]
v_pk_mul_f32 v[198:199], v[198:199], v[218:219]
v_pk_mul_f32 v[200:201], v[200:201], v[220:221]
v_pk_mul_f32 v[202:203], v[202:203], v[222:223]
v_mfma_f32_16x16x32_bf16 v[4:7], a[144:147], a[48:51], v[4:7]
s_mul_i32 s55, s75, 576
ds_read_b64_tr_b16 a[168:169], v207 offset:24576
v_cvt_pk_bf16_f32 v8, v148, v149
v_mfma_f32_16x16x32_bf16 v[4:7], a[148:151], a[56:59], v[4:7]
s_addk_i32 m0, 0x2000
ds_read_b64_tr_b16 a[170:171], v207 offset:26624
v_cvt_pk_bf16_f32 v9, v150, v151
v_mfma_f32_16x16x32_bf16 v[80:83], a[148:151], a[60:63], v[80:83]
ds_read_b64_tr_b16 a[172:173], v207 offset:28672
buffer_load_dwordx4 v235, s[20:23], s55 offen  lds
v_mfma_f32_16x16x32_bf16 v[80:83], a[144:147], a[52:55], v[80:83]
s_waitcnt lgkmcnt(7)
ds_read_b64_tr_b16 a[174:175], v207 offset:30720
v_cvt_pk_bf16_f32 v12, v24, v25
v_mfma_f32_16x16x32_bf16 v[80:83], a[152:155], a[68:71], v[80:83]
ds_read_b64_tr_b16 a[176:177], v207 offset:32768
v_cvt_pk_bf16_f32 v13, v26, v27
v_mfma_f32_16x16x32_bf16 v[80:83], a[156:159], a[76:79], v[80:83]
ds_read_b64_tr_b16 a[178:179], v207 offset:34816
v_cvt_pk_bf16_f32 v16, v36, v38
v_mfma_f32_16x16x32_bf16 v[4:7], a[156:159], a[72:75], v[4:7]
ds_read_b64_tr_b16 a[180:181], v207 offset:36864
v_cvt_pk_bf16_f32 v17, v132, v134
v_mfma_f32_16x16x32_bf16 v[4:7], a[152:155], a[64:67], v[4:7]
s_waitcnt lgkmcnt(7)
ds_read_b64_tr_b16 a[182:183], v207 offset:38912
v_cvt_pk_bf16_f32 v18, v56, v58
v_mfma_f32_16x16x32_bf16 v[4:7], a[160:163], a[80:83], v[4:7]
ds_read_b64_tr_b16 a[184:185], v207 offset:40960
v_cvt_pk_bf16_f32 v19, v72, v74
v_mfma_f32_16x16x32_bf16 v[4:7], a[164:167], a[88:91], v[4:7]
ds_read_b64_tr_b16 a[186:187], v207 offset:43008
v_cvt_pk_bf16_f32 v10, v64, v65
v_mfma_f32_16x16x32_bf16 v[80:83], a[164:167], a[92:95], v[80:83]
ds_read_b64_tr_b16 a[188:189], v207 offset:45056
buffer_load_dwordx4 v252, s[20:23], s55 offen offset:1024  lds
v_mfma_f32_16x16x32_bf16 v[80:83], a[160:163], a[84:87], v[80:83]
s_waitcnt lgkmcnt(7)
ds_read_b64_tr_b16 a[190:191], v207 offset:47104
v_mfma_f32_16x16x32_bf16 v[20:23], v[16:19], a[226:229], 0
v_cvt_pk_bf16_f32 v24, v32, v33
v_cvt_pk_bf16_f32 v25, v34, v35
v_mfma_f32_16x16x32_bf16 v[80:83], a[168:171], a[100:103], v[80:83]
ds_read_b64_tr_b16 a[144:145], v206 offset:0
v_cvt_pk_bf16_f32 v11, v66, v67
v_mfma_f32_16x16x32_bf16 v[80:83], a[172:175], a[108:111], v[80:83]
ds_read_b64_tr_b16 a[146:147], v206 offset:2048
v_mfma_f32_16x16x32_bf16 v[32:35], v[16:19], a[222:225], 0
v_cvt_pk_bf16_f32 v16, v88, v89
v_cvt_pk_bf16_f32 v17, v90, v91
v_mfma_f32_16x16x32_bf16 v[4:7], a[172:175], a[104:107], v[4:7]
ds_read_b64_tr_b16 a[148:149], v206 offset:4096
v_cvt_pk_bf16_f32 v14, v152, v153
v_mfma_f32_16x16x32_bf16 v[4:7], a[168:171], a[96:99], v[4:7]
s_waitcnt lgkmcnt(7)
ds_read_b64_tr_b16 a[150:151], v206 offset:6144
v_cvt_pk_bf16_f32 v15, v154, v155
v_mfma_f32_16x16x32_bf16 v[4:7], a[176:179], v[104:107], v[4:7]
s_mul_i32 s54, s75, 576
ds_read_b64_tr_b16 a[152:153], v206 offset:8192
v_cvt_pk_bf16_f32 v64, -v37, -v39
v_mfma_f32_16x16x32_bf16 v[4:7], a[180:183], v[108:111], v[4:7]
s_addk_i32 m0, 0x2000
ds_read_b64_tr_b16 a[154:155], v206 offset:10240
v_cvt_pk_bf16_f32 v65, -v133, -v135
v_mfma_f32_16x16x32_bf16 v[80:83], a[180:183], v[100:103], v[80:83]
ds_read_b64_tr_b16 a[156:157], v206 offset:12288
buffer_load_dwordx4 v235, s[24:27], s54 offen  lds
v_mfma_f32_16x16x32_bf16 v[80:83], a[176:179], v[96:99], v[80:83]
s_waitcnt lgkmcnt(7)
ds_read_b64_tr_b16 a[158:159], v206 offset:14336
v_cvt_pk_bf16_f32 v66, -v57, -v59
v_mfma_f32_16x16x32_bf16 v[80:83], a[184:187], v[112:115], v[80:83]
ds_read_b64_tr_b16 a[160:161], v206 offset:16384
v_cvt_pk_bf16_f32 v67, -v73, -v75
v_mfma_f32_16x16x32_bf16 v[80:83], a[188:191], v[116:119], v[80:83]
ds_read_b64_tr_b16 a[162:163], v206 offset:18432
v_cvt_pk_bf16_f32 v36, v176, v177
v_mfma_f32_16x16x32_bf16 v[4:7], a[188:191], v[124:127], v[4:7]
ds_read_b64_tr_b16 a[164:165], v206 offset:20480
v_mfma_f32_16x16x32_bf16 v[56:59], v[64:67], a[226:229], 0
v_cvt_pk_bf16_f32 v46, v20, v21
v_cvt_pk_bf16_f32 v47, v22, v23
v_mfma_f32_16x16x32_bf16 v[4:7], a[184:187], v[120:123], v[4:7]
s_waitcnt lgkmcnt(7)
ds_read_b64_tr_b16 a[166:167], v206 offset:22528
v_cvt_pk_bf16_f32 v37, v178, v179
v_mfma_f32_16x16x32_bf16 v[168:171], a[144:147], a[48:51], v[168:171]
ds_read_b64_tr_b16 a[168:169], v206 offset:24576
v_cvt_pk_bf16_f32 v20, v188, v189
v_mfma_f32_16x16x32_bf16 v[168:171], a[148:151], a[56:59], v[168:171]
ds_read_b64_tr_b16 a[170:171], v206 offset:26624
v_cvt_pk_bf16_f32 v21, v190, v191
v_mfma_f32_16x16x32_bf16 v[180:183], a[148:151], a[60:63], v[180:183]
ds_read_b64_tr_b16 a[172:173], v206 offset:28672
buffer_load_dwordx4 v252, s[24:27], s54 offen offset:1024  lds
v_mfma_f32_16x16x32_bf16 v[180:183], a[144:147], a[52:55], v[180:183]
s_waitcnt lgkmcnt(7)
ds_read_b64_tr_b16 a[174:175], v206 offset:30720
v_cvt_pk_bf16_f32 v38, v196, v197
v_mfma_f32_16x16x32_bf16 v[180:183], a[152:155], a[68:71], v[180:183]
ds_read_b64_tr_b16 a[176:177], v206 offset:32768
v_cvt_pk_bf16_f32 v39, v198, v199
v_mfma_f32_16x16x32_bf16 v[180:183], a[156:159], a[76:79], v[180:183]
ds_read_b64_tr_b16 a[178:179], v206 offset:34816
v_cvt_pk_bf16_f32 v22, v200, v201
v_mfma_f32_16x16x32_bf16 v[168:171], a[156:159], a[72:75], v[168:171]
ds_read_b64_tr_b16 a[180:181], v206 offset:36864
v_cvt_pk_bf16_f32 v23, v202, v203
v_mfma_f32_16x16x32_bf16 v[168:171], a[152:155], a[64:67], v[168:171]
s_waitcnt lgkmcnt(7)
ds_read_b64_tr_b16 a[182:183], v206 offset:38912
v_mfma_f32_16x16x32_bf16 v[72:75], v[64:67], a[222:225], 0
v_cvt_pk_bf16_f32 v70, v32, v33
v_cvt_pk_bf16_f32 v71, v34, v35
v_mfma_f32_16x16x32_bf16 v[168:171], a[160:163], a[80:83], v[168:171]
s_mul_i32 s55, s73, 576
ds_read_b64_tr_b16 a[184:185], v206 offset:40960
v_mov_b32 v226, 1.0
v_mfma_f32_16x16x32_bf16 v[168:171], a[164:167], a[88:91], v[168:171]
s_add_u32 s55, s55, s75
ds_read_b64_tr_b16 a[186:187], v206 offset:43008
v_cvt_pk_bf16_f32 v26, v56, v57
v_mfma_f32_16x16x32_bf16 v[180:183], a[164:167], a[92:95], v[180:183]
s_waitcnt vmcnt(11)
ds_read_b64_tr_b16 a[188:189], v206 offset:45056
v_cvt_pk_bf16_f32 v27, v58, v59
v_mfma_f32_16x16x32_bf16 v[180:183], a[160:163], a[84:87], v[180:183]
s_waitcnt lgkmcnt(7)
ds_read_b64_tr_b16 a[190:191], v206 offset:47104
v_exp_f32 v32, v164
v_mfma_f32_16x16x32_bf16 v[180:183], a[168:171], a[100:103], v[180:183]
s_barrier
ds_read_b64_tr_b16 a[144:145], v237 offset:0
v_cvt_pk_bf16_f32 v18, v72, v73
v_mfma_f32_16x16x32_bf16 v[180:183], a[172:175], a[108:111], v[180:183]
s_addk_i32 m0, 0x2000
ds_read_b64_tr_b16 a[146:147], v237 offset:2048
v_cvt_pk_bf16_f32 v19, v74, v75
v_mfma_f32_16x16x32_bf16 v[168:171], a[172:175], a[104:107], v[168:171]
ds_read_b64_tr_b16 a[148:149], v237 offset:4096
buffer_load_dwordx4 v234, s[12:15], s55 offen  lds
v_mfma_f32_16x16x32_bf16 v[168:171], a[168:171], a[96:99], v[168:171]
s_waitcnt lgkmcnt(7)
ds_read_b64_tr_b16 a[150:151], v237 offset:6144
v_exp_f32 v33, v165
v_mfma_f32_16x16x32_bf16 v[168:171], a[176:179], v[104:107], v[168:171]
ds_read_b64_tr_b16 a[152:153], v239 offset:0
v_exp_f32 v34, v166
v_mfma_f32_16x16x32_bf16 v[168:171], a[180:183], v[108:111], v[168:171]
LM_p7:
s_cbranch_execz LM_v105
ds_read_b64_tr_b16 a[154:155], v239 offset:2048
v_exp_f32 v35, v167
v_mfma_f32_16x16x32_bf16 v[180:183], a[180:183], v[100:103], v[180:183]
ds_read_b64_tr_b16 a[156:157], v239 offset:4096
v_exp_f32 v56, v144
v_mfma_f32_16x16x32_bf16 v[180:183], a[176:179], v[96:99], v[180:183]
s_waitcnt lgkmcnt(7)
ds_read_b64_tr_b16 a[158:159], v239 offset:6144
v_exp_f32 v57, v145
v_mfma_f32_16x16x32_bf16 v[180:183], a[184:187], v[112:115], v[180:183]
ds_read_b64_tr_b16 a[160:161], v238 offset:0
v_exp_f32 v58, v146
v_mfma_f32_16x16x32_bf16 v[180:183], a[188:191], v[116:119], v[180:183]
ds_read_b64_tr_b16 a[162:163], v238 offset:2048
v_exp_f32 v59, v147
v_mfma_f32_16x16x32_bf16 v[168:171], a[188:191], v[124:127], v[168:171]
ds_read_b64_tr_b16 a[164:165], v238 offset:4096
buffer_load_dwordx4 v233, s[12:15], s55 offen offset:1024  lds
v_mfma_f32_16x16x32_bf16 v[168:171], a[184:187], v[120:123], v[168:171]
s_waitcnt lgkmcnt(7)
ds_read_b64_tr_b16 a[166:167], v238 offset:6144
v_exp_f32 v64, v84
v_mfma_f32_16x16x32_bf16 v[72:75], a[144:147], v[156:159], 0
s_mul_i32 s54, s70, 576
ds_read_b64_tr_b16 a[168:169], v236 offset:0
v_exp_f32 v65, v85
v_mfma_f32_16x16x32_bf16 v[72:75], a[148:151], v[48:51], v[72:75]
s_add_u32 s54, s54, s76
ds_read_b64_tr_b16 a[170:171], v236 offset:2048
v_exp_f32 v66, v86
v_mfma_f32_16x16x32_bf16 v[88:91], a[148:151], v[136:139], 0
s_addk_i32 m0, 0x2000
ds_read_b64_tr_b16 a[172:173], v236 offset:4096
s_waitcnt vmcnt(7)
v_cmp_gt_u32 vcc, 1, v253
v_mfma_f32_16x16x32_bf16 v[88:91], a[144:147], v[172:175], v[88:91]
s_waitcnt lgkmcnt(7)
ds_read_b64_tr_b16 a[174:175], v236 offset:6144
buffer_load_dwordx4 v234, s[12:15], s54 offen  lds
v_mfma_f32_16x16x32_bf16 v[96:99], a[152:155], v[156:159], 0
s_cbranch_vccnz LM_go2
LM_go2_b:
ds_read_b64_tr_b16 a[176:177], v237 offset:8192
v_readfirstlane_b32 s100, v253
v_mfma_f32_16x16x32_bf16 v[96:99], a[156:159], v[48:51], v[96:99]
s_add_u32 s86, s51, 1
ds_read_b64_tr_b16 a[178:179], v237 offset:10240
v_exp_f32 v67, v87
v_mfma_f32_16x16x32_bf16 v[100:103], a[156:159], v[136:139], 0
s_lshr_b32 s86, s100, s86
ds_read_b64_tr_b16 a[180:181], v237 offset:12288
v_exp_f32 v104, v40
v_mfma_f32_16x16x32_bf16 v[100:103], a[152:155], v[172:175], v[100:103]
s_waitcnt lgkmcnt(7)
ds_read_b64_tr_b16 a[182:183], v237 offset:14336
v_exp_f32 v105, v41
v_mfma_f32_16x16x32_bf16 v[108:111], a[160:163], v[156:159], 0
s_and_b32 s86, s86, 0x2000
ds_read_b64_tr_b16 a[184:185], v239 offset:8192
v_exp_f32 v106, v42
v_mfma_f32_16x16x32_bf16 v[108:111], a[164:167], v[48:51], v[108:111]
s_lshl_b32 s87, s52, 14
ds_read_b64_tr_b16 a[186:187], v239 offset:10240
v_exp_f32 v107, v43
v_mfma_f32_16x16x32_bf16 v[112:115], a[164:167], v[136:139], 0
s_add_u32 s94, s86, 229376
ds_read_b64_tr_b16 a[188:189], v239 offset:12288
v_exp_f32 v116, v80
v_mfma_f32_16x16x32_bf16 v[112:115], a[160:163], v[172:175], v[112:115]
s_waitcnt lgkmcnt(7)
ds_read_b64_tr_b16 a[190:191], v239 offset:14336
buffer_load_dwordx4 v233, s[12:15], s54 offen offset:1024  lds
v_mfma_f32_16x16x32_bf16 v[120:123], a[168:171], v[156:159], 0
s_add_u32 s95, s86, 245760
ds_read_b64_tr_b16 a[144:145], v238 offset:8192
v_exp_f32 v117, v81
v_mfma_f32_16x16x32_bf16 v[120:123], a[172:175], v[48:51], v[120:123]
s_add_u32 s94, s94, s87
ds_read_b64_tr_b16 a[146:147], v238 offset:10240
v_exp_f32 v118, v82
v_mfma_f32_16x16x32_bf16 v[124:127], a[172:175], v[136:139], 0
s_sub_u32 s95, s95, s87
ds_read_b64_tr_b16 a[148:149], v238 offset:12288
v_exp_f32 v119, v83
v_mfma_f32_16x16x32_bf16 v[124:127], a[168:171], v[172:175], v[124:127]
s_waitcnt lgkmcnt(7)
ds_read_b64_tr_b16 a[150:151], v238 offset:14336
v_exp_f32 v132, v4
v_mfma_f32_16x16x32_bf16 v[72:75], a[176:179], v[60:63], v[72:75]
s_mul_i32 s55, s71, 576
ds_read_b64_tr_b16 a[152:153], v236 offset:8192
v_exp_f32 v133, v5
v_mfma_f32_16x16x32_bf16 v[72:75], a[180:183], v[128:131], v[72:75]
s_add_u32 s55, s55, s76
ds_read_b64_tr_b16 a[154:155], v236 offset:10240
v_exp_f32 v134, v6
v_mfma_f32_16x16x32_bf16 v[88:91], a[180:183], v[76:79], v[88:91]
s_addk_i32 m0, 0x2000
ds_read_b64_tr_b16 a[156:157], v236 offset:12288
v_exp_f32 v135, v7
v_mfma_f32_16x16x32_bf16 v[88:91], a[176:179], v[92:95], v[88:91]
s_waitcnt lgkmcnt(7)
ds_read_b64_tr_b16 a[158:159], v236 offset:14336
buffer_load_dwordx4 v234, s[12:15], s55 offen  lds
v_mfma_f32_16x16x32_bf16 v[96:99], a[184:187], v[60:63], v[96:99]
s_mul_i32 s2, s49, 6291456
ds_read_b64_tr_b16 a[160:161], v237 offset:16384
v_exp_f32 v148, v180
v_mfma_f32_16x16x32_bf16 v[96:99], a[188:191], v[128:131], v[96:99]
s_lshr_b32 s86, s100, 8
ds_read_b64_tr_b16 a[162:163], v237 offset:18432
v_exp_f32 v149, v181
v_mfma_f32_16x16x32_bf16 v[100:103], a[188:191], v[76:79], v[100:103]
s_and_b32 s86, s86, 0x2000
ds_read_b64_tr_b16 a[164:165], v237 offset:20480
v_exp_f32 v150, v182
v_mfma_f32_16x16x32_bf16 v[100:103], a[184:187], v[92:95], v[100:103]
s_waitcnt lgkmcnt(7)
ds_read_b64_tr_b16 a[166:167], v237 offset:22528
v_exp_f32 v151, v183
v_mfma_f32_16x16x32_bf16 v[108:111], a[144:147], v[60:63], v[108:111]
s_add_u32 s2, s2, s86
ds_read_b64_tr_b16 a[168:169], v239 offset:16384
v_exp_f32 v152, v168
v_mfma_f32_16x16x32_bf16 v[108:111], a[148:151], v[128:131], v[108:111]
s_add_u32 s2, s2, s53
ds_read_b64_tr_b16 a[170:171], v239 offset:18432
v_exp_f32 v153, v169
v_mfma_f32_16x16x32_bf16 v[112:115], a[148:151], v[76:79], v[112:115]
s_add_u32 s2, s2, 6815744
ds_read_b64_tr_b16 a[172:173], v239 offset:20480
v_exp_f32 v154, v170
v_mfma_f32_16x16x32_bf16 v[112:115], a[144:147], v[92:95], v[112:115]
s_waitcnt lgkmcnt(7)
ds_read_b64_tr_b16 a[174:175], v239 offset:22528
buffer_load_dwordx4 v233, s[12:15], s55 offen offset:1024  lds
v_mfma_f32_16x16x32_bf16 v[120:123], a[152:155], v[60:63], v[120:123]
ds_read_b64_tr_b16 a[176:177], v238 offset:16384
v_exp_f32 v155, v171
v_mfma_f32_16x16x32_bf16 v[120:123], a[156:159], v[128:131], v[120:123]
ds_read_b64_tr_b16 a[178:179], v238 offset:18432
s_nop 0
v_pk_add_f32 v[32:33], v[32:33], v[226:227] op_sel_hi:[1,0]
v_pk_add_f32 v[34:35], v[34:35], v[226:227] op_sel_hi:[1,0]
v_pk_add_f32 v[56:57], v[56:57], v[226:227] op_sel_hi:[1,0]
v_pk_add_f32 v[58:59], v[58:59], v[226:227] op_sel_hi:[1,0]
v_pk_add_f32 v[64:65], v[64:65], v[226:227] op_sel_hi:[1,0]
v_pk_add_f32 v[66:67], v[66:67], v[226:227] op_sel_hi:[1,0]
v_pk_add_f32 v[104:105], v[104:105], v[226:227] op_sel_hi:[1,0]
v_pk_add_f32 v[106:107], v[106:107], v[226:227] op_sel_hi:[1,0]
v_pk_add_f32 v[116:117], v[116:117], v[226:227] op_sel_hi:[1,0]
v_pk_add_f32 v[118:119], v[118:119], v[226:227] op_sel_hi:[1,0]
v_pk_add_f32 v[132:133], v[132:133], v[226:227] op_sel_hi:[1,0]
v_pk_add_f32 v[134:135], v[134:135], v[226:227] op_sel_hi:[1,0]
v_pk_add_f32 v[148:149], v[148:149], v[226:227] op_sel_hi:[1,0]
v_pk_add_f32 v[150:151], v[150:151], v[226:227] op_sel_hi:[1,0]
v_pk_add_f32 v[152:153], v[152:153], v[226:227] op_sel_hi:[1,0]
v_pk_add_f32 v[154:155], v[154:155], v[226:227] op_sel_hi:[1,0]
v_mfma_f32_16x16x32_bf16 v[124:127], a[156:159], v[76:79], v[124:127]
ds_read_b64_tr_b16 a[180:181], v238 offset:20480
v_rcp_f32 v32, v32
v_mfma_f32_16x16x32_bf16 v[124:127], a[152:155], v[92:95], v[124:127]
s_waitcnt lgkmcnt(7)
ds_read_b64_tr_b16 a[182:183], v238 offset:22528
v_rcp_f32 v33, v33
v_mfma_f32_16x16x32_bf16 v[72:75], a[160:163], v[8:11], v[72:75]
s_mul_i32 s54, s72, 576
ds_read_b64_tr_b16 a[184:185], v236 offset:16384
v_rcp_f32 v34, v34
v_mfma_f32_16x16x32_bf16 v[72:75], a[164:167], v[36:39], v[72:75]
s_add_u32 s54, s54, s76
ds_read_b64_tr_b16 a[186:187], v236 offset:18432
v_rcp_f32 v35, v35
v_mfma_f32_16x16x32_bf16 v[88:91], a[164:167], v[20:23], v[88:91]
s_addk_i32 m0, 0x2000
ds_read_b64_tr_b16 a[188:189], v236 offset:20480
v_rcp_f32 v56, v56
v_mfma_f32_16x16x32_bf16 v[88:91], a[160:163], v[12:15], v[88:91]
s_waitcnt lgkmcnt(7)
ds_read_b64_tr_b16 a[190:191], v236 offset:22528
buffer_load_dwordx4 v234, s[12:15], s54 offen  lds
v_mfma_f32_16x16x32_bf16 v[96:99], a[168:171], v[8:11], v[96:99]
ds_read_b128 a[144:147], v248 offset:24576
v_rcp_f32 v57, v57
v_mfma_f32_16x16x32_bf16 v[96:99], a[172:175], v[36:39], v[96:99]
v_rcp_f32 v58, v58
v_mfma_f32_16x16x32_bf16 v[100:103], a[172:175], v[20:23], v[100:103]
ds_read_b128 a[148:151], v230 offset:24576
v_rcp_f32 v59, v59
v_mfma_f32_16x16x32_bf16 v[100:103], a[168:171], v[12:15], v[100:103]
s_waitcnt lgkmcnt(6)
v_rcp_f32 v64, v64
v_mfma_f32_16x16x32_bf16 v[108:111], a[176:179], v[8:11], v[108:111]
ds_read_b128 a[152:155], v248 offset:26624
v_rcp_f32 v65, v65
v_mfma_f32_16x16x32_bf16 v[108:111], a[180:183], v[36:39], v[108:111]
v_rcp_f32 v66, v66
v_mfma_f32_16x16x32_bf16 v[112:115], a[180:183], v[20:23], v[112:115]
ds_read_b128 a[156:159], v230 offset:26624
v_rcp_f32 v67, v67
v_mfma_f32_16x16x32_bf16 v[112:115], a[176:179], v[12:15], v[112:115]
s_waitcnt lgkmcnt(4)
buffer_load_dwordx4 v233, s[12:15], s54 offen offset:1024  lds
v_rcp_f32 v104, v104
v_mfma_f32_16x16x32_bf16 v[120:123], a[184:187], v[8:11], v[120:123]
ds_read_b128 a[160:163], v248 offset:28672
v_rcp_f32 v105, v105
v_mfma_f32_16x16x32_bf16 v[120:123], a[188:191], v[36:39], v[120:123]
v_rcp_f32 v106, v106
v_mfma_f32_16x16x32_bf16 v[124:127], a[188:191], v[20:23], v[124:127]
ds_read_b128 a[164:167], v230 offset:28672
v_rcp_f32 v107, v107
v_mfma_f32_16x16x32_bf16 v[124:127], a[184:187], v[12:15], v[124:127]
s_waitcnt lgkmcnt(4)
v_rcp_f32 v116, v116
v_mfma_f32_16x16x32_bf16 v[72:75], a[144:147], v[28:31], v[72:75]
s_mul_i32 s55, s76, 576
ds_read_b128 a[168:171], v248 offset:30720
v_rcp_f32 v117, v117
v_mfma_f32_16x16x32_bf16 v[72:75], a[148:151], v[44:47], v[72:75]
s_addk_i32 m0, 0x2000
v_rcp_f32 v118, v118
v_mfma_f32_16x16x32_bf16 v[88:91], a[148:151], v[68:71], v[88:91]
ds_read_b128 a[172:175], v230 offset:30720
buffer_load_dwordx4 v235, s[20:23], s55 offen  lds
v_mfma_f32_16x16x32_bf16 v[88:91], a[144:147], v[52:55], v[88:91]
s_waitcnt lgkmcnt(4)
v_rcp_f32 v119, v119
v_mfma_f32_16x16x32_bf16 v[96:99], a[152:155], v[28:31], v[96:99]
ds_read_b128 a[176:179], v248 offset:32768
v_rcp_f32 v132, v132
v_mfma_f32_16x16x32_bf16 v[96:99], a[156:159], v[44:47], v[96:99]
v_rcp_f32 v133, v133
v_mfma_f32_16x16x32_bf16 v[100:103], a[156:159], v[68:71], v[100:103]
ds_read_b128 a[180:183], v230 offset:32768
v_rcp_f32 v134, v134
v_mfma_f32_16x16x32_bf16 v[100:103], a[152:155], v[52:55], v[100:103]
s_waitcnt lgkmcnt(4)
v_rcp_f32 v135, v135
v_mfma_f32_16x16x32_bf16 v[108:111], a[160:163], v[28:31], v[108:111]
ds_read_b128 a[184:187], v248 offset:34816
v_rcp_f32 v148, v148
v_mfma_f32_16x16x32_bf16 v[108:111], a[164:167], v[44:47], v[108:111]
v_rcp_f32 v149, v149
v_mfma_f32_16x16x32_bf16 v[112:115], a[164:167], v[68:71], v[112:115]
ds_read_b128 a[188:191], v230 offset:34816
buffer_load_dwordx4 v252, s[20:23], s55 offen offset:1024  lds
v_mfma_f32_16x16x32_bf16 v[112:115], a[160:163], v[52:55], v[112:115]
s_waitcnt lgkmcnt(4)
v_rcp_f32 v150, v150
v_mfma_f32_16x16x32_bf16 v[120:123], a[168:171], v[28:31], v[120:123]
ds_read_b128 a[144:147], v248 offset:36864
v_rcp_f32 v151, v151
v_mfma_f32_16x16x32_bf16 v[120:123], a[172:175], v[44:47], v[120:123]
v_rcp_f32 v152, v152
v_mfma_f32_16x16x32_bf16 v[124:127], a[172:175], v[68:71], v[124:127]
ds_read_b128 a[148:151], v230 offset:36864
v_rcp_f32 v153, v153
v_mfma_f32_16x16x32_bf16 v[124:127], a[168:171], v[52:55], v[124:127]
s_waitcnt lgkmcnt(4)
v_rcp_f32 v154, v154
v_mfma_f32_16x16x32_bf16 v[72:75], a[176:179], v[160:163], v[72:75]
s_mul_i32 s54, s76, 576
ds_read_b128 a[152:155], v248 offset:38912
v_rcp_f32 v155, v155
v_mfma_f32_16x16x32_bf16 v[72:75], a[180:183], v[24:27], v[72:75]
s_addk_i32 m0, 0x2000
s_nop 0
v_pk_mul_f32 v[32:33], v[32:33], v[164:165]
v_pk_mul_f32 v[34:35], v[34:35], v[166:167]
v_pk_mul_f32 v[56:57], v[56:57], v[144:145]
v_pk_mul_f32 v[58:59], v[58:59], v[146:147]
v_pk_mul_f32 v[64:65], v[64:65], v[84:85]
v_pk_mul_f32 v[66:67], v[66:67], v[86:87]
v_pk_mul_f32 v[104:105], v[104:105], v[40:41]
v_pk_mul_f32 v[106:107], v[106:107], v[42:43]
v_pk_mul_f32 v[116:117], v[116:117], v[80:81]
v_pk_mul_f32 v[118:119], v[118:119], v[82:83]
v_pk_mul_f32 v[132:133], v[132:133], v[4:5]
v_pk_mul_f32 v[134:135], v[134:135], v[6:7]
v_pk_mul_f32 v[148:149], v[148:149], v[180:181]
v_pk_mul_f32 v[150:151], v[150:151], v[182:183]
v_pk_mul_f32 v[152:153], v[152:153], v[168:169]
v_pk_mul_f32 v[154:155], v[154:155], v[170:171]
v_mfma_f32_16x16x32_bf16 v[88:91], a[180:183], v[16:19], v[88:91]
ds_read_b128 a[156:159], v230 offset:38912
buffer_load_dwordx4 v235, s[24:27], s54 offen  lds
v_mfma_f32_16x16x32_bf16 v[88:91], a[176:179], v[140:143], v[88:91]
s_waitcnt lgkmcnt(4)
v_cvt_pk_bf16_f32 v4, v32, v33
v_cvt_pk_bf16_f32 v5, v34, v35
v_mfma_f32_16x16x32_bf16 v[96:99], a[184:187], v[160:163], v[96:99]
ds_read_b64_tr_b16 a[160:161], v237 offset:40960
v_cvt_pk_bf16_f32 v32, v56, v57
v_cvt_pk_bf16_f32 v33, v58, v59
v_mfma_f32_16x16x32_bf16 v[96:99], a[188:191], v[24:27], v[96:99]
ds_read_b64_tr_b16 a[162:163], v237 offset:43008
v_cvt_pk_bf16_f32 v6, v64, v65
v_mfma_f32_16x16x32_bf16 v[100:103], a[188:191], v[16:19], v[100:103]
ds_read_b64_tr_b16 a[164:165], v237 offset:45056
v_cvt_pk_bf16_f32 v7, v66, v67
v_mfma_f32_16x16x32_bf16 v[100:103], a[184:187], v[140:143], v[100:103]
s_waitcnt lgkmcnt(5)
ds_read_b64_tr_b16 a[166:167], v237 offset:47104
v_cvt_pk_bf16_f32 v34, v104, v105
v_mfma_f32_16x16x32_bf16 v[108:111], a[144:147], v[160:163], v[108:111]
ds_read_b64_tr_b16 a[168:169], v239 offset:40960
v_cvt_pk_bf16_f32 v35, v106, v107
v_mfma_f32_16x16x32_bf16 v[108:111], a[148:151], v[24:27], v[108:111]
ds_read_b64_tr_b16 a[170:171], v239 offset:43008
v_cvt_pk_bf16_f32 v40, v116, v117
v_cvt_pk_bf16_f32 v41, v118, v119
v_mfma_f32_16x16x32_bf16 v[112:115], a[148:151], v[16:19], v[112:115]
ds_read_b64_tr_b16 a[172:173], v239 offset:45056
buffer_load_dwordx4 v252, s[24:27], s54 offen offset:1024  lds
v_mfma_f32_16x16x32_bf16 v[112:115], a[144:147], v[140:143], v[112:115]
s_waitcnt lgkmcnt(7)
ds_read_b64_tr_b16 a[174:175], v239 offset:47104
v_cvt_pk_bf16_f32 v56, v132, v133
v_mfma_f32_16x16x32_bf16 v[120:123], a[152:155], v[160:163], v[120:123]
ds_read_b64_tr_b16 a[176:177], v238 offset:40960
v_cvt_pk_bf16_f32 v57, v134, v135
v_mfma_f32_16x16x32_bf16 v[120:123], a[156:159], v[24:27], v[120:123]
ds_read_b64_tr_b16 a[178:179], v238 offset:43008
v_cvt_pk_bf16_f32 v42, v148, v149
v_cvt_pk_bf16_f32 v43, v150, v151
v_mfma_f32_16x16x32_bf16 v[124:127], a[156:159], v[16:19], v[124:127]
ds_read_b64_tr_b16 a[180:181], v238 offset:45056
v_cvt_pk_bf16_f32 v58, v152, v153
v_mfma_f32_16x16x32_bf16 v[124:127], a[152:155], v[140:143], v[124:127]
s_waitcnt lgkmcnt(7)
ds_read_b64_tr_b16 a[182:183], v238 offset:47104
v_cvt_pk_bf16_f32 v59, v154, v155
v_mfma_f32_16x16x32_bf16 v[72:75], a[160:163], v[32:35], v[72:75]
s_mul_i32 s55, s73, 576
ds_read_b64_tr_b16 a[184:185], v236 offset:40960
v_lshl_add_u32 v254, v255, 4, s53
v_mfma_f32_16x16x32_bf16 v[72:75], a[164:167], v[56:59], v[72:75]
s_add_u32 s55, s55, s76
ds_read_b64_tr_b16 a[186:187], v236 offset:43008
v_mfma_f32_16x16x32_bf16 v[88:91], a[164:167], v[40:43], v[88:91]
s_waitcnt vmcnt(10)
ds_read_b64_tr_b16 a[188:189], v236 offset:45056
v_mfma_f32_16x16x32_bf16 v[88:91], a[160:163], v[4:7], v[88:91]
s_waitcnt lgkmcnt(7)
ds_read_b64_tr_b16 a[190:191], v236 offset:47104
v_mfma_f32_16x16x32_bf16 v[96:99], a[168:171], v[32:35], v[96:99]
s_barrier
ds_read_b64_tr_b16 a[144:145], v231 offset:0
v_cvt_pk_bf16_f32 v64, v72, v73
v_mfma_f32_16x16x32_bf16 v[96:99], a[172:175], v[56:59], v[96:99]
s_addk_i32 m0, 0x2000
ds_read_b64_tr_b16 a[146:147], v231 offset:2048
v_cvt_pk_bf16_f32 v65, v74, v75
v_mfma_f32_16x16x32_bf16 v[100:103], a[172:175], v[40:43], v[100:103]
s_lshl_b32 s86, s3, 18
ds_read_b64_tr_b16 a[148:149], v231 offset:4096
buffer_load_dwordx4 v234, s[12:15], s55 offen  lds
v_mfma_f32_16x16x32_bf16 v[100:103], a[168:171], v[4:7], v[100:103]
s_waitcnt lgkmcnt(7)
ds_read_b64_tr_b16 a[150:151], v231 offset:6144
v_add_u32 v253, s86, v254
v_mfma_f32_16x16x32_bf16 v[108:111], a[176:179], v[32:35], v[108:111]
ds_read_b64_tr_b16 a[152:153], v231 offset:8192
v_cvt_pk_bf16_f32 v66, v96, v97
v_mfma_f32_16x16x32_bf16 v[108:111], a[180:183], v[56:59], v[108:111]
ds_read_b64_tr_b16 a[154:155], v231 offset:10240
v_cvt_pk_bf16_f32 v67, v98, v99
v_mfma_f32_16x16x32_bf16 v[112:115], a[180:183], v[40:43], v[112:115]
ds_read_b64_tr_b16 a[156:157], v231 offset:12288
v_cvt_pk_bf16_f32 v72, v88, v89
v_mfma_f32_16x16x32_bf16 v[112:115], a[176:179], v[4:7], v[112:115]
s_waitcnt lgkmcnt(7)
ds_read_b64_tr_b16 a[158:159], v231 offset:14336
v_cvt_pk_bf16_f32 v73, v90, v91
v_mfma_f32_16x16x32_bf16 v[120:123], a[184:187], v[32:35], v[120:123]
ds_read_b64_tr_b16 a[160:161], v231 offset:16384
v_cvt_pk_bf16_f32 v74, v100, v101
v_mfma_f32_16x16x32_bf16 v[120:123], a[188:191], v[56:59], v[120:123]
ds_read_b64_tr_b16 a[162:163], v231 offset:18432
v_cvt_pk_bf16_f32 v75, v102, v103
v_mfma_f32_16x16x32_bf16 v[124:127], a[188:191], v[40:43], v[124:127]
ds_read_b64_tr_b16 a[164:165], v231 offset:20480
buffer_load_dwordx4 v233, s[12:15], s55 offen offset:1024  lds
v_mfma_f32_16x16x32_bf16 v[124:127], a[184:187], v[4:7], v[124:127]
s_waitcnt lgkmcnt(7)
ds_read_b64_tr_b16 a[166:167], v231 offset:22528
v_xor_b32 v249, 0x40000, v253
v_mfma_f32_16x16x32_bf16 v[80:83], a[144:147], v[156:159], 0
s_mul_i32 s54, s70, 576
ds_read_b128 a[168:171], v247 offset:24576
v_cvt_pk_bf16_f32 v84, v120, v121
v_mfma_f32_16x16x32_bf16 v[80:83], a[148:151], v[48:51], v[80:83]
s_add_u32 s54, s54, s77
v_cvt_pk_bf16_f32 v85, v122, v123
v_cvt_pk_bf16_f32 v86, v108, v109
v_mfma_f32_16x16x32_bf16 v[88:91], a[148:151], v[136:139], 0
s_mov_b32 m0, s53
ds_read_b128 a[172:175], v241 offset:24576
v_cvt_pk_bf16_f32 v87, v110, v111
v_mfma_f32_16x16x32_bf16 v[88:91], a[144:147], v[172:175], v[88:91]
s_waitcnt lgkmcnt(6)
buffer_load_dwordx4 v234, s[12:15], s54 offen  lds
v_cvt_pk_bf16_f32 v96, v124, v125
v_mfma_f32_16x16x32_bf16 v[88:91], a[152:155], v[92:95], v[88:91]
s_and_b32 s86, s100, 0x2000
ds_read_b128 a[176:179], v247 offset:32768
v_cvt_pk_bf16_f32 v97, v126, v127
v_mfma_f32_16x16x32_bf16 v[88:91], a[156:159], v[76:79], v[88:91]
s_add_u32 s56, s83, s86
v_cvt_pk_bf16_f32 v98, v112, v113
v_cvt_pk_bf16_f32 v99, v114, v115
v_mfma_f32_16x16x32_bf16 v[80:83], a[156:159], v[128:131], v[80:83]
ds_read_b128 a[180:183], v241 offset:32768
v_mfma_f32_16x16x32_bf16 v[80:83], a[152:155], v[60:63], v[80:83]
s_waitcnt lgkmcnt(4)
v_mfma_f32_16x16x32_bf16 v[80:83], a[160:163], v[8:11], v[80:83]
ds_read_b64_tr_b16 a[184:185], v231 offset:40960
v_mfma_f32_16x16x32_bf16 v[80:83], a[164:167], v[36:39], v[80:83]
ds_read_b64_tr_b16 a[186:187], v231 offset:43008
v_mfma_f32_16x16x32_bf16 v[88:91], a[164:167], v[20:23], v[88:91]
s_lshr_b32 s101, s82, 1
buffer_store_dwordx4 v[64:67], v253, s[32:35], s56 offen offset:0 sc1
ds_read_b64_tr_b16 a[188:189], v231 offset:45056
v_mfma_f32_16x16x32_bf16 v[88:91], a[160:163], v[12:15], v[88:91]
s_waitcnt lgkmcnt(5)
ds_read_b64_tr_b16 a[190:191], v231 offset:47104
buffer_load_dwordx4 v233, s[12:15], s54 offen offset:1024  lds
v_mfma_f32_16x16x32_bf16 v[88:91], a[168:171], v[52:55], v[88:91]
s_lshl_b32 s67, s52, 5
ds_read_b64_tr_b16 a[144:145], v228 offset:0
v_accvgpr_write_b32 a0, 0
v_mfma_f32_16x16x32_bf16 v[88:91], a[172:175], v[68:71], v[88:91]
s_add_u32 s101, s101, s67
ds_read_b64_tr_b16 a[146:147], v228 offset:2048
v_lshl_add_u32 v240, v255, 4, s53
v_mfma_f32_16x16x32_bf16 v[80:83], a[172:175], v[44:47], v[80:83]
ds_read_b64_tr_b16 a[148:149], v228 offset:4096
v_lshrrev_b32 v232, 1, v255
v_mfma_f32_16x16x32_bf16 v[80:83], a[168:171], v[28:31], v[80:83]
s_waitcnt lgkmcnt(7)
ds_read_b64_tr_b16 a[150:151], v228 offset:6144
v_sub_u32 v232, s51, v232
v_mfma_f32_16x16x32_bf16 v[80:83], a[176:179], v[160:163], v[80:83]
s_mul_i32 s55, s71, 576
buffer_store_dwordx4 v[72:75], v253, s[32:35], s56 offen offset:1024 sc1
ds_read_b64_tr_b16 a[152:153], v228 offset:8192
v_mfma_f32_16x16x32_bf16 v[80:83], a[180:183], v[24:27], v[80:83]
s_add_u32 s55, s55, s77
ds_read_b64_tr_b16 a[154:155], v228 offset:10240
v_add_u32 v232, 7, v232
v_mfma_f32_16x16x32_bf16 v[88:91], a[180:183], v[16:19], v[88:91]
s_addk_i32 m0, 0x2000
ds_read_b64_tr_b16 a[156:157], v228 offset:12288
v_and_b32 v232, 7, v232
v_mfma_f32_16x16x32_bf16 v[88:91], a[176:179], v[140:143], v[88:91]
s_waitcnt lgkmcnt(7)
ds_read_b64_tr_b16 a[158:159], v228 offset:14336
buffer_load_dwordx4 v234, s[12:15], s55 offen  lds
v_mfma_f32_16x16x32_bf16 v[88:91], a[184:187], v[4:7], v[88:91]
s_xor_b32 s67, s52, 1
buffer_store_dwordx4 v[84:87], v249, s[32:35], s56 offen offset:0 sc1
ds_read_b64_tr_b16 a[160:161], v228 offset:16384
v_mfma_f32_16x16x32_bf16 v[88:91], a[188:191], v[40:43], v[88:91]
ds_read_b64_tr_b16 a[162:163], v228 offset:18432
v_xor_b32 v227, s67, v255
v_mfma_f32_16x16x32_bf16 v[80:83], a[188:191], v[56:59], v[80:83]
ds_read_b64_tr_b16 a[164:165], v228 offset:20480
v_and_b32 v227, 1, v227
v_mfma_f32_16x16x32_bf16 v[80:83], a[184:187], v[32:35], v[80:83]
s_waitcnt lgkmcnt(7)
ds_read_b64_tr_b16 a[166:167], v228 offset:22528
v_lshl_add_u32 v227, v232, 1, v227
v_mfma_f32_16x16x32_bf16 v[64:67], a[144:147], v[156:159], 0
buffer_store_dwordx4 v[96:99], v249, s[32:35], s56 offen offset:1024 sc1
ds_read_b128 a[168:171], v247 offset:26624
v_mfma_f32_16x16x32_bf16 v[64:67], a[148:151], v[48:51], v[64:67]
s_add_u32 s56, s51, 1
v_cmp_gt_u32 s[92:93], 0, v255
s_nop 1
v_cndmask_b32 v232, 3, 1, s[92:93]
v_mfma_f32_16x16x32_bf16 v[72:75], a[148:151], v[136:139], 0
s_and_b32 s56, s56, 7
ds_read_b128 a[172:175], v241 offset:26624
v_cvt_pk_bf16_f32 v84, v80, v81
v_mfma_f32_16x16x32_bf16 v[72:75], a[144:147], v[172:175], v[72:75]
s_waitcnt lgkmcnt(6)
buffer_load_dwordx4 v233, s[12:15], s55 offen offset:1024  lds
v_cvt_pk_bf16_f32 v85, v82, v83
v_mfma_f32_16x16x32_bf16 v[72:75], a[152:155], v[92:95], v[72:75]
s_add_u32 s56, s56, 1
ds_read_b128 a[176:179], v247 offset:34816
v_cvt_pk_bf16_f32 v80, v88, v89
v_mfma_f32_16x16x32_bf16 v[72:75], a[156:159], v[76:79], v[72:75]
s_lshr_b32 s86, s100, s56
v_cvt_pk_bf16_f32 v81, v90, v91
v_cmp_eq_u32 s[92:93], 0, v227
v_mfma_f32_16x16x32_bf16 v[64:67], a[156:159], v[128:131], v[64:67]
s_and_b32 s86, s86, 0x2000
ds_read_b128 a[180:183], v241 offset:34816
v_add_u32 v232, v232, v255
v_mfma_f32_16x16x32_bf16 v[64:67], a[152:155], v[60:63], v[64:67]
s_waitcnt lgkmcnt(4)
v_cndmask_b32 v232, v232, 0, s[92:93]
v_cndmask_b32 v227, v227, 16, s[92:93]
v_mfma_f32_16x16x32_bf16 v[64:67], a[160:163], v[8:11], v[64:67]
s_mul_i32 s54, s72, 576
ds_read_b64_tr_b16 a[184:185], v228 offset:40960
v_accvgpr_write_b32 a1, 0
v_mfma_f32_16x16x32_bf16 v[64:67], a[164:167], v[36:39], v[64:67]
s_add_u32 s54, s54, s77
ds_read_b64_tr_b16 a[186:187], v228 offset:43008
v_accvgpr_write_b32 a62, 0
v_mfma_f32_16x16x32_bf16 v[72:75], a[164:167], v[20:23], v[72:75]
s_addk_i32 m0, 0x2000
ds_read_b64_tr_b16 a[188:189], v228 offset:45056
v_accvgpr_write_b32 a63, 0
v_mfma_f32_16x16x32_bf16 v[72:75], a[160:163], v[12:15], v[72:75]
s_waitcnt lgkmcnt(5)
ds_read_b64_tr_b16 a[190:191], v228 offset:47104
buffer_load_dwordx4 v234, s[12:15], s54 offen  lds
v_mfma_f32_16x16x32_bf16 v[72:75], a[168:171], v[52:55], v[72:75]
s_lshl_b32 s56, s56, 19
ds_read_b64_tr_b16 a[144:145], v213 offset:0
v_accvgpr_write_b32 a64, 0
v_mfma_f32_16x16x32_bf16 v[72:75], a[172:175], v[68:71], v[72:75]
s_add_u32 s56, s56, s83
ds_read_b64_tr_b16 a[146:147], v213 offset:2048
v_accvgpr_write_b32 a65, 0
v_mfma_f32_16x16x32_bf16 v[64:67], a[172:175], v[44:47], v[64:67]
s_add_u32 s56, s56, s86
ds_read_b64_tr_b16 a[148:149], v213 offset:4096
v_accvgpr_write_b32 a126, 0
v_mfma_f32_16x16x32_bf16 v[64:67], a[168:171], v[28:31], v[64:67]
s_waitcnt lgkmcnt(7)
ds_read_b64_tr_b16 a[150:151], v213 offset:6144
v_accvgpr_write_b32 a127, 0
v_mfma_f32_16x16x32_bf16 v[64:67], a[176:179], v[160:163], v[64:67]
s_sub_u32 s67, s2, 128
ds_read_b64_tr_b16 a[152:153], v213 offset:8192
v_lshl_add_u32 v227, v227, 7, s67
v_mfma_f32_16x16x32_bf16 v[64:67], a[180:183], v[24:27], v[64:67]
s_lshl_b32 s67, s50, 12
ds_read_b64_tr_b16 a[154:155], v213 offset:10240
v_accvgpr_read_b32 v89, a240
v_mfma_f32_16x16x32_bf16 v[72:75], a[180:183], v[16:19], v[72:75]
s_add_u32 s67, s67, 147456
ds_read_b64_tr_b16 a[156:157], v213 offset:12288
v_and_b32 v226, 12, v246
v_mfma_f32_16x16x32_bf16 v[72:75], a[176:179], v[140:143], v[72:75]
s_waitcnt lgkmcnt(7)
ds_read_b64_tr_b16 a[158:159], v213 offset:14336
buffer_load_dwordx4 v233, s[12:15], s54 offen offset:1024  lds
v_mfma_f32_16x16x32_bf16 v[72:75], a[184:187], v[4:7], v[72:75]
ds_read_b64_tr_b16 a[160:161], v213 offset:16384
v_add_u32 v226, v246, v226
v_mfma_f32_16x16x32_bf16 v[72:75], a[188:191], v[40:43], v[72:75]
ds_read_b64_tr_b16 a[162:163], v213 offset:18432
v_lshl_add_u32 v226, v226, 7, s67
v_mfma_f32_16x16x32_bf16 v[64:67], a[188:191], v[56:59], v[64:67]
ds_read_b64_tr_b16 a[164:165], v213 offset:20480
v_and_b32 v246, 7, v255
v_mfma_f32_16x16x32_bf16 v[64:67], a[184:187], v[32:35], v[64:67]
s_waitcnt lgkmcnt(7)
ds_read_b64_tr_b16 a[166:167], v213 offset:22528
v_xor_b32 v246, v246, v245
v_mfma_f32_16x16x32_bf16 v[96:99], a[144:147], v[156:159], 0
s_mul_i32 s55, s77, 576
ds_read_b128 a[168:171], v247 offset:28672
v_lshl_add_u32 v245, v246, 4, v226
v_mfma_f32_16x16x32_bf16 v[96:99], a[148:151], v[48:51], v[96:99]
s_addk_i32 m0, 0x2000
v_xor_b32 v225, 64, v245
v_bfe_u32 v226, v255, 3, 2
v_mfma_f32_16x16x32_bf16 v[100:103], a[148:151], v[136:139], 0
ds_read_b128 a[172:175], v241 offset:28672
buffer_load_dwordx4 v235, s[20:23], s55 offen  lds
v_mfma_f32_16x16x32_bf16 v[100:103], a[144:147], v[172:175], v[100:103]
s_waitcnt lgkmcnt(6)
v_cvt_pk_bf16_f32 v86, v64, v65
v_cvt_pk_bf16_f32 v87, v66, v67
v_mfma_f32_16x16x32_bf16 v[100:103], a[152:155], v[92:95], v[100:103]
ds_read_b128 a[176:179], v247 offset:36864
v_cvt_pk_bf16_f32 v82, v72, v73
v_mfma_f32_16x16x32_bf16 v[100:103], a[156:159], v[76:79], v[100:103]
v_cvt_pk_bf16_f32 v83, v74, v75
v_xor_b32 v226, v226, v255
v_mfma_f32_16x16x32_bf16 v[96:99], a[156:159], v[128:131], v[96:99]
buffer_store_dwordx4 v[84:87], v253, s[32:35], s56 offen offset:0 sc1
ds_read_b128 a[180:183], v241 offset:36864
v_mfma_f32_16x16x32_bf16 v[96:99], a[152:155], v[60:63], v[96:99]
s_waitcnt lgkmcnt(4)
v_lshl_add_u32 v224, v226, 4, s67
LM_p8:
s_cbranch_execz LM_v0
v_xor_b32 v223, 64, v224
v_mfma_f32_16x16x32_bf16 v[96:99], a[160:163], v[8:11], v[96:99]
s_lshl_b32 s67, s49, 2
ds_read_b64_tr_b16 a[184:185], v213 offset:40960
v_lshlrev_b32 v88, 16, v89
v_mfma_f32_16x16x32_bf16 v[96:99], a[164:167], v[36:39], v[96:99]
s_add_u32 s67, s67, s50
ds_read_b64_tr_b16 a[186:187], v213 offset:43008
v_and_b32 v89, s97, v89
v_mfma_f32_16x16x32_bf16 v[100:103], a[164:167], v[20:23], v[100:103]
s_lshl_b32 s67, s67, 5
ds_read_b64_tr_b16 a[188:189], v213 offset:45056
buffer_load_dwordx4 v252, s[20:23], s55 offen offset:1024  lds
v_mfma_f32_16x16x32_bf16 v[100:103], a[160:163], v[12:15], v[100:103]
s_waitcnt lgkmcnt(5)
buffer_store_dwordx4 v[80:83], v253, s[32:35], s56 offen offset:1024 sc1
ds_read_b64_tr_b16 a[190:191], v213 offset:47104
v_mfma_f32_16x16x32_bf16 v[100:103], a[168:171], v[52:55], v[100:103]
s_lshl_b32 s86, s48, 7
ds_read_b64_tr_b16 a[144:145], v212 offset:0
v_lshrrev_b32 v226, 3, v255
v_mfma_f32_16x16x32_bf16 v[100:103], a[172:175], v[68:71], v[100:103]
s_add_u32 s86, s86, s2
ds_read_b64_tr_b16 a[146:147], v212 offset:2048
v_lshrrev_b32 v222, 5, v255
v_mfma_f32_16x16x32_bf16 v[96:99], a[172:175], v[44:47], v[96:99]
ds_read_b64_tr_b16 a[148:149], v212 offset:4096
v_lshl_add_u32 v222, v222, 27, s86
v_mfma_f32_16x16x32_bf16 v[96:99], a[168:171], v[28:31], v[96:99]
s_waitcnt lgkmcnt(7)
ds_read_b64_tr_b16 a[150:151], v212 offset:6144
v_lshl_add_u32 v222, v255, 2, v222
v_mfma_f32_16x16x32_bf16 v[96:99], a[176:179], v[160:163], v[96:99]
s_mul_i32 s54, s77, 576
ds_read_b64_tr_b16 a[152:153], v212 offset:8192
v_mov_b32 v254, 2
v_mfma_f32_16x16x32_bf16 v[96:99], a[180:183], v[24:27], v[96:99]
s_addk_i32 m0, 0x2000
ds_read_b64_tr_b16 a[154:155], v212 offset:10240
v_add_u32 v226, s67, v226
v_mfma_f32_16x16x32_bf16 v[100:103], a[180:183], v[16:19], v[100:103]
s_waitcnt vmcnt(7)
ds_read_b64_tr_b16 a[156:157], v212 offset:12288
buffer_load_dwordx4 v235, s[24:27], s54 offen  lds
v_mfma_f32_16x16x32_bf16 v[100:103], a[176:179], v[140:143], v[100:103]
s_waitcnt lgkmcnt(7)
buffer_store_dword v254, v222, s[32:35], 0 offen sc1
ds_read_b64_tr_b16 a[158:159], v212 offset:14336
v_mfma_f32_16x16x32_bf16 v[100:103], a[184:187], v[4:7], v[100:103]
ds_read_b64_tr_b16 a[160:161], v212 offset:16384
v_mul_u32_u24 v226, 2304, v226
v_mfma_f32_16x16x32_bf16 v[100:103], a[188:191], v[40:43], v[100:103]
ds_read_b64_tr_b16 a[162:163], v212 offset:18432
v_and_b32 v246, 7, v255
v_mfma_f32_16x16x32_bf16 v[96:99], a[188:191], v[56:59], v[96:99]
ds_read_b64_tr_b16 a[164:165], v212 offset:20480
v_lshl_add_u32 v226, v246, 4, v226
v_mfma_f32_16x16x32_bf16 v[96:99], a[184:187], v[32:35], v[96:99]
s_waitcnt lgkmcnt(7)
ds_read_b64_tr_b16 a[166:167], v212 offset:22528
v_accvgpr_read_b32 v91, a241
v_mfma_f32_16x16x32_bf16 v[64:67], a[144:147], v[156:159], 0
s_lshl_b32 s67, s101, 2
ds_read_b128 a[168:171], v247 offset:30720
v_add_u32 v255, s67, v226
v_mfma_f32_16x16x32_bf16 v[64:67], a[148:151], v[48:51], v[64:67]
s_sub_u32 s87, s51, 1
v_lshlrev_b32 v90, 16, v91
v_and_b32 v91, s97, v91
v_mfma_f32_16x16x32_bf16 v[72:75], a[148:151], v[136:139], 0
s_and_b32 s87, s87, 7
ds_read_b128 a[172:175], v241 offset:30720
buffer_load_dwordx4 v252, s[24:27], s54 offen offset:1024  lds
v_mfma_f32_16x16x32_bf16 v[72:75], a[144:147], v[172:175], v[72:75]
s_waitcnt lgkmcnt(6)
v_cvt_pk_bf16_f32 v82, v96, v97
v_cvt_pk_bf16_f32 v83, v98, v99
v_mfma_f32_16x16x32_bf16 v[72:75], a[152:155], v[92:95], v[72:75]
s_lshl_b32 s87, s87, 15
ds_read_b128 a[176:179], v247 offset:38912
v_cvt_pk_bf16_f32 v86, v100, v101
v_mfma_f32_16x16x32_bf16 v[72:75], a[156:159], v[76:79], v[72:75]
s_sub_u32 s60, s94, s87
v_cvt_pk_bf16_f32 v87, v102, v103
v_accvgpr_read_b32 v97, a232
v_mfma_f32_16x16x32_bf16 v[64:67], a[156:159], v[128:131], v[64:67]
s_sub_u32 s61, s95, s87
ds_read_b128 a[180:183], v241 offset:38912
v_lshlrev_b32 v96, 16, v97
v_mfma_f32_16x16x32_bf16 v[64:67], a[152:155], v[60:63], v[64:67]
s_waitcnt lgkmcnt(4)
v_and_b32 v97, s97, v97
v_accvgpr_read_b32 v99, a233
v_mfma_f32_16x16x32_bf16 v[64:67], a[160:163], v[8:11], v[64:67]
s_mul_i32 s55, s73, 576
ds_read_b64_tr_b16 a[184:185], v212 offset:40960
v_lshlrev_b32 v98, 16, v99
v_mfma_f32_16x16x32_bf16 v[64:67], a[164:167], v[36:39], v[64:67]
s_add_u32 s55, s55, s77
ds_read_b64_tr_b16 a[186:187], v212 offset:43008
v_and_b32 v99, s97, v99
v_mfma_f32_16x16x32_bf16 v[72:75], a[164:167], v[20:23], v[72:75]
ds_read_b64_tr_b16 a[188:189], v212 offset:45056
v_sub_f32 v246, v96, v229
v_mfma_f32_16x16x32_bf16 v[72:75], a[160:163], v[12:15], v[72:75]
s_waitcnt lgkmcnt(5)
ds_read_b64_tr_b16 a[190:191], v212 offset:47104
v_mul_f32 v246, v246, v243
v_mfma_f32_16x16x32_bf16 v[72:75], a[168:171], v[52:55], v[72:75]
s_barrier
ds_read_b64_tr_b16 a[144:145], v209 offset:0
v_fmac_f32 v96, v246, v88
v_mfma_f32_16x16x32_bf16 v[72:75], a[172:175], v[68:71], v[72:75]
s_addk_i32 m0, 0x2000
ds_read_b64_tr_b16 a[146:147], v209 offset:2048
v_sub_f32 v246, v97, v229
v_mfma_f32_16x16x32_bf16 v[64:67], a[172:175], v[44:47], v[64:67]
s_sub_u32 s87, s51, 2
ds_read_b64_tr_b16 a[148:149], v209 offset:4096
buffer_load_dwordx4 v234, s[12:15], s55 offen  lds
v_mfma_f32_16x16x32_bf16 v[64:67], a[168:171], v[28:31], v[64:67]
s_waitcnt lgkmcnt(7)
ds_read_b64_tr_b16 a[150:151], v209 offset:6144
v_mul_f32 v246, v246, v243
v_mfma_f32_16x16x32_bf16 v[64:67], a[176:179], v[160:163], v[64:67]
s_and_b32 s87, s87, 7
ds_read_b64_tr_b16 a[152:153], v209 offset:8192
v_fmac_f32 v97, v246, v89
v_mfma_f32_16x16x32_bf16 v[64:67], a[180:183], v[24:27], v[64:67]
s_lshl_b32 s87, s87, 15
ds_read_b64_tr_b16 a[154:155], v209 offset:10240
v_sub_f32 v246, v98, v229
v_mfma_f32_16x16x32_bf16 v[72:75], a[180:183], v[16:19], v[72:75]
s_sub_u32 s62, s94, s87
ds_read_b64_tr_b16 a[156:157], v209 offset:12288
v_mul_f32 v246, v246, v243
v_mfma_f32_16x16x32_bf16 v[72:75], a[176:179], v[140:143], v[72:75]
s_waitcnt lgkmcnt(7)
ds_read_b64_tr_b16 a[158:159], v209 offset:14336
v_fmac_f32 v98, v246, v90
v_mfma_f32_16x16x32_bf16 v[72:75], a[184:187], v[4:7], v[72:75]
s_sub_u32 s63, s95, s87
ds_read_b64_tr_b16 a[160:161], v209 offset:16384
v_sub_f32 v246, v99, v229
v_mfma_f32_16x16x32_bf16 v[72:75], a[188:191], v[40:43], v[72:75]
s_sub_u32 s87, s51, 3
ds_read_b64_tr_b16 a[162:163], v209 offset:18432
v_mul_f32 v246, v246, v243
v_mfma_f32_16x16x32_bf16 v[64:67], a[188:191], v[56:59], v[64:67]
s_and_b32 s87, s87, 7
ds_read_b64_tr_b16 a[164:165], v209 offset:20480
buffer_load_dwordx4 v233, s[12:15], s55 offen offset:1024  lds
v_mfma_f32_16x16x32_bf16 v[64:67], a[184:187], v[32:35], v[64:67]
s_waitcnt lgkmcnt(7)
ds_read_b64_tr_b16 a[166:167], v209 offset:22528
v_fmac_f32 v99, v246, v91
v_mfma_f32_16x16x32_bf16 v[100:103], a[144:147], v[156:159], 0
s_mul_i32 s54, s70, 576
ds_read_b128 a[168:171], v250 offset:24576
v_accvgpr_read_b32 v105, a234
v_mfma_f32_16x16x32_bf16 v[100:103], a[148:151], v[48:51], v[100:103]
s_add_u32 s54, s54, s78
v_lshlrev_b32 v104, 16, v105
v_and_b32 v105, s97, v105
v_mfma_f32_16x16x32_bf16 v[108:111], a[148:151], v[136:139], 0
s_addk_i32 m0, 0x2000
ds_read_b128 a[172:175], v244 offset:24576
v_cvt_pk_bf16_f32 v80, v64, v65
v_mfma_f32_16x16x32_bf16 v[108:111], a[144:147], v[172:175], v[108:111]
s_waitcnt lgkmcnt(6)
buffer_load_dwordx4 v234, s[12:15], s54 offen  lds
v_cvt_pk_bf16_f32 v81, v66, v67
v_mfma_f32_16x16x32_bf16 v[108:111], a[152:155], v[92:95], v[108:111]
s_lshl_b32 s87, s87, 15
ds_read_b128 a[176:179], v250 offset:32768
v_cvt_pk_bf16_f32 v84, v72, v73
v_mfma_f32_16x16x32_bf16 v[108:111], a[156:159], v[76:79], v[108:111]
s_sub_u32 s64, s94, s87
v_cvt_pk_bf16_f32 v85, v74, v75
v_accvgpr_read_b32 v107, a235
v_mfma_f32_16x16x32_bf16 v[100:103], a[156:159], v[128:131], v[100:103]
s_sub_u32 s65, s95, s87
buffer_store_dwordx4 v[80:83], v249, s[32:35], s56 offen offset:0 sc1
ds_read_b128 a[180:183], v244 offset:32768
v_mfma_f32_16x16x32_bf16 v[100:103], a[152:155], v[60:63], v[100:103]
s_waitcnt lgkmcnt(4)
v_lshlrev_b32 v106, 16, v107
v_and_b32 v107, s97, v107
v_mfma_f32_16x16x32_bf16 v[100:103], a[160:163], v[8:11], v[100:103]
s_sub_u32 s87, s51, 4
ds_read_b64_tr_b16 a[184:185], v209 offset:40960
v_sub_f32 v246, v104, v242
v_mfma_f32_16x16x32_bf16 v[100:103], a[164:167], v[36:39], v[100:103]
s_and_b32 s87, s87, 7
ds_read_b64_tr_b16 a[186:187], v209 offset:43008
v_mul_f32 v246, v246, v251
v_mfma_f32_16x16x32_bf16 v[108:111], a[164:167], v[20:23], v[108:111]
s_lshl_b32 s87, s87, 15
buffer_store_dwordx4 v[84:87], v249, s[32:35], s56 offen offset:1024 sc1
ds_read_b64_tr_b16 a[188:189], v209 offset:45056
v_mfma_f32_16x16x32_bf16 v[108:111], a[160:163], v[12:15], v[108:111]
s_waitcnt lgkmcnt(5)
ds_read_b64_tr_b16 a[190:191], v209 offset:47104
buffer_load_dwordx4 v233, s[12:15], s54 offen offset:1024  lds
v_mfma_f32_16x16x32_bf16 v[108:111], a[168:171], v[52:55], v[108:111]
s_add_u32 s56, s51, 2
ds_read_b64_tr_b16 a[144:145], v208 offset:0
v_fmac_f32 v104, v246, v88
v_mfma_f32_16x16x32_bf16 v[108:111], a[172:175], v[68:71], v[108:111]
s_and_b32 s56, s56, 7
ds_read_b64_tr_b16 a[146:147], v208 offset:2048
v_sub_f32 v246, v105, v242
v_mfma_f32_16x16x32_bf16 v[100:103], a[172:175], v[44:47], v[100:103]
s_add_u32 s56, s56, 1
ds_read_b64_tr_b16 a[148:149], v208 offset:4096
v_mul_f32 v246, v246, v251
v_mfma_f32_16x16x32_bf16 v[100:103], a[168:171], v[28:31], v[100:103]
s_waitcnt lgkmcnt(7)
ds_read_b64_tr_b16 a[150:151], v208 offset:6144
v_fmac_f32 v105, v246, v89
v_mfma_f32_16x16x32_bf16 v[100:103], a[176:179], v[160:163], v[100:103]
s_mul_i32 s55, s71, 576
ds_read_b64_tr_b16 a[152:153], v208 offset:8192
v_sub_f32 v246, v106, v242
v_mfma_f32_16x16x32_bf16 v[100:103], a[180:183], v[24:27], v[100:103]
s_add_u32 s55, s55, s78
ds_read_b64_tr_b16 a[154:155], v208 offset:10240
v_mul_f32 v246, v246, v251
v_mfma_f32_16x16x32_bf16 v[108:111], a[180:183], v[16:19], v[108:111]
s_addk_i32 m0, 0x2000
ds_read_b64_tr_b16 a[156:157], v208 offset:12288
v_fmac_f32 v106, v246, v90
v_mfma_f32_16x16x32_bf16 v[108:111], a[176:179], v[140:143], v[108:111]
s_waitcnt lgkmcnt(7)
ds_read_b64_tr_b16 a[158:159], v208 offset:14336
buffer_load_dwordx4 v234, s[12:15], s55 offen  lds
v_mfma_f32_16x16x32_bf16 v[108:111], a[184:187], v[4:7], v[108:111]
s_lshr_b32 s86, s100, s56
ds_read_b64_tr_b16 a[160:161], v208 offset:16384
v_sub_f32 v246, v107, v242
v_mfma_f32_16x16x32_bf16 v[108:111], a[188:191], v[40:43], v[108:111]
s_and_b32 s86, s86, 0x2000
ds_read_b64_tr_b16 a[162:163], v208 offset:18432
v_mul_f32 v246, v246, v251
v_mfma_f32_16x16x32_bf16 v[100:103], a[188:191], v[56:59], v[100:103]
s_lshl_b32 s56, s56, 19
ds_read_b64_tr_b16 a[164:165], v208 offset:20480
v_fmac_f32 v107, v246, v91
v_mfma_f32_16x16x32_bf16 v[100:103], a[184:187], v[32:35], v[100:103]
s_waitcnt lgkmcnt(7)
ds_read_b64_tr_b16 a[166:167], v208 offset:22528
v_accvgpr_read_b32 v65, a242
v_mfma_f32_16x16x32_bf16 v[72:75], a[144:147], v[156:159], 0
s_add_u32 s56, s56, s83
ds_read_b128 a[168:171], v250 offset:26624
v_lshlrev_b32 v64, 16, v65
v_mfma_f32_16x16x32_bf16 v[72:75], a[148:151], v[48:51], v[72:75]
s_add_u32 s56, s56, s86
v_and_b32 v65, s97, v65
v_accvgpr_read_b32 v67, a243
v_mfma_f32_16x16x32_bf16 v[80:83], a[148:151], v[136:139], 0
s_sub_u32 s66, s94, s87
ds_read_b128 a[172:175], v244 offset:26624
v_cvt_pk_bf16_f32 v84, v100, v101
v_mfma_f32_16x16x32_bf16 v[80:83], a[144:147], v[172:175], v[80:83]
s_waitcnt lgkmcnt(6)
buffer_load_dwordx4 v233, s[12:15], s55 offen offset:1024  lds
v_cvt_pk_bf16_f32 v85, v102, v103
v_mfma_f32_16x16x32_bf16 v[80:83], a[152:155], v[92:95], v[80:83]
s_sub_u32 s4, s95, s87
ds_read_b128 a[176:179], v250 offset:34816
v_cvt_pk_bf16_f32 v88, v108, v109
v_mfma_f32_16x16x32_bf16 v[80:83], a[156:159], v[76:79], v[80:83]
s_sub_u32 s87, s51, 5
v_cvt_pk_bf16_f32 v89, v110, v111
v_lshlrev_b32 v66, 16, v67
v_mfma_f32_16x16x32_bf16 v[72:75], a[156:159], v[128:131], v[72:75]
s_and_b32 s87, s87, 7
ds_read_b128 a[180:183], v244 offset:34816
v_and_b32 v67, s97, v67
v_mfma_f32_16x16x32_bf16 v[72:75], a[152:155], v[60:63], v[72:75]
s_waitcnt lgkmcnt(4)
v_accvgpr_read_b32 v101, a236
v_lshlrev_b32 v100, 16, v101
v_mfma_f32_16x16x32_bf16 v[72:75], a[160:163], v[8:11], v[72:75]
s_mul_i32 s54, s72, 576
ds_read_b64_tr_b16 a[184:185], v208 offset:40960
v_and_b32 v101, s97, v101
v_mfma_f32_16x16x32_bf16 v[72:75], a[164:167], v[36:39], v[72:75]
s_add_u32 s54, s54, s78
ds_read_b64_tr_b16 a[186:187], v208 offset:43008
v_accvgpr_read_b32 v103, a237
v_mfma_f32_16x16x32_bf16 v[80:83], a[164:167], v[20:23], v[80:83]
s_addk_i32 m0, 0x2000
ds_read_b64_tr_b16 a[188:189], v208 offset:45056
v_lshlrev_b32 v102, 16, v103
v_mfma_f32_16x16x32_bf16 v[80:83], a[160:163], v[12:15], v[80:83]
s_waitcnt lgkmcnt(5)
ds_read_b64_tr_b16 a[190:191], v208 offset:47104
buffer_load_dwordx4 v234, s[12:15], s54 offen  lds
v_mfma_f32_16x16x32_bf16 v[80:83], a[168:171], v[52:55], v[80:83]
s_lshl_b32 s87, s87, 15
ds_read_b64_tr_b16 a[144:145], v207 offset:0
v_and_b32 v103, s97, v103
v_mfma_f32_16x16x32_bf16 v[80:83], a[172:175], v[68:71], v[80:83]
s_sub_u32 s5, s94, s87
ds_read_b64_tr_b16 a[146:147], v207 offset:2048
v_sub_f32 v246, v100, v229
v_mfma_f32_16x16x32_bf16 v[72:75], a[172:175], v[44:47], v[72:75]
s_sub_u32 s6, s95, s87
ds_read_b64_tr_b16 a[148:149], v207 offset:4096
v_mul_f32 v246, v246, v243
v_mfma_f32_16x16x32_bf16 v[72:75], a[168:171], v[28:31], v[72:75]
s_waitcnt lgkmcnt(7)
ds_read_b64_tr_b16 a[150:151], v207 offset:6144
v_fmac_f32 v100, v246, v64
v_mfma_f32_16x16x32_bf16 v[72:75], a[176:179], v[160:163], v[72:75]
s_sub_u32 s87, s51, 6
ds_read_b64_tr_b16 a[152:153], v207 offset:8192
v_sub_f32 v246, v101, v229
v_mfma_f32_16x16x32_bf16 v[72:75], a[180:183], v[24:27], v[72:75]
s_and_b32 s87, s87, 7
ds_read_b64_tr_b16 a[154:155], v207 offset:10240
v_mul_f32 v246, v246, v243
v_mfma_f32_16x16x32_bf16 v[80:83], a[180:183], v[16:19], v[80:83]
s_lshl_b32 s87, s87, 15
ds_read_b64_tr_b16 a[156:157], v207 offset:12288
v_fmac_f32 v101, v246, v65
v_mfma_f32_16x16x32_bf16 v[80:83], a[176:179], v[140:143], v[80:83]
s_waitcnt lgkmcnt(7)
ds_read_b64_tr_b16 a[158:159], v207 offset:14336
buffer_load_dwordx4 v233, s[12:15], s54 offen offset:1024  lds
v_mfma_f32_16x16x32_bf16 v[80:83], a[184:187], v[4:7], v[80:83]
s_sub_u32 s7, s94, s87
ds_read_b64_tr_b16 a[160:161], v207 offset:16384
v_sub_f32 v246, v102, v229
v_mfma_f32_16x16x32_bf16 v[80:83], a[188:191], v[40:43], v[80:83]
s_sub_u32 s8, s95, s87
ds_read_b64_tr_b16 a[162:163], v207 offset:18432
v_mul_f32 v246, v246, v243
v_mfma_f32_16x16x32_bf16 v[72:75], a[188:191], v[56:59], v[72:75]
s_sub_u32 s87, s51, 7
ds_read_b64_tr_b16 a[164:165], v207 offset:20480
v_fmac_f32 v102, v246, v66
v_mfma_f32_16x16x32_bf16 v[72:75], a[184:187], v[32:35], v[72:75]
s_waitcnt lgkmcnt(7)
ds_read_b64_tr_b16 a[166:167], v207 offset:22528
v_sub_f32 v246, v103, v229
v_mfma_f32_16x16x32_bf16 v[108:111], a[144:147], v[156:159], 0
s_mul_i32 s55, s78, 576
ds_read_b128 a[168:171], v250 offset:28672
v_mul_f32 v246, v246, v243
v_mfma_f32_16x16x32_bf16 v[108:111], a[148:151], v[48:51], v[108:111]
s_addk_i32 m0, 0x2000
v_fmac_f32 v103, v246, v67
v_accvgpr_read_b32 v113, a238
v_mfma_f32_16x16x32_bf16 v[116:119], a[148:151], v[136:139], 0
s_and_b32 s87, s87, 7
ds_read_b128 a[172:175], v244 offset:28672
buffer_load_dwordx4 v235, s[20:23], s55 offen  lds
v_mfma_f32_16x16x32_bf16 v[116:119], a[144:147], v[172:175], v[116:119]
s_waitcnt lgkmcnt(6)
v_cvt_pk_bf16_f32 v86, v72, v73
v_cvt_pk_bf16_f32 v87, v74, v75
v_mfma_f32_16x16x32_bf16 v[116:119], a[152:155], v[92:95], v[116:119]
s_lshl_b32 s87, s87, 15
ds_read_b128 a[176:179], v250 offset:36864
v_cvt_pk_bf16_f32 v90, v80, v81
v_mfma_f32_16x16x32_bf16 v[116:119], a[156:159], v[76:79], v[116:119]
s_sub_u32 s9, s94, s87
v_cvt_pk_bf16_f32 v91, v82, v83
v_lshlrev_b32 v112, 16, v113
v_mfma_f32_16x16x32_bf16 v[108:111], a[156:159], v[128:131], v[108:111]
s_sub_u32 s10, s95, s87
buffer_store_dwordx4 v[84:87], v253, s[32:35], s56 offen offset:0 sc1
ds_read_b128 a[180:183], v244 offset:36864
v_mfma_f32_16x16x32_bf16 v[108:111], a[152:155], v[60:63], v[108:111]
s_waitcnt lgkmcnt(4)
v_and_b32 v113, s97, v113
v_accvgpr_read_b32 v115, a239
v_mfma_f32_16x16x32_bf16 v[108:111], a[160:163], v[8:11], v[108:111]
s_sub_u32 s87, s51, 8
ds_read_b64_tr_b16 a[184:185], v207 offset:40960
v_lshlrev_b32 v114, 16, v115
v_mfma_f32_16x16x32_bf16 v[108:111], a[164:167], v[36:39], v[108:111]
s_and_b32 s87, s87, 7
ds_read_b64_tr_b16 a[186:187], v207 offset:43008
v_and_b32 v115, s97, v115
v_mfma_f32_16x16x32_bf16 v[116:119], a[164:167], v[20:23], v[116:119]
s_lshl_b32 s87, s87, 15
ds_read_b64_tr_b16 a[188:189], v207 offset:45056
buffer_load_dwordx4 v252, s[20:23], s55 offen offset:1024  lds
v_mfma_f32_16x16x32_bf16 v[116:119], a[160:163], v[12:15], v[116:119]
s_waitcnt lgkmcnt(5)
buffer_store_dwordx4 v[88:91], v253, s[32:35], s56 offen offset:1024 sc1
ds_read_b64_tr_b16 a[190:191], v207 offset:47104
v_mfma_f32_16x16x32_bf16 v[116:119], a[168:171], v[52:55], v[116:119]
s_sub_u32 s11, s94, s87
ds_read_b64_tr_b16 a[144:145], v206 offset:0
v_mov_b32 v246, 0
v_mfma_f32_16x16x32_bf16 v[116:119], a[172:175], v[68:71], v[116:119]
ds_read_b64_tr_b16 a[146:147], v206 offset:2048
v_sub_f32 v243, v112, v242
v_mfma_f32_16x16x32_bf16 v[108:111], a[172:175], v[44:47], v[108:111]
ds_read_b64_tr_b16 a[148:149], v206 offset:4096
v_mul_f32 v243, v243, v251
v_mfma_f32_16x16x32_bf16 v[108:111], a[168:171], v[28:31], v[108:111]
s_waitcnt lgkmcnt(7)
ds_read_b64_tr_b16 a[150:151], v206 offset:6144
v_fmac_f32 v112, v243, v64
v_mfma_f32_16x16x32_bf16 v[108:111], a[176:179], v[160:163], v[108:111]
s_mul_i32 s54, s78, 576
ds_read_b64_tr_b16 a[152:153], v206 offset:8192
v_sub_f32 v243, v113, v242
v_mfma_f32_16x16x32_bf16 v[108:111], a[180:183], v[24:27], v[108:111]
s_addk_i32 m0, 0x2000
ds_read_b64_tr_b16 a[154:155], v206 offset:10240
v_mul_f32 v243, v243, v251
v_mfma_f32_16x16x32_bf16 v[116:119], a[180:183], v[16:19], v[116:119]
ds_read_b64_tr_b16 a[156:157], v206 offset:12288
buffer_load_dwordx4 v235, s[24:27], s54 offen  lds
v_mfma_f32_16x16x32_bf16 v[116:119], a[176:179], v[140:143], v[116:119]
s_waitcnt lgkmcnt(7)
ds_read_b64_tr_b16 a[158:159], v206 offset:14336
v_fmac_f32 v113, v243, v65
v_mfma_f32_16x16x32_bf16 v[116:119], a[184:187], v[4:7], v[116:119]
ds_read_b64_tr_b16 a[160:161], v206 offset:16384
v_sub_f32 v243, v114, v242
v_mfma_f32_16x16x32_bf16 v[116:119], a[188:191], v[40:43], v[116:119]
ds_read_b64_tr_b16 a[162:163], v206 offset:18432
v_mul_f32 v243, v243, v251
v_mfma_f32_16x16x32_bf16 v[108:111], a[188:191], v[56:59], v[108:111]
ds_read_b64_tr_b16 a[164:165], v206 offset:20480
v_fmac_f32 v114, v243, v66
v_mfma_f32_16x16x32_bf16 v[108:111], a[184:187], v[32:35], v[108:111]
s_waitcnt lgkmcnt(7)
ds_read_b64_tr_b16 a[166:167], v206 offset:22528
v_sub_f32 v243, v115, v242
v_mfma_f32_16x16x32_bf16 v[72:75], a[144:147], v[156:159], 0
ds_read_b128 a[168:171], v250 offset:30720
v_mul_f32 v243, v243, v251
v_mfma_f32_16x16x32_bf16 v[72:75], a[148:151], v[48:51], v[72:75]
v_fmac_f32 v115, v243, v67
v_mfma_f32_16x16x32_bf16 v[64:67], a[148:151], v[136:139], 0
ds_read_b128 a[172:175], v244 offset:30720
buffer_load_dwordx4 v252, s[24:27], s54 offen offset:1024  lds
v_mfma_f32_16x16x32_bf16 v[64:67], a[144:147], v[172:175], v[64:67]
s_waitcnt lgkmcnt(6)
v_cvt_pk_bf16_f32 v82, v108, v109
v_cvt_pk_bf16_f32 v83, v110, v111
v_mfma_f32_16x16x32_bf16 v[64:67], a[152:155], v[92:95], v[64:67]
ds_read_b128 a[176:179], v250 offset:38912
v_cvt_pk_bf16_f32 v86, v116, v117
v_mfma_f32_16x16x32_bf16 v[64:67], a[156:159], v[76:79], v[64:67]
v_cvt_pk_bf16_f32 v87, v118, v119
v_mfma_f32_16x16x32_bf16 v[72:75], a[156:159], v[128:131], v[72:75]
ds_read_b128 a[180:183], v244 offset:38912
v_mfma_f32_16x16x32_bf16 v[72:75], a[152:155], v[60:63], v[72:75]
s_waitcnt lgkmcnt(4)
v_mfma_f32_16x16x32_bf16 v[72:75], a[160:163], v[8:11], v[72:75]
s_mul_i32 s55, s73, 576
ds_read_b64_tr_b16 a[184:185], v206 offset:40960
v_mfma_f32_16x16x32_bf16 v[72:75], a[164:167], v[36:39], v[72:75]
s_add_u32 s55, s55, s78
ds_read_b64_tr_b16 a[186:187], v206 offset:43008
v_mfma_f32_16x16x32_bf16 v[64:67], a[164:167], v[20:23], v[64:67]
s_waitcnt vmcnt(14)
ds_read_b64_tr_b16 a[188:189], v206 offset:45056
v_mfma_f32_16x16x32_bf16 v[64:67], a[160:163], v[12:15], v[64:67]
s_waitcnt lgkmcnt(5)
ds_read_b64_tr_b16 a[190:191], v206 offset:47104
v_mfma_f32_16x16x32_bf16 v[64:67], a[168:171], v[52:55], v[64:67]
s_barrier
ds_read_b64_tr_b16 a[144:145], v237 offset:0
v_mfma_f32_16x16x32_bf16 v[64:67], a[172:175], v[68:71], v[64:67]
s_addk_i32 m0, 0x2000
ds_read_b64_tr_b16 a[146:147], v237 offset:2048
v_mfma_f32_16x16x32_bf16 v[72:75], a[172:175], v[44:47], v[72:75]
ds_read_b64_tr_b16 a[148:149], v237 offset:4096
buffer_load_dwordx4 v234, s[12:15], s55 offen  lds
v_mfma_f32_16x16x32_bf16 v[72:75], a[168:171], v[28:31], v[72:75]
s_waitcnt lgkmcnt(7)
ds_read_b64_tr_b16 a[150:151], v237 offset:6144
v_mfma_f32_16x16x32_bf16 v[72:75], a[176:179], v[160:163], v[72:75]
ds_read_b64_tr_b16 a[152:153], v237 offset:8192
v_mfma_f32_16x16x32_bf16 v[72:75], a[180:183], v[24:27], v[72:75]
ds_read_b64_tr_b16 a[154:155], v237 offset:10240
v_mfma_f32_16x16x32_bf16 v[64:67], a[180:183], v[16:19], v[64:67]
ds_read_b64_tr_b16 a[156:157], v237 offset:12288
v_mfma_f32_16x16x32_bf16 v[64:67], a[176:179], v[140:143], v[64:67]
s_waitcnt lgkmcnt(7)
ds_read_b64_tr_b16 a[158:159], v237 offset:14336
v_mfma_f32_16x16x32_bf16 v[64:67], a[184:187], v[4:7], v[64:67]
ds_read_b64_tr_b16 a[160:161], v237 offset:16384
v_mfma_f32_16x16x32_bf16 v[64:67], a[188:191], v[40:43], v[64:67]
ds_read_b64_tr_b16 a[162:163], v237 offset:18432
v_mfma_f32_16x16x32_bf16 v[72:75], a[188:191], v[56:59], v[72:75]
ds_read_b64_tr_b16 a[164:165], v237 offset:20480
buffer_load_dwordx4 v233, s[12:15], s55 offen offset:1024  lds
v_mfma_f32_16x16x32_bf16 v[72:75], a[184:187], v[32:35], v[72:75]
s_waitcnt lgkmcnt(7)
ds_read_b64_tr_b16 a[166:167], v237 offset:22528
v_mfma_f32_16x16x32_bf16 v[88:91], a[144:147], v[156:159], 0
s_mul_i32 s54, s70, 576
ds_read_b128 a[168:171], v248 offset:24576
v_mfma_f32_16x16x32_bf16 v[88:91], a[148:151], v[48:51], v[88:91]
s_add_u32 s54, s54, s79
v_mfma_f32_16x16x32_bf16 v[108:111], a[148:151], v[136:139], 0
s_addk_i32 m0, 0x2000
ds_read_b128 a[172:175], v230 offset:24576
v_cvt_pk_bf16_f32 v80, v72, v73
v_mfma_f32_16x16x32_bf16 v[108:111], a[144:147], v[172:175], v[108:111]
s_waitcnt lgkmcnt(6)
buffer_load_dwordx4 v234, s[12:15], s54 offen  lds
v_cvt_pk_bf16_f32 v81, v74, v75
v_mfma_f32_16x16x32_bf16 v[108:111], a[152:155], v[92:95], v[108:111]
ds_read_b128 a[176:179], v248 offset:32768
v_cvt_pk_bf16_f32 v84, v64, v65
v_mfma_f32_16x16x32_bf16 v[108:111], a[156:159], v[76:79], v[108:111]
v_cvt_pk_bf16_f32 v85, v66, v67
v_mfma_f32_16x16x32_bf16 v[88:91], a[156:159], v[128:131], v[88:91]
buffer_store_dwordx4 v[80:83], v249, s[32:35], s56 offen offset:0 sc1
ds_read_b128 a[180:183], v230 offset:32768
v_mfma_f32_16x16x32_bf16 v[88:91], a[152:155], v[60:63], v[88:91]
s_waitcnt lgkmcnt(4)
v_mfma_f32_16x16x32_bf16 v[88:91], a[160:163], v[8:11], v[88:91]
ds_read_b64_tr_b16 a[184:185], v237 offset:40960
v_mfma_f32_16x16x32_bf16 v[88:91], a[164:167], v[36:39], v[88:91]
ds_read_b64_tr_b16 a[186:187], v237 offset:43008
v_mfma_f32_16x16x32_bf16 v[108:111], a[164:167], v[20:23], v[108:111]
buffer_store_dwordx4 v[84:87], v249, s[32:35], s56 offen offset:1024 sc1
ds_read_b64_tr_b16 a[188:189], v237 offset:45056
v_mfma_f32_16x16x32_bf16 v[108:111], a[160:163], v[12:15], v[108:111]
s_waitcnt lgkmcnt(5)
ds_read_b64_tr_b16 a[190:191], v237 offset:47104
buffer_load_dwordx4 v233, s[12:15], s54 offen offset:1024  lds
v_mfma_f32_16x16x32_bf16 v[108:111], a[168:171], v[52:55], v[108:111]
s_add_u32 s56, s51, 3
ds_read_b64_tr_b16 a[144:145], v239 offset:0
v_mfma_f32_16x16x32_bf16 v[108:111], a[172:175], v[68:71], v[108:111]
s_and_b32 s56, s56, 7
ds_read_b64_tr_b16 a[146:147], v239 offset:2048
v_mfma_f32_16x16x32_bf16 v[88:91], a[172:175], v[44:47], v[88:91]
s_add_u32 s56, s56, 1
ds_read_b64_tr_b16 a[148:149], v239 offset:4096
v_mfma_f32_16x16x32_bf16 v[88:91], a[168:171], v[28:31], v[88:91]
s_waitcnt lgkmcnt(7)
ds_read_b64_tr_b16 a[150:151], v239 offset:6144
v_mfma_f32_16x16x32_bf16 v[88:91], a[176:179], v[160:163], v[88:91]
s_mul_i32 s55, s71, 576
ds_read_b64_tr_b16 a[152:153], v239 offset:8192
v_mfma_f32_16x16x32_bf16 v[88:91], a[180:183], v[24:27], v[88:91]
s_add_u32 s55, s55, s79
ds_read_b64_tr_b16 a[154:155], v239 offset:10240
v_mfma_f32_16x16x32_bf16 v[108:111], a[180:183], v[16:19], v[108:111]
s_addk_i32 m0, 0x2000
ds_read_b64_tr_b16 a[156:157], v239 offset:12288
v_mfma_f32_16x16x32_bf16 v[108:111], a[176:179], v[140:143], v[108:111]
s_waitcnt lgkmcnt(7)
ds_read_b64_tr_b16 a[158:159], v239 offset:14336
buffer_load_dwordx4 v234, s[12:15], s55 offen  lds
v_mfma_f32_16x16x32_bf16 v[108:111], a[184:187], v[4:7], v[108:111]
s_lshr_b32 s86, s100, s56
ds_read_b64_tr_b16 a[160:161], v239 offset:16384
v_mfma_f32_16x16x32_bf16 v[108:111], a[188:191], v[40:43], v[108:111]
s_and_b32 s86, s86, 0x2000
ds_read_b64_tr_b16 a[162:163], v239 offset:18432
v_mfma_f32_16x16x32_bf16 v[88:91], a[188:191], v[56:59], v[88:91]
s_lshl_b32 s56, s56, 19
ds_read_b64_tr_b16 a[164:165], v239 offset:20480
v_mfma_f32_16x16x32_bf16 v[88:91], a[184:187], v[32:35], v[88:91]
s_waitcnt lgkmcnt(7)
ds_read_b64_tr_b16 a[166:167], v239 offset:22528
v_mfma_f32_16x16x32_bf16 v[64:67], a[144:147], v[156:159], 0
s_add_u32 s56, s56, s83
ds_read_b128 a[168:171], v248 offset:26624
v_mfma_f32_16x16x32_bf16 v[64:67], a[148:151], v[48:51], v[64:67]
s_add_u32 s56, s56, s86
v_mov_b32 v254, 6
v_mfma_f32_16x16x32_bf16 v[72:75], a[148:151], v[136:139], 0
ds_read_b128 a[172:175], v230 offset:26624
v_cvt_pk_bf16_f32 v80, v88, v89
v_mfma_f32_16x16x32_bf16 v[72:75], a[144:147], v[172:175], v[72:75]
s_waitcnt lgkmcnt(6)
buffer_load_dwordx4 v233, s[12:15], s55 offen offset:1024  lds
v_cvt_pk_bf16_f32 v81, v90, v91
v_mfma_f32_16x16x32_bf16 v[72:75], a[152:155], v[92:95], v[72:75]
ds_read_b128 a[176:179], v248 offset:34816
v_cvt_pk_bf16_f32 v84, v108, v109
v_mfma_f32_16x16x32_bf16 v[72:75], a[156:159], v[76:79], v[72:75]
v_cvt_pk_bf16_f32 v85, v110, v111
v_mfma_f32_16x16x32_bf16 v[64:67], a[156:159], v[128:131], v[64:67]
ds_read_b128 a[180:183], v230 offset:34816
v_mfma_f32_16x16x32_bf16 v[64:67], a[152:155], v[60:63], v[64:67]
s_waitcnt lgkmcnt(4)
v_mfma_f32_16x16x32_bf16 v[64:67], a[160:163], v[8:11], v[64:67]
s_mul_i32 s54, s72, 576
ds_read_b64_tr_b16 a[184:185], v239 offset:40960
v_mfma_f32_16x16x32_bf16 v[64:67], a[164:167], v[36:39], v[64:67]
s_add_u32 s54, s54, s79
ds_read_b64_tr_b16 a[186:187], v239 offset:43008
v_mfma_f32_16x16x32_bf16 v[72:75], a[164:167], v[20:23], v[72:75]
s_addk_i32 m0, 0x2000
ds_read_b64_tr_b16 a[188:189], v239 offset:45056
v_mfma_f32_16x16x32_bf16 v[72:75], a[160:163], v[12:15], v[72:75]
s_waitcnt lgkmcnt(5)
ds_read_b64_tr_b16 a[190:191], v239 offset:47104
buffer_load_dwordx4 v234, s[12:15], s54 offen  lds
v_mfma_f32_16x16x32_bf16 v[72:75], a[168:171], v[52:55], v[72:75]
ds_read_b64_tr_b16 a[144:145], v238 offset:0
v_mfma_f32_16x16x32_bf16 v[72:75], a[172:175], v[68:71], v[72:75]
ds_read_b64_tr_b16 a[146:147], v238 offset:2048
v_mfma_f32_16x16x32_bf16 v[64:67], a[172:175], v[44:47], v[64:67]
ds_read_b64_tr_b16 a[148:149], v238 offset:4096
v_mfma_f32_16x16x32_bf16 v[64:67], a[168:171], v[28:31], v[64:67]
s_waitcnt lgkmcnt(7)
ds_read_b64_tr_b16 a[150:151], v238 offset:6144
v_mfma_f32_16x16x32_bf16 v[64:67], a[176:179], v[160:163], v[64:67]
LM_p9:
s_cbranch_execz LM_v0
ds_read_b64_tr_b16 a[152:153], v238 offset:8192
v_mfma_f32_16x16x32_bf16 v[64:67], a[180:183], v[24:27], v[64:67]
ds_read_b64_tr_b16 a[154:155], v238 offset:10240
v_mfma_f32_16x16x32_bf16 v[72:75], a[180:183], v[16:19], v[72:75]
ds_read_b64_tr_b16 a[156:157], v238 offset:12288
v_mfma_f32_16x16x32_bf16 v[72:75], a[176:179], v[140:143], v[72:75]
s_waitcnt lgkmcnt(7)
ds_read_b64_tr_b16 a[158:159], v238 offset:14336
buffer_load_dwordx4 v233, s[12:15], s54 offen offset:1024  lds
v_mfma_f32_16x16x32_bf16 v[72:75], a[184:187], v[4:7], v[72:75]
ds_read_b64_tr_b16 a[160:161], v238 offset:16384
v_mfma_f32_16x16x32_bf16 v[72:75], a[188:191], v[40:43], v[72:75]
ds_read_b64_tr_b16 a[162:163], v238 offset:18432
v_mfma_f32_16x16x32_bf16 v[64:67], a[188:191], v[56:59], v[64:67]
ds_read_b64_tr_b16 a[164:165], v238 offset:20480
v_mfma_f32_16x16x32_bf16 v[64:67], a[184:187], v[32:35], v[64:67]
s_waitcnt lgkmcnt(7)
ds_read_b64_tr_b16 a[166:167], v238 offset:22528
v_mfma_f32_16x16x32_bf16 v[88:91], a[144:147], v[156:159], 0
s_mul_i32 s55, s79, 576
ds_read_b128 a[168:171], v248 offset:28672
v_mfma_f32_16x16x32_bf16 v[88:91], a[148:151], v[48:51], v[88:91]
s_addk_i32 m0, 0x2000
v_mfma_f32_16x16x32_bf16 v[108:111], a[148:151], v[136:139], 0
s_waitcnt vmcnt(5)
ds_read_b128 a[172:175], v230 offset:28672
buffer_load_dwordx4 v235, s[20:23], s55 offen  lds
v_mfma_f32_16x16x32_bf16 v[108:111], a[144:147], v[172:175], v[108:111]
s_waitcnt lgkmcnt(6)
v_cvt_pk_bf16_f32 v82, v64, v65
v_cvt_pk_bf16_f32 v83, v66, v67
v_mfma_f32_16x16x32_bf16 v[108:111], a[152:155], v[92:95], v[108:111]
ds_read_b128 a[176:179], v248 offset:36864
v_cvt_pk_bf16_f32 v86, v72, v73
v_mfma_f32_16x16x32_bf16 v[108:111], a[156:159], v[76:79], v[108:111]
buffer_store_dword v254, v222, s[32:35], 0 offen sc1
v_cvt_pk_bf16_f32 v87, v74, v75
v_mfma_f32_16x16x32_bf16 v[88:91], a[156:159], v[128:131], v[88:91]
buffer_store_dwordx4 v[80:83], v253, s[32:35], s56 offen offset:0 sc1
ds_read_b128 a[180:183], v230 offset:36864
v_mfma_f32_16x16x32_bf16 v[88:91], a[152:155], v[60:63], v[88:91]
s_waitcnt lgkmcnt(4)
v_mfma_f32_16x16x32_bf16 v[88:91], a[160:163], v[8:11], v[88:91]
ds_read_b64_tr_b16 a[184:185], v238 offset:40960
v_mfma_f32_16x16x32_bf16 v[88:91], a[164:167], v[36:39], v[88:91]
ds_read_b64_tr_b16 a[186:187], v238 offset:43008
v_mfma_f32_16x16x32_bf16 v[108:111], a[164:167], v[20:23], v[108:111]
ds_read_b64_tr_b16 a[188:189], v238 offset:45056
buffer_load_dwordx4 v252, s[20:23], s55 offen offset:1024  lds
v_mfma_f32_16x16x32_bf16 v[108:111], a[160:163], v[12:15], v[108:111]
s_waitcnt lgkmcnt(5)
buffer_store_dwordx4 v[84:87], v253, s[32:35], s56 offen offset:1024 sc1
ds_read_b64_tr_b16 a[190:191], v238 offset:47104
v_mfma_f32_16x16x32_bf16 v[108:111], a[168:171], v[52:55], v[108:111]
ds_read_b64_tr_b16 a[144:145], v236 offset:0
v_mfma_f32_16x16x32_bf16 v[108:111], a[172:175], v[68:71], v[108:111]
ds_read_b64_tr_b16 a[146:147], v236 offset:2048
v_mfma_f32_16x16x32_bf16 v[88:91], a[172:175], v[44:47], v[88:91]
ds_read_b64_tr_b16 a[148:149], v236 offset:4096
v_mfma_f32_16x16x32_bf16 v[88:91], a[168:171], v[28:31], v[88:91]
s_waitcnt lgkmcnt(7)
ds_read_b64_tr_b16 a[150:151], v236 offset:6144
v_mfma_f32_16x16x32_bf16 v[88:91], a[176:179], v[160:163], v[88:91]
s_mul_i32 s54, s79, 576
ds_read_b64_tr_b16 a[152:153], v236 offset:8192
v_mfma_f32_16x16x32_bf16 v[88:91], a[180:183], v[24:27], v[88:91]
s_addk_i32 m0, 0x2000
ds_read_b64_tr_b16 a[154:155], v236 offset:10240
v_mfma_f32_16x16x32_bf16 v[108:111], a[180:183], v[16:19], v[108:111]
ds_read_b64_tr_b16 a[156:157], v236 offset:12288
buffer_load_dwordx4 v235, s[24:27], s54 offen  lds
v_mfma_f32_16x16x32_bf16 v[108:111], a[176:179], v[140:143], v[108:111]
s_waitcnt lgkmcnt(7)
ds_read_b64_tr_b16 a[158:159], v236 offset:14336
v_mfma_f32_16x16x32_bf16 v[108:111], a[184:187], v[4:7], v[108:111]
ds_read_b64_tr_b16 a[160:161], v236 offset:16384
v_mfma_f32_16x16x32_bf16 v[108:111], a[188:191], v[40:43], v[108:111]
ds_read_b64_tr_b16 a[162:163], v236 offset:18432
v_mfma_f32_16x16x32_bf16 v[88:91], a[188:191], v[56:59], v[88:91]
ds_read_b64_tr_b16 a[164:165], v236 offset:20480
v_mfma_f32_16x16x32_bf16 v[88:91], a[184:187], v[32:35], v[88:91]
s_waitcnt lgkmcnt(7)
ds_read_b64_tr_b16 a[166:167], v236 offset:22528
v_mfma_f32_16x16x32_bf16 v[64:67], a[144:147], v[156:159], 0
ds_read_b128 a[168:171], v248 offset:30720
v_mfma_f32_16x16x32_bf16 v[64:67], a[148:151], v[48:51], v[64:67]
v_mfma_f32_16x16x32_bf16 v[72:75], a[148:151], v[136:139], 0
ds_read_b128 a[172:175], v230 offset:30720
buffer_load_dwordx4 v252, s[24:27], s54 offen offset:1024  lds
v_mfma_f32_16x16x32_bf16 v[72:75], a[144:147], v[172:175], v[72:75]
s_waitcnt lgkmcnt(6)
v_cvt_pk_bf16_f32 v82, v88, v89
v_cvt_pk_bf16_f32 v83, v90, v91
v_mfma_f32_16x16x32_bf16 v[72:75], a[152:155], v[92:95], v[72:75]
ds_read_b128 a[176:179], v248 offset:38912
v_cvt_pk_bf16_f32 v86, v108, v109
v_mfma_f32_16x16x32_bf16 v[72:75], a[156:159], v[76:79], v[72:75]
v_cvt_pk_bf16_f32 v87, v110, v111
v_mfma_f32_16x16x32_bf16 v[64:67], a[156:159], v[128:131], v[64:67]
ds_read_b128 a[180:183], v230 offset:38912
v_mfma_f32_16x16x32_bf16 v[64:67], a[152:155], v[60:63], v[64:67]
s_waitcnt lgkmcnt(4)
v_mfma_f32_16x16x32_bf16 v[64:67], a[160:163], v[8:11], v[64:67]
s_mul_i32 s55, s73, 576
ds_read_b64_tr_b16 a[184:185], v236 offset:40960
v_mfma_f32_16x16x32_bf16 v[64:67], a[164:167], v[36:39], v[64:67]
s_add_u32 s55, s55, s79
ds_read_b64_tr_b16 a[186:187], v236 offset:43008
v_mfma_f32_16x16x32_bf16 v[72:75], a[164:167], v[20:23], v[72:75]
ds_read_b64_tr_b16 a[188:189], v236 offset:45056
v_mfma_f32_16x16x32_bf16 v[72:75], a[160:163], v[12:15], v[72:75]
s_waitcnt lgkmcnt(5)
ds_read_b64_tr_b16 a[190:191], v236 offset:47104
v_mfma_f32_16x16x32_bf16 v[72:75], a[168:171], v[52:55], v[72:75]
s_barrier
ds_read_b64_tr_b16 a[144:145], v231 offset:0
v_mfma_f32_16x16x32_bf16 v[72:75], a[172:175], v[68:71], v[72:75]
s_addk_i32 m0, 0x2000
ds_read_b64_tr_b16 a[146:147], v231 offset:2048
v_mfma_f32_16x16x32_bf16 v[64:67], a[172:175], v[44:47], v[64:67]
ds_read_b64_tr_b16 a[148:149], v231 offset:4096
buffer_load_dwordx4 v234, s[12:15], s55 offen  lds
v_mfma_f32_16x16x32_bf16 v[64:67], a[168:171], v[28:31], v[64:67]
s_waitcnt lgkmcnt(7)
ds_read_b64_tr_b16 a[150:151], v231 offset:6144
v_mfma_f32_16x16x32_bf16 v[64:67], a[176:179], v[160:163], v[64:67]
ds_read_b64_tr_b16 a[152:153], v231 offset:8192
v_mfma_f32_16x16x32_bf16 v[64:67], a[180:183], v[24:27], v[64:67]
ds_read_b64_tr_b16 a[154:155], v231 offset:10240
v_mfma_f32_16x16x32_bf16 v[72:75], a[180:183], v[16:19], v[72:75]
ds_read_b64_tr_b16 a[156:157], v231 offset:12288
v_mfma_f32_16x16x32_bf16 v[72:75], a[176:179], v[140:143], v[72:75]
s_waitcnt lgkmcnt(7)
ds_read_b64_tr_b16 a[158:159], v231 offset:14336
v_mfma_f32_16x16x32_bf16 v[72:75], a[184:187], v[4:7], v[72:75]
ds_read_b64_tr_b16 a[160:161], v231 offset:16384
v_mfma_f32_16x16x32_bf16 v[72:75], a[188:191], v[40:43], v[72:75]
ds_read_b64_tr_b16 a[162:163], v231 offset:18432
v_mfma_f32_16x16x32_bf16 v[64:67], a[188:191], v[56:59], v[64:67]
ds_read_b64_tr_b16 a[164:165], v231 offset:20480
buffer_load_dwordx4 v233, s[12:15], s55 offen offset:1024  lds
v_mfma_f32_16x16x32_bf16 v[64:67], a[184:187], v[32:35], v[64:67]
s_waitcnt lgkmcnt(7)
ds_read_b64_tr_b16 a[166:167], v231 offset:22528
v_mfma_f32_16x16x32_bf16 v[88:91], a[144:147], v[156:159], 0
s_mul_i32 s54, s70, 576
ds_read_b128 a[168:171], v247 offset:24576
v_mfma_f32_16x16x32_bf16 v[88:91], a[148:151], v[48:51], v[88:91]
s_add_u32 s54, s54, s80
v_mfma_f32_16x16x32_bf16 v[108:111], a[148:151], v[136:139], 0
s_mov_b32 m0, s53
ds_read_b128 a[172:175], v241 offset:24576
v_cvt_pk_bf16_f32 v80, v64, v65
v_mfma_f32_16x16x32_bf16 v[108:111], a[144:147], v[172:175], v[108:111]
s_waitcnt lgkmcnt(6)
buffer_load_dwordx4 v234, s[12:15], s54 offen  lds
v_cvt_pk_bf16_f32 v81, v66, v67
v_mfma_f32_16x16x32_bf16 v[108:111], a[152:155], v[92:95], v[108:111]
ds_read_b128 a[176:179], v247 offset:32768
v_cvt_pk_bf16_f32 v84, v72, v73
v_mfma_f32_16x16x32_bf16 v[108:111], a[156:159], v[76:79], v[108:111]
v_cvt_pk_bf16_f32 v85, v74, v75
v_mfma_f32_16x16x32_bf16 v[88:91], a[156:159], v[128:131], v[88:91]
buffer_store_dwordx4 v[80:83], v249, s[32:35], s56 offen offset:0 sc1
ds_read_b128 a[180:183], v241 offset:32768
v_mfma_f32_16x16x32_bf16 v[88:91], a[152:155], v[60:63], v[88:91]
s_waitcnt lgkmcnt(4)
v_mfma_f32_16x16x32_bf16 v[88:91], a[160:163], v[8:11], v[88:91]
ds_read_b64_tr_b16 a[184:185], v231 offset:40960
v_mfma_f32_16x16x32_bf16 v[88:91], a[164:167], v[36:39], v[88:91]
ds_read_b64_tr_b16 a[186:187], v231 offset:43008
v_mfma_f32_16x16x32_bf16 v[108:111], a[164:167], v[20:23], v[108:111]
buffer_store_dwordx4 v[84:87], v249, s[32:35], s56 offen offset:1024 sc1
ds_read_b64_tr_b16 a[188:189], v231 offset:45056
v_mfma_f32_16x16x32_bf16 v[108:111], a[160:163], v[12:15], v[108:111]
s_waitcnt lgkmcnt(5)
ds_read_b64_tr_b16 a[190:191], v231 offset:47104
buffer_load_dwordx4 v233, s[12:15], s54 offen offset:1024  lds
v_mfma_f32_16x16x32_bf16 v[108:111], a[168:171], v[52:55], v[108:111]
s_add_u32 s56, s51, 4
ds_read_b64_tr_b16 a[144:145], v228 offset:0
v_mfma_f32_16x16x32_bf16 v[108:111], a[172:175], v[68:71], v[108:111]
s_and_b32 s56, s56, 7
ds_read_b64_tr_b16 a[146:147], v228 offset:2048
v_mfma_f32_16x16x32_bf16 v[88:91], a[172:175], v[44:47], v[88:91]
s_add_u32 s56, s56, 1
ds_read_b64_tr_b16 a[148:149], v228 offset:4096
v_mfma_f32_16x16x32_bf16 v[88:91], a[168:171], v[28:31], v[88:91]
s_waitcnt lgkmcnt(7)
ds_read_b64_tr_b16 a[150:151], v228 offset:6144
v_mfma_f32_16x16x32_bf16 v[88:91], a[176:179], v[160:163], v[88:91]
s_mul_i32 s55, s71, 576
ds_read_b64_tr_b16 a[152:153], v228 offset:8192
v_mfma_f32_16x16x32_bf16 v[88:91], a[180:183], v[24:27], v[88:91]
s_add_u32 s55, s55, s80
ds_read_b64_tr_b16 a[154:155], v228 offset:10240
v_mfma_f32_16x16x32_bf16 v[108:111], a[180:183], v[16:19], v[108:111]
s_addk_i32 m0, 0x2000
ds_read_b64_tr_b16 a[156:157], v228 offset:12288
v_mfma_f32_16x16x32_bf16 v[108:111], a[176:179], v[140:143], v[108:111]
s_waitcnt lgkmcnt(7)
ds_read_b64_tr_b16 a[158:159], v228 offset:14336
buffer_load_dwordx4 v234, s[12:15], s55 offen  lds
v_mfma_f32_16x16x32_bf16 v[108:111], a[184:187], v[4:7], v[108:111]
s_lshr_b32 s86, s100, s56
ds_read_b64_tr_b16 a[160:161], v228 offset:16384
v_mfma_f32_16x16x32_bf16 v[108:111], a[188:191], v[40:43], v[108:111]
s_and_b32 s86, s86, 0x2000
ds_read_b64_tr_b16 a[162:163], v228 offset:18432
v_mfma_f32_16x16x32_bf16 v[88:91], a[188:191], v[56:59], v[88:91]
s_lshl_b32 s56, s56, 19
ds_read_b64_tr_b16 a[164:165], v228 offset:20480
v_mfma_f32_16x16x32_bf16 v[88:91], a[184:187], v[32:35], v[88:91]
s_waitcnt lgkmcnt(7)
ds_read_b64_tr_b16 a[166:167], v228 offset:22528
v_mfma_f32_16x16x32_bf16 v[64:67], a[144:147], v[156:159], 0
s_add_u32 s56, s56, s83
ds_read_b128 a[168:171], v247 offset:26624
v_mfma_f32_16x16x32_bf16 v[64:67], a[148:151], v[48:51], v[64:67]
s_add_u32 s56, s56, s86
v_mfma_f32_16x16x32_bf16 v[72:75], a[148:151], v[136:139], 0
ds_read_b128 a[172:175], v241 offset:26624
v_cvt_pk_bf16_f32 v80, v88, v89
v_mfma_f32_16x16x32_bf16 v[72:75], a[144:147], v[172:175], v[72:75]
s_waitcnt lgkmcnt(6)
buffer_load_dwordx4 v233, s[12:15], s55 offen offset:1024  lds
v_cvt_pk_bf16_f32 v81, v90, v91
v_mfma_f32_16x16x32_bf16 v[72:75], a[152:155], v[92:95], v[72:75]
ds_read_b128 a[176:179], v247 offset:34816
v_cvt_pk_bf16_f32 v84, v108, v109
v_mfma_f32_16x16x32_bf16 v[72:75], a[156:159], v[76:79], v[72:75]
v_cvt_pk_bf16_f32 v85, v110, v111
v_mfma_f32_16x16x32_bf16 v[64:67], a[156:159], v[128:131], v[64:67]
ds_read_b128 a[180:183], v241 offset:34816
v_mfma_f32_16x16x32_bf16 v[64:67], a[152:155], v[60:63], v[64:67]
s_waitcnt lgkmcnt(4)
v_mfma_f32_16x16x32_bf16 v[64:67], a[160:163], v[8:11], v[64:67]
s_mul_i32 s54, s72, 576
ds_read_b64_tr_b16 a[184:185], v228 offset:40960
v_mfma_f32_16x16x32_bf16 v[64:67], a[164:167], v[36:39], v[64:67]
s_add_u32 s54, s54, s80
ds_read_b64_tr_b16 a[186:187], v228 offset:43008
s_mov_b64 exec, 0xf
buffer_atomic_add v246, v227, s[32:35], 0 offen sc0 sc1
s_mov_b64 exec, -1
v_mfma_f32_16x16x32_bf16 v[72:75], a[164:167], v[20:23], v[72:75]
s_addk_i32 m0, 0x2000
ds_read_b64_tr_b16 a[188:189], v228 offset:45056
v_mfma_f32_16x16x32_bf16 v[72:75], a[160:163], v[12:15], v[72:75]
s_waitcnt lgkmcnt(5)
ds_read_b64_tr_b16 a[190:191], v228 offset:47104
buffer_load_dwordx4 v234, s[12:15], s54 offen  lds
v_mfma_f32_16x16x32_bf16 v[72:75], a[168:171], v[52:55], v[72:75]
ds_read_b64_tr_b16 a[144:145], v213 offset:0
v_mfma_f32_16x16x32_bf16 v[72:75], a[172:175], v[68:71], v[72:75]
ds_read_b64_tr_b16 a[146:147], v213 offset:2048
v_mfma_f32_16x16x32_bf16 v[64:67], a[172:175], v[44:47], v[64:67]
ds_read_b64_tr_b16 a[148:149], v213 offset:4096
v_mfma_f32_16x16x32_bf16 v[64:67], a[168:171], v[28:31], v[64:67]
s_waitcnt lgkmcnt(7)
ds_read_b64_tr_b16 a[150:151], v213 offset:6144
v_mfma_f32_16x16x32_bf16 v[64:67], a[176:179], v[160:163], v[64:67]
ds_read_b64_tr_b16 a[152:153], v213 offset:8192
v_mfma_f32_16x16x32_bf16 v[64:67], a[180:183], v[24:27], v[64:67]
ds_read_b64_tr_b16 a[154:155], v213 offset:10240
v_mfma_f32_16x16x32_bf16 v[72:75], a[180:183], v[16:19], v[72:75]
ds_read_b64_tr_b16 a[156:157], v213 offset:12288
v_mfma_f32_16x16x32_bf16 v[72:75], a[176:179], v[140:143], v[72:75]
s_waitcnt lgkmcnt(7)
ds_read_b64_tr_b16 a[158:159], v213 offset:14336
buffer_load_dwordx4 v233, s[12:15], s54 offen offset:1024  lds
v_mfma_f32_16x16x32_bf16 v[72:75], a[184:187], v[4:7], v[72:75]
ds_read_b64_tr_b16 a[160:161], v213 offset:16384
v_mfma_f32_16x16x32_bf16 v[72:75], a[188:191], v[40:43], v[72:75]
ds_read_b64_tr_b16 a[162:163], v213 offset:18432
v_mfma_f32_16x16x32_bf16 v[64:67], a[188:191], v[56:59], v[64:67]
ds_read_b64_tr_b16 a[164:165], v213 offset:20480
v_mfma_f32_16x16x32_bf16 v[64:67], a[184:187], v[32:35], v[64:67]
s_waitcnt lgkmcnt(7)
ds_read_b64_tr_b16 a[166:167], v213 offset:22528
v_mfma_f32_16x16x32_bf16 v[88:91], a[144:147], v[156:159], 0
s_mul_i32 s55, s80, 576
ds_read_b128 a[168:171], v247 offset:28672
v_mfma_f32_16x16x32_bf16 v[88:91], a[148:151], v[48:51], v[88:91]
s_addk_i32 m0, 0x2000
v_mfma_f32_16x16x32_bf16 v[108:111], a[148:151], v[136:139], 0
ds_read_b128 a[172:175], v241 offset:28672
buffer_load_dwordx4 v235, s[20:23], s55 offen  lds
v_mfma_f32_16x16x32_bf16 v[108:111], a[144:147], v[172:175], v[108:111]
s_waitcnt lgkmcnt(6)
v_cvt_pk_bf16_f32 v82, v64, v65
v_cvt_pk_bf16_f32 v83, v66, v67
v_mfma_f32_16x16x32_bf16 v[108:111], a[152:155], v[92:95], v[108:111]
ds_read_b128 a[176:179], v247 offset:36864
v_cvt_pk_bf16_f32 v86, v72, v73
v_mfma_f32_16x16x32_bf16 v[108:111], a[156:159], v[76:79], v[108:111]
v_cvt_pk_bf16_f32 v87, v74, v75
v_mfma_f32_16x16x32_bf16 v[88:91], a[156:159], v[128:131], v[88:91]
buffer_store_dwordx4 v[80:83], v253, s[32:35], s56 offen offset:0 sc1
ds_read_b128 a[180:183], v241 offset:36864
v_mfma_f32_16x16x32_bf16 v[88:91], a[152:155], v[60:63], v[88:91]
s_waitcnt lgkmcnt(4)
v_mfma_f32_16x16x32_bf16 v[88:91], a[160:163], v[8:11], v[88:91]
ds_read_b64_tr_b16 a[184:185], v213 offset:40960
v_mfma_f32_16x16x32_bf16 v[88:91], a[164:167], v[36:39], v[88:91]
ds_read_b64_tr_b16 a[186:187], v213 offset:43008
v_mfma_f32_16x16x32_bf16 v[108:111], a[164:167], v[20:23], v[108:111]
ds_read_b64_tr_b16 a[188:189], v213 offset:45056
buffer_load_dwordx4 v252, s[20:23], s55 offen offset:1024  lds
v_mfma_f32_16x16x32_bf16 v[108:111], a[160:163], v[12:15], v[108:111]
s_waitcnt lgkmcnt(5)
buffer_store_dwordx4 v[84:87], v253, s[32:35], s56 offen offset:1024 sc1
ds_read_b64_tr_b16 a[190:191], v213 offset:47104
v_mfma_f32_16x16x32_bf16 v[108:111], a[168:171], v[52:55], v[108:111]
ds_read_b64_tr_b16 a[144:145], v212 offset:0
v_mfma_f32_16x16x32_bf16 v[108:111], a[172:175], v[68:71], v[108:111]
ds_read_b64_tr_b16 a[146:147], v212 offset:2048
v_mfma_f32_16x16x32_bf16 v[88:91], a[172:175], v[44:47], v[88:91]
ds_read_b64_tr_b16 a[148:149], v212 offset:4096
v_mfma_f32_16x16x32_bf16 v[88:91], a[168:171], v[28:31], v[88:91]
s_waitcnt lgkmcnt(7)
ds_read_b64_tr_b16 a[150:151], v212 offset:6144
v_mfma_f32_16x16x32_bf16 v[88:91], a[176:179], v[160:163], v[88:91]
s_mul_i32 s54, s80, 576
ds_read_b64_tr_b16 a[152:153], v212 offset:8192
v_mfma_f32_16x16x32_bf16 v[88:91], a[180:183], v[24:27], v[88:91]
s_addk_i32 m0, 0x2000
ds_read_b64_tr_b16 a[154:155], v212 offset:10240
v_mfma_f32_16x16x32_bf16 v[108:111], a[180:183], v[16:19], v[108:111]
ds_read_b64_tr_b16 a[156:157], v212 offset:12288
buffer_load_dwordx4 v235, s[24:27], s54 offen  lds
v_mfma_f32_16x16x32_bf16 v[108:111], a[176:179], v[140:143], v[108:111]
s_waitcnt lgkmcnt(7)
ds_read_b64_tr_b16 a[158:159], v212 offset:14336
v_mfma_f32_16x16x32_bf16 v[108:111], a[184:187], v[4:7], v[108:111]
ds_read_b64_tr_b16 a[160:161], v212 offset:16384
v_mfma_f32_16x16x32_bf16 v[108:111], a[188:191], v[40:43], v[108:111]
ds_read_b64_tr_b16 a[162:163], v212 offset:18432
v_mfma_f32_16x16x32_bf16 v[88:91], a[188:191], v[56:59], v[88:91]
ds_read_b64_tr_b16 a[164:165], v212 offset:20480
v_mfma_f32_16x16x32_bf16 v[88:91], a[184:187], v[32:35], v[88:91]
s_waitcnt lgkmcnt(7)
ds_read_b64_tr_b16 a[166:167], v212 offset:22528
v_mfma_f32_16x16x32_bf16 v[64:67], a[144:147], v[156:159], 0
ds_read_b128 a[168:171], v247 offset:30720
v_mfma_f32_16x16x32_bf16 v[64:67], a[148:151], v[48:51], v[64:67]
v_mfma_f32_16x16x32_bf16 v[72:75], a[148:151], v[136:139], 0
ds_read_b128 a[172:175], v241 offset:30720
buffer_load_dwordx4 v252, s[24:27], s54 offen offset:1024  lds
v_mfma_f32_16x16x32_bf16 v[72:75], a[144:147], v[172:175], v[72:75]
s_waitcnt lgkmcnt(6)
s_waitcnt vmcnt(8)
v_cmp_le_u32 vcc, v232, v246
v_cvt_pk_bf16_f32 v82, v88, v89
v_mfma_f32_16x16x32_bf16 v[72:75], a[152:155], v[92:95], v[72:75]
s_and_b32 s99, vcc_lo, 0xf
ds_read_b128 a[176:179], v247 offset:38912
v_cvt_pk_bf16_f32 v83, v90, v91
v_mfma_f32_16x16x32_bf16 v[72:75], a[156:159], v[76:79], v[72:75]
s_andn2_b32 s98, s98, s99
v_cvt_pk_bf16_f32 v86, v108, v109
v_cvt_pk_bf16_f32 v87, v110, v111
v_mfma_f32_16x16x32_bf16 v[64:67], a[156:159], v[128:131], v[64:67]
s_lshl_b32 s57, s98, 20
ds_read_b128 a[180:183], v241 offset:38912
v_mfma_f32_16x16x32_bf16 v[64:67], a[152:155], v[60:63], v[64:67]
s_waitcnt lgkmcnt(4)
v_mfma_f32_16x16x32_bf16 v[64:67], a[160:163], v[8:11], v[64:67]
s_mul_i32 s55, s73, 576
ds_read_b64_tr_b16 a[184:185], v212 offset:40960
v_mfma_f32_16x16x32_bf16 v[64:67], a[164:167], v[36:39], v[64:67]
s_add_u32 s55, s55, s80
ds_read_b64_tr_b16 a[186:187], v212 offset:43008
v_mfma_f32_16x16x32_bf16 v[72:75], a[164:167], v[20:23], v[72:75]
ds_read_b64_tr_b16 a[188:189], v212 offset:45056
v_mfma_f32_16x16x32_bf16 v[72:75], a[160:163], v[12:15], v[72:75]
s_waitcnt lgkmcnt(5)
ds_read_b64_tr_b16 a[190:191], v212 offset:47104
v_mfma_f32_16x16x32_bf16 v[72:75], a[168:171], v[52:55], v[72:75]
s_barrier
ds_read_b64_tr_b16 a[144:145], v209 offset:0
v_mfma_f32_16x16x32_bf16 v[72:75], a[172:175], v[68:71], v[72:75]
s_addk_i32 m0, 0x2000
ds_read_b64_tr_b16 a[146:147], v209 offset:2048
v_mfma_f32_16x16x32_bf16 v[64:67], a[172:175], v[44:47], v[64:67]
s_and_b32 s57, s57, 0x100000
s_or_b32 s57, s57, s60
ds_read_b64_tr_b16 a[148:149], v209 offset:4096
buffer_load_dwordx4 v234, s[12:15], s55 offen  lds
buffer_load_dwordx4 a[2:5], v240, s[44:47], s57 offen offset:0 sc1
v_mfma_f32_16x16x32_bf16 v[64:67], a[168:171], v[28:31], v[64:67]
s_waitcnt lgkmcnt(7)
ds_read_b64_tr_b16 a[150:151], v209 offset:6144
v_mfma_f32_16x16x32_bf16 v[64:67], a[176:179], v[160:163], v[64:67]
ds_read_b64_tr_b16 a[152:153], v209 offset:8192
v_mfma_f32_16x16x32_bf16 v[64:67], a[180:183], v[24:27], v[64:67]
ds_read_b64_tr_b16 a[154:155], v209 offset:10240
v_mfma_f32_16x16x32_bf16 v[72:75], a[180:183], v[16:19], v[72:75]
ds_read_b64_tr_b16 a[156:157], v209 offset:12288
v_mfma_f32_16x16x32_bf16 v[72:75], a[176:179], v[140:143], v[72:75]
s_waitcnt lgkmcnt(7)
ds_read_b64_tr_b16 a[158:159], v209 offset:14336
v_mfma_f32_16x16x32_bf16 v[72:75], a[184:187], v[4:7], v[72:75]
ds_read_b64_tr_b16 a[160:161], v209 offset:16384
v_mfma_f32_16x16x32_bf16 v[72:75], a[188:191], v[40:43], v[72:75]
ds_read_b64_tr_b16 a[162:163], v209 offset:18432
v_mfma_f32_16x16x32_bf16 v[64:67], a[188:191], v[56:59], v[64:67]
ds_read_b64_tr_b16 a[164:165], v209 offset:20480
buffer_load_dwordx4 v233, s[12:15], s55 offen offset:1024  lds
v_mfma_f32_16x16x32_bf16 v[64:67], a[184:187], v[32:35], v[64:67]
s_waitcnt lgkmcnt(7)
ds_read_b64_tr_b16 a[166:167], v209 offset:22528
v_mfma_f32_16x16x32_bf16 v[88:91], a[144:147], v[156:159], 0
s_mul_i32 s54, s70, 576
ds_read_b128 a[168:171], v250 offset:24576
v_mfma_f32_16x16x32_bf16 v[88:91], a[148:151], v[48:51], v[88:91]
s_add_u32 s54, s54, s81
v_mfma_f32_16x16x32_bf16 v[108:111], a[148:151], v[136:139], 0
s_addk_i32 m0, 0x2000
ds_read_b128 a[172:175], v244 offset:24576
v_cvt_pk_bf16_f32 v80, v64, v65
v_mfma_f32_16x16x32_bf16 v[108:111], a[144:147], v[172:175], v[108:111]
s_waitcnt lgkmcnt(6)
buffer_load_dwordx4 v234, s[12:15], s54 offen  lds
v_cvt_pk_bf16_f32 v81, v66, v67
v_mfma_f32_16x16x32_bf16 v[108:111], a[152:155], v[92:95], v[108:111]
ds_read_b128 a[176:179], v250 offset:32768
v_cvt_pk_bf16_f32 v84, v72, v73
v_mfma_f32_16x16x32_bf16 v[108:111], a[156:159], v[76:79], v[108:111]
v_cvt_pk_bf16_f32 v85, v74, v75
v_mfma_f32_16x16x32_bf16 v[88:91], a[156:159], v[128:131], v[88:91]
buffer_store_dwordx4 v[80:83], v249, s[32:35], s56 offen offset:0 sc1
ds_read_b128 a[180:183], v244 offset:32768
v_mfma_f32_16x16x32_bf16 v[88:91], a[152:155], v[60:63], v[88:91]
s_waitcnt lgkmcnt(4)
v_mfma_f32_16x16x32_bf16 v[88:91], a[160:163], v[8:11], v[88:91]
buffer_load_dwordx4 a[66:69], v240, s[44:47], s57 offen offset:1024 sc1
ds_read_b64_tr_b16 a[184:185], v209 offset:40960
v_mfma_f32_16x16x32_bf16 v[88:91], a[164:167], v[36:39], v[88:91]
s_lshl_b32 s57, s98, 19
ds_read_b64_tr_b16 a[186:187], v209 offset:43008
v_mfma_f32_16x16x32_bf16 v[108:111], a[164:167], v[20:23], v[108:111]
s_and_b32 s57, s57, 0x100000
buffer_store_dwordx4 v[84:87], v249, s[32:35], s56 offen offset:1024 sc1
ds_read_b64_tr_b16 a[188:189], v209 offset:45056
v_mfma_f32_16x16x32_bf16 v[108:111], a[160:163], v[12:15], v[108:111]
s_waitcnt lgkmcnt(5)
ds_read_b64_tr_b16 a[190:191], v209 offset:47104
buffer_load_dwordx4 v233, s[12:15], s54 offen offset:1024  lds
v_mfma_f32_16x16x32_bf16 v[108:111], a[168:171], v[52:55], v[108:111]
s_or_b32 s57, s57, s61
ds_read_b64_tr_b16 a[144:145], v208 offset:0
v_mfma_f32_16x16x32_bf16 v[108:111], a[172:175], v[68:71], v[108:111]
s_add_u32 s56, s51, 5
ds_read_b64_tr_b16 a[146:147], v208 offset:2048
v_mfma_f32_16x16x32_bf16 v[88:91], a[172:175], v[44:47], v[88:91]
s_and_b32 s56, s56, 7
ds_read_b64_tr_b16 a[148:149], v208 offset:4096
v_mfma_f32_16x16x32_bf16 v[88:91], a[168:171], v[28:31], v[88:91]
s_waitcnt lgkmcnt(7)
ds_read_b64_tr_b16 a[150:151], v208 offset:6144
v_mfma_f32_16x16x32_bf16 v[88:91], a[176:179], v[160:163], v[88:91]
s_mul_i32 s55, s71, 576
ds_read_b64_tr_b16 a[152:153], v208 offset:8192
v_mfma_f32_16x16x32_bf16 v[88:91], a[180:183], v[24:27], v[88:91]
s_add_u32 s55, s55, s81
ds_read_b64_tr_b16 a[154:155], v208 offset:10240
v_mfma_f32_16x16x32_bf16 v[108:111], a[180:183], v[16:19], v[108:111]
s_addk_i32 m0, 0x2000
ds_read_b64_tr_b16 a[156:157], v208 offset:12288
v_mfma_f32_16x16x32_bf16 v[108:111], a[176:179], v[140:143], v[108:111]
s_waitcnt lgkmcnt(7)
ds_read_b64_tr_b16 a[158:159], v208 offset:14336
buffer_load_dwordx4 v234, s[12:15], s55 offen  lds
v_mfma_f32_16x16x32_bf16 v[108:111], a[184:187], v[4:7], v[108:111]
s_add_u32 s56, s56, 1
ds_read_b64_tr_b16 a[160:161], v208 offset:16384
v_mfma_f32_16x16x32_bf16 v[108:111], a[188:191], v[40:43], v[108:111]
s_lshr_b32 s86, s100, s56
ds_read_b64_tr_b16 a[162:163], v208 offset:18432
v_mfma_f32_16x16x32_bf16 v[88:91], a[188:191], v[56:59], v[88:91]
s_and_b32 s86, s86, 0x2000
ds_read_b64_tr_b16 a[164:165], v208 offset:20480
v_mfma_f32_16x16x32_bf16 v[88:91], a[184:187], v[32:35], v[88:91]
s_waitcnt lgkmcnt(7)
ds_read_b64_tr_b16 a[166:167], v208 offset:22528
v_mfma_f32_16x16x32_bf16 v[64:67], a[144:147], v[156:159], 0
s_lshl_b32 s56, s56, 19
ds_read_b128 a[168:171], v250 offset:26624
v_mfma_f32_16x16x32_bf16 v[64:67], a[148:151], v[48:51], v[64:67]
s_add_u32 s56, s56, s83
v_mfma_f32_16x16x32_bf16 v[72:75], a[148:151], v[136:139], 0
s_add_u32 s56, s56, s86
ds_read_b128 a[172:175], v244 offset:26624
v_cvt_pk_bf16_f32 v80, v88, v89
v_mfma_f32_16x16x32_bf16 v[72:75], a[144:147], v[172:175], v[72:75]
s_waitcnt lgkmcnt(6)
buffer_load_dwordx4 v233, s[12:15], s55 offen offset:1024  lds
v_cvt_pk_bf16_f32 v81, v90, v91
v_mfma_f32_16x16x32_bf16 v[72:75], a[152:155], v[92:95], v[72:75]
ds_read_b128 a[176:179], v250 offset:34816
v_cvt_pk_bf16_f32 v84, v108, v109
v_mfma_f32_16x16x32_bf16 v[72:75], a[156:159], v[76:79], v[72:75]
v_cvt_pk_bf16_f32 v85, v110, v111
v_mov_b32 v254, 10
v_mfma_f32_16x16x32_bf16 v[64:67], a[156:159], v[128:131], v[64:67]
buffer_load_dwordx4 a[6:9], v240, s[44:47], s57 offen offset:0 sc1
ds_read_b128 a[180:183], v244 offset:34816
v_mfma_f32_16x16x32_bf16 v[64:67], a[152:155], v[60:63], v[64:67]
s_waitcnt lgkmcnt(4)
v_mfma_f32_16x16x32_bf16 v[64:67], a[160:163], v[8:11], v[64:67]
s_mul_i32 s54, s72, 576
ds_read_b64_tr_b16 a[184:185], v208 offset:40960
v_mfma_f32_16x16x32_bf16 v[64:67], a[164:167], v[36:39], v[64:67]
s_add_u32 s54, s54, s81
ds_read_b64_tr_b16 a[186:187], v208 offset:43008
v_mfma_f32_16x16x32_bf16 v[72:75], a[164:167], v[20:23], v[72:75]
s_addk_i32 m0, 0x2000
ds_read_b64_tr_b16 a[188:189], v208 offset:45056
v_mfma_f32_16x16x32_bf16 v[72:75], a[160:163], v[12:15], v[72:75]
s_waitcnt lgkmcnt(5)
ds_read_b64_tr_b16 a[190:191], v208 offset:47104
buffer_load_dwordx4 v234, s[12:15], s54 offen  lds
v_mfma_f32_16x16x32_bf16 v[72:75], a[168:171], v[52:55], v[72:75]
ds_read_b64_tr_b16 a[144:145], v207 offset:0
v_mfma_f32_16x16x32_bf16 v[72:75], a[172:175], v[68:71], v[72:75]
ds_read_b64_tr_b16 a[146:147], v207 offset:2048
v_mfma_f32_16x16x32_bf16 v[64:67], a[172:175], v[44:47], v[64:67]
ds_read_b64_tr_b16 a[148:149], v207 offset:4096
v_mfma_f32_16x16x32_bf16 v[64:67], a[168:171], v[28:31], v[64:67]
s_waitcnt lgkmcnt(7)
ds_read_b64_tr_b16 a[150:151], v207 offset:6144
v_mfma_f32_16x16x32_bf16 v[64:67], a[176:179], v[160:163], v[64:67]
ds_read_b64_tr_b16 a[152:153], v207 offset:8192
v_mfma_f32_16x16x32_bf16 v[64:67], a[180:183], v[24:27], v[64:67]
ds_read_b64_tr_b16 a[154:155], v207 offset:10240
v_mfma_f32_16x16x32_bf16 v[72:75], a[180:183], v[16:19], v[72:75]
ds_read_b64_tr_b16 a[156:157], v207 offset:12288
v_mfma_f32_16x16x32_bf16 v[72:75], a[176:179], v[140:143], v[72:75]
s_waitcnt lgkmcnt(7)
ds_read_b64_tr_b16 a[158:159], v207 offset:14336
buffer_load_dwordx4 v233, s[12:15], s54 offen offset:1024  lds
v_mfma_f32_16x16x32_bf16 v[72:75], a[184:187], v[4:7], v[72:75]
ds_read_b64_tr_b16 a[160:161], v207 offset:16384
v_mfma_f32_16x16x32_bf16 v[72:75], a[188:191], v[40:43], v[72:75]
ds_read_b64_tr_b16 a[162:163], v207 offset:18432
v_mfma_f32_16x16x32_bf16 v[64:67], a[188:191], v[56:59], v[64:67]
ds_read_b64_tr_b16 a[164:165], v207 offset:20480
v_mfma_f32_16x16x32_bf16 v[64:67], a[184:187], v[32:35], v[64:67]
s_waitcnt lgkmcnt(7)
ds_read_b64_tr_b16 a[166:167], v207 offset:22528
v_mfma_f32_16x16x32_bf16 v[88:91], a[144:147], v[156:159], 0
s_mul_i32 s55, s81, 576
ds_read_b128 a[168:171], v250 offset:28672
v_mfma_f32_16x16x32_bf16 v[88:91], a[148:151], v[48:51], v[88:91]
s_addk_i32 m0, 0x2000
v_mfma_f32_16x16x32_bf16 v[108:111], a[148:151], v[136:139], 0
s_waitcnt vmcnt(6)
ds_read_b128 a[172:175], v244 offset:28672
buffer_load_dwordx4 v235, s[20:23], s55 offen  lds
v_mfma_f32_16x16x32_bf16 v[108:111], a[144:147], v[172:175], v[108:111]
s_waitcnt lgkmcnt(6)
v_cvt_pk_bf16_f32 v82, v64, v65
v_cvt_pk_bf16_f32 v83, v66, v67
v_mfma_f32_16x16x32_bf16 v[108:111], a[152:155], v[92:95], v[108:111]
LM_p10:
s_cbranch_execz LM_v0
ds_read_b128 a[176:179], v250 offset:36864
v_cvt_pk_bf16_f32 v86, v72, v73
v_mfma_f32_16x16x32_bf16 v[108:111], a[156:159], v[76:79], v[108:111]
buffer_load_dwordx4 a[70:73], v240, s[44:47], s57 offen offset:1024 sc1
v_cvt_pk_bf16_f32 v87, v74, v75
v_mfma_f32_16x16x32_bf16 v[88:91], a[156:159], v[128:131], v[88:91]
s_lshl_b32 s57, s98, 18
buffer_store_dword v254, v222, s[32:35], 0 offen sc1
ds_read_b128 a[180:183], v244 offset:36864
v_mfma_f32_16x16x32_bf16 v[88:91], a[152:155], v[60:63], v[88:91]
s_waitcnt lgkmcnt(4)
buffer_store_dwordx4 v[80:83], v253, s[32:35], s56 offen offset:0 sc1
v_mfma_f32_16x16x32_bf16 v[88:91], a[160:163], v[8:11], v[88:91]
s_and_b32 s57, s57, 0x100000
ds_read_b64_tr_b16 a[184:185], v207 offset:40960
v_mfma_f32_16x16x32_bf16 v[88:91], a[164:167], v[36:39], v[88:91]
s_or_b32 s57, s57, s62
ds_read_b64_tr_b16 a[186:187], v207 offset:43008
v_mfma_f32_16x16x32_bf16 v[108:111], a[164:167], v[20:23], v[108:111]
ds_read_b64_tr_b16 a[188:189], v207 offset:45056
buffer_load_dwordx4 v252, s[20:23], s55 offen offset:1024  lds
v_mfma_f32_16x16x32_bf16 v[108:111], a[160:163], v[12:15], v[108:111]
s_waitcnt lgkmcnt(5)
buffer_store_dwordx4 v[84:87], v253, s[32:35], s56 offen offset:1024 sc1
ds_read_b64_tr_b16 a[190:191], v207 offset:47104
v_mfma_f32_16x16x32_bf16 v[108:111], a[168:171], v[52:55], v[108:111]
ds_read_b64_tr_b16 a[144:145], v206 offset:0
v_mfma_f32_16x16x32_bf16 v[108:111], a[172:175], v[68:71], v[108:111]
ds_read_b64_tr_b16 a[146:147], v206 offset:2048
v_mfma_f32_16x16x32_bf16 v[88:91], a[172:175], v[44:47], v[88:91]
ds_read_b64_tr_b16 a[148:149], v206 offset:4096
v_mfma_f32_16x16x32_bf16 v[88:91], a[168:171], v[28:31], v[88:91]
s_waitcnt lgkmcnt(7)
ds_read_b64_tr_b16 a[150:151], v206 offset:6144
v_mfma_f32_16x16x32_bf16 v[88:91], a[176:179], v[160:163], v[88:91]
s_mul_i32 s54, s81, 576
ds_read_b64_tr_b16 a[152:153], v206 offset:8192
v_mfma_f32_16x16x32_bf16 v[88:91], a[180:183], v[24:27], v[88:91]
s_addk_i32 m0, 0x2000
ds_read_b64_tr_b16 a[154:155], v206 offset:10240
v_mfma_f32_16x16x32_bf16 v[108:111], a[180:183], v[16:19], v[108:111]
ds_read_b64_tr_b16 a[156:157], v206 offset:12288
buffer_load_dwordx4 v235, s[24:27], s54 offen  lds
v_mfma_f32_16x16x32_bf16 v[108:111], a[176:179], v[140:143], v[108:111]
s_waitcnt lgkmcnt(7)
ds_read_b64_tr_b16 a[158:159], v206 offset:14336
v_mfma_f32_16x16x32_bf16 v[108:111], a[184:187], v[4:7], v[108:111]
ds_read_b64_tr_b16 a[160:161], v206 offset:16384
v_mfma_f32_16x16x32_bf16 v[108:111], a[188:191], v[40:43], v[108:111]
ds_read_b64_tr_b16 a[162:163], v206 offset:18432
v_mfma_f32_16x16x32_bf16 v[88:91], a[188:191], v[56:59], v[88:91]
ds_read_b64_tr_b16 a[164:165], v206 offset:20480
v_mfma_f32_16x16x32_bf16 v[88:91], a[184:187], v[32:35], v[88:91]
s_waitcnt lgkmcnt(7)
ds_read_b64_tr_b16 a[166:167], v206 offset:22528
v_mfma_f32_16x16x32_bf16 v[64:67], a[144:147], v[156:159], 0
ds_read_b128 a[168:171], v250 offset:30720
v_mfma_f32_16x16x32_bf16 v[64:67], a[148:151], v[48:51], v[64:67]
v_mfma_f32_16x16x32_bf16 v[72:75], a[148:151], v[136:139], 0
ds_read_b128 a[172:175], v244 offset:30720
buffer_load_dwordx4 v252, s[24:27], s54 offen offset:1024  lds
v_mfma_f32_16x16x32_bf16 v[72:75], a[144:147], v[172:175], v[72:75]
s_waitcnt lgkmcnt(6)
buffer_load_dwordx4 a[10:13], v240, s[44:47], s57 offen offset:0 sc1
v_cvt_pk_bf16_f32 v82, v88, v89
v_mfma_f32_16x16x32_bf16 v[72:75], a[152:155], v[92:95], v[72:75]
ds_read_b128 a[176:179], v250 offset:38912
v_cvt_pk_bf16_f32 v83, v90, v91
v_mfma_f32_16x16x32_bf16 v[72:75], a[156:159], v[76:79], v[72:75]
v_cvt_pk_bf16_f32 v86, v108, v109
v_cvt_pk_bf16_f32 v87, v110, v111
v_mfma_f32_16x16x32_bf16 v[64:67], a[156:159], v[128:131], v[64:67]
ds_read_b128 a[180:183], v244 offset:38912
v_mfma_f32_16x16x32_bf16 v[64:67], a[152:155], v[60:63], v[64:67]
s_waitcnt lgkmcnt(4)
v_mfma_f32_16x16x32_bf16 v[64:67], a[160:163], v[8:11], v[64:67]
s_mul_i32 s55, s73, 576
ds_read_b64_tr_b16 a[184:185], v206 offset:40960
v_mfma_f32_16x16x32_bf16 v[64:67], a[164:167], v[36:39], v[64:67]
s_add_u32 s55, s55, s81
ds_read_b64_tr_b16 a[186:187], v206 offset:43008
v_mfma_f32_16x16x32_bf16 v[72:75], a[164:167], v[20:23], v[72:75]
ds_read_b64_tr_b16 a[188:189], v206 offset:45056
v_mfma_f32_16x16x32_bf16 v[72:75], a[160:163], v[12:15], v[72:75]
s_waitcnt lgkmcnt(5)
ds_read_b64_tr_b16 a[190:191], v206 offset:47104
v_mfma_f32_16x16x32_bf16 v[72:75], a[168:171], v[52:55], v[72:75]
s_barrier
ds_read_b64_tr_b16 a[144:145], v237 offset:0
v_mfma_f32_16x16x32_bf16 v[72:75], a[172:175], v[68:71], v[72:75]
s_addk_i32 m0, 0x2000
ds_read_b64_tr_b16 a[146:147], v237 offset:2048
v_mfma_f32_16x16x32_bf16 v[64:67], a[172:175], v[44:47], v[64:67]
ds_read_b64_tr_b16 a[148:149], v237 offset:4096
buffer_load_dwordx4 v234, s[12:15], s55 offen  lds
v_mfma_f32_16x16x32_bf16 v[64:67], a[168:171], v[28:31], v[64:67]
s_waitcnt lgkmcnt(7)
ds_read_b64_tr_b16 a[150:151], v237 offset:6144
v_mfma_f32_16x16x32_bf16 v[64:67], a[176:179], v[160:163], v[64:67]
ds_read_b64_tr_b16 a[152:153], v237 offset:8192
v_mfma_f32_16x16x32_bf16 v[64:67], a[180:183], v[24:27], v[64:67]
ds_read_b64_tr_b16 a[154:155], v237 offset:10240
v_mfma_f32_16x16x32_bf16 v[72:75], a[180:183], v[16:19], v[72:75]
ds_read_b64_tr_b16 a[156:157], v237 offset:12288
v_mfma_f32_16x16x32_bf16 v[72:75], a[176:179], v[140:143], v[72:75]
s_waitcnt lgkmcnt(7)
ds_read_b64_tr_b16 a[158:159], v237 offset:14336
v_mfma_f32_16x16x32_bf16 v[72:75], a[184:187], v[4:7], v[72:75]
ds_read_b64_tr_b16 a[160:161], v237 offset:16384
v_mfma_f32_16x16x32_bf16 v[72:75], a[188:191], v[40:43], v[72:75]
ds_read_b64_tr_b16 a[162:163], v237 offset:18432
v_mfma_f32_16x16x32_bf16 v[64:67], a[188:191], v[56:59], v[64:67]
ds_read_b64_tr_b16 a[164:165], v237 offset:20480
buffer_load_dwordx4 v233, s[12:15], s55 offen offset:1024  lds
v_mfma_f32_16x16x32_bf16 v[64:67], a[184:187], v[32:35], v[64:67]
s_waitcnt lgkmcnt(7)
ds_read_b64_tr_b16 a[166:167], v237 offset:22528
v_mfma_f32_16x16x32_bf16 v[88:91], a[144:147], v[156:159], 0
s_mul_i32 s54, s70, 576
buffer_load_dwordx4 a[74:77], v240, s[44:47], s57 offen offset:1024 sc1
ds_read_b128 a[168:171], v248 offset:24576
v_mfma_f32_16x16x32_bf16 v[88:91], a[148:151], v[48:51], v[88:91]
s_add_u32 s54, s54, s82
v_mfma_f32_16x16x32_bf16 v[108:111], a[148:151], v[136:139], 0
s_addk_i32 m0, 0x2000
ds_read_b128 a[172:175], v230 offset:24576
v_cvt_pk_bf16_f32 v80, v64, v65
v_mfma_f32_16x16x32_bf16 v[108:111], a[144:147], v[172:175], v[108:111]
s_waitcnt lgkmcnt(6)
buffer_load_dwordx4 v234, s[12:15], s54 offen  lds
v_cvt_pk_bf16_f32 v81, v66, v67
v_mfma_f32_16x16x32_bf16 v[108:111], a[152:155], v[92:95], v[108:111]
s_lshl_b32 s57, s98, 17
ds_read_b128 a[176:179], v248 offset:32768
v_cvt_pk_bf16_f32 v84, v72, v73
v_mfma_f32_16x16x32_bf16 v[108:111], a[156:159], v[76:79], v[108:111]
s_and_b32 s57, s57, 0x100000
v_cvt_pk_bf16_f32 v85, v74, v75
v_mfma_f32_16x16x32_bf16 v[88:91], a[156:159], v[128:131], v[88:91]
s_or_b32 s57, s57, s63
buffer_store_dwordx4 v[80:83], v249, s[32:35], s56 offen offset:0 sc1
ds_read_b128 a[180:183], v230 offset:32768
v_mfma_f32_16x16x32_bf16 v[88:91], a[152:155], v[60:63], v[88:91]
s_waitcnt lgkmcnt(4)
v_mfma_f32_16x16x32_bf16 v[88:91], a[160:163], v[8:11], v[88:91]
ds_read_b64_tr_b16 a[184:185], v237 offset:40960
v_mfma_f32_16x16x32_bf16 v[88:91], a[164:167], v[36:39], v[88:91]
ds_read_b64_tr_b16 a[186:187], v237 offset:43008
v_mfma_f32_16x16x32_bf16 v[108:111], a[164:167], v[20:23], v[108:111]
buffer_store_dwordx4 v[84:87], v249, s[32:35], s56 offen offset:1024 sc1
ds_read_b64_tr_b16 a[188:189], v237 offset:45056
v_mfma_f32_16x16x32_bf16 v[108:111], a[160:163], v[12:15], v[108:111]
s_waitcnt lgkmcnt(5)
ds_read_b64_tr_b16 a[190:191], v237 offset:47104
buffer_load_dwordx4 v233, s[12:15], s54 offen offset:1024  lds
v_mfma_f32_16x16x32_bf16 v[108:111], a[168:171], v[52:55], v[108:111]
s_add_u32 s56, s51, 6
ds_read_b64_tr_b16 a[144:145], v239 offset:0
v_mfma_f32_16x16x32_bf16 v[108:111], a[172:175], v[68:71], v[108:111]
s_and_b32 s56, s56, 7
ds_read_b64_tr_b16 a[146:147], v239 offset:2048
v_mfma_f32_16x16x32_bf16 v[88:91], a[172:175], v[44:47], v[88:91]
s_add_u32 s56, s56, 1
ds_read_b64_tr_b16 a[148:149], v239 offset:4096
v_mfma_f32_16x16x32_bf16 v[88:91], a[168:171], v[28:31], v[88:91]
s_waitcnt lgkmcnt(7)
ds_read_b64_tr_b16 a[150:151], v239 offset:6144
v_mfma_f32_16x16x32_bf16 v[88:91], a[176:179], v[160:163], v[88:91]
s_mul_i32 s55, s71, 576
ds_read_b64_tr_b16 a[152:153], v239 offset:8192
v_mfma_f32_16x16x32_bf16 v[88:91], a[180:183], v[24:27], v[88:91]
s_add_u32 s55, s55, s82
ds_read_b64_tr_b16 a[154:155], v239 offset:10240
v_mfma_f32_16x16x32_bf16 v[108:111], a[180:183], v[16:19], v[108:111]
s_addk_i32 m0, 0x2000
ds_read_b64_tr_b16 a[156:157], v239 offset:12288
v_mfma_f32_16x16x32_bf16 v[108:111], a[176:179], v[140:143], v[108:111]
s_waitcnt lgkmcnt(7)
ds_read_b64_tr_b16 a[158:159], v239 offset:14336
buffer_load_dwordx4 v234, s[12:15], s55 offen  lds
v_mfma_f32_16x16x32_bf16 v[108:111], a[184:187], v[4:7], v[108:111]
s_lshr_b32 s86, s100, s56
ds_read_b64_tr_b16 a[160:161], v239 offset:16384
v_mfma_f32_16x16x32_bf16 v[108:111], a[188:191], v[40:43], v[108:111]
s_and_b32 s86, s86, 0x2000
ds_read_b64_tr_b16 a[162:163], v239 offset:18432
v_mfma_f32_16x16x32_bf16 v[88:91], a[188:191], v[56:59], v[88:91]
s_lshl_b32 s56, s56, 19
buffer_load_dwordx4 a[14:17], v240, s[44:47], s57 offen offset:0 sc1
ds_read_b64_tr_b16 a[164:165], v239 offset:20480
v_mfma_f32_16x16x32_bf16 v[88:91], a[184:187], v[32:35], v[88:91]
s_waitcnt lgkmcnt(7)
ds_read_b64_tr_b16 a[166:167], v239 offset:22528
v_mov_b32 v251, 0
v_mfma_f32_16x16x32_bf16 v[64:67], a[144:147], v[156:159], 0
s_add_u32 s56, s56, s83
ds_read_b128 a[168:171], v248 offset:26624
v_mfma_f32_16x16x32_bf16 v[64:67], a[148:151], v[48:51], v[64:67]
s_add_u32 s56, s56, s86
v_mov_b32 v254, 12
v_mfma_f32_16x16x32_bf16 v[72:75], a[148:151], v[136:139], 0
ds_read_b128 a[172:175], v230 offset:26624
v_cvt_pk_bf16_f32 v80, v88, v89
v_mfma_f32_16x16x32_bf16 v[72:75], a[144:147], v[172:175], v[72:75]
s_waitcnt lgkmcnt(6)
buffer_load_dwordx4 v233, s[12:15], s55 offen offset:1024  lds
v_cvt_pk_bf16_f32 v81, v90, v91
v_mfma_f32_16x16x32_bf16 v[72:75], a[152:155], v[92:95], v[72:75]
ds_read_b128 a[176:179], v248 offset:34816
v_cvt_pk_bf16_f32 v84, v108, v109
v_mfma_f32_16x16x32_bf16 v[72:75], a[156:159], v[76:79], v[72:75]
v_cvt_pk_bf16_f32 v85, v110, v111
v_mfma_f32_16x16x32_bf16 v[64:67], a[156:159], v[128:131], v[64:67]
ds_read_b128 a[180:183], v230 offset:34816
v_mfma_f32_16x16x32_bf16 v[64:67], a[152:155], v[60:63], v[64:67]
s_waitcnt lgkmcnt(4)
v_mfma_f32_16x16x32_bf16 v[64:67], a[160:163], v[8:11], v[64:67]
s_mul_i32 s54, s72, 576
ds_read_b64_tr_b16 a[184:185], v239 offset:40960
v_mfma_f32_16x16x32_bf16 v[64:67], a[164:167], v[36:39], v[64:67]
s_add_u32 s54, s54, s82
ds_read_b64_tr_b16 a[186:187], v239 offset:43008
s_mov_b64 exec, 0xf0
buffer_atomic_add v251, v227, s[32:35], 0 offen sc0 sc1
s_mov_b64 exec, -1
v_mfma_f32_16x16x32_bf16 v[72:75], a[164:167], v[20:23], v[72:75]
s_addk_i32 m0, 0x2000
ds_read_b64_tr_b16 a[188:189], v239 offset:45056
v_mfma_f32_16x16x32_bf16 v[72:75], a[160:163], v[12:15], v[72:75]
s_waitcnt lgkmcnt(5)
ds_read_b64_tr_b16 a[190:191], v239 offset:47104
buffer_load_dwordx4 v234, s[12:15], s54 offen  lds
v_mfma_f32_16x16x32_bf16 v[72:75], a[168:171], v[52:55], v[72:75]
ds_read_b64_tr_b16 a[144:145], v238 offset:0
v_mfma_f32_16x16x32_bf16 v[72:75], a[172:175], v[68:71], v[72:75]
ds_read_b64_tr_b16 a[146:147], v238 offset:2048
v_mfma_f32_16x16x32_bf16 v[64:67], a[172:175], v[44:47], v[64:67]
ds_read_b64_tr_b16 a[148:149], v238 offset:4096
v_mfma_f32_16x16x32_bf16 v[64:67], a[168:171], v[28:31], v[64:67]
s_waitcnt lgkmcnt(7)
ds_read_b64_tr_b16 a[150:151], v238 offset:6144
v_mfma_f32_16x16x32_bf16 v[64:67], a[176:179], v[160:163], v[64:67]
ds_read_b64_tr_b16 a[152:153], v238 offset:8192
v_mfma_f32_16x16x32_bf16 v[64:67], a[180:183], v[24:27], v[64:67]
ds_read_b64_tr_b16 a[154:155], v238 offset:10240
v_mfma_f32_16x16x32_bf16 v[72:75], a[180:183], v[16:19], v[72:75]
ds_read_b64_tr_b16 a[156:157], v238 offset:12288
v_mfma_f32_16x16x32_bf16 v[72:75], a[176:179], v[140:143], v[72:75]
s_waitcnt lgkmcnt(7)
ds_read_b64_tr_b16 a[158:159], v238 offset:14336
buffer_load_dwordx4 v233, s[12:15], s54 offen offset:1024  lds
v_mfma_f32_16x16x32_bf16 v[72:75], a[184:187], v[4:7], v[72:75]
buffer_load_dwordx4 a[78:81], v240, s[44:47], s57 offen offset:1024 sc1
ds_read_b64_tr_b16 a[160:161], v238 offset:16384
v_mfma_f32_16x16x32_bf16 v[72:75], a[188:191], v[40:43], v[72:75]
ds_read_b64_tr_b16 a[162:163], v238 offset:18432
v_mfma_f32_16x16x32_bf16 v[64:67], a[188:191], v[56:59], v[64:67]
ds_read_b64_tr_b16 a[164:165], v238 offset:20480
v_mfma_f32_16x16x32_bf16 v[64:67], a[184:187], v[32:35], v[64:67]
s_waitcnt lgkmcnt(7)
ds_read_b64_tr_b16 a[166:167], v238 offset:22528
v_mfma_f32_16x16x32_bf16 v[88:91], a[144:147], v[156:159], 0
s_mul_i32 s55, s82, 576
ds_read_b128 a[168:171], v248 offset:28672
v_mfma_f32_16x16x32_bf16 v[88:91], a[148:151], v[48:51], v[88:91]
s_addk_i32 m0, 0x2000
v_mfma_f32_16x16x32_bf16 v[108:111], a[148:151], v[136:139], 0
s_waitcnt vmcnt(8)
ds_read_b128 a[172:175], v230 offset:28672
buffer_load_dwordx4 v235, s[20:23], s55 offen  lds
v_mfma_f32_16x16x32_bf16 v[108:111], a[144:147], v[172:175], v[108:111]
s_waitcnt lgkmcnt(6)
v_cvt_pk_bf16_f32 v82, v64, v65
v_cvt_pk_bf16_f32 v83, v66, v67
v_mfma_f32_16x16x32_bf16 v[108:111], a[152:155], v[92:95], v[108:111]
ds_read_b128 a[176:179], v248 offset:36864
v_cvt_pk_bf16_f32 v86, v72, v73
v_mfma_f32_16x16x32_bf16 v[108:111], a[156:159], v[76:79], v[108:111]
buffer_store_dword v254, v222, s[32:35], 0 offen sc1
v_cvt_pk_bf16_f32 v87, v74, v75
v_mfma_f32_16x16x32_bf16 v[88:91], a[156:159], v[128:131], v[88:91]
buffer_store_dwordx4 v[80:83], v253, s[32:35], s56 offen offset:0 sc1
ds_read_b128 a[180:183], v230 offset:36864
v_mfma_f32_16x16x32_bf16 v[88:91], a[152:155], v[60:63], v[88:91]
s_waitcnt lgkmcnt(4)
v_mfma_f32_16x16x32_bf16 v[88:91], a[160:163], v[8:11], v[88:91]
ds_read_b64_tr_b16 a[184:185], v238 offset:40960
v_mfma_f32_16x16x32_bf16 v[88:91], a[164:167], v[36:39], v[88:91]
ds_read_b64_tr_b16 a[186:187], v238 offset:43008
v_mfma_f32_16x16x32_bf16 v[108:111], a[164:167], v[20:23], v[108:111]
ds_read_b64_tr_b16 a[188:189], v238 offset:45056
buffer_load_dwordx4 v252, s[20:23], s55 offen offset:1024  lds
v_mfma_f32_16x16x32_bf16 v[108:111], a[160:163], v[12:15], v[108:111]
s_waitcnt lgkmcnt(5)
buffer_store_dwordx4 v[84:87], v253, s[32:35], s56 offen offset:1024 sc1
ds_read_b64_tr_b16 a[190:191], v238 offset:47104
v_mfma_f32_16x16x32_bf16 v[108:111], a[168:171], v[52:55], v[108:111]
ds_read_b64_tr_b16 a[144:145], v236 offset:0
v_mfma_f32_16x16x32_bf16 v[108:111], a[172:175], v[68:71], v[108:111]
ds_read_b64_tr_b16 a[146:147], v236 offset:2048
v_mfma_f32_16x16x32_bf16 v[88:91], a[172:175], v[44:47], v[88:91]
ds_read_b64_tr_b16 a[148:149], v236 offset:4096
v_mfma_f32_16x16x32_bf16 v[88:91], a[168:171], v[28:31], v[88:91]
s_waitcnt lgkmcnt(7)
ds_read_b64_tr_b16 a[150:151], v236 offset:6144
v_mfma_f32_16x16x32_bf16 v[88:91], a[176:179], v[160:163], v[88:91]
s_mul_i32 s54, s82, 576
ds_read_b64_tr_b16 a[152:153], v236 offset:8192
v_mfma_f32_16x16x32_bf16 v[88:91], a[180:183], v[24:27], v[88:91]
s_addk_i32 m0, 0x2000
ds_read_b64_tr_b16 a[154:155], v236 offset:10240
v_mfma_f32_16x16x32_bf16 v[108:111], a[180:183], v[16:19], v[108:111]
ds_read_b64_tr_b16 a[156:157], v236 offset:12288
buffer_load_dwordx4 v235, s[24:27], s54 offen  lds
v_mfma_f32_16x16x32_bf16 v[108:111], a[176:179], v[140:143], v[108:111]
s_waitcnt lgkmcnt(7)
ds_read_b64_tr_b16 a[158:159], v236 offset:14336
v_mfma_f32_16x16x32_bf16 v[108:111], a[184:187], v[4:7], v[108:111]
ds_read_b64_tr_b16 a[160:161], v236 offset:16384
v_mfma_f32_16x16x32_bf16 v[108:111], a[188:191], v[40:43], v[108:111]
ds_read_b64_tr_b16 a[162:163], v236 offset:18432
v_mfma_f32_16x16x32_bf16 v[88:91], a[188:191], v[56:59], v[88:91]
ds_read_b64_tr_b16 a[164:165], v236 offset:20480
v_mfma_f32_16x16x32_bf16 v[88:91], a[184:187], v[32:35], v[88:91]
s_waitcnt lgkmcnt(7)
ds_read_b64_tr_b16 a[166:167], v236 offset:22528
v_mfma_f32_16x16x32_bf16 v[64:67], a[144:147], v[156:159], 0
ds_read_b128 a[168:171], v248 offset:30720
s_waitcnt vmcnt(9)
v_cmp_le_u32 vcc, v232, v251
v_mfma_f32_16x16x32_bf16 v[64:67], a[148:151], v[48:51], v[64:67]
s_and_b32 s99, vcc_lo, 0xf0
v_mfma_f32_16x16x32_bf16 v[72:75], a[148:151], v[136:139], 0
s_andn2_b32 s98, s98, s99
ds_read_b128 a[172:175], v230 offset:30720
buffer_load_dwordx4 v252, s[24:27], s54 offen offset:1024  lds
v_mfma_f32_16x16x32_bf16 v[72:75], a[144:147], v[172:175], v[72:75]
s_waitcnt lgkmcnt(6)
v_cvt_pk_bf16_f32 v82, v88, v89
v_cvt_pk_bf16_f32 v83, v90, v91
v_mfma_f32_16x16x32_bf16 v[72:75], a[152:155], v[92:95], v[72:75]
s_lshl_b32 s57, s98, 16
ds_read_b128 a[176:179], v248 offset:38912
v_cvt_pk_bf16_f32 v86, v108, v109
v_mfma_f32_16x16x32_bf16 v[72:75], a[156:159], v[76:79], v[72:75]
s_and_b32 s57, s57, 0x100000
v_cvt_pk_bf16_f32 v87, v110, v111
v_mfma_f32_16x16x32_bf16 v[64:67], a[156:159], v[128:131], v[64:67]
s_or_b32 s57, s57, s64
ds_read_b128 a[180:183], v230 offset:38912
v_mfma_f32_16x16x32_bf16 v[64:67], a[152:155], v[60:63], v[64:67]
s_waitcnt lgkmcnt(4)
v_mfma_f32_16x16x32_bf16 v[64:67], a[160:163], v[8:11], v[64:67]
s_mul_i32 s55, s73, 576
buffer_load_dwordx4 a[18:21], v240, s[44:47], s57 offen offset:0 sc1
ds_read_b64_tr_b16 a[184:185], v236 offset:40960
v_mfma_f32_16x16x32_bf16 v[64:67], a[164:167], v[36:39], v[64:67]
s_add_u32 s55, s55, s82
ds_read_b64_tr_b16 a[186:187], v236 offset:43008
v_mfma_f32_16x16x32_bf16 v[72:75], a[164:167], v[20:23], v[72:75]
ds_read_b64_tr_b16 a[188:189], v236 offset:45056
v_mfma_f32_16x16x32_bf16 v[72:75], a[160:163], v[12:15], v[72:75]
s_waitcnt lgkmcnt(5)
ds_read_b64_tr_b16 a[190:191], v236 offset:47104
v_mfma_f32_16x16x32_bf16 v[72:75], a[168:171], v[52:55], v[72:75]
s_barrier
ds_read_b64_tr_b16 a[144:145], v231 offset:0
v_mfma_f32_16x16x32_bf16 v[72:75], a[172:175], v[68:71], v[72:75]
s_addk_i32 m0, 0x2000
ds_read_b64_tr_b16 a[146:147], v231 offset:2048
v_mfma_f32_16x16x32_bf16 v[64:67], a[172:175], v[44:47], v[64:67]
ds_read_b64_tr_b16 a[148:149], v231 offset:4096
buffer_load_dwordx4 v234, s[12:15], s55 offen  lds
v_mfma_f32_16x16x32_bf16 v[64:67], a[168:171], v[28:31], v[64:67]
s_waitcnt lgkmcnt(7)
ds_read_b64_tr_b16 a[150:151], v231 offset:6144
v_mfma_f32_16x16x32_bf16 v[64:67], a[176:179], v[160:163], v[64:67]
ds_read_b64_tr_b16 a[152:153], v231 offset:8192
v_mfma_f32_16x16x32_bf16 v[64:67], a[180:183], v[24:27], v[64:67]
ds_read_b64_tr_b16 a[154:155], v231 offset:10240
v_mfma_f32_16x16x32_bf16 v[72:75], a[180:183], v[16:19], v[72:75]
ds_read_b64_tr_b16 a[156:157], v231 offset:12288
v_mfma_f32_16x16x32_bf16 v[72:75], a[176:179], v[140:143], v[72:75]
s_waitcnt lgkmcnt(7)
ds_read_b64_tr_b16 a[158:159], v231 offset:14336
v_mfma_f32_16x16x32_bf16 v[72:75], a[184:187], v[4:7], v[72:75]
ds_read_b64_tr_b16 a[160:161], v231 offset:16384
v_mfma_f32_16x16x32_bf16 v[72:75], a[188:191], v[40:43], v[72:75]
ds_read_b64_tr_b16 a[162:163], v231 offset:18432
v_mfma_f32_16x16x32_bf16 v[64:67], a[188:191], v[56:59], v[64:67]
ds_read_b64_tr_b16 a[164:165], v231 offset:20480
buffer_load_dwordx4 v233, s[12:15], s55 offen offset:1024  lds
v_mfma_f32_16x16x32_bf16 v[64:67], a[184:187], v[32:35], v[64:67]
s_waitcnt lgkmcnt(7)
ds_read_b64_tr_b16 a[166:167], v231 offset:22528
v_mfma_f32_16x16x32_bf16 v[88:91], a[144:147], v[156:159], 0
buffer_load_dwordx4 a[82:85], v240, s[44:47], s57 offen offset:1024 sc1
ds_read_b128 a[168:171], v247 offset:24576
v_mfma_f32_16x16x32_bf16 v[88:91], a[148:151], v[48:51], v[88:91]
s_lshl_b32 s57, s98, 15
v_mfma_f32_16x16x32_bf16 v[108:111], a[148:151], v[136:139], 0
s_and_b32 s57, s57, 0x100000
ds_read_b128 a[172:175], v241 offset:24576
v_cvt_pk_bf16_f32 v80, v64, v65
v_mfma_f32_16x16x32_bf16 v[108:111], a[144:147], v[172:175], v[108:111]
s_waitcnt lgkmcnt(6)
v_cvt_pk_bf16_f32 v81, v66, v67
v_cvt_pk_bf16_f32 v84, v72, v73
v_mfma_f32_16x16x32_bf16 v[108:111], a[152:155], v[92:95], v[108:111]
s_or_b32 s57, s57, s65
ds_read_b128 a[176:179], v247 offset:32768
v_cvt_pk_bf16_f32 v85, v74, v75
v_mfma_f32_16x16x32_bf16 v[108:111], a[156:159], v[76:79], v[108:111]
v_mfma_f32_16x16x32_bf16 v[88:91], a[156:159], v[128:131], v[88:91]
buffer_store_dwordx4 v[80:83], v249, s[32:35], s56 offen offset:0 sc1
ds_read_b128 a[180:183], v241 offset:32768
v_mfma_f32_16x16x32_bf16 v[88:91], a[152:155], v[60:63], v[88:91]
s_waitcnt lgkmcnt(4)
v_mfma_f32_16x16x32_bf16 v[88:91], a[160:163], v[8:11], v[88:91]
ds_read_b64_tr_b16 a[184:185], v231 offset:40960
v_mfma_f32_16x16x32_bf16 v[88:91], a[164:167], v[36:39], v[88:91]
ds_read_b64_tr_b16 a[186:187], v231 offset:43008
v_mfma_f32_16x16x32_bf16 v[108:111], a[164:167], v[20:23], v[108:111]
buffer_store_dwordx4 v[84:87], v249, s[32:35], s56 offen offset:1024 sc1
ds_read_b64_tr_b16 a[188:189], v231 offset:45056
v_mfma_f32_16x16x32_bf16 v[108:111], a[160:163], v[12:15], v[108:111]
s_waitcnt lgkmcnt(5)
ds_read_b64_tr_b16 a[190:191], v231 offset:47104
v_mfma_f32_16x16x32_bf16 v[108:111], a[168:171], v[52:55], v[108:111]
s_add_u32 s56, s51, 7
ds_read_b64_tr_b16 a[144:145], v228 offset:0
v_mfma_f32_16x16x32_bf16 v[108:111], a[172:175], v[68:71], v[108:111]
s_and_b32 s56, s56, 7
ds_read_b64_tr_b16 a[146:147], v228 offset:2048
v_mfma_f32_16x16x32_bf16 v[88:91], a[172:175], v[44:47], v[88:91]
s_add_u32 s56, s56, 1
ds_read_b64_tr_b16 a[148:149], v228 offset:4096
v_mfma_f32_16x16x32_bf16 v[88:91], a[168:171], v[28:31], v[88:91]
s_waitcnt lgkmcnt(7)
ds_read_b64_tr_b16 a[150:151], v228 offset:6144
v_mfma_f32_16x16x32_bf16 v[88:91], a[176:179], v[160:163], v[88:91]
s_lshr_b32 s86, s100, s56
buffer_load_dwordx4 a[22:25], v240, s[44:47], s57 offen offset:0 sc1
ds_read_b64_tr_b16 a[152:153], v228 offset:8192
v_mfma_f32_16x16x32_bf16 v[88:91], a[180:183], v[24:27], v[88:91]
s_and_b32 s86, s86, 0x2000
ds_read_b64_tr_b16 a[154:155], v228 offset:10240
v_mfma_f32_16x16x32_bf16 v[108:111], a[180:183], v[16:19], v[108:111]
s_lshl_b32 s56, s56, 19
ds_read_b64_tr_b16 a[156:157], v228 offset:12288
v_mfma_f32_16x16x32_bf16 v[108:111], a[176:179], v[140:143], v[108:111]
s_waitcnt lgkmcnt(7)
ds_read_b64_tr_b16 a[158:159], v228 offset:14336
v_mfma_f32_16x16x32_bf16 v[108:111], a[184:187], v[4:7], v[108:111]
s_add_u32 s56, s56, s83
ds_read_b64_tr_b16 a[160:161], v228 offset:16384
v_mfma_f32_16x16x32_bf16 v[108:111], a[188:191], v[40:43], v[108:111]
s_add_u32 s56, s56, s86
ds_read_b64_tr_b16 a[162:163], v228 offset:18432
v_mov_b32 v254, 14
v_mfma_f32_16x16x32_bf16 v[88:91], a[188:191], v[56:59], v[88:91]
ds_read_b64_tr_b16 a[164:165], v228 offset:20480
v_mfma_f32_16x16x32_bf16 v[88:91], a[184:187], v[32:35], v[88:91]
s_waitcnt lgkmcnt(7)
ds_read_b64_tr_b16 a[166:167], v228 offset:22528
v_mfma_f32_16x16x32_bf16 v[64:67], a[144:147], v[156:159], 0
ds_read_b128 a[168:171], v247 offset:26624
v_mfma_f32_16x16x32_bf16 v[64:67], a[148:151], v[48:51], v[64:67]
v_mfma_f32_16x16x32_bf16 v[72:75], a[148:151], v[136:139], 0
ds_read_b128 a[172:175], v241 offset:26624
s_nop 0
v_cvt_pk_bf16_f32 v80, v88, v89
v_mfma_f32_16x16x32_bf16 v[72:75], a[144:147], v[172:175], v[72:75]
s_waitcnt lgkmcnt(6)
v_cvt_pk_bf16_f32 v81, v90, v91
v_cvt_pk_bf16_f32 v84, v108, v109
v_mfma_f32_16x16x32_bf16 v[72:75], a[152:155], v[92:95], v[72:75]
ds_read_b128 a[176:179], v247 offset:34816
v_cvt_pk_bf16_f32 v85, v110, v111
v_mfma_f32_16x16x32_bf16 v[72:75], a[156:159], v[76:79], v[72:75]
v_mfma_f32_16x16x32_bf16 v[64:67], a[156:159], v[128:131], v[64:67]
ds_read_b128 a[180:183], v241 offset:34816
v_mfma_f32_16x16x32_bf16 v[64:67], a[152:155], v[60:63], v[64:67]
s_waitcnt lgkmcnt(4)
v_mfma_f32_16x16x32_bf16 v[64:67], a[160:163], v[8:11], v[64:67]
buffer_load_dwordx4 a[86:89], v240, s[44:47], s57 offen offset:1024 sc1
ds_read_b64_tr_b16 a[184:185], v228 offset:40960
v_mfma_f32_16x16x32_bf16 v[64:67], a[164:167], v[36:39], v[64:67]
s_lshl_b32 s57, s98, 14
ds_read_b64_tr_b16 a[186:187], v228 offset:43008
v_mfma_f32_16x16x32_bf16 v[72:75], a[164:167], v[20:23], v[72:75]
s_and_b32 s57, s57, 0x100000
ds_read_b64_tr_b16 a[188:189], v228 offset:45056
v_mfma_f32_16x16x32_bf16 v[72:75], a[160:163], v[12:15], v[72:75]
s_waitcnt lgkmcnt(5)
ds_read_b64_tr_b16 a[190:191], v228 offset:47104
v_mfma_f32_16x16x32_bf16 v[72:75], a[168:171], v[52:55], v[72:75]
s_or_b32 s57, s57, s66
ds_read_b64_tr_b16 a[144:145], v213 offset:0
v_mfma_f32_16x16x32_bf16 v[72:75], a[172:175], v[68:71], v[72:75]
ds_read_b64_tr_b16 a[146:147], v213 offset:2048
v_mfma_f32_16x16x32_bf16 v[64:67], a[172:175], v[44:47], v[64:67]
ds_read_b64_tr_b16 a[148:149], v213 offset:4096
v_mfma_f32_16x16x32_bf16 v[64:67], a[168:171], v[28:31], v[64:67]
s_waitcnt lgkmcnt(7)
ds_read_b64_tr_b16 a[150:151], v213 offset:6144
v_mfma_f32_16x16x32_bf16 v[64:67], a[176:179], v[160:163], v[64:67]
ds_read_b64_tr_b16 a[152:153], v213 offset:8192
v_mfma_f32_16x16x32_bf16 v[64:67], a[180:183], v[24:27], v[64:67]
ds_read_b64_tr_b16 a[154:155], v213 offset:10240
v_mfma_f32_16x16x32_bf16 v[72:75], a[180:183], v[16:19], v[72:75]
ds_read_b64_tr_b16 a[156:157], v213 offset:12288
v_mfma_f32_16x16x32_bf16 v[72:75], a[176:179], v[140:143], v[72:75]
s_waitcnt lgkmcnt(7)
ds_read_b64_tr_b16 a[158:159], v213 offset:14336
v_mfma_f32_16x16x32_bf16 v[72:75], a[184:187], v[4:7], v[72:75]
ds_read_b64_tr_b16 a[160:161], v213 offset:16384
v_mfma_f32_16x16x32_bf16 v[72:75], a[188:191], v[40:43], v[72:75]
ds_read_b64_tr_b16 a[162:163], v213 offset:18432
v_mfma_f32_16x16x32_bf16 v[64:67], a[188:191], v[56:59], v[64:67]
ds_read_b64_tr_b16 a[164:165], v213 offset:20480
v_mfma_f32_16x16x32_bf16 v[64:67], a[184:187], v[32:35], v[64:67]
s_waitcnt lgkmcnt(7)
ds_read_b64_tr_b16 a[166:167], v213 offset:22528
v_mfma_f32_16x16x32_bf16 v[88:91], a[144:147], v[156:159], 0
buffer_load_dwordx4 a[26:29], v240, s[44:47], s57 offen offset:0 sc1
ds_read_b128 a[168:171], v247 offset:28672
v_mfma_f32_16x16x32_bf16 v[88:91], a[148:151], v[48:51], v[88:91]
v_mfma_f32_16x16x32_bf16 v[108:111], a[148:151], v[136:139], 0
s_waitcnt vmcnt(3)
ds_read_b128 a[172:175], v241 offset:28672
v_cvt_pk_bf16_f32 v82, v64, v65
v_mfma_f32_16x16x32_bf16 v[108:111], a[144:147], v[172:175], v[108:111]
s_waitcnt lgkmcnt(6)
v_cvt_pk_bf16_f32 v83, v66, v67
v_cvt_pk_bf16_f32 v86, v72, v73
v_mfma_f32_16x16x32_bf16 v[108:111], a[152:155], v[92:95], v[108:111]
ds_read_b128 a[176:179], v247 offset:36864
v_cvt_pk_bf16_f32 v87, v74, v75
v_mfma_f32_16x16x32_bf16 v[108:111], a[156:159], v[76:79], v[108:111]
buffer_store_dword v254, v222, s[32:35], 0 offen sc1
v_mfma_f32_16x16x32_bf16 v[88:91], a[156:159], v[128:131], v[88:91]
buffer_store_dwordx4 v[80:83], v253, s[32:35], s56 offen offset:0 sc1
ds_read_b128 a[180:183], v241 offset:36864
v_mfma_f32_16x16x32_bf16 v[88:91], a[152:155], v[60:63], v[88:91]
s_waitcnt lgkmcnt(4)
v_mfma_f32_16x16x32_bf16 v[88:91], a[160:163], v[8:11], v[88:91]
ds_read_b64_tr_b16 a[184:185], v213 offset:40960
v_mfma_f32_16x16x32_bf16 v[88:91], a[164:167], v[36:39], v[88:91]
ds_read_b64_tr_b16 a[186:187], v213 offset:43008
v_mfma_f32_16x16x32_bf16 v[108:111], a[164:167], v[20:23], v[108:111]
buffer_store_dwordx4 v[84:87], v253, s[32:35], s56 offen offset:1024 sc1
ds_read_b64_tr_b16 a[188:189], v213 offset:45056
v_mfma_f32_16x16x32_bf16 v[108:111], a[160:163], v[12:15], v[108:111]
s_waitcnt lgkmcnt(5)
ds_read_b64_tr_b16 a[190:191], v213 offset:47104
v_mfma_f32_16x16x32_bf16 v[108:111], a[168:171], v[52:55], v[108:111]
LM_p11:
s_cbranch_execz LM_v0
ds_read_b64_tr_b16 a[144:145], v212 offset:0
v_mfma_f32_16x16x32_bf16 v[108:111], a[172:175], v[68:71], v[108:111]
ds_read_b64_tr_b16 a[146:147], v212 offset:2048
v_mfma_f32_16x16x32_bf16 v[88:91], a[172:175], v[44:47], v[88:91]
ds_read_b64_tr_b16 a[148:149], v212 offset:4096
v_mfma_f32_16x16x32_bf16 v[88:91], a[168:171], v[28:31], v[88:91]
s_waitcnt lgkmcnt(7)
ds_read_b64_tr_b16 a[150:151], v212 offset:6144
v_mfma_f32_16x16x32_bf16 v[88:91], a[176:179], v[160:163], v[88:91]
buffer_load_dwordx4 a[90:93], v240, s[44:47], s57 offen offset:1024 sc1
ds_read_b64_tr_b16 a[152:153], v212 offset:8192
v_mfma_f32_16x16x32_bf16 v[88:91], a[180:183], v[24:27], v[88:91]
ds_read_b64_tr_b16 a[154:155], v212 offset:10240
v_mov_b32 v252, 0
v_mfma_f32_16x16x32_bf16 v[108:111], a[180:183], v[16:19], v[108:111]
ds_read_b64_tr_b16 a[156:157], v212 offset:12288
v_mfma_f32_16x16x32_bf16 v[108:111], a[176:179], v[140:143], v[108:111]
s_waitcnt lgkmcnt(7)
ds_read_b64_tr_b16 a[158:159], v212 offset:14336
v_mfma_f32_16x16x32_bf16 v[108:111], a[184:187], v[4:7], v[108:111]
ds_read_b64_tr_b16 a[160:161], v212 offset:16384
v_mfma_f32_16x16x32_bf16 v[108:111], a[188:191], v[40:43], v[108:111]
ds_read_b64_tr_b16 a[162:163], v212 offset:18432
v_mfma_f32_16x16x32_bf16 v[88:91], a[188:191], v[56:59], v[88:91]
ds_read_b64_tr_b16 a[164:165], v212 offset:20480
v_mfma_f32_16x16x32_bf16 v[88:91], a[184:187], v[32:35], v[88:91]
s_waitcnt lgkmcnt(7)
ds_read_b64_tr_b16 a[166:167], v212 offset:22528
v_mfma_f32_16x16x32_bf16 v[64:67], a[144:147], v[156:159], 0
ds_read_b128 a[168:171], v247 offset:30720
v_mfma_f32_16x16x32_bf16 v[64:67], a[148:151], v[48:51], v[64:67]
v_mfma_f32_16x16x32_bf16 v[72:75], a[148:151], v[136:139], 0
ds_read_b128 a[172:175], v241 offset:30720
s_mov_b64 exec, 0x300
buffer_atomic_add v252, v227, s[32:35], 0 offen sc0 sc1
s_mov_b64 exec, -1
v_mfma_f32_16x16x32_bf16 v[72:75], a[144:147], v[172:175], v[72:75]
s_waitcnt lgkmcnt(6)
v_cvt_pk_bf16_f32 v82, v88, v89
v_cvt_pk_bf16_f32 v83, v90, v91
v_mfma_f32_16x16x32_bf16 v[72:75], a[152:155], v[92:95], v[72:75]
s_lshl_b32 s57, s98, 13
ds_read_b128 a[176:179], v247 offset:38912
v_cvt_pk_bf16_f32 v86, v108, v109
v_mfma_f32_16x16x32_bf16 v[72:75], a[156:159], v[76:79], v[72:75]
s_and_b32 s57, s57, 0x100000
v_cvt_pk_bf16_f32 v87, v110, v111
v_mfma_f32_16x16x32_bf16 v[64:67], a[156:159], v[128:131], v[64:67]
s_or_b32 s57, s57, s4
ds_read_b128 a[180:183], v241 offset:38912
v_mfma_f32_16x16x32_bf16 v[64:67], a[152:155], v[60:63], v[64:67]
s_waitcnt lgkmcnt(4)
v_mfma_f32_16x16x32_bf16 v[64:67], a[160:163], v[8:11], v[64:67]
buffer_load_dwordx4 a[30:33], v240, s[44:47], s57 offen offset:0 sc1
ds_read_b64_tr_b16 a[184:185], v212 offset:40960
v_mfma_f32_16x16x32_bf16 v[64:67], a[164:167], v[36:39], v[64:67]
ds_read_b64_tr_b16 a[186:187], v212 offset:43008
v_mfma_f32_16x16x32_bf16 v[72:75], a[164:167], v[20:23], v[72:75]
ds_read_b64_tr_b16 a[188:189], v212 offset:45056
v_mfma_f32_16x16x32_bf16 v[72:75], a[160:163], v[12:15], v[72:75]
s_waitcnt lgkmcnt(5)
ds_read_b64_tr_b16 a[190:191], v212 offset:47104
v_mfma_f32_16x16x32_bf16 v[72:75], a[168:171], v[52:55], v[72:75]
s_barrier
ds_read_b64_tr_b16 a[144:145], v209 offset:0
v_mfma_f32_16x16x32_bf16 v[72:75], a[172:175], v[68:71], v[72:75]
ds_read_b64_tr_b16 a[146:147], v209 offset:2048
v_mfma_f32_16x16x32_bf16 v[64:67], a[172:175], v[44:47], v[64:67]
ds_read_b64_tr_b16 a[148:149], v209 offset:4096
v_mfma_f32_16x16x32_bf16 v[64:67], a[168:171], v[28:31], v[64:67]
s_waitcnt lgkmcnt(7)
ds_read_b64_tr_b16 a[150:151], v209 offset:6144
v_mfma_f32_16x16x32_bf16 v[64:67], a[176:179], v[160:163], v[64:67]
ds_read_b64_tr_b16 a[152:153], v209 offset:8192
v_mfma_f32_16x16x32_bf16 v[64:67], a[180:183], v[24:27], v[64:67]
ds_read_b64_tr_b16 a[154:155], v209 offset:10240
v_mfma_f32_16x16x32_bf16 v[72:75], a[180:183], v[16:19], v[72:75]
ds_read_b64_tr_b16 a[156:157], v209 offset:12288
v_mfma_f32_16x16x32_bf16 v[72:75], a[176:179], v[140:143], v[72:75]
s_waitcnt lgkmcnt(7)
ds_read_b64_tr_b16 a[158:159], v209 offset:14336
v_mfma_f32_16x16x32_bf16 v[72:75], a[184:187], v[4:7], v[72:75]
ds_read_b64_tr_b16 a[160:161], v209 offset:16384
v_mfma_f32_16x16x32_bf16 v[72:75], a[188:191], v[40:43], v[72:75]
ds_read_b64_tr_b16 a[162:163], v209 offset:18432
v_mfma_f32_16x16x32_bf16 v[64:67], a[188:191], v[56:59], v[64:67]
ds_read_b64_tr_b16 a[164:165], v209 offset:20480
v_mfma_f32_16x16x32_bf16 v[64:67], a[184:187], v[32:35], v[64:67]
s_waitcnt lgkmcnt(7)
ds_read_b64_tr_b16 a[166:167], v209 offset:22528
v_mfma_f32_16x16x32_bf16 v[88:91], a[144:147], v[156:159], 0
buffer_load_dwordx4 a[94:97], v240, s[44:47], s57 offen offset:1024 sc1
ds_read_b128 a[168:171], v250 offset:24576
v_mfma_f32_16x16x32_bf16 v[88:91], a[148:151], v[48:51], v[88:91]
v_mfma_f32_16x16x32_bf16 v[108:111], a[148:151], v[136:139], 0
ds_read_b128 a[172:175], v244 offset:24576
v_cvt_pk_bf16_f32 v80, v64, v65
v_mfma_f32_16x16x32_bf16 v[108:111], a[144:147], v[172:175], v[108:111]
s_waitcnt lgkmcnt(6)
v_cvt_pk_bf16_f32 v81, v66, v67
v_cvt_pk_bf16_f32 v84, v72, v73
v_mfma_f32_16x16x32_bf16 v[108:111], a[152:155], v[92:95], v[108:111]
ds_read_b128 a[176:179], v250 offset:32768
v_cvt_pk_bf16_f32 v85, v74, v75
v_mfma_f32_16x16x32_bf16 v[108:111], a[156:159], v[76:79], v[108:111]
v_mfma_f32_16x16x32_bf16 v[88:91], a[156:159], v[128:131], v[88:91]
buffer_store_dwordx4 v[80:83], v249, s[32:35], s56 offen offset:0 sc1
ds_read_b128 a[180:183], v244 offset:32768
v_mfma_f32_16x16x32_bf16 v[88:91], a[152:155], v[60:63], v[88:91]
s_waitcnt lgkmcnt(4)
v_mfma_f32_16x16x32_bf16 v[88:91], a[160:163], v[8:11], v[88:91]
ds_read_b64_tr_b16 a[184:185], v209 offset:40960
v_mfma_f32_16x16x32_bf16 v[88:91], a[164:167], v[36:39], v[88:91]
ds_read_b64_tr_b16 a[186:187], v209 offset:43008
v_mfma_f32_16x16x32_bf16 v[108:111], a[164:167], v[20:23], v[108:111]
buffer_store_dwordx4 v[84:87], v249, s[32:35], s56 offen offset:1024 sc1
ds_read_b64_tr_b16 a[188:189], v209 offset:45056
v_mfma_f32_16x16x32_bf16 v[108:111], a[160:163], v[12:15], v[108:111]
s_waitcnt lgkmcnt(5)
ds_read_b64_tr_b16 a[190:191], v209 offset:47104
v_mfma_f32_16x16x32_bf16 v[108:111], a[168:171], v[52:55], v[108:111]
s_add_u32 s56, s51, 8
ds_read_b64_tr_b16 a[144:145], v208 offset:0
v_mfma_f32_16x16x32_bf16 v[108:111], a[172:175], v[68:71], v[108:111]
s_and_b32 s56, s56, 7
ds_read_b64_tr_b16 a[146:147], v208 offset:2048
v_mfma_f32_16x16x32_bf16 v[88:91], a[172:175], v[44:47], v[88:91]
s_add_u32 s56, s56, 1
ds_read_b64_tr_b16 a[148:149], v208 offset:4096
v_mfma_f32_16x16x32_bf16 v[88:91], a[168:171], v[28:31], v[88:91]
s_waitcnt lgkmcnt(7)
ds_read_b64_tr_b16 a[150:151], v208 offset:6144
s_waitcnt vmcnt(4)
v_cmp_le_u32 vcc, v232, v252
v_mfma_f32_16x16x32_bf16 v[88:91], a[176:179], v[160:163], v[88:91]
s_and_b32 s99, vcc_lo, 0x300
ds_read_b64_tr_b16 a[152:153], v208 offset:8192
v_mfma_f32_16x16x32_bf16 v[88:91], a[180:183], v[24:27], v[88:91]
s_andn2_b32 s98, s98, s99
ds_read_b64_tr_b16 a[154:155], v208 offset:10240
v_mfma_f32_16x16x32_bf16 v[108:111], a[180:183], v[16:19], v[108:111]
s_lshl_b32 s57, s98, 12
ds_read_b64_tr_b16 a[156:157], v208 offset:12288
v_mfma_f32_16x16x32_bf16 v[108:111], a[176:179], v[140:143], v[108:111]
s_waitcnt lgkmcnt(7)
ds_read_b64_tr_b16 a[158:159], v208 offset:14336
v_mfma_f32_16x16x32_bf16 v[108:111], a[184:187], v[4:7], v[108:111]
s_and_b32 s57, s57, 0x100000
ds_read_b64_tr_b16 a[160:161], v208 offset:16384
v_mfma_f32_16x16x32_bf16 v[108:111], a[188:191], v[40:43], v[108:111]
s_or_b32 s57, s57, s5
ds_read_b64_tr_b16 a[162:163], v208 offset:18432
v_mfma_f32_16x16x32_bf16 v[88:91], a[188:191], v[56:59], v[88:91]
s_lshr_b32 s86, s100, s56
ds_read_b64_tr_b16 a[164:165], v208 offset:20480
v_mfma_f32_16x16x32_bf16 v[88:91], a[184:187], v[32:35], v[88:91]
s_waitcnt lgkmcnt(7)
buffer_load_dwordx4 a[34:37], v240, s[44:47], s57 offen offset:0 sc1
ds_read_b64_tr_b16 a[166:167], v208 offset:22528
v_mfma_f32_16x16x32_bf16 v[64:67], a[144:147], v[156:159], 0
s_and_b32 s86, s86, 0x2000
ds_read_b128 a[168:171], v250 offset:26624
v_mfma_f32_16x16x32_bf16 v[64:67], a[148:151], v[48:51], v[64:67]
s_lshl_b32 s56, s56, 19
v_mfma_f32_16x16x32_bf16 v[72:75], a[148:151], v[136:139], 0
s_add_u32 s56, s56, s83
ds_read_b128 a[172:175], v244 offset:26624
v_cvt_pk_bf16_f32 v80, v88, v89
v_mfma_f32_16x16x32_bf16 v[72:75], a[144:147], v[172:175], v[72:75]
s_waitcnt lgkmcnt(6)
v_cvt_pk_bf16_f32 v81, v90, v91
v_cvt_pk_bf16_f32 v84, v108, v109
v_mfma_f32_16x16x32_bf16 v[72:75], a[152:155], v[92:95], v[72:75]
s_add_u32 s56, s56, s86
ds_read_b128 a[176:179], v250 offset:34816
v_cvt_pk_bf16_f32 v85, v110, v111
v_mfma_f32_16x16x32_bf16 v[72:75], a[156:159], v[76:79], v[72:75]
v_mov_b32 v254, 16
v_mfma_f32_16x16x32_bf16 v[64:67], a[156:159], v[128:131], v[64:67]
ds_read_b128 a[180:183], v244 offset:34816
v_mfma_f32_16x16x32_bf16 v[64:67], a[152:155], v[60:63], v[64:67]
s_waitcnt lgkmcnt(4)
v_mfma_f32_16x16x32_bf16 v[64:67], a[160:163], v[8:11], v[64:67]
ds_read_b64_tr_b16 a[184:185], v208 offset:40960
v_mfma_f32_16x16x32_bf16 v[64:67], a[164:167], v[36:39], v[64:67]
buffer_load_dwordx4 a[98:101], v240, s[44:47], s57 offen offset:1024 sc1
ds_read_b64_tr_b16 a[186:187], v208 offset:43008
v_mfma_f32_16x16x32_bf16 v[72:75], a[164:167], v[20:23], v[72:75]
ds_read_b64_tr_b16 a[188:189], v208 offset:45056
v_mov_b32 v252, 0
v_mfma_f32_16x16x32_bf16 v[72:75], a[160:163], v[12:15], v[72:75]
s_waitcnt lgkmcnt(5)
ds_read_b64_tr_b16 a[190:191], v208 offset:47104
s_mov_b64 exec, 0xc00
buffer_atomic_add v252, v227, s[32:35], 0 offen sc0 sc1
s_mov_b64 exec, -1
v_mfma_f32_16x16x32_bf16 v[72:75], a[168:171], v[52:55], v[72:75]
s_lshl_b32 s57, s98, 11
ds_read_b64_tr_b16 a[144:145], v207 offset:0
v_mfma_f32_16x16x32_bf16 v[72:75], a[172:175], v[68:71], v[72:75]
s_and_b32 s57, s57, 0x100000
ds_read_b64_tr_b16 a[146:147], v207 offset:2048
v_mfma_f32_16x16x32_bf16 v[64:67], a[172:175], v[44:47], v[64:67]
s_or_b32 s57, s57, s6
ds_read_b64_tr_b16 a[148:149], v207 offset:4096
v_mfma_f32_16x16x32_bf16 v[64:67], a[168:171], v[28:31], v[64:67]
s_waitcnt lgkmcnt(7)
ds_read_b64_tr_b16 a[150:151], v207 offset:6144
v_mfma_f32_16x16x32_bf16 v[64:67], a[176:179], v[160:163], v[64:67]
ds_read_b64_tr_b16 a[152:153], v207 offset:8192
v_mfma_f32_16x16x32_bf16 v[64:67], a[180:183], v[24:27], v[64:67]
ds_read_b64_tr_b16 a[154:155], v207 offset:10240
v_mfma_f32_16x16x32_bf16 v[72:75], a[180:183], v[16:19], v[72:75]
ds_read_b64_tr_b16 a[156:157], v207 offset:12288
v_mfma_f32_16x16x32_bf16 v[72:75], a[176:179], v[140:143], v[72:75]
s_waitcnt lgkmcnt(7)
buffer_load_dwordx4 a[38:41], v240, s[44:47], s57 offen offset:0 sc1
ds_read_b64_tr_b16 a[158:159], v207 offset:14336
v_mfma_f32_16x16x32_bf16 v[72:75], a[184:187], v[4:7], v[72:75]
ds_read_b64_tr_b16 a[160:161], v207 offset:16384
v_mfma_f32_16x16x32_bf16 v[72:75], a[188:191], v[40:43], v[72:75]
ds_read_b64_tr_b16 a[162:163], v207 offset:18432
v_mfma_f32_16x16x32_bf16 v[64:67], a[188:191], v[56:59], v[64:67]
ds_read_b64_tr_b16 a[164:165], v207 offset:20480
v_mfma_f32_16x16x32_bf16 v[64:67], a[184:187], v[32:35], v[64:67]
s_waitcnt lgkmcnt(7)
ds_read_b64_tr_b16 a[166:167], v207 offset:22528
v_mfma_f32_16x16x32_bf16 v[88:91], a[144:147], v[156:159], 0
ds_read_b128 a[168:171], v250 offset:28672
v_mfma_f32_16x16x32_bf16 v[88:91], a[148:151], v[48:51], v[88:91]
v_mfma_f32_16x16x32_bf16 v[108:111], a[148:151], v[136:139], 0
s_waitcnt vmcnt(4)
ds_read_b128 a[172:175], v244 offset:28672
v_cvt_pk_bf16_f32 v82, v64, v65
v_mfma_f32_16x16x32_bf16 v[108:111], a[144:147], v[172:175], v[108:111]
s_waitcnt lgkmcnt(6)
v_cvt_pk_bf16_f32 v83, v66, v67
v_cvt_pk_bf16_f32 v86, v72, v73
v_mfma_f32_16x16x32_bf16 v[108:111], a[152:155], v[92:95], v[108:111]
ds_read_b128 a[176:179], v250 offset:36864
v_cvt_pk_bf16_f32 v87, v74, v75
v_mfma_f32_16x16x32_bf16 v[108:111], a[156:159], v[76:79], v[108:111]
buffer_load_dwordx4 a[102:105], v240, s[44:47], s57 offen offset:1024 sc1
buffer_store_dword v254, v222, s[32:35], 0 offen sc1
v_mfma_f32_16x16x32_bf16 v[88:91], a[156:159], v[128:131], v[88:91]
buffer_store_dwordx4 v[80:83], v253, s[32:35], s56 offen offset:0 sc1
ds_read_b128 a[180:183], v244 offset:36864
v_mfma_f32_16x16x32_bf16 v[88:91], a[152:155], v[60:63], v[88:91]
s_waitcnt lgkmcnt(4)
v_mfma_f32_16x16x32_bf16 v[88:91], a[160:163], v[8:11], v[88:91]
ds_read_b64_tr_b16 a[184:185], v207 offset:40960
v_mfma_f32_16x16x32_bf16 v[88:91], a[164:167], v[36:39], v[88:91]
ds_read_b64_tr_b16 a[186:187], v207 offset:43008
v_mfma_f32_16x16x32_bf16 v[108:111], a[164:167], v[20:23], v[108:111]
buffer_store_dwordx4 v[84:87], v253, s[32:35], s56 offen offset:1024 sc1
ds_read_b64_tr_b16 a[188:189], v207 offset:45056
v_mfma_f32_16x16x32_bf16 v[108:111], a[160:163], v[12:15], v[108:111]
s_waitcnt lgkmcnt(5)
ds_read_b64_tr_b16 a[190:191], v207 offset:47104
v_mov_b32 v254, 17
v_mfma_f32_16x16x32_bf16 v[108:111], a[168:171], v[52:55], v[108:111]
ds_read_b64_tr_b16 a[144:145], v206 offset:0
v_mfma_f32_16x16x32_bf16 v[108:111], a[172:175], v[68:71], v[108:111]
ds_read_b64_tr_b16 a[146:147], v206 offset:2048
v_mfma_f32_16x16x32_bf16 v[88:91], a[172:175], v[44:47], v[88:91]
ds_read_b64_tr_b16 a[148:149], v206 offset:4096
v_mfma_f32_16x16x32_bf16 v[88:91], a[168:171], v[28:31], v[88:91]
s_waitcnt lgkmcnt(7)
ds_read_b64_tr_b16 a[150:151], v206 offset:6144
v_mfma_f32_16x16x32_bf16 v[88:91], a[176:179], v[160:163], v[88:91]
ds_read_b64_tr_b16 a[152:153], v206 offset:8192
v_mfma_f32_16x16x32_bf16 v[88:91], a[180:183], v[24:27], v[88:91]
ds_read_b64_tr_b16 a[154:155], v206 offset:10240
s_waitcnt vmcnt(5)
v_cmp_le_u32 vcc, v232, v252
v_mfma_f32_16x16x32_bf16 v[108:111], a[180:183], v[16:19], v[108:111]
s_and_b32 s99, vcc_lo, 0xc00
ds_read_b64_tr_b16 a[156:157], v206 offset:12288
v_mfma_f32_16x16x32_bf16 v[108:111], a[176:179], v[140:143], v[108:111]
s_waitcnt lgkmcnt(7)
ds_read_b64_tr_b16 a[158:159], v206 offset:14336
v_mfma_f32_16x16x32_bf16 v[108:111], a[184:187], v[4:7], v[108:111]
s_andn2_b32 s98, s98, s99
ds_read_b64_tr_b16 a[160:161], v206 offset:16384
v_mfma_f32_16x16x32_bf16 v[108:111], a[188:191], v[40:43], v[108:111]
s_lshl_b32 s57, s98, 10
ds_read_b64_tr_b16 a[162:163], v206 offset:18432
v_mfma_f32_16x16x32_bf16 v[88:91], a[188:191], v[56:59], v[88:91]
s_and_b32 s57, s57, 0x100000
ds_read_b64_tr_b16 a[164:165], v206 offset:20480
v_mfma_f32_16x16x32_bf16 v[88:91], a[184:187], v[32:35], v[88:91]
s_waitcnt lgkmcnt(7)
ds_read_b64_tr_b16 a[166:167], v206 offset:22528
v_mfma_f32_16x16x32_bf16 v[64:67], a[144:147], v[156:159], 0
s_or_b32 s57, s57, s7
ds_read_b128 a[168:171], v250 offset:30720
v_mfma_f32_16x16x32_bf16 v[64:67], a[148:151], v[48:51], v[64:67]
buffer_load_dwordx4 a[42:45], v240, s[44:47], s57 offen offset:0 sc1
v_mfma_f32_16x16x32_bf16 v[48:51], a[148:151], v[136:139], 0
ds_read_b128 a[172:175], v244 offset:30720
v_mfma_f32_16x16x32_bf16 v[48:51], a[144:147], v[172:175], v[48:51]
s_waitcnt lgkmcnt(6)
v_mfma_f32_16x16x32_bf16 v[48:51], a[152:155], v[92:95], v[48:51]
ds_read_b128 a[176:179], v250 offset:38912
v_mfma_f32_16x16x32_bf16 v[48:51], a[156:159], v[76:79], v[48:51]
v_mfma_f32_16x16x32_bf16 v[64:67], a[156:159], v[128:131], v[64:67]
buffer_load_dwordx4 a[106:109], v240, s[44:47], s57 offen offset:1024 sc1
ds_read_b128 a[180:183], v244 offset:38912
v_mfma_f32_16x16x32_bf16 v[64:67], a[152:155], v[60:63], v[64:67]
s_waitcnt lgkmcnt(4)
v_mfma_f32_16x16x32_bf16 v[64:67], a[160:163], v[8:11], v[64:67]
s_lshl_b32 s57, s98, 9
ds_read_b64_tr_b16 a[184:185], v206 offset:40960
v_mfma_f32_16x16x32_bf16 v[64:67], a[164:167], v[36:39], v[64:67]
s_and_b32 s57, s57, 0x100000
ds_read_b64_tr_b16 a[186:187], v206 offset:43008
v_mfma_f32_16x16x32_bf16 v[48:51], a[164:167], v[20:23], v[48:51]
s_or_b32 s57, s57, s8
ds_read_b64_tr_b16 a[188:189], v206 offset:45056
v_mfma_f32_16x16x32_bf16 v[48:51], a[160:163], v[12:15], v[48:51]
s_waitcnt lgkmcnt(5)
buffer_load_dwordx4 a[46:49], v240, s[44:47], s57 offen offset:0 sc1
ds_read_b64_tr_b16 a[190:191], v206 offset:47104
v_mfma_f32_16x16x32_bf16 v[48:51], a[168:171], v[52:55], v[48:51]
v_mfma_f32_16x16x32_bf16 v[48:51], a[172:175], v[68:71], v[48:51]
v_mfma_f32_16x16x32_bf16 v[64:67], a[172:175], v[44:47], v[64:67]
v_mfma_f32_16x16x32_bf16 v[64:67], a[168:171], v[28:31], v[64:67]
s_waitcnt lgkmcnt(4)
v_mfma_f32_16x16x32_bf16 v[64:67], a[176:179], v[160:163], v[64:67]
s_waitcnt vmcnt(3)
buffer_load_dwordx4 a[110:113], v240, s[44:47], s57 offen offset:1024 sc1
buffer_store_dword v254, v222, s[32:35], 0 offen sc1
v_mfma_f32_16x16x32_bf16 v[64:67], a[180:183], v[24:27], v[64:67]
v_mfma_f32_16x16x32_bf16 v[48:51], a[180:183], v[16:19], v[48:51]
v_mfma_f32_16x16x32_bf16 v[48:51], a[176:179], v[140:143], v[48:51]
s_waitcnt lgkmcnt(0)
v_mfma_f32_16x16x32_bf16 v[48:51], a[184:187], v[4:7], v[48:51]
v_mfma_f32_16x16x32_bf16 v[48:51], a[188:191], v[40:43], v[48:51]
v_mfma_f32_16x16x32_bf16 v[64:67], a[188:191], v[56:59], v[64:67]
v_mfma_f32_16x16x32_bf16 v[64:67], a[184:187], v[32:35], v[64:67]
v_mov_b32 v254, 0
s_mov_b64 exec, 0x7000
buffer_atomic_add v254, v227, s[32:35], 0 offen sc0 sc1
s_mov_b64 exec, -1
s_waitcnt vmcnt(0)
v_cmp_le_u32 vcc, v232, v254
s_nop 0
s_and_b32 s99, vcc_lo, 0x7000
s_andn2_b32 s98, s98, s99
s_lshl_b32 s57, s98, 8
s_and_b32 s57, s57, 0x100000
s_or_b32 s57, s57, s9
buffer_load_dwordx4 a[50:53], v240, s[44:47], s57 offen offset:0 sc1
buffer_load_dwordx4 a[114:117], v240, s[44:47], s57 offen offset:1024 sc1
s_lshl_b32 s57, s98, 7
s_and_b32 s57, s57, 0x100000
s_or_b32 s57, s57, s10
buffer_load_dwordx4 a[54:57], v240, s[44:47], s57 offen offset:0 sc1
buffer_load_dwordx4 a[118:121], v240, s[44:47], s57 offen offset:1024 sc1
s_lshl_b32 s57, s98, 6
s_and_b32 s57, s57, 0x100000
s_or_b32 s57, s57, s11
buffer_load_dwordx4 a[58:61], v240, s[44:47], s57 offen offset:0 sc1
buffer_load_dwordx4 a[122:125], v240, s[44:47], s57 offen offset:1024 sc1
s_mov_b32 s96, 0
s_mov_b32 s59, 0
s_mov_b32 s58, s98
s_branch LM_tl_n
LM_t:
v_mov_b32 v254, 0
s_mov_b32 exec_hi, 0
s_mov_b32 exec_lo, s98
buffer_atomic_add v254, v227, s[32:35], 0 offen sc0 sc1
s_mov_b64 exec, -1
s_mov_b32 s58, s98
s_waitcnt vmcnt(0)
v_cmp_le_u32 vcc, v232, v254
s_nop 0
s_and_b32 s99, vcc_lo, s98
s_andn2_b32 s98, s98, s99
s_cmp_eq_u32 s99, 0
s_cbranch_scc1 LM_tl_n
s_and_b32 s67, s99, 0xf
s_cbranch_scc0 LM_tl_g0
s_bitcmp1_b32 s99, 0
s_cbranch_scc0 LM_tl_0
buffer_load_dwordx4 a[2:5], v240, s[44:47], s60 offen offset:0 sc1
buffer_load_dwordx4 a[66:69], v240, s[44:47], s60 offen offset:1024 sc1
LM_tl_0:
s_bitcmp1_b32 s99, 1
s_cbranch_scc0 LM_tl_1
buffer_load_dwordx4 a[6:9], v240, s[44:47], s61 offen offset:0 sc1
buffer_load_dwordx4 a[70:73], v240, s[44:47], s61 offen offset:1024 sc1
LM_tl_1:
s_bitcmp1_b32 s99, 2
s_cbranch_scc0 LM_tl_2
buffer_load_dwordx4 a[10:13], v240, s[44:47], s62 offen offset:0 sc1
buffer_load_dwordx4 a[74:77], v240, s[44:47], s62 offen offset:1024 sc1
LM_tl_2:
s_bitcmp1_b32 s99, 3
s_cbranch_scc0 LM_tl_3
buffer_load_dwordx4 a[14:17], v240, s[44:47], s63 offen offset:0 sc1
buffer_load_dwordx4 a[78:81], v240, s[44:47], s63 offen offset:1024 sc1
LM_tl_3:
LM_tl_g0:
s_and_b32 s67, s99, 0xf0
s_cbranch_scc0 LM_tl_g4
s_bitcmp1_b32 s99, 4
s_cbranch_scc0 LM_tl_4
buffer_load_dwordx4 a[18:21], v240, s[44:47], s64 offen offset:0 sc1
buffer_load_dwordx4 a[82:85], v240, s[44:47], s64 offen offset:1024 sc1
LM_tl_4:
s_bitcmp1_b32 s99, 5
s_cbranch_scc0 LM_tl_5
buffer_load_dwordx4 a[22:25], v240, s[44:47], s65 offen offset:0 sc1
buffer_load_dwordx4 a[86:89], v240, s[44:47], s65 offen offset:1024 sc1
LM_tl_5:
s_bitcmp1_b32 s99, 6
s_cbranch_scc0 LM_tl_6
buffer_load_dwordx4 a[26:29], v240, s[44:47], s66 offen offset:0 sc1
buffer_load_dwordx4 a[90:93], v240, s[44:47], s66 offen offset:1024 sc1
LM_tl_6:
s_bitcmp1_b32 s99, 7
s_cbranch_scc0 LM_tl_7
buffer_load_dwordx4 a[30:33], v240, s[44:47], s4 offen offset:0 sc1
buffer_load_dwordx4 a[94:97], v240, s[44:47], s4 offen offset:1024 sc1
LM_tl_7:
LM_tl_g4:
s_and_b32 s67, s99, 0xf00
s_cbranch_scc0 LM_tl_g8
s_bitcmp1_b32 s99, 8
s_cbranch_scc0 LM_tl_8
buffer_load_dwordx4 a[34:37], v240, s[44:47], s5 offen offset:0 sc1
buffer_load_dwordx4 a[98:101], v240, s[44:47], s5 offen offset:1024 sc1
LM_tl_8:
s_bitcmp1_b32 s99, 9
s_cbranch_scc0 LM_tl_9
buffer_load_dwordx4 a[38:41], v240, s[44:47], s6 offen offset:0 sc1
buffer_load_dwordx4 a[102:105], v240, s[44:47], s6 offen offset:1024 sc1
LM_tl_9:
s_bitcmp1_b32 s99, 10
s_cbranch_scc0 LM_tl_10
buffer_load_dwordx4 a[42:45], v240, s[44:47], s7 offen offset:0 sc1
buffer_load_dwordx4 a[106:109], v240, s[44:47], s7 offen offset:1024 sc1
LM_tl_10:
s_bitcmp1_b32 s99, 11
s_cbranch_scc0 LM_tl_11
buffer_load_dwordx4 a[46:49], v240, s[44:47], s8 offen offset:0 sc1
buffer_load_dwordx4 a[110:113], v240, s[44:47], s8 offen offset:1024 sc1
LM_tl_11:
LM_tl_g8:
s_and_b32 s67, s99, 0xf000
s_cbranch_scc0 LM_tl_g12
s_bitcmp1_b32 s99, 12
s_cbranch_scc0 LM_tl_12
buffer_load_dwordx4 a[50:53], v240, s[44:47], s9 offen offset:0 sc1
buffer_load_dwordx4 a[114:117], v240, s[44:47], s9 offen offset:1024 sc1
LM_tl_12:
s_bitcmp1_b32 s99, 13
s_cbranch_scc0 LM_tl_13
buffer_load_dwordx4 a[54:57], v240, s[44:47], s10 offen offset:0 sc1
buffer_load_dwordx4 a[118:121], v240, s[44:47], s10 offen offset:1024 sc1
LM_tl_13:
s_bitcmp1_b32 s99, 14
s_cbranch_scc0 LM_tl_14
buffer_load_dwordx4 a[58:61], v240, s[44:47], s11 offen offset:0 sc1
buffer_load_dwordx4 a[122:125], v240, s[44:47], s11 offen offset:1024 sc1
LM_tl_14:
LM_tl_g12:
LM_tl_n:
s_and_b32 s67, s58, 0xfff
s_or_b32 s67, s67, s59
s_cbranch_scc1 LM_t_s
v_mfma_f32_16x16x32_bf16 v[88:91], a[224:227], a[0:3], v[88:91]
v_mfma_f32_16x16x32_bf16 v[108:111], a[224:227], a[64:67], v[108:111]
v_mfma_f32_16x16x32_bf16 v[64:67], a[224:227], a[4:7], v[64:67]
v_mfma_f32_16x16x32_bf16 v[48:51], a[224:227], a[68:71], v[48:51]
v_mfma_f32_16x16x32_bf16 v[88:91], a[224:227], a[8:11], v[88:91]
v_mfma_f32_16x16x32_bf16 v[108:111], a[224:227], a[72:75], v[108:111]
v_mfma_f32_16x16x32_bf16 v[64:67], a[224:227], a[12:15], v[64:67]
v_mfma_f32_16x16x32_bf16 v[48:51], a[224:227], a[76:79], v[48:51]
v_mfma_f32_16x16x32_bf16 v[88:91], a[224:227], a[16:19], v[88:91]
v_mfma_f32_16x16x32_bf16 v[108:111], a[224:227], a[80:83], v[108:111]
v_mfma_f32_16x16x32_bf16 v[64:67], a[224:227], a[20:23], v[64:67]
v_mfma_f32_16x16x32_bf16 v[48:51], a[224:227], a[84:87], v[48:51]
v_mfma_f32_16x16x32_bf16 v[88:91], a[224:227], a[24:27], v[88:91]
v_mfma_f32_16x16x32_bf16 v[108:111], a[224:227], a[88:91], v[108:111]
v_mfma_f32_16x16x32_bf16 v[64:67], a[224:227], a[28:31], v[64:67]
v_mfma_f32_16x16x32_bf16 v[48:51], a[224:227], a[92:95], v[48:51]
v_mfma_f32_16x16x32_bf16 v[88:91], a[224:227], a[32:35], v[88:91]
v_mfma_f32_16x16x32_bf16 v[108:111], a[224:227], a[96:99], v[108:111]
v_mfma_f32_16x16x32_bf16 v[64:67], a[224:227], a[36:39], v[64:67]
v_mfma_f32_16x16x32_bf16 v[48:51], a[224:227], a[100:103], v[48:51]
v_mfma_f32_16x16x32_bf16 v[88:91], a[224:227], a[40:43], v[88:91]
v_mfma_f32_16x16x32_bf16 v[108:111], a[224:227], a[104:107], v[108:111]
v_mfma_f32_16x16x32_bf16 v[64:67], a[224:227], a[44:47], v[64:67]
v_mfma_f32_16x16x32_bf16 v[48:51], a[224:227], a[108:111], v[48:51]
s_mov_b32 s59, 1
LM_t_s:
s_add_u32 s96, s96, 1
s_cmp_lt_u32 s96, 20000
s_cselect_b32 s67, s98, 0
s_cmp_lg_u32 s67, 0
s_cbranch_scc1 LM_t
LM_t_x:
s_cmp_lg_u32 s59, 0
s_waitcnt vmcnt(0)
s_cbranch_scc1 LM_t_h
v_mfma_f32_16x16x32_bf16 v[88:91], a[224:227], a[0:3], v[88:91]
v_mfma_f32_16x16x32_bf16 v[108:111], a[224:227], a[64:67], v[108:111]
v_mfma_f32_16x16x32_bf16 v[64:67], a[224:227], a[4:7], v[64:67]
v_mfma_f32_16x16x32_bf16 v[48:51], a[224:227], a[68:71], v[48:51]
v_mfma_f32_16x16x32_bf16 v[88:91], a[224:227], a[8:11], v[88:91]
v_mfma_f32_16x16x32_bf16 v[108:111], a[224:227], a[72:75], v[108:111]
v_mfma_f32_16x16x32_bf16 v[64:67], a[224:227], a[12:15], v[64:67]
v_mfma_f32_16x16x32_bf16 v[48:51], a[224:227], a[76:79], v[48:51]
v_mfma_f32_16x16x32_bf16 v[88:91], a[224:227], a[16:19], v[88:91]
v_mfma_f32_16x16x32_bf16 v[108:111], a[224:227], a[80:83], v[108:111]
v_mfma_f32_16x16x32_bf16 v[64:67], a[224:227], a[20:23], v[64:67]
v_mfma_f32_16x16x32_bf16 v[48:51], a[224:227], a[84:87], v[48:51]
v_mfma_f32_16x16x32_bf16 v[88:91], a[224:227], a[24:27], v[88:91]
v_mfma_f32_16x16x32_bf16 v[108:111], a[224:227], a[88:91], v[108:111]
v_mfma_f32_16x16x32_bf16 v[64:67], a[224:227], a[28:31], v[64:67]
v_mfma_f32_16x16x32_bf16 v[48:51], a[224:227], a[92:95], v[48:51]
v_mfma_f32_16x16x32_bf16 v[88:91], a[224:227], a[32:35], v[88:91]
v_mfma_f32_16x16x32_bf16 v[108:111], a[224:227], a[96:99], v[108:111]
v_mfma_f32_16x16x32_bf16 v[64:67], a[224:227], a[36:39], v[64:67]
v_mfma_f32_16x16x32_bf16 v[48:51], a[224:227], a[100:103], v[48:51]
v_mfma_f32_16x16x32_bf16 v[88:91], a[224:227], a[40:43], v[88:91]
v_mfma_f32_16x16x32_bf16 v[108:111], a[224:227], a[104:107], v[108:111]
v_mfma_f32_16x16x32_bf16 v[64:67], a[224:227], a[44:47], v[64:67]
v_mfma_f32_16x16x32_bf16 v[48:51], a[224:227], a[108:111], v[48:51]
LM_t_h:
v_mfma_f32_16x16x32_bf16 v[88:91], a[224:227], a[48:51], v[88:91]
v_mfma_f32_16x16x32_bf16 v[108:111], a[224:227], a[112:115], v[108:111]
v_mfma_f32_16x16x32_bf16 v[64:67], a[224:227], a[52:55], v[64:67]
v_mfma_f32_16x16x32_bf16 v[48:51], a[224:227], a[116:119], v[48:51]
v_mfma_f32_16x16x32_bf16 v[88:91], a[224:227], a[56:59], v[88:91]
v_mfma_f32_16x16x32_bf16 v[108:111], a[224:227], a[120:123], v[108:111]
v_mfma_f32_16x16x32_bf16 v[64:67], a[224:227], a[60:63], v[64:67]
v_mfma_f32_16x16x32_bf16 v[48:51], a[224:227], a[124:127], v[48:51]
s_nop 4
v_fmac_f32 v96, 0xbf317218, v88
v_fmac_f32 v97, 0xbf317218, v89
v_fmac_f32 v98, 0xbf317218, v90
v_fmac_f32 v99, 0xbf317218, v91
ds_write_b128 v245, v[96:99] offset:0
v_fmac_f32 v100, 0xbf317218, v64
v_fmac_f32 v101, 0xbf317218, v65
v_fmac_f32 v102, 0xbf317218, v66
v_fmac_f32 v103, 0xbf317218, v67
ds_write_b128 v225, v[100:103] offset:0
v_fmac_f32 v104, 0xbf317218, v108
v_fmac_f32 v105, 0xbf317218, v109
v_fmac_f32 v106, 0xbf317218, v110
v_fmac_f32 v107, 0xbf317218, v111
ds_write_b128 v245, v[104:107] offset:512
v_fmac_f32 v112, 0xbf317218, v48
v_fmac_f32 v113, 0xbf317218, v49
v_fmac_f32 v114, 0xbf317218, v50
v_fmac_f32 v115, 0xbf317218, v51
ds_write_b128 v225, v[112:115] offset:512
ds_read_b128 v[4:7], v224 offset:0
ds_read_b128 v[8:11], v223 offset:1024
ds_read_b128 v[12:15], v224 offset:2048
ds_read_b128 v[16:19], v223 offset:3072
s_mov_b32 s67, 0
s_waitcnt lgkmcnt(3)
buffer_store_dwordx4 v[4:7], v255, s[28:31], s67 offen sc1
s_mov_b32 s67, 18432
s_waitcnt lgkmcnt(2)
buffer_store_dwordx4 v[8:11], v255, s[28:31], s67 offen sc1
s_mov_b32 s67, 36864
s_waitcnt lgkmcnt(1)
buffer_store_dwordx4 v[12:15], v255, s[28:31], s67 offen sc1
s_mov_b32 s67, 55296
s_waitcnt lgkmcnt(0)
buffer_store_dwordx4 v[16:19], v255, s[28:31], s67 offen sc1
s_endpgm
LM_go:
s_nop 7
s_mov_b32 s96, 0
LM_go_l:
s_sleep 2
buffer_load_dword v232, v249, s[36:39], 0 offen sc1
s_waitcnt vmcnt(0)
v_cmp_gt_u32 vcc, 1, v232
s_nop 1
s_cbranch_vccz LM_go_b
s_add_u32 s96, s96, 1
s_cmp_lt_u32 s96, 20000
s_cbranch_scc1 LM_go_l
s_branch LM_go_b
LM_go2:
s_nop 7
s_mov_b32 s96, 0
LM_go2_l:
s_sleep 2
buffer_load_dword v253, v254, s[36:39], 0 offen sc1
s_waitcnt vmcnt(0)
v_cmp_gt_u32 vcc, 1, v253
s_nop 1
s_cbranch_vccz LM_go2_b
s_add_u32 s96, s96, 1
s_cmp_lt_u32 s96, 20000
s_cbranch_scc1 LM_go2_l
s_branch LM_go2_b
LM_g:
s_nop 7
s_mov_b32 s96, 0
LM_g_l:
s_sleep 2
buffer_load_dwordx2 v[198:199], v204, s[40:43], 0 offen offset:1536 sc1
buffer_load_dwordx2 v[196:197], v204, s[40:43], 0 offen offset:1024 sc1
buffer_load_dwordx2 v[194:195], v204, s[40:43], 0 offen offset:512 sc1
buffer_load_dwordx2 v[192:193], v204, s[40:43], 0 offen offset:0 sc1
s_waitcnt vmcnt(0)
s_nop 0
v_pk_fma_f32 v[190:191], v[216:217], v[198:199], v[196:197] op_sel_hi:[0,1,1]
v_pk_fma_f32 v[190:191], v[216:217], v[198:199], v[190:191] op_sel:[1,1,0] op_sel_hi:[1,0,1] neg_lo:[1,0,0]
v_pk_fma_f32 v[188:189], v[216:217], v[190:191], v[194:195] op_sel_hi:[0,1,1]
v_pk_fma_f32 v[188:189], v[216:217], v[190:191], v[188:189] op_sel:[1,1,0] op_sel_hi:[1,0,1] neg_lo:[1,0,0]
v_pk_fma_f32 v[190:191], v[216:217], v[188:189], v[192:193] op_sel_hi:[0,1,1]
v_pk_fma_f32 v[190:191], v[216:217], v[188:189], v[190:191] op_sel:[1,1,0] op_sel_hi:[1,0,1] neg_lo:[1,0,0]
v_cmp_u_f32 vcc, v190, v191
s_nop 1
s_cbranch_vccz LM_g_b
s_add_u32 s96, s96, 1
s_cmp_lt_u32 s96, 20000
s_cbranch_scc1 LM_g_l
s_branch LM_g_b
.p2align 12
LF:
s_mov_b64 exec, -1
v_and_b32 v252, 15, v255
v_lshrrev_b32 v251, 4, v255
v_lshrrev_b32 v248, 1, v252
v_xor_b32 v248, v251, v248
v_lshlrev_b32 v248, 4, v248
v_lshl_add_u32 v248, v252, 7, v248
v_add_u32 v247, s53, v248
v_xor_b32 v246, 64, v247
v_add_u32 v245, 49152, v247
v_add_u32 v244, 49152, v246
v_add_u32 v243, 98304, v247
v_add_u32 v242, 98304, v246
v_mov_b32 v248, 0x3f803f80
v_accvgpr_write_b32 a244, v248
v_accvgpr_write_b32 a245, v248
v_accvgpr_write_b32 a246, v248
v_accvgpr_write_b32 a247, v248
s_mov_b64 s[8:9], s[88:89]
s_mov_b32 s10, 5308416
s_mov_b32 s11, 0x20000
s_mov_b64 s[12:13], s[90:91]
s_mov_b64 s[28:29], s[92:93]
s_mov_b64 s[36:37], s[94:95]
s_mov_b64 s[32:33], s[96:97]
s_mov_b32 s97, 0xffff0000
s_add_u32 s86, s48, 1
s_lshr_b32 s51, s86, 1
s_and_b32 s52, s86, 1
s_xor_b32 s3, s52, 1
s_sub_u32 s86, s49, 9
s_min_u32 s101, s49, s86
s_add_u32 s86, s51, 8
s_and_b32 s86, s86, 7
s_add_u32 s86, s86, s101
s_add_u32 s86, s86, 1
s_sub_u32 s87, s86, 9
s_min_u32 s86, s86, s87
s_lshl_b32 s82, s86, 7
s_sub_u32 s86, s82, s58
s_add_u32 s87, s86, 1152
s_min_u32 s86, s86, s87
s_lshl_b32 s86, s86, 6
s_add_u32 s86, s86, s53
v_lshrrev_b32 v248, 1, v252
v_lshrrev_b32 v241, 1, v251
v_xor_b32 v248, v248, v241
s_lshl_b32 s87, s52, 2
v_xor_b32 v248, s87, v248
v_lshlrev_b32 v248, 4, v248
v_lshl_add_u32 v248, v252, 7, v248
v_and_b32 v241, 1, v251
v_lshl_add_u32 v248, v241, 3, v248
v_add_u32 v240, s86, v248
s_lshl_b32 s87, s52, 6
s_add_u32 s87, s87, s82
v_lshl_add_u32 v239, v251, 3, s87
s_mul_i32 s86, s48, 768
s_sub_u32 s86, s86, 2304
s_add_u32 s68, s86, 0
s_add_u32 s69, s86, 128
s_add_u32 s70, s86, 256
s_add_u32 s71, s86, 384
s_add_u32 s72, s86, 512
s_add_u32 s73, s86, 640
s_lshl_b32 s86, s50, 4
v_add_u32 v238, s86, v254
s_and_b32 s87, s50, 1
s_mul_i32 s87, s87, 12
s_sub_u32 s86, s86, s87
v_and_b32 v241, 4, v254
v_add3_u32 v241, v241, v254, s86
v_mul_u32_u24 v241, 9216, v241
v_and_b32 v248, 6, v254
v_xor_b32 v248, v253, v248
v_lshl_add_u32 v254, v248, 4, v241
v_add_u32 v253, 146432, v254
s_lshl_b32 s86, s3, 2
v_xor_b32 v248, s86, v248
v_lshlrev_b32 v248, 4, v248
v_mul_u32_u24 v241, 1152, v238
v_add_u32 v238, v241, v248
v_add_u32 v237, 8192, v238
v_lshrrev_b32 v248, 2, v252
v_lshl_add_u32 v236, v248, 4, v252
v_lshlrev_b32 v236, 2, v236
v_and_b32 v241, 3, v255
v_cmp_eq_u32 s[88:89], 1, v241
v_cmp_eq_u32 s[90:91], 2, v241
v_cmp_eq_u32 s[92:93], 3, v241
s_waitcnt vmcnt(8)
ds_read_b128 v[4:7], v247 offset:0
ds_read_b128 v[8:11], v246 offset:0
s_addk_i32 m0, 0x2000
s_add_u32 s54, s100, s63
buffer_load_dwordx4 v250, s[4:7], s54 offen  lds
buffer_load_dwordx4 v249, s[4:7], s54 offen offset:1024  lds
s_waitcnt vmcnt(8)
ds_read_b128 v[12:15], v247 offset:8192
ds_read_b128 v[16:19], v246 offset:8192
s_waitcnt lgkmcnt(2)
v_mfma_f32_16x16x32_bf16 a[252:255], a[244:247], v[4:7], 0
v_lshrrev_b32 v248, 2, v255
v_lshlrev_b32 v248, 7, v248
v_mfma_f32_16x16x32_bf16 v[20:23], v[4:7], v[4:7], 0
v_bfe_u32 v241, v255, 3, 2
v_mfma_f32_16x16x32_bf16 a[252:255], a[244:247], v[8:11], a[252:255]
v_mfma_f32_16x16x32_bf16 v[20:23], v[8:11], v[8:11], v[20:23]
s_addk_i32 m0, 0x2000
s_add_u32 s54, s100, s64
buffer_load_dwordx4 v250, s[4:7], s54 offen  lds
buffer_load_dwordx4 v249, s[4:7], s54 offen offset:1024  lds
s_waitcnt vmcnt(8)
ds_read_b128 v[24:27], v247 offset:16384
ds_read_b128 v[28:31], v246 offset:16384
s_waitcnt lgkmcnt(2)
v_mfma_f32_16x16x32_bf16 a[252:255], a[244:247], v[12:15], a[252:255]
v_lshlrev_b32 v32, 16, v4
v_and_b32 v4, s97, v4
v_mfma_f32_16x16x32_bf16 v[20:23], v[12:15], v[12:15], v[20:23]
v_lshlrev_b32 v33, 16, v5
v_and_b32 v5, s97, v5
v_mfma_f32_16x16x32_bf16 a[252:255], a[244:247], v[16:19], a[252:255]
v_lshlrev_b32 v34, 16, v6
v_and_b32 v6, s97, v6
v_mfma_f32_16x16x32_bf16 v[20:23], v[16:19], v[16:19], v[20:23]
v_lshlrev_b32 v35, 16, v7
v_and_b32 v7, s97, v7
v_lshlrev_b32 v36, 16, v8
v_and_b32 v8, s97, v8
v_lshlrev_b32 v37, 16, v9
v_and_b32 v9, s97, v9
v_lshlrev_b32 v38, 16, v10
v_and_b32 v10, s97, v10
v_lshlrev_b32 v39, 16, v11
v_and_b32 v11, s97, v11
v_lshl_add_u32 v248, v241, 5, v248
v_and_b32 v241, 3, v255
v_lshl_add_u32 v235, v241, 3, v248
s_addk_i32 m0, 0x2000
s_add_u32 s54, s100, s65
buffer_load_dwordx4 v250, s[4:7], s54 offen  lds
buffer_load_dwordx4 v249, s[4:7], s54 offen offset:1024  lds
s_waitcnt vmcnt(8)
ds_read_b128 v[40:43], v247 offset:24576
ds_read_b128 v[44:47], v246 offset:24576
s_waitcnt lgkmcnt(2)
v_mfma_f32_16x16x32_bf16 a[252:255], a[244:247], v[24:27], a[252:255]
v_lshlrev_b32 v48, 16, v12
v_and_b32 v12, s97, v12
v_mfma_f32_16x16x32_bf16 v[20:23], v[24:27], v[24:27], v[20:23]
v_lshlrev_b32 v49, 16, v13
v_and_b32 v13, s97, v13
v_mfma_f32_16x16x32_bf16 a[252:255], a[244:247], v[28:31], a[252:255]
v_lshlrev_b32 v50, 16, v14
v_and_b32 v14, s97, v14
v_mfma_f32_16x16x32_bf16 v[20:23], v[28:31], v[28:31], v[20:23]
v_lshlrev_b32 v51, 16, v15
v_and_b32 v15, s97, v15
v_lshlrev_b32 v52, 16, v16
v_and_b32 v16, s97, v16
v_lshlrev_b32 v53, 16, v17
v_and_b32 v17, s97, v17
v_lshlrev_b32 v54, 16, v18
v_and_b32 v18, s97, v18
v_lshlrev_b32 v55, 16, v19
v_and_b32 v19, s97, v19
v_xor_b32 v248, 32, v235
v_xor_b32 v234, 64, v235
v_xor_b32 v233, 96, v235
s_addk_i32 m0, 0x2000
s_add_u32 s54, s100, s66
buffer_load_dwordx4 v250, s[4:7], s54 offen  lds
buffer_load_dwordx4 v249, s[4:7], s54 offen offset:1024  lds
s_waitcnt vmcnt(8)
ds_read_b128 v[56:59], v247 offset:32768
ds_read_b128 v[60:63], v246 offset:32768
s_waitcnt lgkmcnt(2)
v_mfma_f32_16x16x32_bf16 a[252:255], a[244:247], v[40:43], a[252:255]
v_lshlrev_b32 v64, 16, v24
v_and_b32 v24, s97, v24
v_mfma_f32_16x16x32_bf16 v[20:23], v[40:43], v[40:43], v[20:23]
v_lshlrev_b32 v65, 16, v25
v_and_b32 v25, s97, v25
v_mfma_f32_16x16x32_bf16 a[252:255], a[244:247], v[44:47], a[252:255]
v_lshlrev_b32 v66, 16, v26
v_and_b32 v26, s97, v26
v_mfma_f32_16x16x32_bf16 v[20:23], v[44:47], v[44:47], v[20:23]
v_lshlrev_b32 v67, 16, v27
v_and_b32 v27, s97, v27
v_lshlrev_b32 v68, 16, v28
v_and_b32 v28, s97, v28
v_lshlrev_b32 v69, 16, v29
v_and_b32 v29, s97, v29
v_lshlrev_b32 v70, 16, v30
v_and_b32 v30, s97, v30
v_lshlrev_b32 v71, 16, v31
v_and_b32 v31, s97, v31
s_addk_i32 m0, 0x2000
s_sub_u32 s100, s100, 4608
s_add_u32 s54, s100, s58
buffer_load_dwordx4 v250, s[4:7], s54 offen  lds
buffer_load_dwordx4 v249, s[4:7], s54 offen offset:1024  lds
s_waitcnt vmcnt(8)
ds_read_b128 v[72:75], v247 offset:40960
ds_read_b128 v[76:79], v246 offset:40960
s_waitcnt lgkmcnt(2)
v_mfma_f32_16x16x32_bf16 a[252:255], a[244:247], v[56:59], a[252:255]
v_lshlrev_b32 v80, 16, v40
v_and_b32 v40, s97, v40
v_mfma_f32_16x16x32_bf16 v[20:23], v[56:59], v[56:59], v[20:23]
v_lshlrev_b32 v81, 16, v41
v_and_b32 v41, s97, v41
v_mfma_f32_16x16x32_bf16 a[252:255], a[244:247], v[60:63], a[252:255]
v_lshlrev_b32 v82, 16, v42
v_and_b32 v42, s97, v42
v_mfma_f32_16x16x32_bf16 v[20:23], v[60:63], v[60:63], v[20:23]
v_lshlrev_b32 v83, 16, v43
v_and_b32 v43, s97, v43
v_lshlrev_b32 v84, 16, v44
v_and_b32 v44, s97, v44
v_lshlrev_b32 v85, 16, v45
v_and_b32 v45, s97, v45
v_lshlrev_b32 v86, 16, v46
v_and_b32 v46, s97, v46
v_lshlrev_b32 v87, 16, v47
v_and_b32 v47, s97, v47
s_addk_i32 m0, 0x2000
s_add_u32 s54, s100, s59
buffer_load_dwordx4 v250, s[4:7], s54 offen  lds
buffer_load_dwordx4 v249, s[4:7], s54 offen offset:1024  lds
s_waitcnt vmcnt(8)
ds_read_b128 v[88:91], v245 offset:0
ds_read_b128 v[92:95], v244 offset:0
s_mov_b64 exec, 0
s_cmp_eq_u32 s50, 0
s_cbranch_scc1 LF_p4
s_cmp_eq_u32 s50, 1
s_cbranch_scc1 LF_p5
s_cmp_eq_u32 s50, 2
s_cbranch_scc1 LF_p6
s_branch LF_p7
LF_v105:
s_mov_b64 exec, -1
s_waitcnt lgkmcnt(2)
v_mfma_f32_16x16x32_bf16 a[252:255], a[244:247], v[72:75], a[252:255]
v_lshlrev_b32 v96, 16, v56
v_and_b32 v56, s97, v56
v_mfma_f32_16x16x32_bf16 v[20:23], v[72:75], v[72:75], v[20:23]
v_lshlrev_b32 v97, 16, v57
v_and_b32 v57, s97, v57
v_mfma_f32_16x16x32_bf16 a[252:255], a[244:247], v[76:79], a[252:255]
v_lshlrev_b32 v98, 16, v58
v_and_b32 v58, s97, v58
v_mfma_f32_16x16x32_bf16 v[20:23], v[76:79], v[76:79], v[20:23]
v_lshlrev_b32 v99, 16, v59
v_and_b32 v59, s97, v59
v_lshlrev_b32 v100, 16, v60
v_and_b32 v60, s97, v60
v_lshlrev_b32 v101, 16, v61
v_and_b32 v61, s97, v61
v_lshlrev_b32 v102, 16, v62
v_and_b32 v62, s97, v62
v_lshlrev_b32 v103, 16, v63
v_and_b32 v63, s97, v63
s_addk_i32 m0, 0x2000
s_add_u32 s54, s100, s60
buffer_load_dwordx4 v250, s[4:7], s54 offen  lds
buffer_load_dwordx4 v249, s[4:7], s54 offen offset:1024  lds
s_waitcnt vmcnt(8)
ds_read_b128 v[104:107], v245 offset:8192
ds_read_b128 v[108:111], v244 offset:8192
s_waitcnt lgkmcnt(2)
v_mfma_f32_16x16x32_bf16 a[252:255], a[244:247], v[88:91], a[252:255]
v_lshlrev_b32 v112, 16, v72
v_and_b32 v72, s97, v72
v_mfma_f32_16x16x32_bf16 v[20:23], v[88:91], v[88:91], v[20:23]
v_lshlrev_b32 v113, 16, v73
v_and_b32 v73, s97, v73
v_mfma_f32_16x16x32_bf16 a[252:255], a[244:247], v[92:95], a[252:255]
v_lshlrev_b32 v114, 16, v74
v_and_b32 v74, s97, v74
v_mfma_f32_16x16x32_bf16 v[20:23], v[92:95], v[92:95], v[20:23]
v_lshlrev_b32 v115, 16, v75
v_and_b32 v75, s97, v75
v_lshlrev_b32 v116, 16, v76
v_and_b32 v76, s97, v76
v_lshlrev_b32 v117, 16, v77
v_and_b32 v77, s97, v77
v_lshlrev_b32 v118, 16, v78
v_and_b32 v78, s97, v78
v_lshlrev_b32 v119, 16, v79
v_and_b32 v79, s97, v79
s_addk_i32 m0, 0x2000
s_add_u32 s54, s100, s61
buffer_load_dwordx4 v250, s[4:7], s54 offen  lds
buffer_load_dwordx4 v249, s[4:7], s54 offen offset:1024  lds
s_waitcnt vmcnt(8)
ds_read_b128 v[120:123], v245 offset:16384
ds_read_b128 v[124:127], v244 offset:16384
v_xor_b32 v241, 32, v240
ds_read_b64 a[234:235], v240
ds_read_b64 a[238:239], v241
s_waitcnt lgkmcnt(4)
v_mfma_f32_16x16x32_bf16 a[252:255], a[244:247], v[104:107], a[252:255]
v_lshlrev_b32 v128, 16, v88
v_and_b32 v88, s97, v88
v_mfma_f32_16x16x32_bf16 v[20:23], v[104:107], v[104:107], v[20:23]
v_lshlrev_b32 v129, 16, v89
v_and_b32 v89, s97, v89
v_mfma_f32_16x16x32_bf16 a[252:255], a[244:247], v[108:111], a[252:255]
v_lshlrev_b32 v130, 16, v90
v_and_b32 v90, s97, v90
v_mfma_f32_16x16x32_bf16 v[20:23], v[108:111], v[108:111], v[20:23]
v_lshlrev_b32 v131, 16, v91
v_and_b32 v91, s97, v91
v_lshlrev_b32 v132, 16, v92
v_and_b32 v92, s97, v92
v_lshlrev_b32 v133, 16, v93
v_and_b32 v93, s97, v93
v_lshlrev_b32 v134, 16, v94
v_and_b32 v94, s97, v94
v_lshlrev_b32 v135, 16, v95
v_and_b32 v95, s97, v95
s_addk_i32 m0, 0x2000
s_add_u32 s54, s100, s62
buffer_load_dwordx4 v250, s[4:7], s54 offen  lds
buffer_load_dwordx4 v249, s[4:7], s54 offen offset:1024  lds
s_waitcnt vmcnt(8)
ds_read_b128 v[136:139], v245 offset:24576
ds_read_b128 v[140:143], v244 offset:24576
s_waitcnt lgkmcnt(4)
v_mfma_f32_16x16x32_bf16 a[252:255], a[244:247], v[120:123], a[252:255]
v_lshlrev_b32 v144, 16, v104
v_and_b32 v104, s97, v104
v_mfma_f32_16x16x32_bf16 v[20:23], v[120:123], v[120:123], v[20:23]
v_lshlrev_b32 v145, 16, v105
v_and_b32 v105, s97, v105
v_mfma_f32_16x16x32_bf16 a[252:255], a[244:247], v[124:127], a[252:255]
v_lshlrev_b32 v146, 16, v106
v_and_b32 v106, s97, v106
v_mfma_f32_16x16x32_bf16 v[20:23], v[124:127], v[124:127], v[20:23]
v_lshlrev_b32 v147, 16, v107
v_and_b32 v107, s97, v107
v_lshlrev_b32 v148, 16, v108
v_and_b32 v108, s97, v108
v_lshlrev_b32 v149, 16, v109
v_and_b32 v109, s97, v109
v_lshlrev_b32 v150, 16, v110
v_and_b32 v110, s97, v110
v_lshlrev_b32 v151, 16, v111
v_and_b32 v111, s97, v111
v_cndmask_b32 v247, v20, v21, s[88:89]
v_cndmask_b32 v247, v247, v22, s[90:91]
v_cndmask_b32 v247, v247, v23, s[92:93]
ds_bpermute_b32 v247, v236, v247
v_accvgpr_read_b32 v246, a252
v_mul_f32 v246, 0x3ae38e39, v246
v_cvt_pk_bf16_f32 v232, 0, v246
v_mul_f32 v246, v246, v246
s_addk_i32 m0, 0x2000
s_add_u32 s54, s100, s63
buffer_load_dwordx4 v250, s[4:7], s54 offen  lds
buffer_load_dwordx4 v249, s[4:7], s54 offen offset:1024  lds
s_waitcnt vmcnt(8)
ds_read_b128 v[20:23], v245 offset:32768
ds_read_b128 v[152:155], v244 offset:32768
s_waitcnt lgkmcnt(3)
v_mfma_f32_16x16x32_bf16 a[248:251], a[244:247], v[136:139], 0
v_lshlrev_b32 v156, 16, v120
v_and_b32 v120, s97, v120
v_mfma_f32_16x16x32_bf16 v[160:163], v[136:139], v[136:139], 0
v_lshlrev_b32 v157, 16, v121
v_and_b32 v121, s97, v121
v_mfma_f32_16x16x32_bf16 a[248:251], a[244:247], v[140:143], a[248:251]
v_lshlrev_b32 v158, 16, v122
v_and_b32 v122, s97, v122
v_mfma_f32_16x16x32_bf16 v[160:163], v[140:143], v[140:143], v[160:163]
v_lshlrev_b32 v159, 16, v123
v_and_b32 v123, s97, v123
v_lshlrev_b32 v164, 16, v124
v_and_b32 v124, s97, v124
v_lshlrev_b32 v165, 16, v125
v_and_b32 v125, s97, v125
v_lshlrev_b32 v166, 16, v126
v_and_b32 v126, s97, v126
v_lshlrev_b32 v167, 16, v127
v_and_b32 v127, s97, v127
s_waitcnt lgkmcnt(2)
v_mul_f32 v247, 0x3ae38e39, v247
v_sub_f32 v247, v247, v246
v_max_f32 v247, 0, v247
v_cvt_pk_bf16_f32 v247, 0, v247
v_add_f32 v247, 0x3727c5ac, v247
v_cvt_pk_bf16_f32 v247, 0, v247
v_sqrt_f32 v247, v247
s_nop 0
v_cvt_pk_bf16_f32 v247, 0, v247
v_rcp_f32 v246, v247
s_nop 0
v_mul_f32 v230, 0xbfb8aa3b, v246
v_mul_f32 v231, v232, v230
s_addk_i32 m0, 0x2000
s_add_u32 s54, s100, s64
buffer_load_dwordx4 v250, s[4:7], s54 offen  lds
buffer_load_dwordx4 v249, s[4:7], s54 offen offset:1024  lds
s_waitcnt vmcnt(8)
ds_read_b128 v[168:171], v245 offset:40960
ds_read_b128 v[172:175], v244 offset:40960
s_waitcnt lgkmcnt(2)
v_mfma_f32_16x16x32_bf16 a[248:251], a[244:247], v[20:23], a[248:251]
v_mfma_f32_16x16x32_bf16 v[160:163], v[20:23], v[20:23], v[160:163]
v_mfma_f32_16x16x32_bf16 a[248:251], a[244:247], v[152:155], a[248:251]
v_mfma_f32_16x16x32_bf16 v[160:163], v[152:155], v[152:155], v[160:163]
s_nop 0
v_pk_fma_f32 v[32:33], v[32:33], v[230:231], v[230:231] op_sel:[0,0,1] op_sel_hi:[1,0,1] neg_lo:[0,0,1] neg_hi:[0,0,1]
v_pk_fma_f32 v[34:35], v[34:35], v[230:231], v[230:231] op_sel:[0,0,1] op_sel_hi:[1,0,1] neg_lo:[0,0,1] neg_hi:[0,0,1]
v_pk_fma_f32 v[4:5], v[4:5], v[230:231], v[230:231] op_sel:[0,0,1] op_sel_hi:[1,0,1] neg_lo:[0,0,1] neg_hi:[0,0,1]
v_pk_fma_f32 v[6:7], v[6:7], v[230:231], v[230:231] op_sel:[0,0,1] op_sel_hi:[1,0,1] neg_lo:[0,0,1] neg_hi:[0,0,1]
v_pk_fma_f32 v[36:37], v[36:37], v[230:231], v[230:231] op_sel:[0,0,1] op_sel_hi:[1,0,1] neg_lo:[0,0,1] neg_hi:[0,0,1]
v_pk_fma_f32 v[38:39], v[38:39], v[230:231], v[230:231] op_sel:[0,0,1] op_sel_hi:[1,0,1] neg_lo:[0,0,1] neg_hi:[0,0,1]
v_pk_fma_f32 v[8:9], v[8:9], v[230:231], v[230:231] op_sel:[0,0,1] op_sel_hi:[1,0,1] neg_lo:[0,0,1] neg_hi:[0,0,1]
v_pk_fma_f32 v[10:11], v[10:11], v[230:231], v[230:231] op_sel:[0,0,1] op_sel_hi:[1,0,1] neg_lo:[0,0,1] neg_hi:[0,0,1]
v_cvt_pk_bf16_f32 v4, v32, v4
v_cvt_pk_bf16_f32 v5, v33, v5
v_cvt_pk_bf16_f32 v6, v34, v6
v_cvt_pk_bf16_f32 v7, v35, v7
v_cvt_pk_bf16_f32 v8, v36, v8
v_cvt_pk_bf16_f32 v9, v37, v9
v_cvt_pk_bf16_f32 v10, v38, v10
v_cvt_pk_bf16_f32 v11, v39, v11
s_addk_i32 m0, 0x2000
s_add_u32 s54, s100, s65
buffer_load_dwordx4 v250, s[4:7], s54 offen  lds
buffer_load_dwordx4 v249, s[4:7], s54 offen offset:1024  lds
s_waitcnt vmcnt(8)
ds_read_b128 v[32:35], v243 offset:0
ds_read_b128 v[36:39], v242 offset:0
s_waitcnt lgkmcnt(2)
v_mfma_f32_16x16x32_bf16 a[248:251], a[244:247], v[168:171], a[248:251]
v_lshlrev_b32 v176, 16, v136
v_and_b32 v136, s97, v136
v_mfma_f32_16x16x32_bf16 v[160:163], v[168:171], v[168:171], v[160:163]
v_lshlrev_b32 v177, 16, v137
v_and_b32 v137, s97, v137
v_mfma_f32_16x16x32_bf16 a[248:251], a[244:247], v[172:175], a[248:251]
v_lshlrev_b32 v178, 16, v138
v_and_b32 v138, s97, v138
v_mfma_f32_16x16x32_bf16 v[160:163], v[172:175], v[172:175], v[160:163]
v_lshlrev_b32 v179, 16, v139
v_and_b32 v139, s97, v139
v_lshlrev_b32 v180, 16, v140
v_and_b32 v140, s97, v140
v_lshlrev_b32 v181, 16, v141
v_and_b32 v141, s97, v141
v_lshlrev_b32 v182, 16, v142
v_and_b32 v142, s97, v142
v_lshlrev_b32 v183, 16, v143
v_and_b32 v143, s97, v143
v_pk_fma_f32 v[48:49], v[48:49], v[230:231], v[230:231] op_sel:[0,0,1] op_sel_hi:[1,0,1] neg_lo:[0,0,1] neg_hi:[0,0,1]
v_pk_fma_f32 v[50:51], v[50:51], v[230:231], v[230:231] op_sel:[0,0,1] op_sel_hi:[1,0,1] neg_lo:[0,0,1] neg_hi:[0,0,1]
v_pk_fma_f32 v[12:13], v[12:13], v[230:231], v[230:231] op_sel:[0,0,1] op_sel_hi:[1,0,1] neg_lo:[0,0,1] neg_hi:[0,0,1]
v_pk_fma_f32 v[14:15], v[14:15], v[230:231], v[230:231] op_sel:[0,0,1] op_sel_hi:[1,0,1] neg_lo:[0,0,1] neg_hi:[0,0,1]
v_pk_fma_f32 v[52:53], v[52:53], v[230:231], v[230:231] op_sel:[0,0,1] op_sel_hi:[1,0,1] neg_lo:[0,0,1] neg_hi:[0,0,1]
v_pk_fma_f32 v[54:55], v[54:55], v[230:231], v[230:231] op_sel:[0,0,1] op_sel_hi:[1,0,1] neg_lo:[0,0,1] neg_hi:[0,0,1]
v_pk_fma_f32 v[16:17], v[16:17], v[230:231], v[230:231] op_sel:[0,0,1] op_sel_hi:[1,0,1] neg_lo:[0,0,1] neg_hi:[0,0,1]
v_pk_fma_f32 v[18:19], v[18:19], v[230:231], v[230:231] op_sel:[0,0,1] op_sel_hi:[1,0,1] neg_lo:[0,0,1] neg_hi:[0,0,1]
v_cvt_pk_bf16_f32 v12, v48, v12
v_cvt_pk_bf16_f32 v13, v49, v13
v_cvt_pk_bf16_f32 v14, v50, v14
v_cvt_pk_bf16_f32 v15, v51, v15
v_cvt_pk_bf16_f32 v16, v52, v16
v_cvt_pk_bf16_f32 v17, v53, v17
v_cvt_pk_bf16_f32 v18, v54, v18
v_cvt_pk_bf16_f32 v19, v55, v19
s_addk_i32 m0, 0x2000
s_add_u32 s54, s100, s66
buffer_load_dwordx4 v250, s[4:7], s54 offen  lds
buffer_load_dwordx4 v249, s[4:7], s54 offen offset:1024  lds
s_waitcnt vmcnt(8)
ds_read_b128 v[48:51], v243 offset:8192
ds_read_b128 v[52:55], v242 offset:8192
s_waitcnt lgkmcnt(2)
v_mfma_f32_16x16x32_bf16 a[248:251], a[244:247], v[32:35], a[248:251]
v_lshlrev_b32 v184, 16, v20
v_and_b32 v20, s97, v20
v_mfma_f32_16x16x32_bf16 v[160:163], v[32:35], v[32:35], v[160:163]
v_lshlrev_b32 v185, 16, v21
v_and_b32 v21, s97, v21
v_mfma_f32_16x16x32_bf16 a[248:251], a[244:247], v[36:39], a[248:251]
v_lshlrev_b32 v186, 16, v22
v_and_b32 v22, s97, v22
v_mfma_f32_16x16x32_bf16 v[160:163], v[36:39], v[36:39], v[160:163]
v_lshlrev_b32 v187, 16, v23
v_and_b32 v23, s97, v23
v_lshlrev_b32 v188, 16, v152
v_and_b32 v152, s97, v152
v_lshlrev_b32 v189, 16, v153
v_and_b32 v153, s97, v153
v_lshlrev_b32 v190, 16, v154
v_and_b32 v154, s97, v154
v_lshlrev_b32 v191, 16, v155
v_and_b32 v155, s97, v155
v_pk_fma_f32 v[64:65], v[64:65], v[230:231], v[230:231] op_sel:[0,0,1] op_sel_hi:[1,0,1] neg_lo:[0,0,1] neg_hi:[0,0,1]
v_pk_fma_f32 v[66:67], v[66:67], v[230:231], v[230:231] op_sel:[0,0,1] op_sel_hi:[1,0,1] neg_lo:[0,0,1] neg_hi:[0,0,1]
v_pk_fma_f32 v[24:25], v[24:25], v[230:231], v[230:231] op_sel:[0,0,1] op_sel_hi:[1,0,1] neg_lo:[0,0,1] neg_hi:[0,0,1]
v_pk_fma_f32 v[26:27], v[26:27], v[230:231], v[230:231] op_sel:[0,0,1] op_sel_hi:[1,0,1] neg_lo:[0,0,1] neg_hi:[0,0,1]
v_pk_fma_f32 v[68:69], v[68:69], v[230:231], v[230:231] op_sel:[0,0,1] op_sel_hi:[1,0,1] neg_lo:[0,0,1] neg_hi:[0,0,1]
v_pk_fma_f32 v[70:71], v[70:71], v[230:231], v[230:231] op_sel:[0,0,1] op_sel_hi:[1,0,1] neg_lo:[0,0,1] neg_hi:[0,0,1]
v_pk_fma_f32 v[28:29], v[28:29], v[230:231], v[230:231] op_sel:[0,0,1] op_sel_hi:[1,0,1] neg_lo:[0,0,1] neg_hi:[0,0,1]
v_pk_fma_f32 v[30:31], v[30:31], v[230:231], v[230:231] op_sel:[0,0,1] op_sel_hi:[1,0,1] neg_lo:[0,0,1] neg_hi:[0,0,1]
v_cvt_pk_bf16_f32 v24, v64, v24
v_cvt_pk_bf16_f32 v25, v65, v25
v_cvt_pk_bf16_f32 v26, v66, v26
v_cvt_pk_bf16_f32 v27, v67, v27
v_cvt_pk_bf16_f32 v28, v68, v28
v_cvt_pk_bf16_f32 v29, v69, v29
v_cvt_pk_bf16_f32 v30, v70, v30
v_cvt_pk_bf16_f32 v31, v71, v31
s_mul_i32 s54, s58, 4608
s_add_u32 s54, s54, s68
s_mov_b32 m0, s53
s_nop 0
buffer_load_dwordx4 v254, s[8:11], s54 offen  lds
buffer_load_dwordx4 v253, s[8:11], s54 offen offset:1024  lds
s_waitcnt vmcnt(8)
ds_read_b128 v[64:67], v243 offset:16384
ds_read_b128 v[68:71], v242 offset:16384
s_waitcnt lgkmcnt(2)
v_mfma_f32_16x16x32_bf16 a[248:251], a[244:247], v[48:51], a[248:251]
v_lshlrev_b32 v192, 16, v168
v_and_b32 v168, s97, v168
v_mfma_f32_16x16x32_bf16 v[160:163], v[48:51], v[48:51], v[160:163]
v_lshlrev_b32 v193, 16, v169
v_and_b32 v169, s97, v169
v_mfma_f32_16x16x32_bf16 a[248:251], a[244:247], v[52:55], a[248:251]
v_lshlrev_b32 v194, 16, v170
v_and_b32 v170, s97, v170
v_mfma_f32_16x16x32_bf16 v[160:163], v[52:55], v[52:55], v[160:163]
v_lshlrev_b32 v195, 16, v171
v_and_b32 v171, s97, v171
v_lshlrev_b32 v196, 16, v172
v_and_b32 v172, s97, v172
v_lshlrev_b32 v197, 16, v173
v_and_b32 v173, s97, v173
v_lshlrev_b32 v198, 16, v174
v_and_b32 v174, s97, v174
v_lshlrev_b32 v199, 16, v175
v_and_b32_e64 v175, s97, v175
v_pk_fma_f32 v[80:81], v[80:81], v[230:231], v[230:231] op_sel:[0,0,1] op_sel_hi:[1,0,1] neg_lo:[0,0,1] neg_hi:[0,0,1]
v_pk_fma_f32 v[82:83], v[82:83], v[230:231], v[230:231] op_sel:[0,0,1] op_sel_hi:[1,0,1] neg_lo:[0,0,1] neg_hi:[0,0,1]
v_pk_fma_f32 v[40:41], v[40:41], v[230:231], v[230:231] op_sel:[0,0,1] op_sel_hi:[1,0,1] neg_lo:[0,0,1] neg_hi:[0,0,1]
v_pk_fma_f32 v[42:43], v[42:43], v[230:231], v[230:231] op_sel:[0,0,1] op_sel_hi:[1,0,1] neg_lo:[0,0,1] neg_hi:[0,0,1]
v_pk_fma_f32 v[84:85], v[84:85], v[230:231], v[230:231] op_sel:[0,0,1] op_sel_hi:[1,0,1] neg_lo:[0,0,1] neg_hi:[0,0,1]
v_pk_fma_f32 v[86:87], v[86:87], v[230:231], v[230:231] op_sel:[0,0,1] op_sel_hi:[1,0,1] neg_lo:[0,0,1] neg_hi:[0,0,1]
v_pk_fma_f32 v[44:45], v[44:45], v[230:231], v[230:231] op_sel:[0,0,1] op_sel_hi:[1,0,1] neg_lo:[0,0,1] neg_hi:[0,0,1]
v_pk_fma_f32 v[46:47], v[46:47], v[230:231], v[230:231] op_sel:[0,0,1] op_sel_hi:[1,0,1] neg_lo:[0,0,1] neg_hi:[0,0,1]
v_cvt_pk_bf16_f32 v40, v80, v40
v_cvt_pk_bf16_f32 v41, v81, v41
v_cvt_pk_bf16_f32 v42, v82, v42
v_cvt_pk_bf16_f32 v43, v83, v43
v_cvt_pk_bf16_f32 v44, v84, v44
v_cvt_pk_bf16_f32 v45, v85, v45
v_cvt_pk_bf16_f32 v46, v86, v46
v_cvt_pk_bf16_f32 v47, v87, v47
s_mul_i32 s55, s59, 4608
s_add_u32 s55, s55, s68
s_addk_i32 m0, 0x2000
s_nop 0
buffer_load_dwordx4 v254, s[8:11], s55 offen  lds
buffer_load_dwordx4 v253, s[8:11], s55 offen offset:1024  lds
s_waitcnt vmcnt(8)
ds_read_b128 v[80:83], v243 offset:24576
ds_read_b128 v[84:87], v242 offset:24576
s_waitcnt lgkmcnt(2)
v_mfma_f32_16x16x32_bf16 a[248:251], a[244:247], v[64:67], a[248:251]
v_lshlrev_b32 v200, 16, v32
v_and_b32 v32, s97, v32
v_mfma_f32_16x16x32_bf16 v[160:163], v[64:67], v[64:67], v[160:163]
v_lshlrev_b32 v201, 16, v33
v_and_b32 v33, s97, v33
v_mfma_f32_16x16x32_bf16 a[248:251], a[244:247], v[68:71], a[248:251]
v_lshlrev_b32 v202, 16, v34
v_and_b32 v34, s97, v34
v_mfma_f32_16x16x32_bf16 v[160:163], v[68:71], v[68:71], v[160:163]
v_lshlrev_b32 v203, 16, v35
v_and_b32 v35, s97, v35
v_lshlrev_b32 v204, 16, v36
v_and_b32 v36, s97, v36
v_lshlrev_b32 v205, 16, v37
v_and_b32 v37, s97, v37
v_lshlrev_b32 v206, 16, v38
v_and_b32 v38, s97, v38
v_lshlrev_b32 v207, 16, v39
v_and_b32_e64 v39, s97, v39
v_pk_fma_f32 v[96:97], v[96:97], v[230:231], v[230:231] op_sel:[0,0,1] op_sel_hi:[1,0,1] neg_lo:[0,0,1] neg_hi:[0,0,1]
v_pk_fma_f32 v[98:99], v[98:99], v[230:231], v[230:231] op_sel:[0,0,1] op_sel_hi:[1,0,1] neg_lo:[0,0,1] neg_hi:[0,0,1]
v_pk_fma_f32 v[56:57], v[56:57], v[230:231], v[230:231] op_sel:[0,0,1] op_sel_hi:[1,0,1] neg_lo:[0,0,1] neg_hi:[0,0,1]
v_pk_fma_f32 v[58:59], v[58:59], v[230:231], v[230:231] op_sel:[0,0,1] op_sel_hi:[1,0,1] neg_lo:[0,0,1] neg_hi:[0,0,1]
v_pk_fma_f32 v[100:101], v[100:101], v[230:231], v[230:231] op_sel:[0,0,1] op_sel_hi:[1,0,1] neg_lo:[0,0,1] neg_hi:[0,0,1]
v_pk_fma_f32 v[102:103], v[102:103], v[230:231], v[230:231] op_sel:[0,0,1] op_sel_hi:[1,0,1] neg_lo:[0,0,1] neg_hi:[0,0,1]
v_pk_fma_f32 v[60:61], v[60:61], v[230:231], v[230:231] op_sel:[0,0,1] op_sel_hi:[1,0,1] neg_lo:[0,0,1] neg_hi:[0,0,1]
v_pk_fma_f32 v[62:63], v[62:63], v[230:231], v[230:231] op_sel:[0,0,1] op_sel_hi:[1,0,1] neg_lo:[0,0,1] neg_hi:[0,0,1]
v_cvt_pk_bf16_f32 v56, v96, v56
v_cvt_pk_bf16_f32 v57, v97, v57
v_cvt_pk_bf16_f32 v58, v98, v58
v_cvt_pk_bf16_f32 v59, v99, v59
v_cvt_pk_bf16_f32 v60, v100, v60
v_cvt_pk_bf16_f32 v61, v101, v61
v_cvt_pk_bf16_f32 v62, v102, v62
v_cvt_pk_bf16_f32 v63, v103, v63
s_mul_i32 s54, s60, 4608
s_add_u32 s54, s54, s68
s_addk_i32 m0, 0x2000
s_nop 0
buffer_load_dwordx4 v254, s[8:11], s54 offen  lds
buffer_load_dwordx4 v253, s[8:11], s54 offen offset:1024  lds
s_waitcnt vmcnt(8)
ds_read_b128 v[96:99], v243 offset:32768
ds_read_b128 v[100:103], v242 offset:32768
s_waitcnt lgkmcnt(2)
v_mfma_f32_16x16x32_bf16 a[248:251], a[244:247], v[80:83], a[248:251]
v_lshlrev_b32 v208, 16, v48
v_and_b32 v48, s97, v48
v_mfma_f32_16x16x32_bf16 v[160:163], v[80:83], v[80:83], v[160:163]
v_lshlrev_b32 v209, 16, v49
v_and_b32 v49, s97, v49
v_mfma_f32_16x16x32_bf16 a[248:251], a[244:247], v[84:87], a[248:251]
v_lshlrev_b32 v210, 16, v50
v_and_b32 v50, s97, v50
v_mfma_f32_16x16x32_bf16 v[160:163], v[84:87], v[84:87], v[160:163]
v_lshlrev_b32 v211, 16, v51
v_and_b32 v51, s97, v51
v_lshlrev_b32 v212, 16, v52
v_and_b32 v52, s97, v52
v_lshlrev_b32 v213, 16, v53
v_and_b32 v53, s97, v53
v_lshlrev_b32 v214, 16, v54
v_and_b32 v54, s97, v54
v_lshlrev_b32 v215, 16, v55
v_and_b32_e64 v55, s97, v55
v_pk_fma_f32 v[112:113], v[112:113], v[230:231], v[230:231] op_sel:[0,0,1] op_sel_hi:[1,0,1] neg_lo:[0,0,1] neg_hi:[0,0,1]
v_pk_fma_f32 v[114:115], v[114:115], v[230:231], v[230:231] op_sel:[0,0,1] op_sel_hi:[1,0,1] neg_lo:[0,0,1] neg_hi:[0,0,1]
v_pk_fma_f32 v[72:73], v[72:73], v[230:231], v[230:231] op_sel:[0,0,1] op_sel_hi:[1,0,1] neg_lo:[0,0,1] neg_hi:[0,0,1]
v_pk_fma_f32 v[74:75], v[74:75], v[230:231], v[230:231] op_sel:[0,0,1] op_sel_hi:[1,0,1] neg_lo:[0,0,1] neg_hi:[0,0,1]
v_pk_fma_f32 v[116:117], v[116:117], v[230:231], v[230:231] op_sel:[0,0,1] op_sel_hi:[1,0,1] neg_lo:[0,0,1] neg_hi:[0,0,1]
v_pk_fma_f32 v[118:119], v[118:119], v[230:231], v[230:231] op_sel:[0,0,1] op_sel_hi:[1,0,1] neg_lo:[0,0,1] neg_hi:[0,0,1]
v_pk_fma_f32 v[76:77], v[76:77], v[230:231], v[230:231] op_sel:[0,0,1] op_sel_hi:[1,0,1] neg_lo:[0,0,1] neg_hi:[0,0,1]
v_pk_fma_f32 v[78:79], v[78:79], v[230:231], v[230:231] op_sel:[0,0,1] op_sel_hi:[1,0,1] neg_lo:[0,0,1] neg_hi:[0,0,1]
v_cvt_pk_bf16_f32 v72, v112, v72
v_cvt_pk_bf16_f32 v73, v113, v73
v_cvt_pk_bf16_f32 v74, v114, v74
v_cvt_pk_bf16_f32 v75, v115, v75
v_cvt_pk_bf16_f32 v76, v116, v76
v_cvt_pk_bf16_f32 v77, v117, v77
v_cvt_pk_bf16_f32 v78, v118, v78
v_cvt_pk_bf16_f32 v79, v119, v79
s_mul_i32 s55, s61, 4608
s_add_u32 s55, s55, s68
s_addk_i32 m0, 0x2000
s_nop 0
buffer_load_dwordx4 v254, s[8:11], s55 offen  lds
buffer_load_dwordx4 v253, s[8:11], s55 offen offset:1024  lds
s_waitcnt vmcnt(8)
ds_read_b128 v[112:115], v243 offset:40960
ds_read_b128 v[116:119], v242 offset:40960
global_load_dwordx2 a[240:241], v239, s[84:85]
global_load_dwordx2 a[242:243], v239, s[84:85] offset:32
v_add_u32 v240, 73728, v240
v_xor_b32 v241, 32, v240
ds_read_b64 a[232:233], v240
ds_read_b64 a[236:237], v241
s_waitcnt lgkmcnt(4)
v_mfma_f32_16x16x32_bf16 a[248:251], a[244:247], v[96:99], a[248:251]
v_lshlrev_b32 v216, 16, v64
v_and_b32 v64, s97, v64
v_mfma_f32_16x16x32_bf16 v[160:163], v[96:99], v[96:99], v[160:163]
v_lshlrev_b32 v217, 16, v65
v_and_b32 v65, s97, v65
v_mfma_f32_16x16x32_bf16 a[248:251], a[244:247], v[100:103], a[248:251]
v_lshlrev_b32 v218, 16, v66
v_and_b32 v66, s97, v66
v_mfma_f32_16x16x32_bf16 v[160:163], v[100:103], v[100:103], v[160:163]
v_lshlrev_b32 v219, 16, v67
v_and_b32 v67, s97, v67
v_lshlrev_b32 v220, 16, v68
v_and_b32 v68, s97, v68
v_lshlrev_b32 v221, 16, v69
v_and_b32 v69, s97, v69
v_lshlrev_b32 v222, 16, v70
v_and_b32 v70, s97, v70
v_lshlrev_b32 v223, 16, v71
v_and_b32 v71, s97, v71
v_pk_fma_f32 v[128:129], v[128:129], v[230:231], v[230:231] op_sel:[0,0,1] op_sel_hi:[1,0,1] neg_lo:[0,0,1] neg_hi:[0,0,1]
v_pk_fma_f32 v[130:131], v[130:131], v[230:231], v[230:231] op_sel:[0,0,1] op_sel_hi:[1,0,1] neg_lo:[0,0,1] neg_hi:[0,0,1]
v_pk_fma_f32 v[88:89], v[88:89], v[230:231], v[230:231] op_sel:[0,0,1] op_sel_hi:[1,0,1] neg_lo:[0,0,1] neg_hi:[0,0,1]
v_pk_fma_f32 v[90:91], v[90:91], v[230:231], v[230:231] op_sel:[0,0,1] op_sel_hi:[1,0,1] neg_lo:[0,0,1] neg_hi:[0,0,1]
v_pk_fma_f32 v[132:133], v[132:133], v[230:231], v[230:231] op_sel:[0,0,1] op_sel_hi:[1,0,1] neg_lo:[0,0,1] neg_hi:[0,0,1]
v_pk_fma_f32 v[134:135], v[134:135], v[230:231], v[230:231] op_sel:[0,0,1] op_sel_hi:[1,0,1] neg_lo:[0,0,1] neg_hi:[0,0,1]
v_pk_fma_f32 v[92:93], v[92:93], v[230:231], v[230:231] op_sel:[0,0,1] op_sel_hi:[1,0,1] neg_lo:[0,0,1] neg_hi:[0,0,1]
v_pk_fma_f32 v[94:95], v[94:95], v[230:231], v[230:231] op_sel:[0,0,1] op_sel_hi:[1,0,1] neg_lo:[0,0,1] neg_hi:[0,0,1]
v_cvt_pk_bf16_f32 v88, v128, v88
v_cvt_pk_bf16_f32 v89, v129, v89
v_cvt_pk_bf16_f32 v90, v130, v90
v_cvt_pk_bf16_f32 v91, v131, v91
v_cvt_pk_bf16_f32 v92, v132, v92
v_cvt_pk_bf16_f32 v93, v133, v93
v_cvt_pk_bf16_f32 v94, v134, v94
v_cvt_pk_bf16_f32 v95, v135, v95
s_mul_i32 s54, s62, 4608
s_add_u32 s54, s54, s68
s_addk_i32 m0, 0x2000
s_nop 0
buffer_load_dwordx4 v254, s[8:11], s54 offen  lds
buffer_load_dwordx4 v253, s[8:11], s54 offen offset:1024  lds
s_waitcnt lgkmcnt(2)
v_mfma_f32_16x16x32_bf16 a[248:251], a[244:247], v[112:115], a[248:251]
LF_p1:
s_cbranch_execz LF
v_lshlrev_b32 v128, 16, v80
v_and_b32 v80, s97, v80
v_mfma_f32_16x16x32_bf16 v[160:163], v[112:115], v[112:115], v[160:163]
v_lshlrev_b32 v129, 16, v81
v_and_b32 v81, s97, v81
v_mfma_f32_16x16x32_bf16 a[248:251], a[244:247], v[116:119], a[248:251]
v_lshlrev_b32 v130, 16, v82
v_and_b32 v82, s97, v82
v_mfma_f32_16x16x32_bf16 v[160:163], v[116:119], v[116:119], v[160:163]
v_lshlrev_b32 v131, 16, v83
v_and_b32 v83, s97, v83
v_lshlrev_b32 v132, 16, v84
v_and_b32 v84, s97, v84
v_lshlrev_b32 v133, 16, v85
v_and_b32 v85, s97, v85
v_lshlrev_b32 v134, 16, v86
v_and_b32 v86, s97, v86
v_lshlrev_b32 v135, 16, v87
v_and_b32_e64 v87, s97, v87
v_pk_fma_f32 v[144:145], v[144:145], v[230:231], v[230:231] op_sel:[0,0,1] op_sel_hi:[1,0,1] neg_lo:[0,0,1] neg_hi:[0,0,1]
v_pk_fma_f32 v[146:147], v[146:147], v[230:231], v[230:231] op_sel:[0,0,1] op_sel_hi:[1,0,1] neg_lo:[0,0,1] neg_hi:[0,0,1]
v_pk_fma_f32 v[104:105], v[104:105], v[230:231], v[230:231] op_sel:[0,0,1] op_sel_hi:[1,0,1] neg_lo:[0,0,1] neg_hi:[0,0,1]
v_pk_fma_f32 v[106:107], v[106:107], v[230:231], v[230:231] op_sel:[0,0,1] op_sel_hi:[1,0,1] neg_lo:[0,0,1] neg_hi:[0,0,1]
v_pk_fma_f32 v[148:149], v[148:149], v[230:231], v[230:231] op_sel:[0,0,1] op_sel_hi:[1,0,1] neg_lo:[0,0,1] neg_hi:[0,0,1]
v_pk_fma_f32 v[150:151], v[150:151], v[230:231], v[230:231] op_sel:[0,0,1] op_sel_hi:[1,0,1] neg_lo:[0,0,1] neg_hi:[0,0,1]
v_pk_fma_f32 v[108:109], v[108:109], v[230:231], v[230:231] op_sel:[0,0,1] op_sel_hi:[1,0,1] neg_lo:[0,0,1] neg_hi:[0,0,1]
v_pk_fma_f32 v[110:111], v[110:111], v[230:231], v[230:231] op_sel:[0,0,1] op_sel_hi:[1,0,1] neg_lo:[0,0,1] neg_hi:[0,0,1]
v_cvt_pk_bf16_f32 v104, v144, v104
v_cvt_pk_bf16_f32 v105, v145, v105
v_cvt_pk_bf16_f32 v106, v146, v106
v_cvt_pk_bf16_f32 v107, v147, v107
v_cvt_pk_bf16_f32 v108, v148, v108
v_cvt_pk_bf16_f32 v109, v149, v109
v_cvt_pk_bf16_f32 v110, v150, v110
v_cvt_pk_bf16_f32 v111, v151, v111
v_cndmask_b32 v250, v160, v161, s[88:89]
v_cndmask_b32 v250, v250, v162, s[90:91]
v_cndmask_b32 v250, v250, v163, s[92:93]
ds_bpermute_b32 v250, v236, v250
v_accvgpr_read_b32 v249, a248
v_mul_f32 v249, 0x3ae38e39, v249
v_cvt_pk_bf16_f32 v247, 0, v249
v_mul_f32_e64 v249, v249, v249
v_pk_fma_f32 v[156:157], v[156:157], v[230:231], v[230:231] op_sel:[0,0,1] op_sel_hi:[1,0,1] neg_lo:[0,0,1] neg_hi:[0,0,1]
v_pk_fma_f32 v[158:159], v[158:159], v[230:231], v[230:231] op_sel:[0,0,1] op_sel_hi:[1,0,1] neg_lo:[0,0,1] neg_hi:[0,0,1]
v_pk_fma_f32 v[120:121], v[120:121], v[230:231], v[230:231] op_sel:[0,0,1] op_sel_hi:[1,0,1] neg_lo:[0,0,1] neg_hi:[0,0,1]
v_pk_fma_f32 v[122:123], v[122:123], v[230:231], v[230:231] op_sel:[0,0,1] op_sel_hi:[1,0,1] neg_lo:[0,0,1] neg_hi:[0,0,1]
v_pk_fma_f32 v[164:165], v[164:165], v[230:231], v[230:231] op_sel:[0,0,1] op_sel_hi:[1,0,1] neg_lo:[0,0,1] neg_hi:[0,0,1]
v_pk_fma_f32 v[166:167], v[166:167], v[230:231], v[230:231] op_sel:[0,0,1] op_sel_hi:[1,0,1] neg_lo:[0,0,1] neg_hi:[0,0,1]
v_pk_fma_f32 v[124:125], v[124:125], v[230:231], v[230:231] op_sel:[0,0,1] op_sel_hi:[1,0,1] neg_lo:[0,0,1] neg_hi:[0,0,1]
v_pk_fma_f32 v[126:127], v[126:127], v[230:231], v[230:231] op_sel:[0,0,1] op_sel_hi:[1,0,1] neg_lo:[0,0,1] neg_hi:[0,0,1]
v_cvt_pk_bf16_f32 v120, v156, v120
v_cvt_pk_bf16_f32 v121, v157, v121
v_cvt_pk_bf16_f32 v122, v158, v122
v_cvt_pk_bf16_f32 v123, v159, v123
v_cvt_pk_bf16_f32 v124, v164, v124
v_cvt_pk_bf16_f32 v125, v165, v125
v_cvt_pk_bf16_f32 v126, v166, v126
v_cvt_pk_bf16_f32 v127, v167, v127
v_lshlrev_b32 v144, 16, v96
v_and_b32 v96, s97, v96
v_lshlrev_b32 v145, 16, v97
v_and_b32 v97, s97, v97
v_lshlrev_b32 v146, 16, v98
v_and_b32 v98, s97, v98
v_lshlrev_b32 v147, 16, v99
v_and_b32 v99, s97, v99
v_lshlrev_b32 v148, 16, v100
v_and_b32 v100, s97, v100
v_lshlrev_b32 v149, 16, v101
v_and_b32 v101, s97, v101
v_lshlrev_b32 v150, 16, v102
v_and_b32 v102, s97, v102
v_lshlrev_b32 v151, 16, v103
v_and_b32 v103, s97, v103
s_waitcnt lgkmcnt(0)
v_mul_f32 v250, 0x3ae38e39, v250
v_sub_f32 v250, v250, v249
v_max_f32 v250, 0, v250
v_cvt_pk_bf16_f32 v250, 0, v250
v_add_f32 v250, 0x3727c5ac, v250
v_cvt_pk_bf16_f32 v250, 0, v250
v_sqrt_f32 v250, v250
s_nop 0
v_cvt_pk_bf16_f32 v250, 0, v250
v_rcp_f32 v249, v250
s_nop 0
v_mul_f32 v244, 0xbfb8aa3b, v249
v_mul_f32 v245, v247, v244
s_mul_i32 s55, s63, 4608
s_add_u32 s55, s55, s68
s_addk_i32 m0, 0x2000
s_nop 0
buffer_load_dwordx4 v254, s[8:11], s55 offen  lds
buffer_load_dwordx4 v253, s[8:11], s55 offen offset:1024  lds
s_nop 0
v_pk_fma_f32 v[176:177], v[176:177], v[244:245], v[244:245] op_sel:[0,0,1] op_sel_hi:[1,0,1] neg_lo:[0,0,1] neg_hi:[0,0,1]
v_pk_fma_f32 v[178:179], v[178:179], v[244:245], v[244:245] op_sel:[0,0,1] op_sel_hi:[1,0,1] neg_lo:[0,0,1] neg_hi:[0,0,1]
v_pk_fma_f32 v[136:137], v[136:137], v[244:245], v[244:245] op_sel:[0,0,1] op_sel_hi:[1,0,1] neg_lo:[0,0,1] neg_hi:[0,0,1]
v_pk_fma_f32 v[138:139], v[138:139], v[244:245], v[244:245] op_sel:[0,0,1] op_sel_hi:[1,0,1] neg_lo:[0,0,1] neg_hi:[0,0,1]
v_pk_fma_f32 v[180:181], v[180:181], v[244:245], v[244:245] op_sel:[0,0,1] op_sel_hi:[1,0,1] neg_lo:[0,0,1] neg_hi:[0,0,1]
v_pk_fma_f32 v[182:183], v[182:183], v[244:245], v[244:245] op_sel:[0,0,1] op_sel_hi:[1,0,1] neg_lo:[0,0,1] neg_hi:[0,0,1]
v_pk_fma_f32 v[140:141], v[140:141], v[244:245], v[244:245] op_sel:[0,0,1] op_sel_hi:[1,0,1] neg_lo:[0,0,1] neg_hi:[0,0,1]
v_pk_fma_f32 v[142:143], v[142:143], v[244:245], v[244:245] op_sel:[0,0,1] op_sel_hi:[1,0,1] neg_lo:[0,0,1] neg_hi:[0,0,1]
v_cvt_pk_bf16_f32 v136, v176, v136
v_cvt_pk_bf16_f32 v137, v177, v137
v_cvt_pk_bf16_f32 v138, v178, v138
v_cvt_pk_bf16_f32 v139, v179, v139
v_cvt_pk_bf16_f32 v140, v180, v140
v_cvt_pk_bf16_f32 v141, v181, v141
v_cvt_pk_bf16_f32 v142, v182, v142
v_cvt_pk_bf16_f32 v143, v183, v143
s_mul_i32 s54, s64, 4608
s_add_u32 s54, s54, s68
s_addk_i32 m0, 0x2000
s_nop 0
buffer_load_dwordx4 v254, s[8:11], s54 offen  lds
buffer_load_dwordx4 v253, s[8:11], s54 offen offset:1024  lds
s_nop 0
v_pk_fma_f32 v[184:185], v[184:185], v[244:245], v[244:245] op_sel:[0,0,1] op_sel_hi:[1,0,1] neg_lo:[0,0,1] neg_hi:[0,0,1]
v_pk_fma_f32 v[186:187], v[186:187], v[244:245], v[244:245] op_sel:[0,0,1] op_sel_hi:[1,0,1] neg_lo:[0,0,1] neg_hi:[0,0,1]
v_pk_fma_f32 v[20:21], v[20:21], v[244:245], v[244:245] op_sel:[0,0,1] op_sel_hi:[1,0,1] neg_lo:[0,0,1] neg_hi:[0,0,1]
v_pk_fma_f32 v[22:23], v[22:23], v[244:245], v[244:245] op_sel:[0,0,1] op_sel_hi:[1,0,1] neg_lo:[0,0,1] neg_hi:[0,0,1]
v_pk_fma_f32 v[188:189], v[188:189], v[244:245], v[244:245] op_sel:[0,0,1] op_sel_hi:[1,0,1] neg_lo:[0,0,1] neg_hi:[0,0,1]
v_pk_fma_f32 v[190:191], v[190:191], v[244:245], v[244:245] op_sel:[0,0,1] op_sel_hi:[1,0,1] neg_lo:[0,0,1] neg_hi:[0,0,1]
v_pk_fma_f32 v[152:153], v[152:153], v[244:245], v[244:245] op_sel:[0,0,1] op_sel_hi:[1,0,1] neg_lo:[0,0,1] neg_hi:[0,0,1]
v_pk_fma_f32 v[154:155], v[154:155], v[244:245], v[244:245] op_sel:[0,0,1] op_sel_hi:[1,0,1] neg_lo:[0,0,1] neg_hi:[0,0,1]
v_cvt_pk_bf16_f32 v20, v184, v20
v_cvt_pk_bf16_f32 v21, v185, v21
v_cvt_pk_bf16_f32 v22, v186, v22
v_cvt_pk_bf16_f32 v23, v187, v23
v_cvt_pk_bf16_f32 v152, v188, v152
v_cvt_pk_bf16_f32 v153, v189, v153
v_cvt_pk_bf16_f32 v154, v190, v154
v_cvt_pk_bf16_f32 v155, v191, v155
s_mul_i32 s55, s65, 4608
s_add_u32 s55, s55, s68
s_addk_i32 m0, 0x2000
s_nop 0
buffer_load_dwordx4 v254, s[8:11], s55 offen  lds
buffer_load_dwordx4 v253, s[8:11], s55 offen offset:1024  lds
s_nop 0
v_pk_fma_f32 v[192:193], v[192:193], v[244:245], v[244:245] op_sel:[0,0,1] op_sel_hi:[1,0,1] neg_lo:[0,0,1] neg_hi:[0,0,1]
v_pk_fma_f32 v[194:195], v[194:195], v[244:245], v[244:245] op_sel:[0,0,1] op_sel_hi:[1,0,1] neg_lo:[0,0,1] neg_hi:[0,0,1]
v_pk_fma_f32 v[168:169], v[168:169], v[244:245], v[244:245] op_sel:[0,0,1] op_sel_hi:[1,0,1] neg_lo:[0,0,1] neg_hi:[0,0,1]
v_pk_fma_f32 v[170:171], v[170:171], v[244:245], v[244:245] op_sel:[0,0,1] op_sel_hi:[1,0,1] neg_lo:[0,0,1] neg_hi:[0,0,1]
v_pk_fma_f32 v[196:197], v[196:197], v[244:245], v[244:245] op_sel:[0,0,1] op_sel_hi:[1,0,1] neg_lo:[0,0,1] neg_hi:[0,0,1]
v_pk_fma_f32 v[198:199], v[198:199], v[244:245], v[244:245] op_sel:[0,0,1] op_sel_hi:[1,0,1] neg_lo:[0,0,1] neg_hi:[0,0,1]
v_pk_fma_f32 v[172:173], v[172:173], v[244:245], v[244:245] op_sel:[0,0,1] op_sel_hi:[1,0,1] neg_lo:[0,0,1] neg_hi:[0,0,1]
v_pk_fma_f32 v[174:175], v[174:175], v[244:245], v[244:245] op_sel:[0,0,1] op_sel_hi:[1,0,1] neg_lo:[0,0,1] neg_hi:[0,0,1]
v_cvt_pk_bf16_f32 v168, v192, v168
v_cvt_pk_bf16_f32 v169, v193, v169
v_cvt_pk_bf16_f32 v170, v194, v170
v_cvt_pk_bf16_f32 v171, v195, v171
v_cvt_pk_bf16_f32 v172, v196, v172
v_cvt_pk_bf16_f32 v173, v197, v173
v_cvt_pk_bf16_f32 v174, v198, v174
v_cvt_pk_bf16_f32 v175, v199, v175
v_pk_fma_f32 v[200:201], v[200:201], v[244:245], v[244:245] op_sel:[0,0,1] op_sel_hi:[1,0,1] neg_lo:[0,0,1] neg_hi:[0,0,1]
v_pk_fma_f32 v[202:203], v[202:203], v[244:245], v[244:245] op_sel:[0,0,1] op_sel_hi:[1,0,1] neg_lo:[0,0,1] neg_hi:[0,0,1]
v_pk_fma_f32 v[32:33], v[32:33], v[244:245], v[244:245] op_sel:[0,0,1] op_sel_hi:[1,0,1] neg_lo:[0,0,1] neg_hi:[0,0,1]
v_pk_fma_f32 v[34:35], v[34:35], v[244:245], v[244:245] op_sel:[0,0,1] op_sel_hi:[1,0,1] neg_lo:[0,0,1] neg_hi:[0,0,1]
v_pk_fma_f32 v[204:205], v[204:205], v[244:245], v[244:245] op_sel:[0,0,1] op_sel_hi:[1,0,1] neg_lo:[0,0,1] neg_hi:[0,0,1]
v_pk_fma_f32 v[206:207], v[206:207], v[244:245], v[244:245] op_sel:[0,0,1] op_sel_hi:[1,0,1] neg_lo:[0,0,1] neg_hi:[0,0,1]
v_pk_fma_f32 v[36:37], v[36:37], v[244:245], v[244:245] op_sel:[0,0,1] op_sel_hi:[1,0,1] neg_lo:[0,0,1] neg_hi:[0,0,1]
v_pk_fma_f32 v[38:39], v[38:39], v[244:245], v[244:245] op_sel:[0,0,1] op_sel_hi:[1,0,1] neg_lo:[0,0,1] neg_hi:[0,0,1]
v_cvt_pk_bf16_f32 v32, v200, v32
v_cvt_pk_bf16_f32 v33, v201, v33
v_cvt_pk_bf16_f32 v34, v202, v34
v_cvt_pk_bf16_f32 v35, v203, v35
v_cvt_pk_bf16_f32 v36, v204, v36
v_cvt_pk_bf16_f32 v37, v205, v37
v_cvt_pk_bf16_f32 v38, v206, v38
v_cvt_pk_bf16_f32 v39, v207, v39
v_pk_fma_f32 v[208:209], v[208:209], v[244:245], v[244:245] op_sel:[0,0,1] op_sel_hi:[1,0,1] neg_lo:[0,0,1] neg_hi:[0,0,1]
v_pk_fma_f32 v[210:211], v[210:211], v[244:245], v[244:245] op_sel:[0,0,1] op_sel_hi:[1,0,1] neg_lo:[0,0,1] neg_hi:[0,0,1]
v_pk_fma_f32 v[48:49], v[48:49], v[244:245], v[244:245] op_sel:[0,0,1] op_sel_hi:[1,0,1] neg_lo:[0,0,1] neg_hi:[0,0,1]
v_pk_fma_f32 v[50:51], v[50:51], v[244:245], v[244:245] op_sel:[0,0,1] op_sel_hi:[1,0,1] neg_lo:[0,0,1] neg_hi:[0,0,1]
v_pk_fma_f32 v[212:213], v[212:213], v[244:245], v[244:245] op_sel:[0,0,1] op_sel_hi:[1,0,1] neg_lo:[0,0,1] neg_hi:[0,0,1]
v_pk_fma_f32 v[214:215], v[214:215], v[244:245], v[244:245] op_sel:[0,0,1] op_sel_hi:[1,0,1] neg_lo:[0,0,1] neg_hi:[0,0,1]
v_pk_fma_f32 v[52:53], v[52:53], v[244:245], v[244:245] op_sel:[0,0,1] op_sel_hi:[1,0,1] neg_lo:[0,0,1] neg_hi:[0,0,1]
v_pk_fma_f32 v[54:55], v[54:55], v[244:245], v[244:245] op_sel:[0,0,1] op_sel_hi:[1,0,1] neg_lo:[0,0,1] neg_hi:[0,0,1]
v_cvt_pk_bf16_f32 v48, v208, v48
v_cvt_pk_bf16_f32 v49, v209, v49
v_cvt_pk_bf16_f32 v50, v210, v50
v_cvt_pk_bf16_f32 v51, v211, v51
v_cvt_pk_bf16_f32 v52, v212, v52
v_cvt_pk_bf16_f32 v53, v213, v53
v_cvt_pk_bf16_f32 v54, v214, v54
v_cvt_pk_bf16_f32 v55, v215, v55
s_mov_b64 exec, 0
s_cmp_eq_u32 s50, 0
s_cbranch_scc1 LF_p8
s_cmp_eq_u32 s50, 1
s_cbranch_scc1 LF_p9
s_cmp_eq_u32 s50, 2
s_cbranch_scc1 LF_p10
s_branch LF_p11
LF_v0:
s_mov_b64 exec, -1
s_waitcnt vmcnt(4)
s_barrier
ds_read_b64_tr_b16 a[144:145], v235 offset:0
ds_read_b64_tr_b16 a[146:147], v235 offset:2048
ds_read_b64_tr_b16 a[148:149], v235 offset:4096
ds_read_b64_tr_b16 a[150:151], v235 offset:6144
ds_read_b64_tr_b16 a[152:153], v235 offset:8192
ds_read_b64_tr_b16 a[154:155], v235 offset:10240
ds_read_b64_tr_b16 a[156:157], v235 offset:12288
ds_read_b64_tr_b16 a[158:159], v235 offset:14336
ds_read_b64_tr_b16 a[160:161], v235 offset:16384
ds_read_b64_tr_b16 a[162:163], v235 offset:18432
ds_read_b64_tr_b16 a[164:165], v235 offset:20480
ds_read_b64_tr_b16 a[166:167], v235 offset:22528
s_nop 0
v_pk_fma_f32 v[216:217], v[216:217], v[244:245], v[244:245] op_sel:[0,0,1] op_sel_hi:[1,0,1] neg_lo:[0,0,1] neg_hi:[0,0,1]
v_pk_fma_f32 v[218:219], v[218:219], v[244:245], v[244:245] op_sel:[0,0,1] op_sel_hi:[1,0,1] neg_lo:[0,0,1] neg_hi:[0,0,1]
v_pk_fma_f32 v[64:65], v[64:65], v[244:245], v[244:245] op_sel:[0,0,1] op_sel_hi:[1,0,1] neg_lo:[0,0,1] neg_hi:[0,0,1]
v_pk_fma_f32 v[66:67], v[66:67], v[244:245], v[244:245] op_sel:[0,0,1] op_sel_hi:[1,0,1] neg_lo:[0,0,1] neg_hi:[0,0,1]
v_pk_fma_f32 v[220:221], v[220:221], v[244:245], v[244:245] op_sel:[0,0,1] op_sel_hi:[1,0,1] neg_lo:[0,0,1] neg_hi:[0,0,1]
v_pk_fma_f32 v[222:223], v[222:223], v[244:245], v[244:245] op_sel:[0,0,1] op_sel_hi:[1,0,1] neg_lo:[0,0,1] neg_hi:[0,0,1]
v_pk_fma_f32 v[68:69], v[68:69], v[244:245], v[244:245] op_sel:[0,0,1] op_sel_hi:[1,0,1] neg_lo:[0,0,1] neg_hi:[0,0,1]
v_pk_fma_f32 v[70:71], v[70:71], v[244:245], v[244:245] op_sel:[0,0,1] op_sel_hi:[1,0,1] neg_lo:[0,0,1] neg_hi:[0,0,1]
v_cvt_pk_bf16_f32 v64, v216, v64
v_cvt_pk_bf16_f32 v65, v217, v65
v_cvt_pk_bf16_f32 v66, v218, v66
v_cvt_pk_bf16_f32 v67, v219, v67
v_cvt_pk_bf16_f32 v68, v220, v68
v_cvt_pk_bf16_f32 v69, v221, v69
v_cvt_pk_bf16_f32 v70, v222, v70
v_cvt_pk_bf16_f32 v71, v223, v71
v_pk_fma_f32 v[128:129], v[128:129], v[244:245], v[244:245] op_sel:[0,0,1] op_sel_hi:[1,0,1] neg_lo:[0,0,1] neg_hi:[0,0,1]
v_pk_fma_f32 v[130:131], v[130:131], v[244:245], v[244:245] op_sel:[0,0,1] op_sel_hi:[1,0,1] neg_lo:[0,0,1] neg_hi:[0,0,1]
v_pk_fma_f32 v[80:81], v[80:81], v[244:245], v[244:245] op_sel:[0,0,1] op_sel_hi:[1,0,1] neg_lo:[0,0,1] neg_hi:[0,0,1]
v_pk_fma_f32 v[82:83], v[82:83], v[244:245], v[244:245] op_sel:[0,0,1] op_sel_hi:[1,0,1] neg_lo:[0,0,1] neg_hi:[0,0,1]
v_pk_fma_f32 v[132:133], v[132:133], v[244:245], v[244:245] op_sel:[0,0,1] op_sel_hi:[1,0,1] neg_lo:[0,0,1] neg_hi:[0,0,1]
v_pk_fma_f32 v[134:135], v[134:135], v[244:245], v[244:245] op_sel:[0,0,1] op_sel_hi:[1,0,1] neg_lo:[0,0,1] neg_hi:[0,0,1]
v_pk_fma_f32 v[84:85], v[84:85], v[244:245], v[244:245] op_sel:[0,0,1] op_sel_hi:[1,0,1] neg_lo:[0,0,1] neg_hi:[0,0,1]
v_pk_fma_f32 v[86:87], v[86:87], v[244:245], v[244:245] op_sel:[0,0,1] op_sel_hi:[1,0,1] neg_lo:[0,0,1] neg_hi:[0,0,1]
v_cvt_pk_bf16_f32 v80, v128, v80
v_cvt_pk_bf16_f32 v81, v129, v81
v_cvt_pk_bf16_f32 v82, v130, v82
v_cvt_pk_bf16_f32 v83, v131, v83
v_cvt_pk_bf16_f32 v84, v132, v84
v_cvt_pk_bf16_f32 v85, v133, v85
v_cvt_pk_bf16_f32 v86, v134, v86
v_cvt_pk_bf16_f32 v87, v135, v87
v_pk_fma_f32 v[144:145], v[144:145], v[244:245], v[244:245] op_sel:[0,0,1] op_sel_hi:[1,0,1] neg_lo:[0,0,1] neg_hi:[0,0,1]
v_pk_fma_f32 v[146:147], v[146:147], v[244:245], v[244:245] op_sel:[0,0,1] op_sel_hi:[1,0,1] neg_lo:[0,0,1] neg_hi:[0,0,1]
v_pk_fma_f32 v[96:97], v[96:97], v[244:245], v[244:245] op_sel:[0,0,1] op_sel_hi:[1,0,1] neg_lo:[0,0,1] neg_hi:[0,0,1]
v_pk_fma_f32 v[98:99], v[98:99], v[244:245], v[244:245] op_sel:[0,0,1] op_sel_hi:[1,0,1] neg_lo:[0,0,1] neg_hi:[0,0,1]
v_pk_fma_f32 v[148:149], v[148:149], v[244:245], v[244:245] op_sel:[0,0,1] op_sel_hi:[1,0,1] neg_lo:[0,0,1] neg_hi:[0,0,1]
v_pk_fma_f32 v[150:151], v[150:151], v[244:245], v[244:245] op_sel:[0,0,1] op_sel_hi:[1,0,1] neg_lo:[0,0,1] neg_hi:[0,0,1]
v_pk_fma_f32 v[100:101], v[100:101], v[244:245], v[244:245] op_sel:[0,0,1] op_sel_hi:[1,0,1] neg_lo:[0,0,1] neg_hi:[0,0,1]
v_pk_fma_f32 v[102:103], v[102:103], v[244:245], v[244:245] op_sel:[0,0,1] op_sel_hi:[1,0,1] neg_lo:[0,0,1] neg_hi:[0,0,1]
v_cvt_pk_bf16_f32 v96, v144, v96
v_cvt_pk_bf16_f32 v97, v145, v97
v_cvt_pk_bf16_f32 v98, v146, v98
v_cvt_pk_bf16_f32 v99, v147, v99
v_cvt_pk_bf16_f32 v100, v148, v100
v_cvt_pk_bf16_f32 v101, v149, v101
v_cvt_pk_bf16_f32 v102, v150, v102
v_cvt_pk_bf16_f32 v103, v151, v103
v_lshlrev_b32 v128, 16, v112
v_and_b32 v112, s97, v112
v_lshlrev_b32 v129, 16, v113
v_and_b32 v113, s97, v113
v_lshlrev_b32 v130, 16, v114
v_and_b32 v114, s97, v114
v_lshlrev_b32 v131, 16, v115
v_and_b32 v115, s97, v115
v_lshlrev_b32 v132, 16, v116
v_and_b32 v116, s97, v116
v_lshlrev_b32 v133, 16, v117
v_and_b32 v117, s97, v117
v_lshlrev_b32 v134, 16, v118
v_and_b32 v118, s97, v118
v_lshlrev_b32 v135, 16, v119
v_and_b32 v119, s97, v119
v_pk_fma_f32 v[128:129], v[128:129], v[244:245], v[244:245] op_sel:[0,0,1] op_sel_hi:[1,0,1] neg_lo:[0,0,1] neg_hi:[0,0,1]
v_pk_fma_f32 v[130:131], v[130:131], v[244:245], v[244:245] op_sel:[0,0,1] op_sel_hi:[1,0,1] neg_lo:[0,0,1] neg_hi:[0,0,1]
v_pk_fma_f32 v[112:113], v[112:113], v[244:245], v[244:245] op_sel:[0,0,1] op_sel_hi:[1,0,1] neg_lo:[0,0,1] neg_hi:[0,0,1]
v_pk_fma_f32 v[114:115], v[114:115], v[244:245], v[244:245] op_sel:[0,0,1] op_sel_hi:[1,0,1] neg_lo:[0,0,1] neg_hi:[0,0,1]
v_pk_fma_f32 v[132:133], v[132:133], v[244:245], v[244:245] op_sel:[0,0,1] op_sel_hi:[1,0,1] neg_lo:[0,0,1] neg_hi:[0,0,1]
v_pk_fma_f32 v[134:135], v[134:135], v[244:245], v[244:245] op_sel:[0,0,1] op_sel_hi:[1,0,1] neg_lo:[0,0,1] neg_hi:[0,0,1]
v_pk_fma_f32 v[116:117], v[116:117], v[244:245], v[244:245] op_sel:[0,0,1] op_sel_hi:[1,0,1] neg_lo:[0,0,1] neg_hi:[0,0,1]
v_pk_fma_f32 v[118:119], v[118:119], v[244:245], v[244:245] op_sel:[0,0,1] op_sel_hi:[1,0,1] neg_lo:[0,0,1] neg_hi:[0,0,1]
v_cvt_pk_bf16_f32 v112, v128, v112
v_cvt_pk_bf16_f32 v113, v129, v113
v_cvt_pk_bf16_f32 v114, v130, v114
v_cvt_pk_bf16_f32 v115, v131, v115
v_cvt_pk_bf16_f32 v116, v132, v116
v_cvt_pk_bf16_f32 v117, v133, v117
v_cvt_pk_bf16_f32 v118, v134, v118
v_cvt_pk_bf16_f32 v119, v135, v119
s_waitcnt lgkmcnt(10)
v_mfma_f32_16x16x32_bf16 v[128:131], a[144:147], v[136:139], 0
s_mul_i32 s54, s66, 4608
ds_read_b64_tr_b16 a[168:169], v235 offset:24576
v_add_u32 v250, 49152, v235
s_waitcnt lgkmcnt(9)
v_mfma_f32_16x16x32_bf16 v[128:131], a[148:151], v[140:143], v[128:131]
s_add_u32 s54, s54, s68
ds_read_b64_tr_b16 a[170:171], v235 offset:26624
v_add_u32 v245, 49152, v248
v_mfma_f32_16x16x32_bf16 v[132:135], a[148:151], v[8:11], 0
s_addk_i32 m0, 0x2000
ds_read_b64_tr_b16 a[172:173], v235 offset:28672
v_add_u32 v244, 49152, v234
v_mfma_f32_16x16x32_bf16 v[132:135], a[144:147], v[4:7], v[132:135]
s_waitcnt lgkmcnt(7)
ds_read_b64_tr_b16 a[174:175], v235 offset:30720
buffer_load_dwordx4 v254, s[8:11], s54 offen  lds
v_mfma_f32_16x16x32_bf16 v[132:135], a[152:155], v[12:15], v[132:135]
s_mov_b32 s14, 5308416
ds_read_b64_tr_b16 a[176:177], v235 offset:32768
v_add_u32 v243, 49152, v233
v_mfma_f32_16x16x32_bf16 v[132:135], a[156:159], v[16:19], v[132:135]
s_mov_b32 s15, 0x20000
ds_read_b64_tr_b16 a[178:179], v235 offset:34816
v_accvgpr_write_b32 a0, v136
v_mfma_f32_16x16x32_bf16 v[128:131], a[156:159], v[152:155], v[128:131]
s_mov_b32 s30, 4718592
ds_read_b64_tr_b16 a[180:181], v235 offset:36864
v_accvgpr_write_b32 a1, v137
v_mfma_f32_16x16x32_bf16 v[128:131], a[152:155], v[20:23], v[128:131]
s_waitcnt lgkmcnt(7)
ds_read_b64_tr_b16 a[182:183], v235 offset:38912
buffer_load_dwordx4 v253, s[8:11], s54 offen offset:1024  lds
v_mfma_f32_16x16x32_bf16 v[128:131], a[160:163], v[168:171], v[128:131]
s_mul_i32 s55, s58, 4608
ds_read_b64_tr_b16 a[184:185], v235 offset:40960
v_accvgpr_write_b32 a2, v138
v_mfma_f32_16x16x32_bf16 v[128:131], a[164:167], v[172:175], v[128:131]
s_add_u32 s55, s55, s69
ds_read_b64_tr_b16 a[186:187], v235 offset:43008
v_accvgpr_write_b32 a3, v139
v_mfma_f32_16x16x32_bf16 v[132:135], a[164:167], v[28:31], v[132:135]
s_addk_i32 m0, 0x2000
ds_read_b64_tr_b16 a[188:189], v235 offset:45056
v_accvgpr_write_b32 a4, v4
v_mfma_f32_16x16x32_bf16 v[132:135], a[160:163], v[24:27], v[132:135]
s_waitcnt lgkmcnt(7)
ds_read_b64_tr_b16 a[190:191], v235 offset:47104
buffer_load_dwordx4 v254, s[8:11], s55 offen  lds
v_mfma_f32_16x16x32_bf16 v[132:135], a[168:171], v[40:43], v[132:135]
s_mov_b32 s31, 0x20000
ds_read_b64_tr_b16 a[144:145], v248 offset:0
v_accvgpr_write_b32 a5, v5
v_mfma_f32_16x16x32_bf16 v[132:135], a[172:175], v[44:47], v[132:135]
s_mov_b32 s38, 256
ds_read_b64_tr_b16 a[146:147], v248 offset:2048
v_accvgpr_write_b32 a6, v6
v_mfma_f32_16x16x32_bf16 v[128:131], a[172:175], v[36:39], v[128:131]
s_mov_b32 s39, 0x20000
ds_read_b64_tr_b16 a[148:149], v248 offset:4096
v_accvgpr_write_b32 a7, v7
v_mfma_f32_16x16x32_bf16 v[128:131], a[168:171], v[32:35], v[128:131]
s_waitcnt lgkmcnt(7)
ds_read_b64_tr_b16 a[150:151], v248 offset:6144
buffer_load_dwordx4 v253, s[8:11], s55 offen offset:1024  lds
v_mfma_f32_16x16x32_bf16 v[128:131], a[176:179], v[48:51], v[128:131]
s_mul_i32 s54, s59, 4608
ds_read_b64_tr_b16 a[152:153], v248 offset:8192
v_accvgpr_write_b32 a8, v140
v_mfma_f32_16x16x32_bf16 v[128:131], a[180:183], v[52:55], v[128:131]
s_add_u32 s54, s54, s69
ds_read_b64_tr_b16 a[154:155], v248 offset:10240
v_accvgpr_write_b32 a9, v141
v_mfma_f32_16x16x32_bf16 v[132:135], a[180:183], v[60:63], v[132:135]
s_addk_i32 m0, 0x2000
ds_read_b64_tr_b16 a[156:157], v248 offset:12288
v_accvgpr_write_b32 a10, v142
v_mfma_f32_16x16x32_bf16 v[132:135], a[176:179], v[56:59], v[132:135]
s_waitcnt lgkmcnt(7)
ds_read_b64_tr_b16 a[158:159], v248 offset:14336
buffer_load_dwordx4 v254, s[8:11], s54 offen  lds
v_mfma_f32_16x16x32_bf16 v[132:135], a[184:187], v[72:75], v[132:135]
s_mov_b32 s34, 134217728
ds_read_b64_tr_b16 a[160:161], v248 offset:16384
v_accvgpr_write_b32 a11, v143
v_mfma_f32_16x16x32_bf16 v[132:135], a[188:191], v[76:79], v[132:135]
s_mov_b32 s35, 0x20000
ds_read_b64_tr_b16 a[162:163], v248 offset:18432
v_accvgpr_write_b32 a12, v8
v_mfma_f32_16x16x32_bf16 v[128:131], a[188:191], v[68:71], v[128:131]
s_mov_b32 s46, 245760
ds_read_b64_tr_b16 a[164:165], v248 offset:20480
v_accvgpr_write_b32 a13, v9
v_mfma_f32_16x16x32_bf16 v[128:131], a[184:187], v[64:67], v[128:131]
s_waitcnt lgkmcnt(7)
ds_read_b64_tr_b16 a[166:167], v248 offset:22528
buffer_load_dwordx4 v253, s[8:11], s54 offen offset:1024  lds
v_mfma_f32_16x16x32_bf16 v[144:147], a[144:147], v[136:139], 0
s_mul_i32 s55, s60, 4608
ds_read_b64_tr_b16 a[168:169], v248 offset:24576
v_accvgpr_write_b32 a14, v10
v_mfma_f32_16x16x32_bf16 v[144:147], a[148:151], v[140:143], v[144:147]
s_add_u32 s55, s55, s69
ds_read_b64_tr_b16 a[170:171], v248 offset:26624
v_accvgpr_write_b32 a15, v11
v_mfma_f32_16x16x32_bf16 v[148:151], a[148:151], v[8:11], 0
s_addk_i32 m0, 0x2000
ds_read_b64_tr_b16 a[172:173], v248 offset:28672
v_accvgpr_write_b32 a16, v20
v_mfma_f32_16x16x32_bf16 v[148:151], a[144:147], v[4:7], v[148:151]
s_waitcnt lgkmcnt(7)
ds_read_b64_tr_b16 a[174:175], v248 offset:30720
buffer_load_dwordx4 v254, s[8:11], s55 offen  lds
v_mfma_f32_16x16x32_bf16 v[148:151], a[152:155], v[12:15], v[148:151]
s_mov_b32 s47, 0x20000
ds_read_b64_tr_b16 a[176:177], v248 offset:32768
v_accvgpr_write_b32 a17, v21
v_mfma_f32_16x16x32_bf16 v[148:151], a[156:159], v[16:19], v[148:151]
s_mov_b32 s98, 0x7fff
ds_read_b64_tr_b16 a[178:179], v248 offset:34816
v_accvgpr_write_b32 a18, v22
v_mfma_f32_16x16x32_bf16 v[144:147], a[156:159], v[152:155], v[144:147]
s_mov_b32 s99, 0
ds_read_b64_tr_b16 a[180:181], v248 offset:36864
v_accvgpr_write_b32 a19, v23
v_mfma_f32_16x16x32_bf16 v[144:147], a[152:155], v[20:23], v[144:147]
s_waitcnt lgkmcnt(7)
ds_read_b64_tr_b16 a[182:183], v248 offset:38912
buffer_load_dwordx4 v253, s[8:11], s55 offen offset:1024  lds
v_mfma_f32_16x16x32_bf16 v[144:147], a[160:163], v[168:171], v[144:147]
s_mul_i32 s54, s61, 4608
ds_read_b64_tr_b16 a[184:185], v248 offset:40960
v_accvgpr_write_b32 a20, v12
v_mfma_f32_16x16x32_bf16 v[144:147], a[164:167], v[172:175], v[144:147]
s_add_u32 s54, s54, s69
ds_read_b64_tr_b16 a[186:187], v248 offset:43008
v_accvgpr_write_b32 a21, v13
v_mfma_f32_16x16x32_bf16 v[148:151], a[164:167], v[28:31], v[148:151]
s_addk_i32 m0, 0x2000
ds_read_b64_tr_b16 a[188:189], v248 offset:45056
v_accvgpr_write_b32 a22, v14
v_mfma_f32_16x16x32_bf16 v[148:151], a[160:163], v[24:27], v[148:151]
s_waitcnt lgkmcnt(7)
ds_read_b64_tr_b16 a[190:191], v248 offset:47104
buffer_load_dwordx4 v254, s[8:11], s54 offen  lds
v_mfma_f32_16x16x32_bf16 v[148:151], a[168:171], v[40:43], v[148:151]
s_lshl_b32 s74, s101, 7
ds_read_b64_tr_b16 a[144:145], v234 offset:0
v_accvgpr_write_b32 a23, v15
v_mfma_f32_16x16x32_bf16 v[148:151], a[172:175], v[44:47], v[148:151]
s_add_u32 s86, s51, 1
ds_read_b64_tr_b16 a[146:147], v234 offset:2048
v_accvgpr_write_b32 a24, v152
v_mfma_f32_16x16x32_bf16 v[144:147], a[172:175], v[36:39], v[144:147]
s_and_b32 s86, s86, 7
ds_read_b64_tr_b16 a[148:149], v234 offset:4096
v_accvgpr_write_b32 a25, v153
v_mfma_f32_16x16x32_bf16 v[144:147], a[168:171], v[32:35], v[144:147]
s_waitcnt lgkmcnt(7)
ds_read_b64_tr_b16 a[150:151], v234 offset:6144
buffer_load_dwordx4 v253, s[8:11], s54 offen offset:1024  lds
v_mfma_f32_16x16x32_bf16 v[144:147], a[176:179], v[48:51], v[144:147]
s_mul_i32 s55, s62, 4608
ds_read_b64_tr_b16 a[152:153], v234 offset:8192
v_accvgpr_write_b32 a26, v154
v_mfma_f32_16x16x32_bf16 v[144:147], a[180:183], v[52:55], v[144:147]
s_add_u32 s55, s55, s69
ds_read_b64_tr_b16 a[154:155], v234 offset:10240
v_accvgpr_write_b32 a27, v155
v_mfma_f32_16x16x32_bf16 v[148:151], a[180:183], v[60:63], v[148:151]
s_addk_i32 m0, 0x2000
ds_read_b64_tr_b16 a[156:157], v234 offset:12288
v_accvgpr_write_b32 a28, v16
v_mfma_f32_16x16x32_bf16 v[148:151], a[176:179], v[56:59], v[148:151]
s_waitcnt lgkmcnt(7)
ds_read_b64_tr_b16 a[158:159], v234 offset:14336
buffer_load_dwordx4 v254, s[8:11], s55 offen  lds
v_mfma_f32_16x16x32_bf16 v[148:151], a[184:187], v[72:75], v[148:151]
s_add_u32 s86, s86, s101
ds_read_b64_tr_b16 a[160:161], v234 offset:16384
v_accvgpr_write_b32 a29, v17
v_mfma_f32_16x16x32_bf16 v[148:151], a[188:191], v[76:79], v[148:151]
s_add_u32 s86, s86, 1
ds_read_b64_tr_b16 a[162:163], v234 offset:18432
v_accvgpr_write_b32 a30, v18
v_mfma_f32_16x16x32_bf16 v[144:147], a[188:191], v[68:71], v[144:147]
s_sub_u32 s87, s86, 9
ds_read_b64_tr_b16 a[164:165], v234 offset:20480
v_accvgpr_write_b32 a31, v19
v_mfma_f32_16x16x32_bf16 v[144:147], a[184:187], v[64:67], v[144:147]
s_waitcnt lgkmcnt(7)
ds_read_b64_tr_b16 a[166:167], v234 offset:22528
buffer_load_dwordx4 v253, s[8:11], s55 offen offset:1024  lds
v_mfma_f32_16x16x32_bf16 v[156:159], a[144:147], v[136:139], 0
s_mul_i32 s54, s63, 4608
ds_read_b64_tr_b16 a[168:169], v234 offset:24576
v_accvgpr_write_b32 a32, v168
v_mfma_f32_16x16x32_bf16 v[156:159], a[148:151], v[140:143], v[156:159]
s_add_u32 s54, s54, s69
ds_read_b64_tr_b16 a[170:171], v234 offset:26624
v_accvgpr_write_b32 a33, v169
v_mfma_f32_16x16x32_bf16 v[160:163], a[148:151], v[8:11], 0
s_addk_i32 m0, 0x2000
ds_read_b64_tr_b16 a[172:173], v234 offset:28672
v_accvgpr_write_b32 a34, v170
v_mfma_f32_16x16x32_bf16 v[160:163], a[144:147], v[4:7], v[160:163]
s_waitcnt lgkmcnt(7)
ds_read_b64_tr_b16 a[174:175], v234 offset:30720
buffer_load_dwordx4 v254, s[8:11], s54 offen  lds
v_mfma_f32_16x16x32_bf16 v[160:163], a[152:155], v[12:15], v[160:163]
s_min_u32 s86, s86, s87
ds_read_b64_tr_b16 a[176:177], v234 offset:32768
v_accvgpr_write_b32 a35, v171
v_mfma_f32_16x16x32_bf16 v[160:163], a[156:159], v[16:19], v[160:163]
s_lshl_b32 s75, s86, 7
ds_read_b64_tr_b16 a[178:179], v234 offset:34816
v_accvgpr_write_b32 a36, v24
v_mfma_f32_16x16x32_bf16 v[156:159], a[156:159], v[152:155], v[156:159]
s_add_u32 s86, s51, 2
ds_read_b64_tr_b16 a[180:181], v234 offset:36864
v_accvgpr_write_b32 a37, v25
v_mfma_f32_16x16x32_bf16 v[156:159], a[152:155], v[20:23], v[156:159]
s_waitcnt lgkmcnt(7)
ds_read_b64_tr_b16 a[182:183], v234 offset:38912
buffer_load_dwordx4 v253, s[8:11], s54 offen offset:1024  lds
v_mfma_f32_16x16x32_bf16 v[156:159], a[160:163], v[168:171], v[156:159]
s_mul_i32 s55, s64, 4608
ds_read_b64_tr_b16 a[184:185], v234 offset:40960
v_accvgpr_write_b32 a38, v26
v_mfma_f32_16x16x32_bf16 v[156:159], a[164:167], v[172:175], v[156:159]
s_add_u32 s55, s55, s69
ds_read_b64_tr_b16 a[186:187], v234 offset:43008
v_accvgpr_write_b32 a39, v27
v_accvgpr_write_b32 a40, v172
v_mfma_f32_16x16x32_bf16 v[160:163], a[164:167], v[28:31], v[160:163]
s_addk_i32 m0, 0x2000
ds_read_b64_tr_b16 a[188:189], v234 offset:45056
v_accvgpr_write_b32 a41, v173
v_mfma_f32_16x16x32_bf16 v[160:163], a[160:163], v[24:27], v[160:163]
s_waitcnt lgkmcnt(7)
ds_read_b64_tr_b16 a[190:191], v234 offset:47104
buffer_load_dwordx4 v254, s[8:11], s55 offen  lds
v_mfma_f32_16x16x32_bf16 v[160:163], a[168:171], v[40:43], v[160:163]
s_and_b32 s86, s86, 7
ds_read_b64_tr_b16 a[144:145], v233 offset:0
v_accvgpr_write_b32 a42, v174
v_mfma_f32_16x16x32_bf16 v[160:163], a[172:175], v[44:47], v[160:163]
s_add_u32 s86, s86, s101
ds_read_b64_tr_b16 a[146:147], v233 offset:2048
v_accvgpr_write_b32 a43, v175
v_mfma_f32_16x16x32_bf16 v[156:159], a[172:175], v[36:39], v[156:159]
s_add_u32 s86, s86, 1
ds_read_b64_tr_b16 a[148:149], v233 offset:4096
v_accvgpr_write_b32 a44, v28
v_mfma_f32_16x16x32_bf16 v[156:159], a[168:171], v[32:35], v[156:159]
s_waitcnt lgkmcnt(7)
ds_read_b64_tr_b16 a[150:151], v233 offset:6144
buffer_load_dwordx4 v253, s[8:11], s55 offen offset:1024  lds
v_mfma_f32_16x16x32_bf16 v[156:159], a[176:179], v[48:51], v[156:159]
s_mul_i32 s54, s65, 4608
ds_read_b64_tr_b16 a[152:153], v233 offset:8192
v_accvgpr_write_b32 a45, v29
v_mfma_f32_16x16x32_bf16 v[156:159], a[180:183], v[52:55], v[156:159]
s_add_u32 s54, s54, s69
ds_read_b64_tr_b16 a[154:155], v233 offset:10240
v_accvgpr_write_b32 a46, v30
v_mfma_f32_16x16x32_bf16 v[160:163], a[180:183], v[60:63], v[160:163]
s_addk_i32 m0, 0x2000
ds_read_b64_tr_b16 a[156:157], v233 offset:12288
v_accvgpr_write_b32 a47, v31
v_mfma_f32_16x16x32_bf16 v[160:163], a[176:179], v[56:59], v[160:163]
s_waitcnt lgkmcnt(7)
ds_read_b64_tr_b16 a[158:159], v233 offset:14336
buffer_load_dwordx4 v254, s[8:11], s54 offen  lds
v_mfma_f32_16x16x32_bf16 v[160:163], a[184:187], v[72:75], v[160:163]
LF_p2:
s_cbranch_execz LF
s_sub_u32 s87, s86, 9
ds_read_b64_tr_b16 a[160:161], v233 offset:16384
v_accvgpr_write_b32 a48, v32
v_mfma_f32_16x16x32_bf16 v[160:163], a[188:191], v[76:79], v[160:163]
s_min_u32 s86, s86, s87
ds_read_b64_tr_b16 a[162:163], v233 offset:18432
v_accvgpr_write_b32 a49, v33
v_mfma_f32_16x16x32_bf16 v[156:159], a[188:191], v[68:71], v[156:159]
s_lshl_b32 s76, s86, 7
ds_read_b64_tr_b16 a[164:165], v233 offset:20480
v_accvgpr_write_b32 a50, v34
v_mfma_f32_16x16x32_bf16 v[156:159], a[184:187], v[64:67], v[156:159]
s_waitcnt lgkmcnt(7)
ds_read_b64_tr_b16 a[166:167], v233 offset:22528
buffer_load_dwordx4 v253, s[8:11], s54 offen offset:1024  lds
v_mfma_f32_16x16x32_bf16 v[164:167], a[144:147], v[136:139], 0
s_mul_i32 s55, s66, 4608
ds_read_b64_tr_b16 a[168:169], v233 offset:24576
v_accvgpr_write_b32 a51, v35
v_mfma_f32_16x16x32_bf16 v[164:167], a[148:151], v[140:143], v[164:167]
s_add_u32 s55, s55, s69
ds_read_b64_tr_b16 a[170:171], v233 offset:26624
v_accvgpr_write_b32 a52, v40
v_mfma_f32_16x16x32_bf16 v[136:139], a[148:151], v[8:11], 0
s_addk_i32 m0, 0x2000
ds_read_b64_tr_b16 a[172:173], v233 offset:28672
v_accvgpr_write_b32 a53, v41
v_mfma_f32_16x16x32_bf16 v[136:139], a[144:147], v[4:7], v[136:139]
s_waitcnt lgkmcnt(7)
ds_read_b64_tr_b16 a[174:175], v233 offset:30720
buffer_load_dwordx4 v254, s[8:11], s55 offen  lds
v_mfma_f32_16x16x32_bf16 v[136:139], a[152:155], v[12:15], v[136:139]
s_add_u32 s86, s51, 3
ds_read_b64_tr_b16 a[176:177], v233 offset:32768
v_accvgpr_write_b32 a54, v42
v_mfma_f32_16x16x32_bf16 v[136:139], a[156:159], v[16:19], v[136:139]
s_and_b32 s86, s86, 7
ds_read_b64_tr_b16 a[178:179], v233 offset:34816
v_accvgpr_write_b32 a55, v43
v_mfma_f32_16x16x32_bf16 v[164:167], a[156:159], v[152:155], v[164:167]
s_add_u32 s86, s86, s101
ds_read_b64_tr_b16 a[180:181], v233 offset:36864
v_accvgpr_write_b32 a56, v36
v_mfma_f32_16x16x32_bf16 v[164:167], a[152:155], v[20:23], v[164:167]
s_waitcnt lgkmcnt(7)
ds_read_b64_tr_b16 a[182:183], v233 offset:38912
buffer_load_dwordx4 v253, s[8:11], s55 offen offset:1024  lds
v_mfma_f32_16x16x32_bf16 v[164:167], a[160:163], v[168:171], v[164:167]
s_add_u32 s86, s86, 1
ds_read_b64_tr_b16 a[184:185], v233 offset:40960
v_accvgpr_write_b32 a57, v37
v_mfma_f32_16x16x32_bf16 v[164:167], a[164:167], v[172:175], v[164:167]
s_sub_u32 s87, s86, 9
ds_read_b64_tr_b16 a[186:187], v233 offset:43008
v_accvgpr_write_b32 a58, v38
v_mfma_f32_16x16x32_bf16 v[136:139], a[164:167], v[28:31], v[136:139]
s_waitcnt vmcnt(12)
ds_read_b64_tr_b16 a[188:189], v233 offset:45056
v_accvgpr_write_b32 a59, v39
v_mfma_f32_16x16x32_bf16 v[136:139], a[160:163], v[24:27], v[136:139]
s_waitcnt lgkmcnt(7)
ds_read_b64_tr_b16 a[190:191], v233 offset:47104
v_accvgpr_write_b32 a60, v44
v_mfma_f32_16x16x32_bf16 v[136:139], a[168:171], v[40:43], v[136:139]
s_barrier
ds_read_b64_tr_b16 a[144:145], v250 offset:0
v_accvgpr_write_b32 a61, v45
v_mfma_f32_16x16x32_bf16 v[136:139], a[172:175], v[44:47], v[136:139]
s_min_u32 s86, s86, s87
ds_read_b64_tr_b16 a[146:147], v250 offset:2048
v_accvgpr_write_b32 a62, v46
v_mfma_f32_16x16x32_bf16 v[164:167], a[172:175], v[36:39], v[164:167]
s_lshl_b32 s77, s86, 7
ds_read_b64_tr_b16 a[148:149], v250 offset:4096
v_accvgpr_write_b32 a63, v47
v_mfma_f32_16x16x32_bf16 v[164:167], a[168:171], v[32:35], v[164:167]
s_waitcnt lgkmcnt(7)
ds_read_b64_tr_b16 a[150:151], v250 offset:6144
v_accvgpr_write_b32 a64, v48
v_mfma_f32_16x16x32_bf16 v[164:167], a[176:179], v[48:51], v[164:167]
s_add_u32 s86, s51, 4
ds_read_b64_tr_b16 a[152:153], v250 offset:8192
v_accvgpr_write_b32 a65, v49
v_mfma_f32_16x16x32_bf16 v[164:167], a[180:183], v[52:55], v[164:167]
s_and_b32 s86, s86, 7
ds_read_b64_tr_b16 a[154:155], v250 offset:10240
v_accvgpr_write_b32 a66, v50
v_mfma_f32_16x16x32_bf16 v[136:139], a[180:183], v[60:63], v[136:139]
s_add_u32 s86, s86, s101
ds_read_b64_tr_b16 a[156:157], v250 offset:12288
v_accvgpr_write_b32 a67, v51
v_mfma_f32_16x16x32_bf16 v[136:139], a[176:179], v[56:59], v[136:139]
s_waitcnt lgkmcnt(7)
ds_read_b64_tr_b16 a[158:159], v250 offset:14336
v_accvgpr_write_b32 a68, v56
v_mfma_f32_16x16x32_bf16 v[136:139], a[184:187], v[72:75], v[136:139]
s_add_u32 s86, s86, 1
ds_read_b64_tr_b16 a[160:161], v250 offset:16384
v_accvgpr_write_b32 a69, v57
v_mfma_f32_16x16x32_bf16 v[136:139], a[188:191], v[76:79], v[136:139]
s_sub_u32 s87, s86, 9
ds_read_b64_tr_b16 a[162:163], v250 offset:18432
v_accvgpr_write_b32 a70, v58
v_mfma_f32_16x16x32_bf16 v[164:167], a[188:191], v[68:71], v[164:167]
s_min_u32 s86, s86, s87
ds_read_b64_tr_b16 a[164:165], v250 offset:20480
v_accvgpr_write_b32 a71, v59
v_mfma_f32_16x16x32_bf16 v[164:167], a[184:187], v[64:67], v[164:167]
s_waitcnt lgkmcnt(7)
ds_read_b64_tr_b16 a[166:167], v250 offset:22528
v_accvgpr_write_b32 a72, v52
v_mfma_f32_16x16x32_bf16 v[128:131], a[144:147], v[80:83], v[128:131]
s_mul_i32 s54, s58, 4608
ds_read_b64_tr_b16 a[168:169], v245 offset:0
v_accvgpr_write_b32 a73, v53
v_mfma_f32_16x16x32_bf16 v[128:131], a[148:151], v[84:87], v[128:131]
s_add_u32 s54, s54, s70
ds_read_b64_tr_b16 a[170:171], v245 offset:2048
v_accvgpr_write_b32 a74, v54
v_mfma_f32_16x16x32_bf16 v[132:135], a[148:151], v[92:95], v[132:135]
s_mov_b32 m0, s53
ds_read_b64_tr_b16 a[172:173], v245 offset:4096
v_accvgpr_write_b32 a75, v55
v_mfma_f32_16x16x32_bf16 v[132:135], a[144:147], v[88:91], v[132:135]
s_waitcnt lgkmcnt(7)
ds_read_b64_tr_b16 a[174:175], v245 offset:6144
buffer_load_dwordx4 v254, s[8:11], s54 offen  lds
v_mfma_f32_16x16x32_bf16 v[132:135], a[152:155], v[104:107], v[132:135]
s_lshl_b32 s78, s86, 7
ds_read_b64_tr_b16 a[176:177], v245 offset:8192
v_accvgpr_write_b32 a76, v60
v_mfma_f32_16x16x32_bf16 v[132:135], a[156:159], v[108:111], v[132:135]
s_add_u32 s86, s51, 5
ds_read_b64_tr_b16 a[178:179], v245 offset:10240
v_accvgpr_write_b32 a77, v61
v_mfma_f32_16x16x32_bf16 v[128:131], a[156:159], v[100:103], v[128:131]
s_and_b32 s86, s86, 7
ds_read_b64_tr_b16 a[180:181], v245 offset:12288
v_accvgpr_write_b32 a78, v62
v_mfma_f32_16x16x32_bf16 v[128:131], a[152:155], v[96:99], v[128:131]
s_waitcnt lgkmcnt(7)
ds_read_b64_tr_b16 a[182:183], v245 offset:14336
v_accvgpr_write_b32 a79, v63
v_mfma_f32_16x16x32_bf16 v[128:131], a[160:163], v[112:115], v[128:131]
s_add_u32 s86, s86, s101
ds_read_b64_tr_b16 a[184:185], v245 offset:16384
v_add_u32 v242, 98304, v235
v_mfma_f32_16x16x32_bf16 v[128:131], a[164:167], v[116:119], v[128:131]
s_add_u32 s86, s86, 1
ds_read_b64_tr_b16 a[186:187], v245 offset:18432
v_add_u32 v241, 98304, v248
v_mfma_f32_16x16x32_bf16 v[132:135], a[164:167], v[124:127], v[132:135]
s_sub_u32 s87, s86, 9
ds_read_b64_tr_b16 a[188:189], v245 offset:20480
v_add_u32 v240, 98304, v234
v_mfma_f32_16x16x32_bf16 v[132:135], a[160:163], v[120:123], v[132:135]
s_waitcnt lgkmcnt(7)
ds_read_b64_tr_b16 a[190:191], v245 offset:22528
buffer_load_dwordx4 v253, s[8:11], s54 offen offset:1024  lds
v_mfma_f32_16x16x32_bf16 v[144:147], a[168:171], v[80:83], v[144:147]
s_min_u32 s86, s86, s87
ds_read_b64_tr_b16 a[144:145], v244 offset:0
v_add_u32 v239, 98304, v233
v_mfma_f32_16x16x32_bf16 v[144:147], a[172:175], v[84:87], v[144:147]
s_lshl_b32 s79, s86, 7
ds_read_b64_tr_b16 a[146:147], v244 offset:2048
v_exp_f32 v236, v128
v_mfma_f32_16x16x32_bf16 v[148:151], a[172:175], v[92:95], v[148:151]
s_add_u32 s86, s51, 6
ds_read_b64_tr_b16 a[148:149], v244 offset:4096
v_exp_f32 v231, v129
v_mfma_f32_16x16x32_bf16 v[148:151], a[168:171], v[88:91], v[148:151]
s_waitcnt lgkmcnt(7)
ds_read_b64_tr_b16 a[150:151], v244 offset:6144
v_add_f32 v236, 1.0, v236
v_mfma_f32_16x16x32_bf16 v[148:151], a[176:179], v[104:107], v[148:151]
s_mul_i32 s55, s59, 4608
ds_read_b64_tr_b16 a[152:153], v244 offset:8192
v_exp_f32 v230, v130
v_mfma_f32_16x16x32_bf16 v[148:151], a[180:183], v[108:111], v[148:151]
s_add_u32 s55, s55, s70
ds_read_b64_tr_b16 a[154:155], v244 offset:10240
v_rcp_f32 v236, v236
v_mfma_f32_16x16x32_bf16 v[144:147], a[180:183], v[100:103], v[144:147]
s_addk_i32 m0, 0x2000
ds_read_b64_tr_b16 a[156:157], v244 offset:12288
v_add_f32 v231, 1.0, v231
v_exp_f32 v229, v131
v_mfma_f32_16x16x32_bf16 v[144:147], a[176:179], v[96:99], v[144:147]
s_waitcnt lgkmcnt(7)
ds_read_b64_tr_b16 a[158:159], v244 offset:14336
buffer_load_dwordx4 v254, s[8:11], s55 offen  lds
v_mfma_f32_16x16x32_bf16 v[144:147], a[184:187], v[112:115], v[144:147]
s_and_b32 s86, s86, 7
ds_read_b64_tr_b16 a[160:161], v244 offset:16384
v_mul_f32 v236, v236, v128
v_mfma_f32_16x16x32_bf16 v[144:147], a[188:191], v[116:119], v[144:147]
s_add_u32 s86, s86, s101
ds_read_b64_tr_b16 a[162:163], v244 offset:18432
v_rcp_f32 v231, v231
v_mfma_f32_16x16x32_bf16 v[148:151], a[188:191], v[124:127], v[148:151]
s_add_u32 s86, s86, 1
ds_read_b64_tr_b16 a[164:165], v244 offset:20480
v_add_f32 v230, 1.0, v230
v_mfma_f32_16x16x32_bf16 v[148:151], a[184:187], v[120:123], v[148:151]
s_waitcnt lgkmcnt(7)
ds_read_b64_tr_b16 a[166:167], v244 offset:22528
v_exp_f32 v228, v132
v_mfma_f32_16x16x32_bf16 v[156:159], a[144:147], v[80:83], v[156:159]
s_sub_u32 s87, s86, 9
ds_read_b64_tr_b16 a[168:169], v243 offset:0
v_mul_f32 v231, v231, v129
v_mfma_f32_16x16x32_bf16 v[156:159], a[148:151], v[84:87], v[156:159]
s_min_u32 s86, s86, s87
ds_read_b64_tr_b16 a[170:171], v243 offset:2048
v_rcp_f32 v230, v230
v_mfma_f32_16x16x32_bf16 v[160:163], a[148:151], v[92:95], v[160:163]
s_lshl_b32 s80, s86, 7
ds_read_b64_tr_b16 a[172:173], v243 offset:4096
v_add_f32 v229, 1.0, v229
v_mfma_f32_16x16x32_bf16 v[160:163], a[144:147], v[88:91], v[160:163]
s_waitcnt lgkmcnt(7)
ds_read_b64_tr_b16 a[174:175], v243 offset:6144
buffer_load_dwordx4 v253, s[8:11], s55 offen offset:1024  lds
v_mfma_f32_16x16x32_bf16 v[160:163], a[152:155], v[104:107], v[160:163]
s_add_u32 s86, s51, 7
ds_read_b64_tr_b16 a[176:177], v243 offset:8192
v_cvt_pk_bf16_f32 v4, v236, v231
v_mfma_f32_16x16x32_bf16 v[160:163], a[156:159], v[108:111], v[160:163]
s_and_b32 s86, s86, 7
ds_read_b64_tr_b16 a[178:179], v243 offset:10240
v_exp_f32 v236, v133
v_mfma_f32_16x16x32_bf16 v[156:159], a[156:159], v[100:103], v[156:159]
s_add_u32 s86, s86, s101
ds_read_b64_tr_b16 a[180:181], v243 offset:12288
v_mul_f32 v230, v230, v130
v_mfma_f32_16x16x32_bf16 v[156:159], a[152:155], v[96:99], v[156:159]
s_waitcnt lgkmcnt(7)
ds_read_b64_tr_b16 a[182:183], v243 offset:14336
v_rcp_f32 v229, v229
v_mfma_f32_16x16x32_bf16 v[156:159], a[160:163], v[112:115], v[156:159]
s_mul_i32 s54, s60, 4608
ds_read_b64_tr_b16 a[184:185], v243 offset:16384
v_add_f32 v228, 1.0, v228
v_mfma_f32_16x16x32_bf16 v[156:159], a[164:167], v[116:119], v[156:159]
s_add_u32 s54, s54, s70
ds_read_b64_tr_b16 a[186:187], v243 offset:18432
v_exp_f32 v231, v134
v_mfma_f32_16x16x32_bf16 v[160:163], a[164:167], v[124:127], v[160:163]
s_addk_i32 m0, 0x2000
ds_read_b64_tr_b16 a[188:189], v243 offset:20480
v_mul_f32 v229, v229, v131
v_mfma_f32_16x16x32_bf16 v[160:163], a[160:163], v[120:123], v[160:163]
s_waitcnt lgkmcnt(7)
ds_read_b64_tr_b16 a[190:191], v243 offset:22528
buffer_load_dwordx4 v254, s[8:11], s54 offen  lds
v_mfma_f32_16x16x32_bf16 v[164:167], a[168:171], v[80:83], v[164:167]
s_add_u32 s86, s86, 1
ds_read_b64_tr_b16 a[144:145], v250 offset:24576
v_rcp_f32 v228, v228
v_mfma_f32_16x16x32_bf16 v[164:167], a[172:175], v[84:87], v[164:167]
s_sub_u32 s87, s86, 9
ds_read_b64_tr_b16 a[146:147], v250 offset:26624
v_add_f32 v236, 1.0, v236
v_mfma_f32_16x16x32_bf16 v[136:139], a[172:175], v[92:95], v[136:139]
s_min_u32 s86, s86, s87
ds_read_b64_tr_b16 a[148:149], v250 offset:28672
v_cvt_pk_bf16_f32 v5, v230, v229
v_mfma_f32_16x16x32_bf16 v[136:139], a[168:171], v[88:91], v[136:139]
s_waitcnt lgkmcnt(7)
ds_read_b64_tr_b16 a[150:151], v250 offset:30720
v_exp_f32 v230, v135
v_mfma_f32_16x16x32_bf16 v[136:139], a[176:179], v[104:107], v[136:139]
s_lshl_b32 s81, s86, 7
ds_read_b64_tr_b16 a[152:153], v250 offset:32768
v_mul_f32 v228, v228, v132
v_mfma_f32_16x16x32_bf16 v[136:139], a[180:183], v[108:111], v[136:139]
s_mul_i32 s86, s49, 6291456
ds_read_b64_tr_b16 a[154:155], v250 offset:34816
v_rcp_f32 v236, v236
v_mfma_f32_16x16x32_bf16 v[164:167], a[180:183], v[100:103], v[164:167]
s_add_u32 s86, s86, 2097152
ds_read_b64_tr_b16 a[156:157], v250 offset:36864
v_add_f32 v231, 1.0, v231
v_mfma_f32_16x16x32_bf16 v[164:167], a[176:179], v[96:99], v[164:167]
s_waitcnt lgkmcnt(7)
ds_read_b64_tr_b16 a[158:159], v250 offset:38912
buffer_load_dwordx4 v253, s[8:11], s54 offen offset:1024  lds
v_mfma_f32_16x16x32_bf16 v[164:167], a[184:187], v[112:115], v[164:167]
s_lshl_b32 s87, s48, 14
ds_read_b64_tr_b16 a[160:161], v250 offset:40960
v_exp_f32 v229, v144
v_mfma_f32_16x16x32_bf16 v[164:167], a[188:191], v[116:119], v[164:167]
s_sub_u32 s83, s86, s87
ds_read_b64_tr_b16 a[162:163], v250 offset:43008
v_mul_f32 v236, v236, v133
v_mfma_f32_16x16x32_bf16 v[136:139], a[188:191], v[124:127], v[136:139]
s_add_u32 s83, s83, 229376
ds_read_b64_tr_b16 a[164:165], v250 offset:45056
v_rcp_f32 v231, v231
v_mfma_f32_16x16x32_bf16 v[136:139], a[184:187], v[120:123], v[136:139]
s_waitcnt lgkmcnt(7)
ds_read_b64_tr_b16 a[166:167], v250 offset:47104
v_add_f32 v230, 1.0, v230
v_mfma_f32_16x16x32_bf16 v[8:11], a[144:147], a[0:3], 0
s_mul_i32 s55, s61, 4608
ds_read_b64_tr_b16 a[168:169], v245 offset:24576
v_cvt_pk_bf16_f32 v12, v228, v236
v_mfma_f32_16x16x32_bf16 v[8:11], a[148:151], a[8:11], v[8:11]
s_add_u32 s55, s55, s70
ds_read_b64_tr_b16 a[170:171], v245 offset:26624
v_exp_f32 v236, v145
v_mfma_f32_16x16x32_bf16 v[16:19], a[148:151], a[12:15], 0
s_addk_i32 m0, 0x2000
ds_read_b64_tr_b16 a[172:173], v245 offset:28672
v_mul_f32 v231, v231, v134
v_mfma_f32_16x16x32_bf16 v[16:19], a[144:147], a[4:7], v[16:19]
s_waitcnt lgkmcnt(7)
ds_read_b64_tr_b16 a[174:175], v245 offset:30720
buffer_load_dwordx4 v254, s[8:11], s55 offen  lds
v_mfma_f32_16x16x32_bf16 v[16:19], a[152:155], a[20:23], v[16:19]
s_add_u32 s87, s48, 3
ds_read_b64_tr_b16 a[176:177], v245 offset:32768
v_rcp_f32 v230, v230
v_mfma_f32_16x16x32_bf16 v[16:19], a[156:159], a[28:31], v[16:19]
s_lshl_b32 s87, s87, 18
ds_read_b64_tr_b16 a[178:179], v245 offset:34816
v_add_f32 v229, 1.0, v229
v_mfma_f32_16x16x32_bf16 v[8:11], a[156:159], a[24:27], v[8:11]
s_add_u32 s86, s86, s87
ds_read_b64_tr_b16 a[180:181], v245 offset:36864
v_exp_f32 v228, v146
v_mfma_f32_16x16x32_bf16 v[8:11], a[152:155], a[16:19], v[8:11]
s_waitcnt lgkmcnt(7)
ds_read_b64_tr_b16 a[182:183], v245 offset:38912
v_mul_f32 v230, v230, v135
v_mfma_f32_16x16x32_bf16 v[8:11], a[160:163], a[32:35], v[8:11]
s_add_u32 s44, s32, s86
s_addc_u32 s45, s33, 0
ds_read_b64_tr_b16 a[184:185], v245 offset:40960
v_rcp_f32 v229, v229
v_mfma_f32_16x16x32_bf16 v[8:11], a[164:167], a[40:43], v[8:11]
ds_read_b64_tr_b16 a[186:187], v245 offset:43008
v_add_f32 v236, 1.0, v236
v_mfma_f32_16x16x32_bf16 v[16:19], a[164:167], a[44:47], v[16:19]
ds_read_b64_tr_b16 a[188:189], v245 offset:45056
v_cvt_pk_bf16_f32 v13, v231, v230
v_mfma_f32_16x16x32_bf16 v[16:19], a[160:163], a[36:39], v[16:19]
s_waitcnt lgkmcnt(7)
ds_read_b64_tr_b16 a[190:191], v245 offset:47104
buffer_load_dwordx4 v253, s[8:11], s55 offen offset:1024  lds
v_mfma_f32_16x16x32_bf16 v[20:23], a[168:171], a[0:3], 0
ds_read_b64_tr_b16 a[144:145], v244 offset:24576
v_exp_f32 v231, v147
v_mfma_f32_16x16x32_bf16 v[20:23], a[172:175], a[8:11], v[20:23]
ds_read_b64_tr_b16 a[146:147], v244 offset:26624
v_mul_f32 v229, v229, v144
v_mfma_f32_16x16x32_bf16 v[24:27], a[172:175], a[12:15], 0
ds_read_b64_tr_b16 a[148:149], v244 offset:28672
v_rcp_f32 v236, v236
v_mfma_f32_16x16x32_bf16 v[24:27], a[168:171], a[4:7], v[24:27]
s_waitcnt lgkmcnt(7)
ds_read_b64_tr_b16 a[150:151], v244 offset:30720
v_add_f32 v228, 1.0, v228
v_mfma_f32_16x16x32_bf16 v[24:27], a[176:179], a[20:23], v[24:27]
s_mul_i32 s54, s62, 4608
ds_read_b64_tr_b16 a[152:153], v244 offset:32768
v_exp_f32 v230, v148
v_mfma_f32_16x16x32_bf16 v[24:27], a[180:183], a[28:31], v[24:27]
s_add_u32 s54, s54, s70
ds_read_b64_tr_b16 a[154:155], v244 offset:34816
v_mul_f32 v236, v236, v145
v_mfma_f32_16x16x32_bf16 v[20:23], a[180:183], a[24:27], v[20:23]
s_addk_i32 m0, 0x2000
ds_read_b64_tr_b16 a[156:157], v244 offset:36864
v_rcp_f32 v228, v228
v_mfma_f32_16x16x32_bf16 v[20:23], a[176:179], a[16:19], v[20:23]
s_waitcnt lgkmcnt(7)
ds_read_b64_tr_b16 a[158:159], v244 offset:38912
buffer_load_dwordx4 v254, s[8:11], s54 offen  lds
v_mfma_f32_16x16x32_bf16 v[20:23], a[184:187], a[32:35], v[20:23]
ds_read_b64_tr_b16 a[160:161], v244 offset:40960
v_add_f32 v231, 1.0, v231
v_mfma_f32_16x16x32_bf16 v[20:23], a[188:191], a[40:43], v[20:23]
ds_read_b64_tr_b16 a[162:163], v244 offset:43008
v_cvt_pk_bf16_f32 v6, v229, v236
v_mfma_f32_16x16x32_bf16 v[24:27], a[188:191], a[44:47], v[24:27]
ds_read_b64_tr_b16 a[164:165], v244 offset:45056
v_exp_f32 v236, v149
v_mfma_f32_16x16x32_bf16 v[24:27], a[184:187], a[36:39], v[24:27]
s_waitcnt lgkmcnt(7)
ds_read_b64_tr_b16 a[166:167], v244 offset:47104
v_mul_f32 v228, v228, v146
v_mfma_f32_16x16x32_bf16 v[28:31], a[144:147], a[0:3], 0
ds_read_b64_tr_b16 a[168:169], v243 offset:24576
v_rcp_f32 v231, v231
v_mfma_f32_16x16x32_bf16 v[28:31], a[148:151], a[8:11], v[28:31]
ds_read_b64_tr_b16 a[170:171], v243 offset:26624
v_add_f32 v230, 1.0, v230
v_mfma_f32_16x16x32_bf16 v[32:35], a[148:151], a[12:15], 0
ds_read_b64_tr_b16 a[172:173], v243 offset:28672
v_exp_f32 v229, v150
v_mfma_f32_16x16x32_bf16 v[32:35], a[144:147], a[4:7], v[32:35]
s_waitcnt lgkmcnt(7)
ds_read_b64_tr_b16 a[174:175], v243 offset:30720
buffer_load_dwordx4 v253, s[8:11], s54 offen offset:1024  lds
v_mul_f32 v231, v231, v147
v_mfma_f32_16x16x32_bf16 v[32:35], a[152:155], a[20:23], v[32:35]
ds_read_b64_tr_b16 a[176:177], v243 offset:32768
v_rcp_f32 v230, v230
v_mfma_f32_16x16x32_bf16 v[32:35], a[156:159], a[28:31], v[32:35]
ds_read_b64_tr_b16 a[178:179], v243 offset:34816
v_add_f32 v236, 1.0, v236
v_mfma_f32_16x16x32_bf16 v[28:31], a[156:159], a[24:27], v[28:31]
ds_read_b64_tr_b16 a[180:181], v243 offset:36864
v_cvt_pk_bf16_f32 v7, v228, v231
v_mfma_f32_16x16x32_bf16 v[28:31], a[152:155], a[16:19], v[28:31]
s_waitcnt lgkmcnt(7)
ds_read_b64_tr_b16 a[182:183], v243 offset:38912
v_exp_f32 v231, v151
v_mfma_f32_16x16x32_bf16 v[28:31], a[160:163], a[32:35], v[28:31]
s_mul_i32 s55, s63, 4608
ds_read_b64_tr_b16 a[184:185], v243 offset:40960
v_mul_f32 v230, v230, v148
v_mfma_f32_16x16x32_bf16 v[28:31], a[164:167], a[40:43], v[28:31]
s_add_u32 s55, s55, s70
ds_read_b64_tr_b16 a[186:187], v243 offset:43008
v_rcp_f32 v236, v236
v_mfma_f32_16x16x32_bf16 v[32:35], a[164:167], a[44:47], v[32:35]
s_waitcnt vmcnt(10)
ds_read_b64_tr_b16 a[188:189], v243 offset:45056
v_add_f32 v229, 1.0, v229
v_mfma_f32_16x16x32_bf16 v[32:35], a[160:163], a[36:39], v[32:35]
s_waitcnt lgkmcnt(7)
ds_read_b64_tr_b16 a[190:191], v243 offset:47104
v_exp_f32 v228, v156
v_mfma_f32_16x16x32_bf16 v[36:39], a[168:171], a[0:3], 0
s_barrier
ds_read_b64_tr_b16 a[144:145], v242 offset:0
v_mul_f32 v236, v236, v149
v_mfma_f32_16x16x32_bf16 v[36:39], a[172:175], a[8:11], v[36:39]
s_addk_i32 m0, 0x2000
ds_read_b64_tr_b16 a[146:147], v242 offset:2048
v_rcp_f32 v229, v229
v_mfma_f32_16x16x32_bf16 v[40:43], a[172:175], a[12:15], 0
ds_read_b64_tr_b16 a[148:149], v242 offset:4096
buffer_load_dwordx4 v254, s[8:11], s55 offen  lds
v_mfma_f32_16x16x32_bf16 v[40:43], a[168:171], a[4:7], v[40:43]
s_waitcnt lgkmcnt(7)
ds_read_b64_tr_b16 a[150:151], v242 offset:6144
v_add_f32 v231, 1.0, v231
v_mfma_f32_16x16x32_bf16 v[40:43], a[176:179], a[20:23], v[40:43]
ds_read_b64_tr_b16 a[152:153], v242 offset:8192
v_cvt_pk_bf16_f32 v14, v230, v236
v_mfma_f32_16x16x32_bf16 v[40:43], a[180:183], a[28:31], v[40:43]
ds_read_b64_tr_b16 a[154:155], v242 offset:10240
v_exp_f32 v236, v157
v_mfma_f32_16x16x32_bf16 v[36:39], a[180:183], a[24:27], v[36:39]
ds_read_b64_tr_b16 a[156:157], v242 offset:12288
v_mul_f32 v229, v229, v150
v_mfma_f32_16x16x32_bf16 v[36:39], a[176:179], a[16:19], v[36:39]
s_waitcnt lgkmcnt(7)
ds_read_b64_tr_b16 a[158:159], v242 offset:14336
v_rcp_f32 v231, v231
v_mfma_f32_16x16x32_bf16 v[36:39], a[184:187], a[32:35], v[36:39]
ds_read_b64_tr_b16 a[160:161], v242 offset:16384
v_add_f32 v228, 1.0, v228
v_mfma_f32_16x16x32_bf16 v[36:39], a[188:191], a[40:43], v[36:39]
ds_read_b64_tr_b16 a[162:163], v242 offset:18432
v_exp_f32 v230, v158
v_mfma_f32_16x16x32_bf16 v[40:43], a[188:191], a[44:47], v[40:43]
ds_read_b64_tr_b16 a[164:165], v242 offset:20480
buffer_load_dwordx4 v253, s[8:11], s55 offen offset:1024  lds
v_mfma_f32_16x16x32_bf16 v[40:43], a[184:187], a[36:39], v[40:43]
s_waitcnt lgkmcnt(7)
ds_read_b64_tr_b16 a[166:167], v242 offset:22528
v_mul_f32 v231, v231, v151
v_mfma_f32_16x16x32_bf16 v[8:11], a[144:147], a[48:51], v[8:11]
s_mul_i32 s54, s64, 4608
ds_read_b64_tr_b16 a[168:169], v242 offset:24576
v_rcp_f32 v228, v228
v_mfma_f32_16x16x32_bf16 v[8:11], a[148:151], a[56:59], v[8:11]
s_add_u32 s54, s54, s70
ds_read_b64_tr_b16 a[170:171], v242 offset:26624
v_add_f32 v236, 1.0, v236
v_mfma_f32_16x16x32_bf16 v[16:19], a[148:151], a[60:63], v[16:19]
s_addk_i32 m0, 0x2000
ds_read_b64_tr_b16 a[172:173], v242 offset:28672
v_cvt_pk_bf16_f32 v15, v229, v231
v_mfma_f32_16x16x32_bf16 v[16:19], a[144:147], a[52:55], v[16:19]
s_waitcnt lgkmcnt(7)
ds_read_b64_tr_b16 a[174:175], v242 offset:30720
buffer_load_dwordx4 v254, s[8:11], s54 offen  lds
v_mfma_f32_16x16x32_bf16 v[16:19], a[152:155], a[68:71], v[16:19]
ds_read_b64_tr_b16 a[176:177], v242 offset:32768
v_exp_f32 v231, v159
v_mfma_f32_16x16x32_bf16 v[16:19], a[156:159], a[76:79], v[16:19]
ds_read_b64_tr_b16 a[178:179], v242 offset:34816
v_mul_f32 v228, v228, v156
v_mfma_f32_16x16x32_bf16 v[8:11], a[156:159], a[72:75], v[8:11]
ds_read_b64_tr_b16 a[180:181], v242 offset:36864
v_rcp_f32 v236, v236
v_mfma_f32_16x16x32_bf16 v[8:11], a[152:155], a[64:67], v[8:11]
s_waitcnt lgkmcnt(7)
ds_read_b64_tr_b16 a[182:183], v242 offset:38912
v_add_f32 v230, 1.0, v230
v_mfma_f32_16x16x32_bf16 v[8:11], a[160:163], v[64:67], v[8:11]
ds_read_b64_tr_b16 a[184:185], v242 offset:40960
v_exp_f32 v229, v160
v_mfma_f32_16x16x32_bf16 v[8:11], a[164:167], v[68:71], v[8:11]
ds_read_b64_tr_b16 a[186:187], v242 offset:43008
v_mul_f32 v236, v236, v157
v_mfma_f32_16x16x32_bf16 v[16:19], a[164:167], v[76:79], v[16:19]
ds_read_b64_tr_b16 a[188:189], v242 offset:45056
v_rcp_f32 v230, v230
v_mfma_f32_16x16x32_bf16 v[16:19], a[160:163], v[72:75], v[16:19]
s_waitcnt lgkmcnt(7)
ds_read_b64_tr_b16 a[190:191], v242 offset:47104
buffer_load_dwordx4 v253, s[8:11], s54 offen offset:1024  lds
v_mfma_f32_16x16x32_bf16 v[16:19], a[168:171], v[88:91], v[16:19]
ds_read_b64_tr_b16 a[144:145], v241 offset:0
v_add_f32 v231, 1.0, v231
v_mfma_f32_16x16x32_bf16 v[16:19], a[172:175], v[92:95], v[16:19]
ds_read_b64_tr_b16 a[146:147], v241 offset:2048
v_cvt_pk_bf16_f32 v44, v228, v236
v_mfma_f32_16x16x32_bf16 v[8:11], a[172:175], v[84:87], v[8:11]
ds_read_b64_tr_b16 a[148:149], v241 offset:4096
v_exp_f32 v236, v161
v_mfma_f32_16x16x32_bf16 v[8:11], a[168:171], v[80:83], v[8:11]
s_waitcnt lgkmcnt(7)
ds_read_b64_tr_b16 a[150:151], v241 offset:6144
v_mul_f32 v230, v230, v158
v_mfma_f32_16x16x32_bf16 v[8:11], a[176:179], v[96:99], v[8:11]
s_mul_i32 s55, s65, 4608
ds_read_b64_tr_b16 a[152:153], v241 offset:8192
v_rcp_f32 v231, v231
v_mfma_f32_16x16x32_bf16 v[8:11], a[180:183], v[100:103], v[8:11]
s_add_u32 s55, s55, s70
ds_read_b64_tr_b16 a[154:155], v241 offset:10240
v_add_f32 v229, 1.0, v229
v_mfma_f32_16x16x32_bf16 v[16:19], a[180:183], v[108:111], v[16:19]
s_addk_i32 m0, 0x2000
ds_read_b64_tr_b16 a[156:157], v241 offset:12288
v_exp_f32 v228, v162
v_mfma_f32_16x16x32_bf16 v[16:19], a[176:179], v[104:107], v[16:19]
s_waitcnt lgkmcnt(7)
ds_read_b64_tr_b16 a[158:159], v241 offset:14336
buffer_load_dwordx4 v254, s[8:11], s55 offen  lds
v_mfma_f32_16x16x32_bf16 v[16:19], a[184:187], v[120:123], v[16:19]
ds_read_b64_tr_b16 a[160:161], v241 offset:16384
v_mul_f32 v231, v231, v159
v_mfma_f32_16x16x32_bf16 v[16:19], a[188:191], v[124:127], v[16:19]
ds_read_b64_tr_b16 a[162:163], v241 offset:18432
v_rcp_f32 v229, v229
v_mfma_f32_16x16x32_bf16 v[8:11], a[188:191], v[116:119], v[8:11]
ds_read_b64_tr_b16 a[164:165], v241 offset:20480
v_add_f32 v236, 1.0, v236
v_mfma_f32_16x16x32_bf16 v[8:11], a[184:187], v[112:115], v[8:11]
s_waitcnt lgkmcnt(7)
ds_read_b64_tr_b16 a[166:167], v241 offset:22528
v_cvt_pk_bf16_f32 v45, v230, v231
v_mfma_f32_16x16x32_bf16 v[20:23], a[144:147], a[48:51], v[20:23]
ds_read_b64_tr_b16 a[168:169], v241 offset:24576
v_exp_f32 v231, v163
v_mfma_f32_16x16x32_bf16 v[20:23], a[148:151], a[56:59], v[20:23]
ds_read_b64_tr_b16 a[170:171], v241 offset:26624
v_mul_f32 v229, v229, v160
v_mfma_f32_16x16x32_bf16 v[24:27], a[148:151], a[60:63], v[24:27]
ds_read_b64_tr_b16 a[172:173], v241 offset:28672
v_rcp_f32 v236, v236
v_mfma_f32_16x16x32_bf16 v[24:27], a[144:147], a[52:55], v[24:27]
s_waitcnt lgkmcnt(7)
ds_read_b64_tr_b16 a[174:175], v241 offset:30720
buffer_load_dwordx4 v253, s[8:11], s55 offen offset:1024  lds
v_mfma_f32_16x16x32_bf16 v[24:27], a[152:155], a[68:71], v[24:27]
ds_read_b64_tr_b16 a[176:177], v241 offset:32768
v_add_f32 v228, 1.0, v228
v_mfma_f32_16x16x32_bf16 v[24:27], a[156:159], a[76:79], v[24:27]
ds_read_b64_tr_b16 a[178:179], v241 offset:34816
v_exp_f32 v230, v164
v_mfma_f32_16x16x32_bf16 v[20:23], a[156:159], a[72:75], v[20:23]
ds_read_b64_tr_b16 a[180:181], v241 offset:36864
v_mul_f32 v236, v236, v161
v_mfma_f32_16x16x32_bf16 v[20:23], a[152:155], a[64:67], v[20:23]
s_waitcnt lgkmcnt(7)
ds_read_b64_tr_b16 a[182:183], v241 offset:38912
v_rcp_f32 v228, v228
v_mfma_f32_16x16x32_bf16 v[20:23], a[160:163], v[64:67], v[20:23]
s_mul_i32 s54, s66, 4608
ds_read_b64_tr_b16 a[184:185], v241 offset:40960
v_add_f32 v231, 1.0, v231
v_mfma_f32_16x16x32_bf16 v[20:23], a[164:167], v[68:71], v[20:23]
s_add_u32 s54, s54, s70
ds_read_b64_tr_b16 a[186:187], v241 offset:43008
v_cvt_pk_bf16_f32 v48, v229, v236
v_mfma_f32_16x16x32_bf16 v[24:27], a[164:167], v[76:79], v[24:27]
s_addk_i32 m0, 0x2000
ds_read_b64_tr_b16 a[188:189], v241 offset:45056
v_exp_f32 v236, v165
v_mfma_f32_16x16x32_bf16 v[24:27], a[160:163], v[72:75], v[24:27]
s_waitcnt lgkmcnt(7)
ds_read_b64_tr_b16 a[190:191], v241 offset:47104
buffer_load_dwordx4 v254, s[8:11], s54 offen  lds
v_mfma_f32_16x16x32_bf16 v[24:27], a[168:171], v[88:91], v[24:27]
ds_read_b64_tr_b16 a[144:145], v240 offset:0
v_mul_f32 v228, v228, v162
v_rcp_f32 v231, v231
v_mfma_f32_16x16x32_bf16 v[24:27], a[172:175], v[92:95], v[24:27]
ds_read_b64_tr_b16 a[146:147], v240 offset:2048
v_add_f32 v230, 1.0, v230
v_mfma_f32_16x16x32_bf16 v[20:23], a[172:175], v[84:87], v[20:23]
ds_read_b64_tr_b16 a[148:149], v240 offset:4096
v_exp_f32 v229, v166
v_mfma_f32_16x16x32_bf16 v[20:23], a[168:171], v[80:83], v[20:23]
s_waitcnt lgkmcnt(7)
ds_read_b64_tr_b16 a[150:151], v240 offset:6144
v_mul_f32 v231, v231, v163
v_mfma_f32_16x16x32_bf16 v[20:23], a[176:179], v[96:99], v[20:23]
LF_p3:
s_cbranch_execz LF
ds_read_b64_tr_b16 a[152:153], v240 offset:8192
v_rcp_f32 v230, v230
v_mfma_f32_16x16x32_bf16 v[20:23], a[180:183], v[100:103], v[20:23]
ds_read_b64_tr_b16 a[154:155], v240 offset:10240
v_add_f32 v236, 1.0, v236
v_mfma_f32_16x16x32_bf16 v[24:27], a[180:183], v[108:111], v[24:27]
ds_read_b64_tr_b16 a[156:157], v240 offset:12288
v_cvt_pk_bf16_f32 v49, v228, v231
v_mfma_f32_16x16x32_bf16 v[24:27], a[176:179], v[104:107], v[24:27]
s_waitcnt lgkmcnt(7)
ds_read_b64_tr_b16 a[158:159], v240 offset:14336
buffer_load_dwordx4 v253, s[8:11], s54 offen offset:1024  lds
v_mfma_f32_16x16x32_bf16 v[24:27], a[184:187], v[120:123], v[24:27]
ds_read_b64_tr_b16 a[160:161], v240 offset:16384
v_exp_f32 v231, v167
v_mfma_f32_16x16x32_bf16 v[24:27], a[188:191], v[124:127], v[24:27]
ds_read_b64_tr_b16 a[162:163], v240 offset:18432
v_mul_f32 v230, v230, v164
v_mfma_f32_16x16x32_bf16 v[20:23], a[188:191], v[116:119], v[20:23]
ds_read_b64_tr_b16 a[164:165], v240 offset:20480
v_rcp_f32 v236, v236
v_mfma_f32_16x16x32_bf16 v[20:23], a[184:187], v[112:115], v[20:23]
s_waitcnt lgkmcnt(7)
ds_read_b64_tr_b16 a[166:167], v240 offset:22528
v_add_f32 v229, 1.0, v229
v_mfma_f32_16x16x32_bf16 v[28:31], a[144:147], a[48:51], v[28:31]
s_mul_i32 s55, s58, 4608
ds_read_b64_tr_b16 a[168:169], v240 offset:24576
v_exp_f32 v228, v136
v_mfma_f32_16x16x32_bf16 v[28:31], a[148:151], a[56:59], v[28:31]
s_add_u32 s55, s55, s71
ds_read_b64_tr_b16 a[170:171], v240 offset:26624
v_mul_f32 v236, v236, v165
v_mfma_f32_16x16x32_bf16 v[32:35], a[148:151], a[60:63], v[32:35]
s_addk_i32 m0, 0x2000
ds_read_b64_tr_b16 a[172:173], v240 offset:28672
v_rcp_f32 v229, v229
v_mfma_f32_16x16x32_bf16 v[32:35], a[144:147], a[52:55], v[32:35]
s_waitcnt lgkmcnt(7)
ds_read_b64_tr_b16 a[174:175], v240 offset:30720
buffer_load_dwordx4 v254, s[8:11], s55 offen  lds
v_mfma_f32_16x16x32_bf16 v[32:35], a[152:155], a[68:71], v[32:35]
ds_read_b64_tr_b16 a[176:177], v240 offset:32768
v_add_f32 v231, 1.0, v231
v_mfma_f32_16x16x32_bf16 v[32:35], a[156:159], a[76:79], v[32:35]
ds_read_b64_tr_b16 a[178:179], v240 offset:34816
v_cvt_pk_bf16_f32 v46, v230, v236
v_mfma_f32_16x16x32_bf16 v[28:31], a[156:159], a[72:75], v[28:31]
ds_read_b64_tr_b16 a[180:181], v240 offset:36864
v_exp_f32 v236, v137
v_mfma_f32_16x16x32_bf16 v[28:31], a[152:155], a[64:67], v[28:31]
s_waitcnt lgkmcnt(7)
ds_read_b64_tr_b16 a[182:183], v240 offset:38912
v_mul_f32 v229, v229, v166
v_mfma_f32_16x16x32_bf16 v[28:31], a[160:163], v[64:67], v[28:31]
ds_read_b64_tr_b16 a[184:185], v240 offset:40960
v_rcp_f32 v231, v231
v_mfma_f32_16x16x32_bf16 v[28:31], a[164:167], v[68:71], v[28:31]
ds_read_b64_tr_b16 a[186:187], v240 offset:43008
v_add_f32 v228, 1.0, v228
v_mfma_f32_16x16x32_bf16 v[32:35], a[164:167], v[76:79], v[32:35]
ds_read_b64_tr_b16 a[188:189], v240 offset:45056
v_exp_f32 v230, v138
v_mfma_f32_16x16x32_bf16 v[32:35], a[160:163], v[72:75], v[32:35]
s_waitcnt lgkmcnt(7)
ds_read_b64_tr_b16 a[190:191], v240 offset:47104
buffer_load_dwordx4 v253, s[8:11], s55 offen offset:1024  lds
v_mfma_f32_16x16x32_bf16 v[32:35], a[168:171], v[88:91], v[32:35]
ds_read_b64_tr_b16 a[144:145], v239 offset:0
v_mul_f32 v231, v231, v167
v_mfma_f32_16x16x32_bf16 v[32:35], a[172:175], v[92:95], v[32:35]
ds_read_b64_tr_b16 a[146:147], v239 offset:2048
v_rcp_f32 v228, v228
v_mfma_f32_16x16x32_bf16 v[28:31], a[172:175], v[84:87], v[28:31]
ds_read_b64_tr_b16 a[148:149], v239 offset:4096
v_add_f32 v236, 1.0, v236
v_mfma_f32_16x16x32_bf16 v[28:31], a[168:171], v[80:83], v[28:31]
s_waitcnt lgkmcnt(7)
ds_read_b64_tr_b16 a[150:151], v239 offset:6144
v_cvt_pk_bf16_f32 v47, v229, v231
v_mfma_f32_16x16x32_bf16 v[28:31], a[176:179], v[96:99], v[28:31]
s_mul_i32 s54, s59, 4608
ds_read_b64_tr_b16 a[152:153], v239 offset:8192
v_exp_f32 v231, v139
v_mfma_f32_16x16x32_bf16 v[28:31], a[180:183], v[100:103], v[28:31]
s_add_u32 s54, s54, s71
ds_read_b64_tr_b16 a[154:155], v239 offset:10240
v_mul_f32 v228, v228, v136
v_mfma_f32_16x16x32_bf16 v[32:35], a[180:183], v[108:111], v[32:35]
s_addk_i32 m0, 0x2000
ds_read_b64_tr_b16 a[156:157], v239 offset:12288
v_rcp_f32 v236, v236
v_mfma_f32_16x16x32_bf16 v[32:35], a[176:179], v[104:107], v[32:35]
s_waitcnt lgkmcnt(7)
ds_read_b64_tr_b16 a[158:159], v239 offset:14336
buffer_load_dwordx4 v254, s[8:11], s54 offen  lds
v_mfma_f32_16x16x32_bf16 v[32:35], a[184:187], v[120:123], v[32:35]
ds_read_b64_tr_b16 a[160:161], v239 offset:16384
v_add_f32 v230, 1.0, v230
v_mfma_f32_16x16x32_bf16 v[32:35], a[188:191], v[124:127], v[32:35]
ds_read_b64_tr_b16 a[162:163], v239 offset:18432
v_exp_f32 v229, v16
v_mfma_f32_16x16x32_bf16 v[28:31], a[188:191], v[116:119], v[28:31]
ds_read_b64_tr_b16 a[164:165], v239 offset:20480
v_mul_f32 v236, v236, v137
v_mfma_f32_16x16x32_bf16 v[28:31], a[184:187], v[112:115], v[28:31]
s_waitcnt lgkmcnt(7)
ds_read_b64_tr_b16 a[166:167], v239 offset:22528
v_rcp_f32 v230, v230
v_mfma_f32_16x16x32_bf16 v[36:39], a[144:147], a[48:51], v[36:39]
ds_read_b64_tr_b16 a[168:169], v239 offset:24576
v_add_f32 v231, 1.0, v231
v_mfma_f32_16x16x32_bf16 v[36:39], a[148:151], a[56:59], v[36:39]
ds_read_b64_tr_b16 a[170:171], v239 offset:26624
v_cvt_pk_bf16_f32 v50, v228, v236
v_mfma_f32_16x16x32_bf16 v[40:43], a[148:151], a[60:63], v[40:43]
ds_read_b64_tr_b16 a[172:173], v239 offset:28672
v_exp_f32 v236, v17
v_mfma_f32_16x16x32_bf16 v[40:43], a[144:147], a[52:55], v[40:43]
s_waitcnt lgkmcnt(7)
ds_read_b64_tr_b16 a[174:175], v239 offset:30720
buffer_load_dwordx4 v253, s[8:11], s54 offen offset:1024  lds
v_mfma_f32_16x16x32_bf16 v[40:43], a[152:155], a[68:71], v[40:43]
ds_read_b64_tr_b16 a[176:177], v239 offset:32768
v_mul_f32 v230, v230, v138
v_mfma_f32_16x16x32_bf16 v[40:43], a[156:159], a[76:79], v[40:43]
ds_read_b64_tr_b16 a[178:179], v239 offset:34816
v_rcp_f32 v231, v231
v_mfma_f32_16x16x32_bf16 v[36:39], a[156:159], a[72:75], v[36:39]
ds_read_b64_tr_b16 a[180:181], v239 offset:36864
v_add_f32 v229, 1.0, v229
v_mfma_f32_16x16x32_bf16 v[36:39], a[152:155], a[64:67], v[36:39]
s_waitcnt lgkmcnt(7)
ds_read_b64_tr_b16 a[182:183], v239 offset:38912
v_exp_f32 v228, v18
v_mfma_f32_16x16x32_bf16 v[36:39], a[160:163], v[64:67], v[36:39]
s_mul_i32 s55, s60, 4608
ds_read_b64_tr_b16 a[184:185], v239 offset:40960
v_mul_f32 v231, v231, v139
v_mfma_f32_16x16x32_bf16 v[36:39], a[164:167], v[68:71], v[36:39]
s_add_u32 s55, s55, s71
ds_read_b64_tr_b16 a[186:187], v239 offset:43008
v_rcp_f32 v229, v229
v_mfma_f32_16x16x32_bf16 v[40:43], a[164:167], v[76:79], v[40:43]
s_waitcnt vmcnt(10)
ds_read_b64_tr_b16 a[188:189], v239 offset:45056
v_add_f32 v236, 1.0, v236
v_mfma_f32_16x16x32_bf16 v[40:43], a[160:163], v[72:75], v[40:43]
s_waitcnt lgkmcnt(7)
ds_read_b64_tr_b16 a[190:191], v239 offset:47104
v_cvt_pk_bf16_f32 v51, v230, v231
v_mfma_f32_16x16x32_bf16 v[40:43], a[168:171], v[88:91], v[40:43]
s_barrier
ds_read_b64_tr_b16 a[144:145], v235 offset:0
v_exp_f32 v231, v19
v_mfma_f32_16x16x32_bf16 v[40:43], a[172:175], v[92:95], v[40:43]
s_addk_i32 m0, 0x2000
ds_read_b64_tr_b16 a[146:147], v235 offset:2048
v_mul_f32 v229, v229, v16
v_mfma_f32_16x16x32_bf16 v[36:39], a[172:175], v[84:87], v[36:39]
ds_read_b64_tr_b16 a[148:149], v235 offset:4096
buffer_load_dwordx4 v254, s[8:11], s55 offen  lds
v_mfma_f32_16x16x32_bf16 v[36:39], a[168:171], v[80:83], v[36:39]
s_waitcnt lgkmcnt(7)
ds_read_b64_tr_b16 a[150:151], v235 offset:6144
v_rcp_f32 v236, v236
v_mfma_f32_16x16x32_bf16 v[36:39], a[176:179], v[96:99], v[36:39]
ds_read_b64_tr_b16 a[152:153], v235 offset:8192
v_add_f32 v228, 1.0, v228
v_mfma_f32_16x16x32_bf16 v[36:39], a[180:183], v[100:103], v[36:39]
ds_read_b64_tr_b16 a[154:155], v235 offset:10240
v_exp_f32 v230, v8
v_mfma_f32_16x16x32_bf16 v[40:43], a[180:183], v[108:111], v[40:43]
ds_read_b64_tr_b16 a[156:157], v235 offset:12288
v_mul_f32 v236, v236, v17
v_mfma_f32_16x16x32_bf16 v[40:43], a[176:179], v[104:107], v[40:43]
s_waitcnt lgkmcnt(7)
ds_read_b64_tr_b16 a[158:159], v235 offset:14336
v_rcp_f32 v228, v228
v_mfma_f32_16x16x32_bf16 v[40:43], a[184:187], v[120:123], v[40:43]
ds_read_b64_tr_b16 a[160:161], v235 offset:16384
v_add_f32 v231, 1.0, v231
v_mfma_f32_16x16x32_bf16 v[40:43], a[188:191], v[124:127], v[40:43]
ds_read_b64_tr_b16 a[162:163], v235 offset:18432
v_cvt_pk_bf16_f32 v52, v229, v236
v_exp_f32 v236, v9
v_mfma_f32_16x16x32_bf16 v[36:39], a[188:191], v[116:119], v[36:39]
ds_read_b64_tr_b16 a[164:165], v235 offset:20480
buffer_load_dwordx4 v253, s[8:11], s55 offen offset:1024  lds
v_mfma_f32_16x16x32_bf16 v[36:39], a[184:187], v[112:115], v[36:39]
s_waitcnt lgkmcnt(7)
ds_read_b64_tr_b16 a[166:167], v235 offset:22528
v_mul_f32 v228, v228, v18
v_mfma_f32_16x16x32_bf16 v[56:59], a[144:147], a[0:3], 0
s_mul_i32 s54, s61, 4608
ds_read_b64_tr_b16 a[168:169], v235 offset:24576
v_rcp_f32 v231, v231
v_mfma_f32_16x16x32_bf16 v[56:59], a[148:151], a[8:11], v[56:59]
s_add_u32 s54, s54, s71
ds_read_b64_tr_b16 a[170:171], v235 offset:26624
v_add_f32 v230, 1.0, v230
v_mfma_f32_16x16x32_bf16 v[60:63], a[148:151], a[12:15], 0
s_addk_i32 m0, 0x2000
ds_read_b64_tr_b16 a[172:173], v235 offset:28672
v_exp_f32 v229, v10
v_mfma_f32_16x16x32_bf16 v[60:63], a[144:147], a[4:7], v[60:63]
s_waitcnt lgkmcnt(7)
ds_read_b64_tr_b16 a[174:175], v235 offset:30720
buffer_load_dwordx4 v254, s[8:11], s54 offen  lds
v_mfma_f32_16x16x32_bf16 v[60:63], a[152:155], a[20:23], v[60:63]
ds_read_b64_tr_b16 a[176:177], v235 offset:32768
v_mul_f32 v231, v231, v19
v_mfma_f32_16x16x32_bf16 v[60:63], a[156:159], a[28:31], v[60:63]
ds_read_b64_tr_b16 a[178:179], v235 offset:34816
v_rcp_f32 v230, v230
v_mfma_f32_16x16x32_bf16 v[56:59], a[156:159], a[24:27], v[56:59]
ds_read_b64_tr_b16 a[180:181], v235 offset:36864
v_add_f32 v236, 1.0, v236
v_mfma_f32_16x16x32_bf16 v[56:59], a[152:155], a[16:19], v[56:59]
s_waitcnt lgkmcnt(7)
ds_read_b64_tr_b16 a[182:183], v235 offset:38912
v_cvt_pk_bf16_f32 v53, v228, v231
v_mfma_f32_16x16x32_bf16 v[56:59], a[160:163], a[32:35], v[56:59]
ds_read_b64_tr_b16 a[184:185], v235 offset:40960
v_exp_f32 v231, v11
v_mfma_f32_16x16x32_bf16 v[56:59], a[164:167], a[40:43], v[56:59]
ds_read_b64_tr_b16 a[186:187], v235 offset:43008
v_mul_f32 v230, v230, v8
v_mfma_f32_16x16x32_bf16 v[60:63], a[164:167], a[44:47], v[60:63]
ds_read_b64_tr_b16 a[188:189], v235 offset:45056
v_rcp_f32 v236, v236
v_mfma_f32_16x16x32_bf16 v[60:63], a[160:163], a[36:39], v[60:63]
s_waitcnt lgkmcnt(7)
ds_read_b64_tr_b16 a[190:191], v235 offset:47104
buffer_load_dwordx4 v253, s[8:11], s54 offen offset:1024  lds
v_mfma_f32_16x16x32_bf16 v[60:63], a[168:171], a[52:55], v[60:63]
ds_read_b64_tr_b16 a[144:145], v248 offset:0
v_add_f32 v229, 1.0, v229
v_mfma_f32_16x16x32_bf16 v[60:63], a[172:175], a[60:63], v[60:63]
ds_read_b64_tr_b16 a[146:147], v248 offset:2048
v_exp_f32 v228, v24
v_mfma_f32_16x16x32_bf16 v[56:59], a[172:175], a[56:59], v[56:59]
ds_read_b64_tr_b16 a[148:149], v248 offset:4096
v_mul_f32 v236, v236, v9
v_mfma_f32_16x16x32_bf16 v[56:59], a[168:171], a[48:51], v[56:59]
s_waitcnt lgkmcnt(7)
ds_read_b64_tr_b16 a[150:151], v248 offset:6144
v_rcp_f32 v229, v229
v_mfma_f32_16x16x32_bf16 v[56:59], a[176:179], a[64:67], v[56:59]
s_mul_i32 s55, s62, 4608
ds_read_b64_tr_b16 a[152:153], v248 offset:8192
v_add_f32 v231, 1.0, v231
v_mfma_f32_16x16x32_bf16 v[56:59], a[180:183], a[72:75], v[56:59]
s_add_u32 s55, s55, s71
ds_read_b64_tr_b16 a[154:155], v248 offset:10240
v_cvt_pk_bf16_f32 v16, v230, v236
v_mfma_f32_16x16x32_bf16 v[60:63], a[180:183], a[76:79], v[60:63]
s_addk_i32 m0, 0x2000
ds_read_b64_tr_b16 a[156:157], v248 offset:12288
v_exp_f32 v236, v25
v_mfma_f32_16x16x32_bf16 v[60:63], a[176:179], a[68:71], v[60:63]
s_waitcnt lgkmcnt(7)
ds_read_b64_tr_b16 a[158:159], v248 offset:14336
buffer_load_dwordx4 v254, s[8:11], s55 offen  lds
v_mfma_f32_16x16x32_bf16 v[60:63], a[184:187], v[72:75], v[60:63]
ds_read_b64_tr_b16 a[160:161], v248 offset:16384
v_mul_f32 v229, v229, v10
v_mfma_f32_16x16x32_bf16 v[60:63], a[188:191], v[76:79], v[60:63]
ds_read_b64_tr_b16 a[162:163], v248 offset:18432
v_rcp_f32 v231, v231
v_mfma_f32_16x16x32_bf16 v[56:59], a[188:191], v[68:71], v[56:59]
ds_read_b64_tr_b16 a[164:165], v248 offset:20480
v_add_f32 v228, 1.0, v228
v_mfma_f32_16x16x32_bf16 v[56:59], a[184:187], v[64:67], v[56:59]
s_waitcnt lgkmcnt(7)
ds_read_b64_tr_b16 a[166:167], v248 offset:22528
v_exp_f32 v230, v26
v_mfma_f32_16x16x32_bf16 v[128:131], a[144:147], a[0:3], 0
ds_read_b64_tr_b16 a[168:169], v248 offset:24576
v_mul_f32 v231, v231, v11
v_mfma_f32_16x16x32_bf16 v[128:131], a[148:151], a[8:11], v[128:131]
ds_read_b64_tr_b16 a[170:171], v248 offset:26624
v_rcp_f32 v228, v228
v_mfma_f32_16x16x32_bf16 v[8:11], a[148:151], a[12:15], 0
ds_read_b64_tr_b16 a[172:173], v248 offset:28672
v_add_f32 v236, 1.0, v236
v_mfma_f32_16x16x32_bf16 v[8:11], a[144:147], a[4:7], v[8:11]
s_waitcnt lgkmcnt(7)
ds_read_b64_tr_b16 a[174:175], v248 offset:30720
buffer_load_dwordx4 v253, s[8:11], s55 offen offset:1024  lds
v_mfma_f32_16x16x32_bf16 v[8:11], a[152:155], a[20:23], v[8:11]
ds_read_b64_tr_b16 a[176:177], v248 offset:32768
v_cvt_pk_bf16_f32 v17, v229, v231
v_mfma_f32_16x16x32_bf16 v[8:11], a[156:159], a[28:31], v[8:11]
ds_read_b64_tr_b16 a[178:179], v248 offset:34816
v_exp_f32 v231, v27
v_mfma_f32_16x16x32_bf16 v[128:131], a[156:159], a[24:27], v[128:131]
ds_read_b64_tr_b16 a[180:181], v248 offset:36864
v_mul_f32 v228, v228, v24
v_mfma_f32_16x16x32_bf16 v[128:131], a[152:155], a[16:19], v[128:131]
s_waitcnt lgkmcnt(7)
ds_read_b64_tr_b16 a[182:183], v248 offset:38912
v_rcp_f32 v236, v236
v_mfma_f32_16x16x32_bf16 v[128:131], a[160:163], a[32:35], v[128:131]
s_mul_i32 s54, s63, 4608
ds_read_b64_tr_b16 a[184:185], v248 offset:40960
v_add_f32 v230, 1.0, v230
v_mfma_f32_16x16x32_bf16 v[128:131], a[164:167], a[40:43], v[128:131]
s_add_u32 s54, s54, s71
ds_read_b64_tr_b16 a[186:187], v248 offset:43008
v_exp_f32 v229, v20
v_mfma_f32_16x16x32_bf16 v[8:11], a[164:167], a[44:47], v[8:11]
s_addk_i32 m0, 0x2000
ds_read_b64_tr_b16 a[188:189], v248 offset:45056
v_mul_f32 v236, v236, v25
v_mfma_f32_16x16x32_bf16 v[8:11], a[160:163], a[36:39], v[8:11]
s_waitcnt lgkmcnt(7)
ds_read_b64_tr_b16 a[190:191], v248 offset:47104
buffer_load_dwordx4 v254, s[8:11], s54 offen  lds
v_mfma_f32_16x16x32_bf16 v[8:11], a[168:171], a[52:55], v[8:11]
ds_read_b64_tr_b16 a[144:145], v234 offset:0
v_rcp_f32 v230, v230
v_mfma_f32_16x16x32_bf16 v[8:11], a[172:175], a[60:63], v[8:11]
ds_read_b64_tr_b16 a[146:147], v234 offset:2048
v_add_f32 v231, 1.0, v231
v_mfma_f32_16x16x32_bf16 v[128:131], a[172:175], a[56:59], v[128:131]
ds_read_b64_tr_b16 a[148:149], v234 offset:4096
v_cvt_pk_bf16_f32 v54, v228, v236
v_mfma_f32_16x16x32_bf16 v[128:131], a[168:171], a[48:51], v[128:131]
s_waitcnt lgkmcnt(7)
ds_read_b64_tr_b16 a[150:151], v234 offset:6144
v_exp_f32 v236, v21
v_mfma_f32_16x16x32_bf16 v[128:131], a[176:179], a[64:67], v[128:131]
ds_read_b64_tr_b16 a[152:153], v234 offset:8192
v_mul_f32 v230, v230, v26
v_mfma_f32_16x16x32_bf16 v[128:131], a[180:183], a[72:75], v[128:131]
ds_read_b64_tr_b16 a[154:155], v234 offset:10240
v_rcp_f32 v231, v231
v_mfma_f32_16x16x32_bf16 v[8:11], a[180:183], a[76:79], v[8:11]
ds_read_b64_tr_b16 a[156:157], v234 offset:12288
v_add_f32 v229, 1.0, v229
v_mfma_f32_16x16x32_bf16 v[8:11], a[176:179], a[68:71], v[8:11]
s_waitcnt lgkmcnt(7)
ds_read_b64_tr_b16 a[158:159], v234 offset:14336
buffer_load_dwordx4 v253, s[8:11], s54 offen offset:1024  lds
v_mfma_f32_16x16x32_bf16 v[8:11], a[184:187], v[72:75], v[8:11]
ds_read_b64_tr_b16 a[160:161], v234 offset:16384
v_exp_f32 v228, v22
v_mfma_f32_16x16x32_bf16 v[8:11], a[188:191], v[76:79], v[8:11]
ds_read_b64_tr_b16 a[162:163], v234 offset:18432
v_mul_f32 v231, v231, v27
v_mfma_f32_16x16x32_bf16 v[128:131], a[188:191], v[68:71], v[128:131]
ds_read_b64_tr_b16 a[164:165], v234 offset:20480
v_rcp_f32 v229, v229
v_mfma_f32_16x16x32_bf16 v[128:131], a[184:187], v[64:67], v[128:131]
s_waitcnt lgkmcnt(7)
ds_read_b64_tr_b16 a[166:167], v234 offset:22528
v_add_f32 v236, 1.0, v236
v_mfma_f32_16x16x32_bf16 v[24:27], a[144:147], a[0:3], 0
s_mul_i32 s55, s64, 4608
ds_read_b64_tr_b16 a[168:169], v234 offset:24576
v_cvt_pk_bf16_f32 v55, v230, v231
v_mfma_f32_16x16x32_bf16 v[24:27], a[148:151], a[8:11], v[24:27]
s_add_u32 s55, s55, s71
ds_read_b64_tr_b16 a[170:171], v234 offset:26624
v_exp_f32 v231, v23
v_mfma_f32_16x16x32_bf16 v[132:135], a[148:151], a[12:15], 0
s_addk_i32 m0, 0x2000
ds_read_b64_tr_b16 a[172:173], v234 offset:28672
v_mul_f32 v229, v229, v20
v_mfma_f32_16x16x32_bf16 v[132:135], a[144:147], a[4:7], v[132:135]
s_waitcnt lgkmcnt(7)
ds_read_b64_tr_b16 a[174:175], v234 offset:30720
buffer_load_dwordx4 v254, s[8:11], s55 offen  lds
v_mfma_f32_16x16x32_bf16 v[132:135], a[152:155], a[20:23], v[132:135]
ds_read_b64_tr_b16 a[176:177], v234 offset:32768
v_rcp_f32 v236, v236
v_mfma_f32_16x16x32_bf16 v[132:135], a[156:159], a[28:31], v[132:135]
ds_read_b64_tr_b16 a[178:179], v234 offset:34816
v_add_f32 v228, 1.0, v228
v_mfma_f32_16x16x32_bf16 v[24:27], a[156:159], a[24:27], v[24:27]
ds_read_b64_tr_b16 a[180:181], v234 offset:36864
v_exp_f32 v230, v32
v_mfma_f32_16x16x32_bf16 v[24:27], a[152:155], a[16:19], v[24:27]
s_waitcnt lgkmcnt(7)
ds_read_b64_tr_b16 a[182:183], v234 offset:38912
v_mul_f32 v236, v236, v21
v_rcp_f32 v228, v228
v_mfma_f32_16x16x32_bf16 v[24:27], a[160:163], a[32:35], v[24:27]
ds_read_b64_tr_b16 a[184:185], v234 offset:40960
v_add_f32 v231, 1.0, v231
v_mfma_f32_16x16x32_bf16 v[24:27], a[164:167], a[40:43], v[24:27]
ds_read_b64_tr_b16 a[186:187], v234 offset:43008
v_cvt_pk_bf16_f32 v18, v229, v236
v_mfma_f32_16x16x32_bf16 v[132:135], a[164:167], a[44:47], v[132:135]
ds_read_b64_tr_b16 a[188:189], v234 offset:45056
v_exp_f32 v236, v33
v_mfma_f32_16x16x32_bf16 v[132:135], a[160:163], a[36:39], v[132:135]
s_waitcnt lgkmcnt(7)
ds_read_b64_tr_b16 a[190:191], v234 offset:47104
buffer_load_dwordx4 v253, s[8:11], s55 offen offset:1024  lds
v_mfma_f32_16x16x32_bf16 v[132:135], a[168:171], a[52:55], v[132:135]
ds_read_b64_tr_b16 a[144:145], v233 offset:0
v_mul_f32 v228, v228, v22
v_mfma_f32_16x16x32_bf16 v[132:135], a[172:175], a[60:63], v[132:135]
ds_read_b64_tr_b16 a[146:147], v233 offset:2048
v_rcp_f32 v231, v231
v_mfma_f32_16x16x32_bf16 v[24:27], a[172:175], a[56:59], v[24:27]
ds_read_b64_tr_b16 a[148:149], v233 offset:4096
v_add_f32 v230, 1.0, v230
v_mfma_f32_16x16x32_bf16 v[24:27], a[168:171], a[48:51], v[24:27]
s_waitcnt lgkmcnt(7)
ds_read_b64_tr_b16 a[150:151], v233 offset:6144
v_exp_f32 v229, v34
v_mfma_f32_16x16x32_bf16 v[24:27], a[176:179], a[64:67], v[24:27]
s_mul_i32 s54, s65, 4608
ds_read_b64_tr_b16 a[152:153], v233 offset:8192
v_mul_f32 v231, v231, v23
v_mfma_f32_16x16x32_bf16 v[24:27], a[180:183], a[72:75], v[24:27]
s_add_u32 s54, s54, s71
ds_read_b64_tr_b16 a[154:155], v233 offset:10240
v_rcp_f32 v230, v230
v_mfma_f32_16x16x32_bf16 v[132:135], a[180:183], a[76:79], v[132:135]
s_addk_i32 m0, 0x2000
ds_read_b64_tr_b16 a[156:157], v233 offset:12288
v_add_f32 v236, 1.0, v236
v_mfma_f32_16x16x32_bf16 v[132:135], a[176:179], a[68:71], v[132:135]
s_waitcnt lgkmcnt(7)
ds_read_b64_tr_b16 a[158:159], v233 offset:14336
buffer_load_dwordx4 v254, s[8:11], s54 offen  lds
v_mfma_f32_16x16x32_bf16 v[132:135], a[184:187], v[72:75], v[132:135]
ds_read_b64_tr_b16 a[160:161], v233 offset:16384
v_cvt_pk_bf16_f32 v19, v228, v231
v_mfma_f32_16x16x32_bf16 v[132:135], a[188:191], v[76:79], v[132:135]
ds_read_b64_tr_b16 a[162:163], v233 offset:18432
v_exp_f32 v231, v35
v_mfma_f32_16x16x32_bf16 v[24:27], a[188:191], v[68:71], v[24:27]
ds_read_b64_tr_b16 a[164:165], v233 offset:20480
v_mul_f32 v230, v230, v32
v_mfma_f32_16x16x32_bf16 v[24:27], a[184:187], v[64:67], v[24:27]
s_waitcnt lgkmcnt(7)
ds_read_b64_tr_b16 a[166:167], v233 offset:22528
v_rcp_f32 v236, v236
v_mfma_f32_16x16x32_bf16 v[20:23], a[144:147], a[0:3], 0
ds_read_b64_tr_b16 a[168:169], v233 offset:24576
v_add_f32 v229, 1.0, v229
v_mfma_f32_16x16x32_bf16 v[20:23], a[148:151], a[8:11], v[20:23]
ds_read_b64_tr_b16 a[170:171], v233 offset:26624
v_exp_f32 v228, v28
v_mfma_f32_16x16x32_bf16 v[136:139], a[148:151], a[12:15], 0
ds_read_b64_tr_b16 a[172:173], v233 offset:28672
v_mul_f32 v236, v236, v33
v_mfma_f32_16x16x32_bf16 v[136:139], a[144:147], a[4:7], v[136:139]
s_waitcnt lgkmcnt(7)
ds_read_b64_tr_b16 a[174:175], v233 offset:30720
buffer_load_dwordx4 v253, s[8:11], s54 offen offset:1024  lds
v_mfma_f32_16x16x32_bf16 v[136:139], a[152:155], a[20:23], v[136:139]
ds_read_b64_tr_b16 a[176:177], v233 offset:32768
v_rcp_f32 v229, v229
v_mfma_f32_16x16x32_bf16 v[136:139], a[156:159], a[28:31], v[136:139]
ds_read_b64_tr_b16 a[178:179], v233 offset:34816
v_add_f32 v231, 1.0, v231
v_mfma_f32_16x16x32_bf16 v[20:23], a[156:159], a[24:27], v[20:23]
ds_read_b64_tr_b16 a[180:181], v233 offset:36864
v_cvt_pk_bf16_f32 v140, v230, v236
v_mfma_f32_16x16x32_bf16 v[20:23], a[152:155], a[16:19], v[20:23]
s_waitcnt lgkmcnt(7)
ds_read_b64_tr_b16 a[182:183], v233 offset:38912
v_exp_f32 v236, v29
v_mfma_f32_16x16x32_bf16 v[20:23], a[160:163], a[32:35], v[20:23]
s_mul_i32 s55, s66, 4608
ds_read_b64_tr_b16 a[184:185], v233 offset:40960
v_mul_f32 v229, v229, v34
v_mfma_f32_16x16x32_bf16 v[20:23], a[164:167], a[40:43], v[20:23]
s_add_u32 s55, s55, s71
ds_read_b64_tr_b16 a[186:187], v233 offset:43008
v_rcp_f32 v231, v231
v_mfma_f32_16x16x32_bf16 v[136:139], a[164:167], a[44:47], v[136:139]
s_waitcnt vmcnt(10)
ds_read_b64_tr_b16 a[188:189], v233 offset:45056
v_add_f32 v228, 1.0, v228
v_mfma_f32_16x16x32_bf16 v[136:139], a[160:163], a[36:39], v[136:139]
s_waitcnt lgkmcnt(7)
ds_read_b64_tr_b16 a[190:191], v233 offset:47104
v_exp_f32 v230, v30
v_mfma_f32_16x16x32_bf16 v[136:139], a[168:171], a[52:55], v[136:139]
s_barrier
ds_read_b64_tr_b16 a[144:145], v250 offset:0
v_mul_f32 v231, v231, v35
v_mfma_f32_16x16x32_bf16 v[136:139], a[172:175], a[60:63], v[136:139]
s_addk_i32 m0, 0x2000
ds_read_b64_tr_b16 a[146:147], v250 offset:2048
v_rcp_f32 v228, v228
v_mfma_f32_16x16x32_bf16 v[20:23], a[172:175], a[56:59], v[20:23]
ds_read_b64_tr_b16 a[148:149], v250 offset:4096
buffer_load_dwordx4 v254, s[8:11], s55 offen  lds
v_mfma_f32_16x16x32_bf16 v[20:23], a[168:171], a[48:51], v[20:23]
s_waitcnt lgkmcnt(7)
ds_read_b64_tr_b16 a[150:151], v250 offset:6144
v_add_f32 v236, 1.0, v236
v_mfma_f32_16x16x32_bf16 v[20:23], a[176:179], a[64:67], v[20:23]
ds_read_b64_tr_b16 a[152:153], v250 offset:8192
v_cvt_pk_bf16_f32 v141, v229, v231
v_mfma_f32_16x16x32_bf16 v[20:23], a[180:183], a[72:75], v[20:23]
ds_read_b64_tr_b16 a[154:155], v250 offset:10240
v_exp_f32 v231, v31
v_mfma_f32_16x16x32_bf16 v[136:139], a[180:183], a[76:79], v[136:139]
ds_read_b64_tr_b16 a[156:157], v250 offset:12288
v_mul_f32 v228, v228, v28
v_mfma_f32_16x16x32_bf16 v[136:139], a[176:179], a[68:71], v[136:139]
s_waitcnt lgkmcnt(7)
ds_read_b64_tr_b16 a[158:159], v250 offset:14336
v_rcp_f32 v236, v236
v_mfma_f32_16x16x32_bf16 v[136:139], a[184:187], v[72:75], v[136:139]
ds_read_b64_tr_b16 a[160:161], v250 offset:16384
v_add_f32 v230, 1.0, v230
v_mfma_f32_16x16x32_bf16 v[136:139], a[188:191], v[76:79], v[136:139]
ds_read_b64_tr_b16 a[162:163], v250 offset:18432
v_exp_f32 v229, v40
v_mfma_f32_16x16x32_bf16 v[20:23], a[188:191], v[68:71], v[20:23]
ds_read_b64_tr_b16 a[164:165], v250 offset:20480
buffer_load_dwordx4 v253, s[8:11], s55 offen offset:1024  lds
v_mfma_f32_16x16x32_bf16 v[20:23], a[184:187], v[64:67], v[20:23]
s_waitcnt lgkmcnt(7)
ds_read_b64_tr_b16 a[166:167], v250 offset:22528
v_mul_f32 v236, v236, v29
v_mfma_f32_16x16x32_bf16 v[56:59], a[144:147], v[80:83], v[56:59]
s_mul_i32 s54, s58, 4608
ds_read_b64_tr_b16 a[168:169], v245 offset:0
v_rcp_f32 v230, v230
v_mfma_f32_16x16x32_bf16 v[56:59], a[148:151], v[84:87], v[56:59]
s_add_u32 s54, s54, s72
ds_read_b64_tr_b16 a[170:171], v245 offset:2048
v_add_f32 v231, 1.0, v231
v_mfma_f32_16x16x32_bf16 v[60:63], a[148:151], v[92:95], v[60:63]
s_mov_b32 m0, s53
ds_read_b64_tr_b16 a[172:173], v245 offset:4096
v_cvt_pk_bf16_f32 v32, v228, v236
v_mfma_f32_16x16x32_bf16 v[60:63], a[144:147], v[88:91], v[60:63]
s_waitcnt lgkmcnt(7)
ds_read_b64_tr_b16 a[174:175], v245 offset:6144
buffer_load_dwordx4 v254, s[8:11], s54 offen  lds
v_mfma_f32_16x16x32_bf16 v[60:63], a[152:155], v[104:107], v[60:63]
ds_read_b64_tr_b16 a[176:177], v245 offset:8192
v_exp_f32 v236, v41
v_mfma_f32_16x16x32_bf16 v[60:63], a[156:159], v[108:111], v[60:63]
ds_read_b64_tr_b16 a[178:179], v245 offset:10240
v_mul_f32 v230, v230, v30
v_mfma_f32_16x16x32_bf16 v[56:59], a[156:159], v[100:103], v[56:59]
ds_read_b64_tr_b16 a[180:181], v245 offset:12288
v_rcp_f32 v231, v231
v_mfma_f32_16x16x32_bf16 v[56:59], a[152:155], v[96:99], v[56:59]
s_waitcnt lgkmcnt(7)
ds_read_b64_tr_b16 a[182:183], v245 offset:14336
v_add_f32 v229, 1.0, v229
v_mfma_f32_16x16x32_bf16 v[56:59], a[160:163], v[112:115], v[56:59]
ds_read_b64_tr_b16 a[184:185], v245 offset:16384
v_exp_f32 v228, v42
v_mfma_f32_16x16x32_bf16 v[56:59], a[164:167], v[116:119], v[56:59]
ds_read_b64_tr_b16 a[186:187], v245 offset:18432
v_mul_f32 v231, v231, v31
v_mfma_f32_16x16x32_bf16 v[60:63], a[164:167], v[124:127], v[60:63]
ds_read_b64_tr_b16 a[188:189], v245 offset:20480
v_rcp_f32 v229, v229
v_mfma_f32_16x16x32_bf16 v[60:63], a[160:163], v[120:123], v[60:63]
s_waitcnt lgkmcnt(7)
ds_read_b64_tr_b16 a[190:191], v245 offset:22528
buffer_load_dwordx4 v253, s[8:11], s54 offen offset:1024  lds
v_mfma_f32_16x16x32_bf16 v[128:131], a[168:171], v[80:83], v[128:131]
ds_read_b64_tr_b16 a[144:145], v244 offset:0
v_add_f32 v236, 1.0, v236
v_mfma_f32_16x16x32_bf16 v[128:131], a[172:175], v[84:87], v[128:131]
ds_read_b64_tr_b16 a[146:147], v244 offset:2048
v_cvt_pk_bf16_f32 v33, v230, v231
v_mfma_f32_16x16x32_bf16 v[8:11], a[172:175], v[92:95], v[8:11]
ds_read_b64_tr_b16 a[148:149], v244 offset:4096
v_exp_f32 v231, v43
v_mfma_f32_16x16x32_bf16 v[8:11], a[168:171], v[88:91], v[8:11]
s_waitcnt lgkmcnt(7)
ds_read_b64_tr_b16 a[150:151], v244 offset:6144
v_mul_f32 v229, v229, v40
v_mfma_f32_16x16x32_bf16 v[8:11], a[176:179], v[104:107], v[8:11]
s_mul_i32 s55, s59, 4608
ds_read_b64_tr_b16 a[152:153], v244 offset:8192
v_rcp_f32 v236, v236
v_add_f32 v228, 1.0, v228
v_mfma_f32_16x16x32_bf16 v[8:11], a[180:183], v[108:111], v[8:11]
s_add_u32 s55, s55, s72
ds_read_b64_tr_b16 a[154:155], v244 offset:10240
v_exp_f32 v230, v36
v_mfma_f32_16x16x32_bf16 v[128:131], a[180:183], v[100:103], v[128:131]
s_addk_i32 m0, 0x2000
ds_read_b64_tr_b16 a[156:157], v244 offset:12288
v_mul_f32 v236, v236, v41
v_mfma_f32_16x16x32_bf16 v[128:131], a[176:179], v[96:99], v[128:131]
s_waitcnt lgkmcnt(7)
ds_read_b64_tr_b16 a[158:159], v244 offset:14336
buffer_load_dwordx4 v254, s[8:11], s55 offen  lds
v_mfma_f32_16x16x32_bf16 v[128:131], a[184:187], v[112:115], v[128:131]
ds_read_b64_tr_b16 a[160:161], v244 offset:16384
v_rcp_f32 v228, v228
v_mfma_f32_16x16x32_bf16 v[128:131], a[188:191], v[116:119], v[128:131]
ds_read_b64_tr_b16 a[162:163], v244 offset:18432
v_add_f32 v231, 1.0, v231
v_mfma_f32_16x16x32_bf16 v[8:11], a[188:191], v[124:127], v[8:11]
ds_read_b64_tr_b16 a[164:165], v244 offset:20480
v_cvt_pk_bf16_f32 v142, v229, v236
v_mfma_f32_16x16x32_bf16 v[8:11], a[184:187], v[120:123], v[8:11]
s_waitcnt lgkmcnt(7)
ds_read_b64_tr_b16 a[166:167], v244 offset:22528
v_exp_f32 v236, v37
v_mfma_f32_16x16x32_bf16 v[24:27], a[144:147], v[80:83], v[24:27]
ds_read_b64_tr_b16 a[168:169], v243 offset:0
v_mul_f32 v228, v228, v42
v_mfma_f32_16x16x32_bf16 v[24:27], a[148:151], v[84:87], v[24:27]
LF_p4:
s_cbranch_execz LF_v105
ds_read_b64_tr_b16 a[170:171], v243 offset:2048
v_rcp_f32 v231, v231
v_mfma_f32_16x16x32_bf16 v[132:135], a[148:151], v[92:95], v[132:135]
ds_read_b64_tr_b16 a[172:173], v243 offset:4096
v_add_f32 v230, 1.0, v230
v_mfma_f32_16x16x32_bf16 v[132:135], a[144:147], v[88:91], v[132:135]
s_waitcnt lgkmcnt(7)
ds_read_b64_tr_b16 a[174:175], v243 offset:6144
buffer_load_dwordx4 v253, s[8:11], s55 offen offset:1024  lds
v_mfma_f32_16x16x32_bf16 v[132:135], a[152:155], v[104:107], v[132:135]
ds_read_b64_tr_b16 a[176:177], v243 offset:8192
v_exp_f32 v229, v38
v_mfma_f32_16x16x32_bf16 v[132:135], a[156:159], v[108:111], v[132:135]
ds_read_b64_tr_b16 a[178:179], v243 offset:10240
v_mul_f32 v231, v231, v43
v_mfma_f32_16x16x32_bf16 v[24:27], a[156:159], v[100:103], v[24:27]
ds_read_b64_tr_b16 a[180:181], v243 offset:12288
v_rcp_f32 v230, v230
v_mfma_f32_16x16x32_bf16 v[24:27], a[152:155], v[96:99], v[24:27]
s_waitcnt lgkmcnt(7)
ds_read_b64_tr_b16 a[182:183], v243 offset:14336
v_add_f32 v236, 1.0, v236
v_mfma_f32_16x16x32_bf16 v[24:27], a[160:163], v[112:115], v[24:27]
s_mul_i32 s54, s60, 4608
ds_read_b64_tr_b16 a[184:185], v243 offset:16384
v_cvt_pk_bf16_f32 v143, v228, v231
v_mfma_f32_16x16x32_bf16 v[24:27], a[164:167], v[116:119], v[24:27]
s_add_u32 s54, s54, s72
ds_read_b64_tr_b16 a[186:187], v243 offset:18432
v_exp_f32 v231, v39
v_mfma_f32_16x16x32_bf16 v[132:135], a[164:167], v[124:127], v[132:135]
s_addk_i32 m0, 0x2000
ds_read_b64_tr_b16 a[188:189], v243 offset:20480
v_mul_f32 v230, v230, v36
v_mfma_f32_16x16x32_bf16 v[132:135], a[160:163], v[120:123], v[132:135]
s_waitcnt lgkmcnt(7)
ds_read_b64_tr_b16 a[190:191], v243 offset:22528
buffer_load_dwordx4 v254, s[8:11], s54 offen  lds
v_mfma_f32_16x16x32_bf16 v[20:23], a[168:171], v[80:83], v[20:23]
ds_read_b64_tr_b16 a[144:145], v250 offset:24576
v_rcp_f32 v236, v236
v_mfma_f32_16x16x32_bf16 v[20:23], a[172:175], v[84:87], v[20:23]
ds_read_b64_tr_b16 a[146:147], v250 offset:26624
v_add_f32 v229, 1.0, v229
v_mfma_f32_16x16x32_bf16 v[136:139], a[172:175], v[92:95], v[136:139]
ds_read_b64_tr_b16 a[148:149], v250 offset:28672
v_exp_f32 v228, v56
v_mfma_f32_16x16x32_bf16 v[136:139], a[168:171], v[88:91], v[136:139]
s_waitcnt lgkmcnt(7)
ds_read_b64_tr_b16 a[150:151], v250 offset:30720
v_mul_f32 v236, v236, v37
v_mfma_f32_16x16x32_bf16 v[136:139], a[176:179], v[104:107], v[136:139]
ds_read_b64_tr_b16 a[152:153], v250 offset:32768
v_rcp_f32 v229, v229
v_mfma_f32_16x16x32_bf16 v[136:139], a[180:183], v[108:111], v[136:139]
ds_read_b64_tr_b16 a[154:155], v250 offset:34816
v_add_f32 v231, 1.0, v231
v_mfma_f32_16x16x32_bf16 v[20:23], a[180:183], v[100:103], v[20:23]
ds_read_b64_tr_b16 a[156:157], v250 offset:36864
v_cvt_pk_bf16_f32 v34, v230, v236
v_mfma_f32_16x16x32_bf16 v[20:23], a[176:179], v[96:99], v[20:23]
s_waitcnt lgkmcnt(7)
ds_read_b64_tr_b16 a[158:159], v250 offset:38912
buffer_load_dwordx4 v253, s[8:11], s54 offen offset:1024  lds
v_mfma_f32_16x16x32_bf16 v[20:23], a[184:187], v[112:115], v[20:23]
ds_read_b64_tr_b16 a[160:161], v250 offset:40960
v_exp_f32 v236, v57
v_mfma_f32_16x16x32_bf16 v[20:23], a[188:191], v[116:119], v[20:23]
ds_read_b64_tr_b16 a[162:163], v250 offset:43008
v_mul_f32 v229, v229, v38
v_mfma_f32_16x16x32_bf16 v[136:139], a[188:191], v[124:127], v[136:139]
ds_read_b64_tr_b16 a[164:165], v250 offset:45056
v_rcp_f32 v231, v231
v_mfma_f32_16x16x32_bf16 v[136:139], a[184:187], v[120:123], v[136:139]
s_waitcnt lgkmcnt(7)
ds_read_b64_tr_b16 a[166:167], v250 offset:47104
v_add_f32 v228, 1.0, v228
v_mfma_f32_16x16x32_bf16 v[28:31], a[144:147], a[0:3], 0
s_mul_i32 s55, s61, 4608
ds_read_b64_tr_b16 a[168:169], v245 offset:24576
v_exp_f32 v230, v58
v_mfma_f32_16x16x32_bf16 v[28:31], a[148:151], a[8:11], v[28:31]
s_add_u32 s55, s55, s72
ds_read_b64_tr_b16 a[170:171], v245 offset:26624
v_mul_f32 v231, v231, v39
v_mfma_f32_16x16x32_bf16 v[36:39], a[148:151], a[12:15], 0
s_addk_i32 m0, 0x2000
ds_read_b64_tr_b16 a[172:173], v245 offset:28672
v_rcp_f32 v228, v228
v_mfma_f32_16x16x32_bf16 v[36:39], a[144:147], a[4:7], v[36:39]
s_waitcnt lgkmcnt(7)
ds_read_b64_tr_b16 a[174:175], v245 offset:30720
buffer_load_dwordx4 v254, s[8:11], s55 offen  lds
v_mfma_f32_16x16x32_bf16 v[36:39], a[152:155], a[20:23], v[36:39]
ds_read_b64_tr_b16 a[176:177], v245 offset:32768
v_add_f32 v236, 1.0, v236
v_mfma_f32_16x16x32_bf16 v[36:39], a[156:159], a[28:31], v[36:39]
ds_read_b64_tr_b16 a[178:179], v245 offset:34816
v_cvt_pk_bf16_f32 v35, v229, v231
v_mfma_f32_16x16x32_bf16 v[28:31], a[156:159], a[24:27], v[28:31]
ds_read_b64_tr_b16 a[180:181], v245 offset:36864
v_exp_f32 v231, v59
v_mfma_f32_16x16x32_bf16 v[28:31], a[152:155], a[16:19], v[28:31]
s_waitcnt lgkmcnt(7)
ds_read_b64_tr_b16 a[182:183], v245 offset:38912
v_mul_f32 v228, v228, v56
v_mfma_f32_16x16x32_bf16 v[28:31], a[160:163], a[32:35], v[28:31]
ds_read_b64_tr_b16 a[184:185], v245 offset:40960
v_rcp_f32 v236, v236
v_mfma_f32_16x16x32_bf16 v[28:31], a[164:167], a[40:43], v[28:31]
ds_read_b64_tr_b16 a[186:187], v245 offset:43008
v_add_f32 v230, 1.0, v230
v_mfma_f32_16x16x32_bf16 v[36:39], a[164:167], a[44:47], v[36:39]
ds_read_b64_tr_b16 a[188:189], v245 offset:45056
v_exp_f32 v229, v60
v_mfma_f32_16x16x32_bf16 v[36:39], a[160:163], a[36:39], v[36:39]
s_waitcnt lgkmcnt(7)
ds_read_b64_tr_b16 a[190:191], v245 offset:47104
buffer_load_dwordx4 v253, s[8:11], s55 offen offset:1024  lds
v_mfma_f32_16x16x32_bf16 v[40:43], a[168:171], a[0:3], 0
ds_read_b64_tr_b16 a[144:145], v244 offset:24576
v_mul_f32 v236, v236, v57
v_mfma_f32_16x16x32_bf16 v[40:43], a[172:175], a[8:11], v[40:43]
ds_read_b64_tr_b16 a[146:147], v244 offset:26624
v_rcp_f32 v230, v230
v_mfma_f32_16x16x32_bf16 v[144:147], a[172:175], a[12:15], 0
ds_read_b64_tr_b16 a[148:149], v244 offset:28672
v_add_f32 v231, 1.0, v231
v_mfma_f32_16x16x32_bf16 v[144:147], a[168:171], a[4:7], v[144:147]
s_waitcnt lgkmcnt(7)
ds_read_b64_tr_b16 a[150:151], v244 offset:30720
v_cvt_pk_bf16_f32 v148, v228, v236
v_mfma_f32_16x16x32_bf16 v[144:147], a[176:179], a[20:23], v[144:147]
s_mul_i32 s54, s62, 4608
ds_read_b64_tr_b16 a[152:153], v244 offset:32768
v_exp_f32 v236, v61
v_mfma_f32_16x16x32_bf16 v[144:147], a[180:183], a[28:31], v[144:147]
s_add_u32 s54, s54, s72
ds_read_b64_tr_b16 a[154:155], v244 offset:34816
v_mul_f32 v230, v230, v58
v_mfma_f32_16x16x32_bf16 v[40:43], a[180:183], a[24:27], v[40:43]
s_addk_i32 m0, 0x2000
ds_read_b64_tr_b16 a[156:157], v244 offset:36864
v_rcp_f32 v231, v231
v_mfma_f32_16x16x32_bf16 v[40:43], a[176:179], a[16:19], v[40:43]
s_waitcnt lgkmcnt(7)
ds_read_b64_tr_b16 a[158:159], v244 offset:38912
buffer_load_dwordx4 v254, s[8:11], s54 offen  lds
v_mfma_f32_16x16x32_bf16 v[40:43], a[184:187], a[32:35], v[40:43]
ds_read_b64_tr_b16 a[160:161], v244 offset:40960
v_add_f32 v229, 1.0, v229
v_mfma_f32_16x16x32_bf16 v[40:43], a[188:191], a[40:43], v[40:43]
ds_read_b64_tr_b16 a[162:163], v244 offset:43008
v_exp_f32 v228, v62
v_mfma_f32_16x16x32_bf16 v[144:147], a[188:191], a[44:47], v[144:147]
ds_read_b64_tr_b16 a[164:165], v244 offset:45056
v_mul_f32 v231, v231, v59
v_mfma_f32_16x16x32_bf16 v[144:147], a[184:187], a[36:39], v[144:147]
s_waitcnt lgkmcnt(7)
ds_read_b64_tr_b16 a[166:167], v244 offset:47104
v_rcp_f32 v229, v229
v_mfma_f32_16x16x32_bf16 v[56:59], a[144:147], a[0:3], 0
ds_read_b64_tr_b16 a[168:169], v243 offset:24576
v_add_f32 v236, 1.0, v236
v_mfma_f32_16x16x32_bf16 v[56:59], a[148:151], a[8:11], v[56:59]
ds_read_b64_tr_b16 a[170:171], v243 offset:26624
v_cvt_pk_bf16_f32 v149, v230, v231
v_exp_f32 v231, v63
v_mfma_f32_16x16x32_bf16 v[152:155], a[148:151], a[12:15], 0
ds_read_b64_tr_b16 a[172:173], v243 offset:28672
v_mul_f32 v229, v229, v60
v_mfma_f32_16x16x32_bf16 v[152:155], a[144:147], a[4:7], v[152:155]
s_waitcnt lgkmcnt(7)
ds_read_b64_tr_b16 a[174:175], v243 offset:30720
buffer_load_dwordx4 v253, s[8:11], s54 offen offset:1024  lds
v_mfma_f32_16x16x32_bf16 v[152:155], a[152:155], a[20:23], v[152:155]
ds_read_b64_tr_b16 a[176:177], v243 offset:32768
v_rcp_f32 v236, v236
v_mfma_f32_16x16x32_bf16 v[152:155], a[156:159], a[28:31], v[152:155]
ds_read_b64_tr_b16 a[178:179], v243 offset:34816
v_add_f32 v228, 1.0, v228
v_mfma_f32_16x16x32_bf16 v[56:59], a[156:159], a[24:27], v[56:59]
ds_read_b64_tr_b16 a[180:181], v243 offset:36864
v_exp_f32 v230, v128
v_mfma_f32_16x16x32_bf16 v[56:59], a[152:155], a[16:19], v[56:59]
s_waitcnt lgkmcnt(7)
ds_read_b64_tr_b16 a[182:183], v243 offset:38912
v_mul_f32 v236, v236, v61
v_mfma_f32_16x16x32_bf16 v[56:59], a[160:163], a[32:35], v[56:59]
s_mul_i32 s55, s63, 4608
ds_read_b64_tr_b16 a[184:185], v243 offset:40960
v_rcp_f32 v228, v228
v_mfma_f32_16x16x32_bf16 v[56:59], a[164:167], a[40:43], v[56:59]
s_add_u32 s55, s55, s72
ds_read_b64_tr_b16 a[186:187], v243 offset:43008
v_add_f32 v231, 1.0, v231
v_mfma_f32_16x16x32_bf16 v[152:155], a[164:167], a[44:47], v[152:155]
s_waitcnt vmcnt(10)
ds_read_b64_tr_b16 a[188:189], v243 offset:45056
v_cvt_pk_bf16_f32 v156, v229, v236
v_mfma_f32_16x16x32_bf16 v[152:155], a[160:163], a[36:39], v[152:155]
s_waitcnt lgkmcnt(7)
ds_read_b64_tr_b16 a[190:191], v243 offset:47104
v_exp_f32 v236, v129
v_mfma_f32_16x16x32_bf16 v[160:163], a[168:171], a[0:3], 0
s_barrier
ds_read_b64_tr_b16 a[144:145], v242 offset:0
v_mul_f32 v228, v228, v62
v_mfma_f32_16x16x32_bf16 v[160:163], a[172:175], a[8:11], v[160:163]
s_addk_i32 m0, 0x2000
ds_read_b64_tr_b16 a[146:147], v242 offset:2048
v_rcp_f32 v231, v231
v_mfma_f32_16x16x32_bf16 v[164:167], a[172:175], a[12:15], 0
ds_read_b64_tr_b16 a[148:149], v242 offset:4096
buffer_load_dwordx4 v254, s[8:11], s55 offen  lds
v_mfma_f32_16x16x32_bf16 v[164:167], a[168:171], a[4:7], v[164:167]
s_waitcnt lgkmcnt(7)
ds_read_b64_tr_b16 a[150:151], v242 offset:6144
v_add_f32 v230, 1.0, v230
v_mfma_f32_16x16x32_bf16 v[164:167], a[176:179], a[20:23], v[164:167]
ds_read_b64_tr_b16 a[152:153], v242 offset:8192
v_exp_f32 v229, v130
v_mfma_f32_16x16x32_bf16 v[164:167], a[180:183], a[28:31], v[164:167]
ds_read_b64_tr_b16 a[154:155], v242 offset:10240
v_mul_f32 v231, v231, v63
v_mfma_f32_16x16x32_bf16 v[160:163], a[180:183], a[24:27], v[160:163]
ds_read_b64_tr_b16 a[156:157], v242 offset:12288
v_rcp_f32 v230, v230
v_mfma_f32_16x16x32_bf16 v[160:163], a[176:179], a[16:19], v[160:163]
s_waitcnt lgkmcnt(7)
ds_read_b64_tr_b16 a[158:159], v242 offset:14336
v_add_f32 v236, 1.0, v236
v_mfma_f32_16x16x32_bf16 v[160:163], a[184:187], a[32:35], v[160:163]
ds_read_b64_tr_b16 a[160:161], v242 offset:16384
v_cvt_pk_bf16_f32 v157, v228, v231
v_mfma_f32_16x16x32_bf16 v[160:163], a[188:191], a[40:43], v[160:163]
ds_read_b64_tr_b16 a[162:163], v242 offset:18432
v_exp_f32 v231, v131
v_mfma_f32_16x16x32_bf16 v[164:167], a[188:191], a[44:47], v[164:167]
ds_read_b64_tr_b16 a[164:165], v242 offset:20480
buffer_load_dwordx4 v253, s[8:11], s55 offen offset:1024  lds
v_mfma_f32_16x16x32_bf16 v[164:167], a[184:187], a[36:39], v[164:167]
s_waitcnt lgkmcnt(7)
ds_read_b64_tr_b16 a[166:167], v242 offset:22528
v_mul_f32 v230, v230, v128
v_mfma_f32_16x16x32_bf16 v[28:31], a[144:147], a[48:51], v[28:31]
s_mul_i32 s54, s64, 4608
ds_read_b64_tr_b16 a[168:169], v242 offset:24576
v_rcp_f32 v236, v236
v_mfma_f32_16x16x32_bf16 v[28:31], a[148:151], a[56:59], v[28:31]
s_add_u32 s54, s54, s72
ds_read_b64_tr_b16 a[170:171], v242 offset:26624
v_add_f32 v229, 1.0, v229
v_mfma_f32_16x16x32_bf16 v[36:39], a[148:151], a[60:63], v[36:39]
s_addk_i32 m0, 0x2000
ds_read_b64_tr_b16 a[172:173], v242 offset:28672
v_exp_f32 v228, v8
v_mfma_f32_16x16x32_bf16 v[36:39], a[144:147], a[52:55], v[36:39]
s_waitcnt lgkmcnt(7)
ds_read_b64_tr_b16 a[174:175], v242 offset:30720
buffer_load_dwordx4 v254, s[8:11], s54 offen  lds
v_mfma_f32_16x16x32_bf16 v[36:39], a[152:155], a[68:71], v[36:39]
ds_read_b64_tr_b16 a[176:177], v242 offset:32768
v_mul_f32 v236, v236, v129
v_mfma_f32_16x16x32_bf16 v[36:39], a[156:159], a[76:79], v[36:39]
ds_read_b64_tr_b16 a[178:179], v242 offset:34816
v_rcp_f32 v229, v229
v_mfma_f32_16x16x32_bf16 v[28:31], a[156:159], a[72:75], v[28:31]
ds_read_b64_tr_b16 a[180:181], v242 offset:36864
v_add_f32 v231, 1.0, v231
v_mfma_f32_16x16x32_bf16 v[28:31], a[152:155], a[64:67], v[28:31]
s_waitcnt lgkmcnt(7)
ds_read_b64_tr_b16 a[182:183], v242 offset:38912
v_cvt_pk_bf16_f32 v150, v230, v236
v_mfma_f32_16x16x32_bf16 v[28:31], a[160:163], v[64:67], v[28:31]
ds_read_b64_tr_b16 a[184:185], v242 offset:40960
v_exp_f32 v236, v9
v_mfma_f32_16x16x32_bf16 v[28:31], a[164:167], v[68:71], v[28:31]
ds_read_b64_tr_b16 a[186:187], v242 offset:43008
v_mul_f32 v229, v229, v130
v_mfma_f32_16x16x32_bf16 v[36:39], a[164:167], v[76:79], v[36:39]
ds_read_b64_tr_b16 a[188:189], v242 offset:45056
v_rcp_f32 v231, v231
v_mfma_f32_16x16x32_bf16 v[36:39], a[160:163], v[72:75], v[36:39]
s_waitcnt lgkmcnt(7)
ds_read_b64_tr_b16 a[190:191], v242 offset:47104
buffer_load_dwordx4 v253, s[8:11], s54 offen offset:1024  lds
v_mfma_f32_16x16x32_bf16 v[36:39], a[168:171], v[88:91], v[36:39]
ds_read_b64_tr_b16 a[144:145], v241 offset:0
v_add_f32 v228, 1.0, v228
v_mfma_f32_16x16x32_bf16 v[36:39], a[172:175], v[92:95], v[36:39]
ds_read_b64_tr_b16 a[146:147], v241 offset:2048
v_exp_f32 v230, v10
v_mfma_f32_16x16x32_bf16 v[28:31], a[172:175], v[84:87], v[28:31]
ds_read_b64_tr_b16 a[148:149], v241 offset:4096
v_mul_f32 v231, v231, v131
v_mfma_f32_16x16x32_bf16 v[28:31], a[168:171], v[80:83], v[28:31]
s_waitcnt lgkmcnt(7)
ds_read_b64_tr_b16 a[150:151], v241 offset:6144
v_rcp_f32 v228, v228
v_mfma_f32_16x16x32_bf16 v[28:31], a[176:179], v[96:99], v[28:31]
s_mul_i32 s55, s65, 4608
ds_read_b64_tr_b16 a[152:153], v241 offset:8192
v_add_f32 v236, 1.0, v236
v_mfma_f32_16x16x32_bf16 v[28:31], a[180:183], v[100:103], v[28:31]
s_add_u32 s55, s55, s72
ds_read_b64_tr_b16 a[154:155], v241 offset:10240
v_cvt_pk_bf16_f32 v151, v229, v231
v_mfma_f32_16x16x32_bf16 v[36:39], a[180:183], v[108:111], v[36:39]
s_addk_i32 m0, 0x2000
ds_read_b64_tr_b16 a[156:157], v241 offset:12288
v_exp_f32 v231, v11
v_mfma_f32_16x16x32_bf16 v[36:39], a[176:179], v[104:107], v[36:39]
s_waitcnt lgkmcnt(7)
ds_read_b64_tr_b16 a[158:159], v241 offset:14336
buffer_load_dwordx4 v254, s[8:11], s55 offen  lds
v_mfma_f32_16x16x32_bf16 v[36:39], a[184:187], v[120:123], v[36:39]
ds_read_b64_tr_b16 a[160:161], v241 offset:16384
v_mul_f32 v228, v228, v8
v_mfma_f32_16x16x32_bf16 v[36:39], a[188:191], v[124:127], v[36:39]
ds_read_b64_tr_b16 a[162:163], v241 offset:18432
v_rcp_f32 v236, v236
v_mfma_f32_16x16x32_bf16 v[28:31], a[188:191], v[116:119], v[28:31]
ds_read_b64_tr_b16 a[164:165], v241 offset:20480
v_add_f32 v230, 1.0, v230
v_mfma_f32_16x16x32_bf16 v[28:31], a[184:187], v[112:115], v[28:31]
s_waitcnt lgkmcnt(7)
ds_read_b64_tr_b16 a[166:167], v241 offset:22528
v_exp_f32 v229, v24
v_mfma_f32_16x16x32_bf16 v[40:43], a[144:147], a[48:51], v[40:43]
ds_read_b64_tr_b16 a[168:169], v241 offset:24576
v_mul_f32 v236, v236, v9
v_mfma_f32_16x16x32_bf16 v[40:43], a[148:151], a[56:59], v[40:43]
ds_read_b64_tr_b16 a[170:171], v241 offset:26624
v_rcp_f32 v230, v230
v_mfma_f32_16x16x32_bf16 v[144:147], a[148:151], a[60:63], v[144:147]
ds_read_b64_tr_b16 a[172:173], v241 offset:28672
v_add_f32 v231, 1.0, v231
v_mfma_f32_16x16x32_bf16 v[144:147], a[144:147], a[52:55], v[144:147]
s_waitcnt lgkmcnt(7)
ds_read_b64_tr_b16 a[174:175], v241 offset:30720
buffer_load_dwordx4 v253, s[8:11], s55 offen offset:1024  lds
v_mfma_f32_16x16x32_bf16 v[144:147], a[152:155], a[68:71], v[144:147]
ds_read_b64_tr_b16 a[176:177], v241 offset:32768
v_cvt_pk_bf16_f32 v158, v228, v236
v_mfma_f32_16x16x32_bf16 v[144:147], a[156:159], a[76:79], v[144:147]
ds_read_b64_tr_b16 a[178:179], v241 offset:34816
v_exp_f32 v236, v25
v_mfma_f32_16x16x32_bf16 v[40:43], a[156:159], a[72:75], v[40:43]
ds_read_b64_tr_b16 a[180:181], v241 offset:36864
v_mul_f32 v230, v230, v10
v_mfma_f32_16x16x32_bf16 v[40:43], a[152:155], a[64:67], v[40:43]
s_waitcnt lgkmcnt(7)
ds_read_b64_tr_b16 a[182:183], v241 offset:38912
v_rcp_f32 v231, v231
v_mfma_f32_16x16x32_bf16 v[40:43], a[160:163], v[64:67], v[40:43]
s_mul_i32 s54, s66, 4608
ds_read_b64_tr_b16 a[184:185], v241 offset:40960
v_add_f32 v229, 1.0, v229
v_mfma_f32_16x16x32_bf16 v[40:43], a[164:167], v[68:71], v[40:43]
s_add_u32 s54, s54, s72
ds_read_b64_tr_b16 a[186:187], v241 offset:43008
v_exp_f32 v228, v26
v_mfma_f32_16x16x32_bf16 v[144:147], a[164:167], v[76:79], v[144:147]
s_addk_i32 m0, 0x2000
ds_read_b64_tr_b16 a[188:189], v241 offset:45056
v_mul_f32 v231, v231, v11
v_rcp_f32 v229, v229
v_mfma_f32_16x16x32_bf16 v[144:147], a[160:163], v[72:75], v[144:147]
s_waitcnt lgkmcnt(7)
ds_read_b64_tr_b16 a[190:191], v241 offset:47104
buffer_load_dwordx4 v254, s[8:11], s54 offen  lds
v_mfma_f32_16x16x32_bf16 v[144:147], a[168:171], v[88:91], v[144:147]
ds_read_b64_tr_b16 a[144:145], v240 offset:0
v_add_f32 v236, 1.0, v236
v_mfma_f32_16x16x32_bf16 v[144:147], a[172:175], v[92:95], v[144:147]
ds_read_b64_tr_b16 a[146:147], v240 offset:2048
v_cvt_pk_bf16_f32 v159, v230, v231
v_mfma_f32_16x16x32_bf16 v[40:43], a[172:175], v[84:87], v[40:43]
ds_read_b64_tr_b16 a[148:149], v240 offset:4096
v_exp_f32 v231, v27
v_mfma_f32_16x16x32_bf16 v[40:43], a[168:171], v[80:83], v[40:43]
s_waitcnt lgkmcnt(7)
ds_read_b64_tr_b16 a[150:151], v240 offset:6144
v_mul_f32 v229, v229, v24
v_mfma_f32_16x16x32_bf16 v[40:43], a[176:179], v[96:99], v[40:43]
ds_read_b64_tr_b16 a[152:153], v240 offset:8192
v_rcp_f32 v236, v236
v_mfma_f32_16x16x32_bf16 v[40:43], a[180:183], v[100:103], v[40:43]
ds_read_b64_tr_b16 a[154:155], v240 offset:10240
v_add_f32 v228, 1.0, v228
v_mfma_f32_16x16x32_bf16 v[144:147], a[180:183], v[108:111], v[144:147]
ds_read_b64_tr_b16 a[156:157], v240 offset:12288
v_exp_f32 v230, v132
v_mfma_f32_16x16x32_bf16 v[144:147], a[176:179], v[104:107], v[144:147]
s_waitcnt lgkmcnt(7)
ds_read_b64_tr_b16 a[158:159], v240 offset:14336
buffer_load_dwordx4 v253, s[8:11], s54 offen offset:1024  lds
v_mfma_f32_16x16x32_bf16 v[144:147], a[184:187], v[120:123], v[144:147]
ds_read_b64_tr_b16 a[160:161], v240 offset:16384
v_mul_f32 v236, v236, v25
v_mfma_f32_16x16x32_bf16 v[144:147], a[188:191], v[124:127], v[144:147]
ds_read_b64_tr_b16 a[162:163], v240 offset:18432
v_rcp_f32 v228, v228
v_mfma_f32_16x16x32_bf16 v[40:43], a[188:191], v[116:119], v[40:43]
ds_read_b64_tr_b16 a[164:165], v240 offset:20480
v_add_f32 v231, 1.0, v231
v_mfma_f32_16x16x32_bf16 v[40:43], a[184:187], v[112:115], v[40:43]
s_waitcnt lgkmcnt(7)
ds_read_b64_tr_b16 a[166:167], v240 offset:22528
v_cvt_pk_bf16_f32 v8, v229, v236
v_mfma_f32_16x16x32_bf16 v[56:59], a[144:147], a[48:51], v[56:59]
s_mul_i32 s55, s58, 4608
ds_read_b64_tr_b16 a[168:169], v240 offset:24576
v_exp_f32 v236, v133
v_mfma_f32_16x16x32_bf16 v[56:59], a[148:151], a[56:59], v[56:59]
s_add_u32 s55, s55, s73
ds_read_b64_tr_b16 a[170:171], v240 offset:26624
v_mul_f32 v228, v228, v26
v_mfma_f32_16x16x32_bf16 v[152:155], a[148:151], a[60:63], v[152:155]
s_addk_i32 m0, 0x2000
ds_read_b64_tr_b16 a[172:173], v240 offset:28672
v_rcp_f32 v231, v231
v_mfma_f32_16x16x32_bf16 v[152:155], a[144:147], a[52:55], v[152:155]
s_waitcnt lgkmcnt(7)
ds_read_b64_tr_b16 a[174:175], v240 offset:30720
buffer_load_dwordx4 v254, s[8:11], s55 offen  lds
v_mfma_f32_16x16x32_bf16 v[152:155], a[152:155], a[68:71], v[152:155]
ds_read_b64_tr_b16 a[176:177], v240 offset:32768
v_add_f32 v230, 1.0, v230
v_mfma_f32_16x16x32_bf16 v[152:155], a[156:159], a[76:79], v[152:155]
ds_read_b64_tr_b16 a[178:179], v240 offset:34816
v_exp_f32 v229, v134
v_mfma_f32_16x16x32_bf16 v[56:59], a[156:159], a[72:75], v[56:59]
ds_read_b64_tr_b16 a[180:181], v240 offset:36864
v_mul_f32 v231, v231, v27
v_mfma_f32_16x16x32_bf16 v[56:59], a[152:155], a[64:67], v[56:59]
s_waitcnt lgkmcnt(7)
ds_read_b64_tr_b16 a[182:183], v240 offset:38912
v_rcp_f32 v230, v230
v_mfma_f32_16x16x32_bf16 v[56:59], a[160:163], v[64:67], v[56:59]
ds_read_b64_tr_b16 a[184:185], v240 offset:40960
v_add_f32 v236, 1.0, v236
v_mfma_f32_16x16x32_bf16 v[56:59], a[164:167], v[68:71], v[56:59]
ds_read_b64_tr_b16 a[186:187], v240 offset:43008
v_cvt_pk_bf16_f32 v9, v228, v231
v_mfma_f32_16x16x32_bf16 v[152:155], a[164:167], v[76:79], v[152:155]
ds_read_b64_tr_b16 a[188:189], v240 offset:45056
v_exp_f32 v231, v135
v_mfma_f32_16x16x32_bf16 v[152:155], a[160:163], v[72:75], v[152:155]
s_waitcnt lgkmcnt(7)
ds_read_b64_tr_b16 a[190:191], v240 offset:47104
buffer_load_dwordx4 v253, s[8:11], s55 offen offset:1024  lds
v_mfma_f32_16x16x32_bf16 v[152:155], a[168:171], v[88:91], v[152:155]
ds_read_b64_tr_b16 a[144:145], v239 offset:0
v_mul_f32 v230, v230, v132
v_mfma_f32_16x16x32_bf16 v[152:155], a[172:175], v[92:95], v[152:155]
ds_read_b64_tr_b16 a[146:147], v239 offset:2048
v_rcp_f32 v236, v236
v_mfma_f32_16x16x32_bf16 v[56:59], a[172:175], v[84:87], v[56:59]
ds_read_b64_tr_b16 a[148:149], v239 offset:4096
v_add_f32 v229, 1.0, v229
v_mfma_f32_16x16x32_bf16 v[56:59], a[168:171], v[80:83], v[56:59]
s_waitcnt lgkmcnt(7)
ds_read_b64_tr_b16 a[150:151], v239 offset:6144
v_exp_f32 v228, v20
v_mfma_f32_16x16x32_bf16 v[56:59], a[176:179], v[96:99], v[56:59]
s_mul_i32 s54, s59, 4608
ds_read_b64_tr_b16 a[152:153], v239 offset:8192
v_mul_f32 v236, v236, v133
v_mfma_f32_16x16x32_bf16 v[56:59], a[180:183], v[100:103], v[56:59]
s_add_u32 s54, s54, s73
ds_read_b64_tr_b16 a[154:155], v239 offset:10240
v_rcp_f32 v229, v229
v_mfma_f32_16x16x32_bf16 v[152:155], a[180:183], v[108:111], v[152:155]
s_addk_i32 m0, 0x2000
ds_read_b64_tr_b16 a[156:157], v239 offset:12288
v_add_f32 v231, 1.0, v231
v_mfma_f32_16x16x32_bf16 v[152:155], a[176:179], v[104:107], v[152:155]
s_waitcnt lgkmcnt(7)
ds_read_b64_tr_b16 a[158:159], v239 offset:14336
buffer_load_dwordx4 v254, s[8:11], s54 offen  lds
v_mfma_f32_16x16x32_bf16 v[152:155], a[184:187], v[120:123], v[152:155]
ds_read_b64_tr_b16 a[160:161], v239 offset:16384
v_cvt_pk_bf16_f32 v24, v230, v236
v_mfma_f32_16x16x32_bf16 v[152:155], a[188:191], v[124:127], v[152:155]
ds_read_b64_tr_b16 a[162:163], v239 offset:18432
v_exp_f32 v236, v21
v_mfma_f32_16x16x32_bf16 v[56:59], a[188:191], v[116:119], v[56:59]
ds_read_b64_tr_b16 a[164:165], v239 offset:20480
v_mul_f32 v229, v229, v134
v_mfma_f32_16x16x32_bf16 v[56:59], a[184:187], v[112:115], v[56:59]
s_waitcnt lgkmcnt(7)
ds_read_b64_tr_b16 a[166:167], v239 offset:22528
v_rcp_f32 v231, v231
v_mfma_f32_16x16x32_bf16 v[160:163], a[144:147], a[48:51], v[160:163]
ds_read_b64_tr_b16 a[168:169], v239 offset:24576
v_add_f32 v228, 1.0, v228
v_mfma_f32_16x16x32_bf16 v[160:163], a[148:151], a[56:59], v[160:163]
ds_read_b64_tr_b16 a[170:171], v239 offset:26624
v_exp_f32 v230, v22
v_mfma_f32_16x16x32_bf16 v[164:167], a[148:151], a[60:63], v[164:167]
ds_read_b64_tr_b16 a[172:173], v239 offset:28672
v_mul_f32 v231, v231, v135
v_mfma_f32_16x16x32_bf16 v[164:167], a[144:147], a[52:55], v[164:167]
s_waitcnt lgkmcnt(7)
ds_read_b64_tr_b16 a[174:175], v239 offset:30720
buffer_load_dwordx4 v253, s[8:11], s54 offen offset:1024  lds
v_mfma_f32_16x16x32_bf16 v[164:167], a[152:155], a[68:71], v[164:167]
ds_read_b64_tr_b16 a[176:177], v239 offset:32768
v_rcp_f32 v228, v228
v_mfma_f32_16x16x32_bf16 v[164:167], a[156:159], a[76:79], v[164:167]
ds_read_b64_tr_b16 a[178:179], v239 offset:34816
v_add_f32 v236, 1.0, v236
v_mfma_f32_16x16x32_bf16 v[160:163], a[156:159], a[72:75], v[160:163]
ds_read_b64_tr_b16 a[180:181], v239 offset:36864
v_cvt_pk_bf16_f32 v25, v229, v231
v_mfma_f32_16x16x32_bf16 v[160:163], a[152:155], a[64:67], v[160:163]
s_waitcnt lgkmcnt(7)
ds_read_b64_tr_b16 a[182:183], v239 offset:38912
v_exp_f32 v231, v23
v_mfma_f32_16x16x32_bf16 v[160:163], a[160:163], v[64:67], v[160:163]
s_mul_i32 s55, s60, 4608
ds_read_b64_tr_b16 a[184:185], v239 offset:40960
v_mul_f32 v228, v228, v20
v_mfma_f32_16x16x32_bf16 v[160:163], a[164:167], v[68:71], v[160:163]
s_add_u32 s55, s55, s73
ds_read_b64_tr_b16 a[186:187], v239 offset:43008
v_rcp_f32 v236, v236
v_mfma_f32_16x16x32_bf16 v[164:167], a[164:167], v[76:79], v[164:167]
s_waitcnt vmcnt(10)
ds_read_b64_tr_b16 a[188:189], v239 offset:45056
v_add_f32 v230, 1.0, v230
v_mfma_f32_16x16x32_bf16 v[164:167], a[160:163], v[72:75], v[164:167]
s_waitcnt lgkmcnt(7)
ds_read_b64_tr_b16 a[190:191], v239 offset:47104
v_exp_f32 v229, v136
v_mfma_f32_16x16x32_bf16 v[164:167], a[168:171], v[88:91], v[164:167]
s_barrier
ds_read_b64_tr_b16 a[144:145], v235 offset:0
v_mul_f32 v236, v236, v21
v_mfma_f32_16x16x32_bf16 v[164:167], a[172:175], v[92:95], v[164:167]
s_addk_i32 m0, 0x2000
ds_read_b64_tr_b16 a[146:147], v235 offset:2048
v_rcp_f32 v230, v230
v_mfma_f32_16x16x32_bf16 v[160:163], a[172:175], v[84:87], v[160:163]
ds_read_b64_tr_b16 a[148:149], v235 offset:4096
buffer_load_dwordx4 v254, s[8:11], s55 offen  lds
v_mfma_f32_16x16x32_bf16 v[160:163], a[168:171], v[80:83], v[160:163]
s_waitcnt lgkmcnt(7)
ds_read_b64_tr_b16 a[150:151], v235 offset:6144
v_add_f32 v231, 1.0, v231
v_mfma_f32_16x16x32_bf16 v[160:163], a[176:179], v[96:99], v[160:163]
ds_read_b64_tr_b16 a[152:153], v235 offset:8192
v_cvt_pk_bf16_f32 v10, v228, v236
v_mfma_f32_16x16x32_bf16 v[160:163], a[180:183], v[100:103], v[160:163]
ds_read_b64_tr_b16 a[154:155], v235 offset:10240
v_exp_f32 v236, v137
v_mfma_f32_16x16x32_bf16 v[164:167], a[180:183], v[108:111], v[164:167]
ds_read_b64_tr_b16 a[156:157], v235 offset:12288
v_mul_f32 v230, v230, v22
v_mfma_f32_16x16x32_bf16 v[164:167], a[176:179], v[104:107], v[164:167]
s_waitcnt lgkmcnt(7)
ds_read_b64_tr_b16 a[158:159], v235 offset:14336
v_rcp_f32 v231, v231
v_add_f32 v229, 1.0, v229
v_mfma_f32_16x16x32_bf16 v[164:167], a[184:187], v[120:123], v[164:167]
ds_read_b64_tr_b16 a[160:161], v235 offset:16384
v_exp_f32 v228, v138
v_mfma_f32_16x16x32_bf16 v[164:167], a[188:191], v[124:127], v[164:167]
ds_read_b64_tr_b16 a[162:163], v235 offset:18432
v_mul_f32 v231, v231, v23
v_mfma_f32_16x16x32_bf16 v[160:163], a[188:191], v[116:119], v[160:163]
ds_read_b64_tr_b16 a[164:165], v235 offset:20480
buffer_load_dwordx4 v253, s[8:11], s55 offen offset:1024  lds
v_mfma_f32_16x16x32_bf16 v[160:163], a[184:187], v[112:115], v[160:163]
s_waitcnt lgkmcnt(7)
ds_read_b64_tr_b16 a[166:167], v235 offset:22528
v_rcp_f32 v229, v229
v_mfma_f32_16x16x32_bf16 v[20:23], a[144:147], a[0:3], 0
s_mul_i32 s54, s61, 4608
ds_read_b64_tr_b16 a[168:169], v235 offset:24576
v_add_f32 v236, 1.0, v236
v_mfma_f32_16x16x32_bf16 v[20:23], a[148:151], a[8:11], v[20:23]
s_add_u32 s54, s54, s73
ds_read_b64_tr_b16 a[170:171], v235 offset:26624
v_cvt_pk_bf16_f32 v11, v230, v231
v_mfma_f32_16x16x32_bf16 v[60:63], a[148:151], a[12:15], 0
s_addk_i32 m0, 0x2000
ds_read_b64_tr_b16 a[172:173], v235 offset:28672
v_exp_f32 v231, v139
v_mfma_f32_16x16x32_bf16 v[60:63], a[144:147], a[4:7], v[60:63]
s_waitcnt lgkmcnt(7)
ds_read_b64_tr_b16 a[174:175], v235 offset:30720
buffer_load_dwordx4 v254, s[8:11], s54 offen  lds
v_mfma_f32_16x16x32_bf16 v[60:63], a[152:155], a[20:23], v[60:63]
ds_read_b64_tr_b16 a[176:177], v235 offset:32768
v_mul_f32 v229, v229, v136
v_mfma_f32_16x16x32_bf16 v[60:63], a[156:159], a[28:31], v[60:63]
ds_read_b64_tr_b16 a[178:179], v235 offset:34816
v_rcp_f32 v236, v236
v_mfma_f32_16x16x32_bf16 v[20:23], a[156:159], a[24:27], v[20:23]
ds_read_b64_tr_b16 a[180:181], v235 offset:36864
v_add_f32 v228, 1.0, v228
v_mfma_f32_16x16x32_bf16 v[20:23], a[152:155], a[16:19], v[20:23]
s_waitcnt lgkmcnt(7)
ds_read_b64_tr_b16 a[182:183], v235 offset:38912
v_mul_f32 v236, v236, v137
v_mfma_f32_16x16x32_bf16 v[20:23], a[160:163], a[32:35], v[20:23]
ds_read_b64_tr_b16 a[184:185], v235 offset:40960
v_rcp_f32 v228, v228
v_mfma_f32_16x16x32_bf16 v[20:23], a[164:167], a[40:43], v[20:23]
ds_read_b64_tr_b16 a[186:187], v235 offset:43008
v_add_f32 v231, 1.0, v231
v_mfma_f32_16x16x32_bf16 v[60:63], a[164:167], a[44:47], v[60:63]
ds_read_b64_tr_b16 a[188:189], v235 offset:45056
v_cvt_pk_bf16_f32 v26, v229, v236
v_mfma_f32_16x16x32_bf16 v[60:63], a[160:163], a[36:39], v[60:63]
s_waitcnt lgkmcnt(7)
ds_read_b64_tr_b16 a[190:191], v235 offset:47104
buffer_load_dwordx4 v253, s[8:11], s54 offen offset:1024  lds
v_mfma_f32_16x16x32_bf16 v[60:63], a[168:171], a[52:55], v[60:63]
LF_p5:
s_cbranch_execz LF_v105
ds_read_b64_tr_b16 a[144:145], v248 offset:0
v_mul_f32 v228, v228, v138
v_mfma_f32_16x16x32_bf16 v[60:63], a[172:175], a[60:63], v[60:63]
ds_read_b64_tr_b16 a[146:147], v248 offset:2048
v_rcp_f32 v231, v231
v_mfma_f32_16x16x32_bf16 v[20:23], a[172:175], a[56:59], v[20:23]
ds_read_b64_tr_b16 a[148:149], v248 offset:4096
v_mul_f32 v231, v231, v139
v_mfma_f32_16x16x32_bf16 v[20:23], a[168:171], a[48:51], v[20:23]
s_waitcnt lgkmcnt(7)
ds_read_b64_tr_b16 a[150:151], v248 offset:6144
v_cvt_pk_bf16_f32 v27, v228, v231
v_mfma_f32_16x16x32_bf16 v[20:23], a[176:179], a[64:67], v[20:23]
s_mul_i32 s55, s62, 4608
ds_read_b64_tr_b16 a[152:153], v248 offset:8192
v_mov_b32 v230, 1.0
v_mfma_f32_16x16x32_bf16 v[20:23], a[180:183], a[72:75], v[20:23]
s_add_u32 s55, s55, s73
ds_read_b64_tr_b16 a[154:155], v248 offset:10240
v_exp_f32 v128, v36
v_mfma_f32_16x16x32_bf16 v[60:63], a[180:183], a[76:79], v[60:63]
s_addk_i32 m0, 0x2000
ds_read_b64_tr_b16 a[156:157], v248 offset:12288
v_exp_f32 v129, v37
v_mfma_f32_16x16x32_bf16 v[60:63], a[176:179], a[68:71], v[60:63]
s_waitcnt lgkmcnt(7)
ds_read_b64_tr_b16 a[158:159], v248 offset:14336
buffer_load_dwordx4 v254, s[8:11], s55 offen  lds
v_mfma_f32_16x16x32_bf16 v[60:63], a[184:187], v[72:75], v[60:63]
ds_read_b64_tr_b16 a[160:161], v248 offset:16384
v_exp_f32 v130, v38
v_mfma_f32_16x16x32_bf16 v[60:63], a[188:191], v[76:79], v[60:63]
ds_read_b64_tr_b16 a[162:163], v248 offset:18432
v_exp_f32 v131, v39
v_mfma_f32_16x16x32_bf16 v[20:23], a[188:191], v[68:71], v[20:23]
ds_read_b64_tr_b16 a[164:165], v248 offset:20480
v_exp_f32 v132, v28
v_mfma_f32_16x16x32_bf16 v[20:23], a[184:187], v[64:67], v[20:23]
s_waitcnt lgkmcnt(7)
ds_read_b64_tr_b16 a[166:167], v248 offset:22528
v_exp_f32 v133, v29
v_mfma_f32_16x16x32_bf16 v[136:139], a[144:147], a[0:3], 0
ds_read_b64_tr_b16 a[168:169], v248 offset:24576
v_exp_f32 v134, v30
v_mfma_f32_16x16x32_bf16 v[136:139], a[148:151], a[8:11], v[136:139]
ds_read_b64_tr_b16 a[170:171], v248 offset:26624
v_exp_f32 v135, v31
v_mfma_f32_16x16x32_bf16 v[168:171], a[148:151], a[12:15], 0
ds_read_b64_tr_b16 a[172:173], v248 offset:28672
v_exp_f32 v172, v144
v_mfma_f32_16x16x32_bf16 v[168:171], a[144:147], a[4:7], v[168:171]
s_waitcnt lgkmcnt(7)
ds_read_b64_tr_b16 a[174:175], v248 offset:30720
buffer_load_dwordx4 v253, s[8:11], s55 offen offset:1024  lds
v_mfma_f32_16x16x32_bf16 v[168:171], a[152:155], a[20:23], v[168:171]
ds_read_b64_tr_b16 a[176:177], v248 offset:32768
v_exp_f32 v173, v145
v_mfma_f32_16x16x32_bf16 v[168:171], a[156:159], a[28:31], v[168:171]
ds_read_b64_tr_b16 a[178:179], v248 offset:34816
v_exp_f32 v174, v146
v_mfma_f32_16x16x32_bf16 v[136:139], a[156:159], a[24:27], v[136:139]
ds_read_b64_tr_b16 a[180:181], v248 offset:36864
v_exp_f32 v175, v147
v_mfma_f32_16x16x32_bf16 v[136:139], a[152:155], a[16:19], v[136:139]
s_waitcnt lgkmcnt(7)
ds_read_b64_tr_b16 a[182:183], v248 offset:38912
v_exp_f32 v176, v40
v_mfma_f32_16x16x32_bf16 v[136:139], a[160:163], a[32:35], v[136:139]
s_mul_i32 s54, s63, 4608
ds_read_b64_tr_b16 a[184:185], v248 offset:40960
v_exp_f32 v177, v41
v_mfma_f32_16x16x32_bf16 v[136:139], a[164:167], a[40:43], v[136:139]
s_add_u32 s54, s54, s73
ds_read_b64_tr_b16 a[186:187], v248 offset:43008
v_exp_f32 v178, v42
v_mfma_f32_16x16x32_bf16 v[168:171], a[164:167], a[44:47], v[168:171]
s_addk_i32 m0, 0x2000
ds_read_b64_tr_b16 a[188:189], v248 offset:45056
v_exp_f32 v179, v43
v_mfma_f32_16x16x32_bf16 v[168:171], a[160:163], a[36:39], v[168:171]
s_waitcnt lgkmcnt(7)
ds_read_b64_tr_b16 a[190:191], v248 offset:47104
buffer_load_dwordx4 v254, s[8:11], s54 offen  lds
v_mfma_f32_16x16x32_bf16 v[168:171], a[168:171], a[52:55], v[168:171]
ds_read_b64_tr_b16 a[144:145], v234 offset:0
v_exp_f32 v180, v152
v_mfma_f32_16x16x32_bf16 v[168:171], a[172:175], a[60:63], v[168:171]
ds_read_b64_tr_b16 a[146:147], v234 offset:2048
v_exp_f32 v181, v153
v_mfma_f32_16x16x32_bf16 v[136:139], a[172:175], a[56:59], v[136:139]
ds_read_b64_tr_b16 a[148:149], v234 offset:4096
v_exp_f32 v182, v154
v_mfma_f32_16x16x32_bf16 v[136:139], a[168:171], a[48:51], v[136:139]
s_waitcnt lgkmcnt(7)
ds_read_b64_tr_b16 a[150:151], v234 offset:6144
v_exp_f32 v183, v155
v_mfma_f32_16x16x32_bf16 v[136:139], a[176:179], a[64:67], v[136:139]
ds_read_b64_tr_b16 a[152:153], v234 offset:8192
v_exp_f32 v184, v56
v_mfma_f32_16x16x32_bf16 v[136:139], a[180:183], a[72:75], v[136:139]
ds_read_b64_tr_b16 a[154:155], v234 offset:10240
v_exp_f32 v185, v57
v_mfma_f32_16x16x32_bf16 v[168:171], a[180:183], a[76:79], v[168:171]
ds_read_b64_tr_b16 a[156:157], v234 offset:12288
v_exp_f32 v186, v58
v_mfma_f32_16x16x32_bf16 v[168:171], a[176:179], a[68:71], v[168:171]
s_waitcnt lgkmcnt(7)
ds_read_b64_tr_b16 a[158:159], v234 offset:14336
buffer_load_dwordx4 v253, s[8:11], s54 offen offset:1024  lds
v_mfma_f32_16x16x32_bf16 v[168:171], a[184:187], v[72:75], v[168:171]
ds_read_b64_tr_b16 a[160:161], v234 offset:16384
v_exp_f32 v187, v59
v_mfma_f32_16x16x32_bf16 v[168:171], a[188:191], v[76:79], v[168:171]
ds_read_b64_tr_b16 a[162:163], v234 offset:18432
v_exp_f32 v188, v164
v_mfma_f32_16x16x32_bf16 v[136:139], a[188:191], v[68:71], v[136:139]
ds_read_b64_tr_b16 a[164:165], v234 offset:20480
v_exp_f32 v189, v165
v_mfma_f32_16x16x32_bf16 v[136:139], a[184:187], v[64:67], v[136:139]
s_waitcnt lgkmcnt(7)
ds_read_b64_tr_b16 a[166:167], v234 offset:22528
v_exp_f32 v190, v166
v_mfma_f32_16x16x32_bf16 v[192:195], a[144:147], a[0:3], 0
s_mul_i32 s55, s64, 4608
ds_read_b64_tr_b16 a[168:169], v234 offset:24576
v_exp_f32 v191, v167
v_mfma_f32_16x16x32_bf16 v[192:195], a[148:151], a[8:11], v[192:195]
s_add_u32 s55, s55, s73
ds_read_b64_tr_b16 a[170:171], v234 offset:26624
v_exp_f32 v196, v160
v_mfma_f32_16x16x32_bf16 v[200:203], a[148:151], a[12:15], 0
s_addk_i32 m0, 0x2000
ds_read_b64_tr_b16 a[172:173], v234 offset:28672
v_exp_f32 v197, v161
v_mfma_f32_16x16x32_bf16 v[200:203], a[144:147], a[4:7], v[200:203]
s_waitcnt lgkmcnt(7)
ds_read_b64_tr_b16 a[174:175], v234 offset:30720
buffer_load_dwordx4 v254, s[8:11], s55 offen  lds
v_mfma_f32_16x16x32_bf16 v[200:203], a[152:155], a[20:23], v[200:203]
ds_read_b64_tr_b16 a[176:177], v234 offset:32768
v_exp_f32 v198, v162
v_mfma_f32_16x16x32_bf16 v[200:203], a[156:159], a[28:31], v[200:203]
ds_read_b64_tr_b16 a[178:179], v234 offset:34816
v_exp_f32 v199, v163
v_pk_add_f32 v[128:129], v[128:129], v[230:231] op_sel_hi:[1,0]
v_pk_add_f32 v[130:131], v[130:131], v[230:231] op_sel_hi:[1,0]
v_pk_add_f32 v[132:133], v[132:133], v[230:231] op_sel_hi:[1,0]
v_pk_add_f32 v[134:135], v[134:135], v[230:231] op_sel_hi:[1,0]
v_pk_add_f32 v[172:173], v[172:173], v[230:231] op_sel_hi:[1,0]
v_pk_add_f32 v[174:175], v[174:175], v[230:231] op_sel_hi:[1,0]
v_pk_add_f32 v[176:177], v[176:177], v[230:231] op_sel_hi:[1,0]
v_pk_add_f32 v[178:179], v[178:179], v[230:231] op_sel_hi:[1,0]
v_pk_add_f32 v[180:181], v[180:181], v[230:231] op_sel_hi:[1,0]
v_pk_add_f32 v[182:183], v[182:183], v[230:231] op_sel_hi:[1,0]
v_pk_add_f32 v[184:185], v[184:185], v[230:231] op_sel_hi:[1,0]
v_pk_add_f32 v[186:187], v[186:187], v[230:231] op_sel_hi:[1,0]
v_pk_add_f32 v[188:189], v[188:189], v[230:231] op_sel_hi:[1,0]
v_pk_add_f32 v[190:191], v[190:191], v[230:231] op_sel_hi:[1,0]
v_pk_add_f32 v[196:197], v[196:197], v[230:231] op_sel_hi:[1,0]
v_pk_add_f32 v[198:199], v[198:199], v[230:231] op_sel_hi:[1,0]
v_mfma_f32_16x16x32_bf16 v[192:195], a[156:159], a[24:27], v[192:195]
ds_read_b64_tr_b16 a[180:181], v234 offset:36864
v_rcp_f32 v128, v128
v_mfma_f32_16x16x32_bf16 v[192:195], a[152:155], a[16:19], v[192:195]
s_waitcnt lgkmcnt(7)
ds_read_b64_tr_b16 a[182:183], v234 offset:38912
v_rcp_f32 v129, v129
v_mfma_f32_16x16x32_bf16 v[192:195], a[160:163], a[32:35], v[192:195]
ds_read_b64_tr_b16 a[184:185], v234 offset:40960
v_rcp_f32 v130, v130
v_mfma_f32_16x16x32_bf16 v[192:195], a[164:167], a[40:43], v[192:195]
ds_read_b64_tr_b16 a[186:187], v234 offset:43008
v_rcp_f32 v131, v131
v_mfma_f32_16x16x32_bf16 v[200:203], a[164:167], a[44:47], v[200:203]
ds_read_b64_tr_b16 a[188:189], v234 offset:45056
v_rcp_f32 v132, v132
v_mfma_f32_16x16x32_bf16 v[200:203], a[160:163], a[36:39], v[200:203]
s_waitcnt lgkmcnt(7)
ds_read_b64_tr_b16 a[190:191], v234 offset:47104
buffer_load_dwordx4 v253, s[8:11], s55 offen offset:1024  lds
v_mfma_f32_16x16x32_bf16 v[200:203], a[168:171], a[52:55], v[200:203]
ds_read_b64_tr_b16 a[144:145], v233 offset:0
v_rcp_f32 v133, v133
v_mfma_f32_16x16x32_bf16 v[200:203], a[172:175], a[60:63], v[200:203]
ds_read_b64_tr_b16 a[146:147], v233 offset:2048
v_rcp_f32 v134, v134
v_mfma_f32_16x16x32_bf16 v[192:195], a[172:175], a[56:59], v[192:195]
ds_read_b64_tr_b16 a[148:149], v233 offset:4096
v_rcp_f32 v135, v135
v_mfma_f32_16x16x32_bf16 v[192:195], a[168:171], a[48:51], v[192:195]
s_waitcnt lgkmcnt(7)
ds_read_b64_tr_b16 a[150:151], v233 offset:6144
v_rcp_f32 v172, v172
v_mfma_f32_16x16x32_bf16 v[192:195], a[176:179], a[64:67], v[192:195]
s_mul_i32 s54, s65, 4608
ds_read_b64_tr_b16 a[152:153], v233 offset:8192
v_rcp_f32 v173, v173
v_mfma_f32_16x16x32_bf16 v[192:195], a[180:183], a[72:75], v[192:195]
s_add_u32 s54, s54, s73
ds_read_b64_tr_b16 a[154:155], v233 offset:10240
v_rcp_f32 v174, v174
v_mfma_f32_16x16x32_bf16 v[200:203], a[180:183], a[76:79], v[200:203]
s_addk_i32 m0, 0x2000
ds_read_b64_tr_b16 a[156:157], v233 offset:12288
v_rcp_f32 v175, v175
v_mfma_f32_16x16x32_bf16 v[200:203], a[176:179], a[68:71], v[200:203]
s_waitcnt lgkmcnt(7)
ds_read_b64_tr_b16 a[158:159], v233 offset:14336
buffer_load_dwordx4 v254, s[8:11], s54 offen  lds
v_mfma_f32_16x16x32_bf16 v[200:203], a[184:187], v[72:75], v[200:203]
ds_read_b64_tr_b16 a[160:161], v233 offset:16384
v_rcp_f32 v176, v176
v_mfma_f32_16x16x32_bf16 v[200:203], a[188:191], v[76:79], v[200:203]
ds_read_b64_tr_b16 a[162:163], v233 offset:18432
v_rcp_f32 v177, v177
v_mfma_f32_16x16x32_bf16 v[192:195], a[188:191], v[68:71], v[192:195]
ds_read_b64_tr_b16 a[164:165], v233 offset:20480
v_rcp_f32 v178, v178
v_mfma_f32_16x16x32_bf16 v[192:195], a[184:187], v[64:67], v[192:195]
s_waitcnt lgkmcnt(7)
ds_read_b64_tr_b16 a[166:167], v233 offset:22528
v_rcp_f32 v179, v179
v_mfma_f32_16x16x32_bf16 v[204:207], a[144:147], a[0:3], 0
ds_read_b64_tr_b16 a[168:169], v233 offset:24576
v_rcp_f32 v180, v180
v_mfma_f32_16x16x32_bf16 v[204:207], a[148:151], a[8:11], v[204:207]
ds_read_b64_tr_b16 a[170:171], v233 offset:26624
v_rcp_f32 v181, v181
v_mfma_f32_16x16x32_bf16 v[208:211], a[148:151], a[12:15], 0
ds_read_b64_tr_b16 a[172:173], v233 offset:28672
v_rcp_f32 v182, v182
v_mfma_f32_16x16x32_bf16 v[208:211], a[144:147], a[4:7], v[208:211]
s_waitcnt lgkmcnt(7)
ds_read_b64_tr_b16 a[174:175], v233 offset:30720
buffer_load_dwordx4 v253, s[8:11], s54 offen offset:1024  lds
v_mfma_f32_16x16x32_bf16 v[208:211], a[152:155], a[20:23], v[208:211]
ds_read_b64_tr_b16 a[176:177], v233 offset:32768
v_rcp_f32 v183, v183
v_mfma_f32_16x16x32_bf16 v[208:211], a[156:159], a[28:31], v[208:211]
ds_read_b64_tr_b16 a[178:179], v233 offset:34816
v_rcp_f32 v184, v184
v_mfma_f32_16x16x32_bf16 v[204:207], a[156:159], a[24:27], v[204:207]
ds_read_b64_tr_b16 a[180:181], v233 offset:36864
v_rcp_f32 v185, v185
v_mfma_f32_16x16x32_bf16 v[204:207], a[152:155], a[16:19], v[204:207]
s_waitcnt lgkmcnt(7)
ds_read_b64_tr_b16 a[182:183], v233 offset:38912
v_rcp_f32 v186, v186
v_mfma_f32_16x16x32_bf16 v[204:207], a[160:163], a[32:35], v[204:207]
s_mul_i32 s55, s66, 4608
ds_read_b64_tr_b16 a[184:185], v233 offset:40960
v_rcp_f32 v187, v187
v_mfma_f32_16x16x32_bf16 v[204:207], a[164:167], a[40:43], v[204:207]
s_add_u32 s55, s55, s73
ds_read_b64_tr_b16 a[186:187], v233 offset:43008
v_rcp_f32 v188, v188
v_mfma_f32_16x16x32_bf16 v[208:211], a[164:167], a[44:47], v[208:211]
s_waitcnt vmcnt(10)
ds_read_b64_tr_b16 a[188:189], v233 offset:45056
v_rcp_f32 v189, v189
v_mfma_f32_16x16x32_bf16 v[208:211], a[160:163], a[36:39], v[208:211]
s_waitcnt lgkmcnt(7)
ds_read_b64_tr_b16 a[190:191], v233 offset:47104
v_rcp_f32 v190, v190
v_mfma_f32_16x16x32_bf16 v[208:211], a[168:171], a[52:55], v[208:211]
s_barrier
ds_read_b64_tr_b16 a[144:145], v250 offset:0
v_rcp_f32 v191, v191
v_mfma_f32_16x16x32_bf16 v[208:211], a[172:175], a[60:63], v[208:211]
s_addk_i32 m0, 0x2000
ds_read_b64_tr_b16 a[146:147], v250 offset:2048
v_rcp_f32 v196, v196
v_mfma_f32_16x16x32_bf16 v[204:207], a[172:175], a[56:59], v[204:207]
ds_read_b64_tr_b16 a[148:149], v250 offset:4096
buffer_load_dwordx4 v254, s[8:11], s55 offen  lds
v_mfma_f32_16x16x32_bf16 v[204:207], a[168:171], a[48:51], v[204:207]
s_waitcnt lgkmcnt(7)
ds_read_b64_tr_b16 a[150:151], v250 offset:6144
v_rcp_f32 v197, v197
v_mfma_f32_16x16x32_bf16 v[204:207], a[176:179], a[64:67], v[204:207]
ds_read_b64_tr_b16 a[152:153], v250 offset:8192
v_rcp_f32 v198, v198
v_mfma_f32_16x16x32_bf16 v[204:207], a[180:183], a[72:75], v[204:207]
ds_read_b64_tr_b16 a[154:155], v250 offset:10240
v_rcp_f32 v199, v199
v_mfma_f32_16x16x32_bf16 v[208:211], a[180:183], a[76:79], v[208:211]
ds_read_b64_tr_b16 a[156:157], v250 offset:12288
s_nop 0
v_pk_mul_f32 v[128:129], v[128:129], v[36:37]
v_pk_mul_f32 v[130:131], v[130:131], v[38:39]
v_pk_mul_f32 v[132:133], v[132:133], v[28:29]
v_pk_mul_f32 v[134:135], v[134:135], v[30:31]
v_pk_mul_f32 v[172:173], v[172:173], v[144:145]
v_pk_mul_f32 v[174:175], v[174:175], v[146:147]
v_pk_mul_f32 v[176:177], v[176:177], v[40:41]
v_pk_mul_f32 v[178:179], v[178:179], v[42:43]
v_pk_mul_f32 v[180:181], v[180:181], v[152:153]
v_pk_mul_f32 v[182:183], v[182:183], v[154:155]
v_pk_mul_f32 v[184:185], v[184:185], v[56:57]
v_pk_mul_f32 v[186:187], v[186:187], v[58:59]
v_pk_mul_f32 v[188:189], v[188:189], v[164:165]
v_pk_mul_f32 v[190:191], v[190:191], v[166:167]
v_pk_mul_f32 v[196:197], v[196:197], v[160:161]
v_pk_mul_f32 v[198:199], v[198:199], v[162:163]
v_mfma_f32_16x16x32_bf16 v[208:211], a[176:179], a[68:71], v[208:211]
s_waitcnt lgkmcnt(7)
ds_read_b64_tr_b16 a[158:159], v250 offset:14336
v_cvt_pk_bf16_f32 v28, v128, v129
v_mfma_f32_16x16x32_bf16 v[208:211], a[184:187], v[72:75], v[208:211]
ds_read_b64_tr_b16 a[160:161], v250 offset:16384
v_cvt_pk_bf16_f32 v29, v130, v131
v_mfma_f32_16x16x32_bf16 v[208:211], a[188:191], v[76:79], v[208:211]
ds_read_b64_tr_b16 a[162:163], v250 offset:18432
v_cvt_pk_bf16_f32 v36, v132, v133
v_mfma_f32_16x16x32_bf16 v[204:207], a[188:191], v[68:71], v[204:207]
ds_read_b64_tr_b16 a[164:165], v250 offset:20480
buffer_load_dwordx4 v253, s[8:11], s55 offen offset:1024  lds
v_mfma_f32_16x16x32_bf16 v[204:207], a[184:187], v[64:67], v[204:207]
s_waitcnt lgkmcnt(7)
ds_read_b64_tr_b16 a[166:167], v250 offset:22528
v_cvt_pk_bf16_f32 v37, v134, v135
v_mfma_f32_16x16x32_bf16 v[20:23], a[144:147], v[80:83], v[20:23]
s_mul_i32 s54, s68, 576
ds_read_b64_tr_b16 a[168:169], v245 offset:0
v_cvt_pk_bf16_f32 v30, v172, v173
v_mfma_f32_16x16x32_bf16 v[20:23], a[148:151], v[84:87], v[20:23]
s_add_u32 s54, s54, s74
ds_read_b64_tr_b16 a[170:171], v245 offset:2048
v_cvt_pk_bf16_f32 v31, v174, v175
v_mfma_f32_16x16x32_bf16 v[60:63], a[148:151], v[92:95], v[60:63]
s_mov_b32 m0, s53
ds_read_b64_tr_b16 a[172:173], v245 offset:4096
v_cvt_pk_bf16_f32 v38, v176, v177
v_mfma_f32_16x16x32_bf16 v[60:63], a[144:147], v[88:91], v[60:63]
s_waitcnt lgkmcnt(7)
ds_read_b64_tr_b16 a[174:175], v245 offset:6144
buffer_load_dwordx4 v238, s[12:15], s54 offen  lds
v_mfma_f32_16x16x32_bf16 v[60:63], a[152:155], v[104:107], v[60:63]
ds_read_b64_tr_b16 a[176:177], v245 offset:8192
v_cvt_pk_bf16_f32 v39, v178, v179
v_mfma_f32_16x16x32_bf16 v[60:63], a[156:159], v[108:111], v[60:63]
ds_read_b64_tr_b16 a[178:179], v245 offset:10240
v_cvt_pk_bf16_f32 v40, v180, v181
v_mfma_f32_16x16x32_bf16 v[20:23], a[156:159], v[100:103], v[20:23]
ds_read_b64_tr_b16 a[180:181], v245 offset:12288
v_cvt_pk_bf16_f32 v41, v182, v183
v_mfma_f32_16x16x32_bf16 v[20:23], a[152:155], v[96:99], v[20:23]
s_waitcnt lgkmcnt(7)
ds_read_b64_tr_b16 a[182:183], v245 offset:14336
v_cvt_pk_bf16_f32 v56, v184, v185
v_mfma_f32_16x16x32_bf16 v[20:23], a[160:163], v[112:115], v[20:23]
ds_read_b64_tr_b16 a[184:185], v245 offset:16384
v_cvt_pk_bf16_f32 v57, v186, v187
v_mfma_f32_16x16x32_bf16 v[20:23], a[164:167], v[116:119], v[20:23]
ds_read_b64_tr_b16 a[186:187], v245 offset:18432
v_cvt_pk_bf16_f32 v42, v188, v189
v_mfma_f32_16x16x32_bf16 v[60:63], a[164:167], v[124:127], v[60:63]
ds_read_b64_tr_b16 a[188:189], v245 offset:20480
v_cvt_pk_bf16_f32 v43, v190, v191
v_mfma_f32_16x16x32_bf16 v[60:63], a[160:163], v[120:123], v[60:63]
s_waitcnt lgkmcnt(7)
ds_read_b64_tr_b16 a[190:191], v245 offset:22528
buffer_load_dwordx4 v237, s[12:15], s54 offen offset:1024  lds
v_mfma_f32_16x16x32_bf16 v[136:139], a[168:171], v[80:83], v[136:139]
ds_read_b64_tr_b16 a[144:145], v244 offset:0
v_cvt_pk_bf16_f32 v58, v196, v197
v_mfma_f32_16x16x32_bf16 v[136:139], a[172:175], v[84:87], v[136:139]
ds_read_b64_tr_b16 a[146:147], v244 offset:2048
v_cvt_pk_bf16_f32 v59, v198, v199
v_mfma_f32_16x16x32_bf16 v[168:171], a[172:175], v[92:95], v[168:171]
ds_read_b64_tr_b16 a[148:149], v244 offset:4096
v_exp_f32 v254, v20
v_exp_f32 v253, v21
v_mfma_f32_16x16x32_bf16 v[168:171], a[168:171], v[88:91], v[168:171]
s_waitcnt lgkmcnt(7)
ds_read_b64_tr_b16 a[150:151], v244 offset:6144
v_add_f32 v254, 1.0, v254
v_mfma_f32_16x16x32_bf16 v[168:171], a[176:179], v[104:107], v[168:171]
s_mul_i32 s55, s69, 576
ds_read_b64_tr_b16 a[152:153], v244 offset:8192
v_exp_f32 v236, v22
v_mfma_f32_16x16x32_bf16 v[168:171], a[180:183], v[108:111], v[168:171]
s_add_u32 s55, s55, s74
ds_read_b64_tr_b16 a[154:155], v244 offset:10240
v_rcp_f32 v254, v254
v_mfma_f32_16x16x32_bf16 v[136:139], a[180:183], v[100:103], v[136:139]
s_addk_i32 m0, 0x2000
ds_read_b64_tr_b16 a[156:157], v244 offset:12288
v_add_f32 v253, 1.0, v253
v_mfma_f32_16x16x32_bf16 v[136:139], a[176:179], v[96:99], v[136:139]
s_waitcnt lgkmcnt(7)
ds_read_b64_tr_b16 a[158:159], v244 offset:14336
buffer_load_dwordx4 v238, s[12:15], s55 offen  lds
v_mfma_f32_16x16x32_bf16 v[136:139], a[184:187], v[112:115], v[136:139]
ds_read_b64_tr_b16 a[160:161], v244 offset:16384
v_exp_f32 v231, v23
v_mfma_f32_16x16x32_bf16 v[136:139], a[188:191], v[116:119], v[136:139]
ds_read_b64_tr_b16 a[162:163], v244 offset:18432
v_mul_f32 v254, v254, v20
v_mfma_f32_16x16x32_bf16 v[168:171], a[188:191], v[124:127], v[168:171]
ds_read_b64_tr_b16 a[164:165], v244 offset:20480
v_rcp_f32 v253, v253
v_mfma_f32_16x16x32_bf16 v[168:171], a[184:187], v[120:123], v[168:171]
s_waitcnt lgkmcnt(7)
ds_read_b64_tr_b16 a[166:167], v244 offset:22528
v_add_f32 v236, 1.0, v236
v_mfma_f32_16x16x32_bf16 v[192:195], a[144:147], v[80:83], v[192:195]
ds_read_b64_tr_b16 a[168:169], v243 offset:0
v_exp_f32 v230, v60
v_mfma_f32_16x16x32_bf16 v[192:195], a[148:151], v[84:87], v[192:195]
ds_read_b64_tr_b16 a[170:171], v243 offset:2048
v_mul_f32 v253, v253, v21
v_mfma_f32_16x16x32_bf16 v[200:203], a[148:151], v[92:95], v[200:203]
ds_read_b64_tr_b16 a[172:173], v243 offset:4096
v_rcp_f32 v236, v236
v_mfma_f32_16x16x32_bf16 v[200:203], a[144:147], v[88:91], v[200:203]
s_waitcnt lgkmcnt(7)
ds_read_b64_tr_b16 a[174:175], v243 offset:6144
buffer_load_dwordx4 v237, s[12:15], s55 offen offset:1024  lds
v_mfma_f32_16x16x32_bf16 v[200:203], a[152:155], v[104:107], v[200:203]
ds_read_b64_tr_b16 a[176:177], v243 offset:8192
v_add_f32 v231, 1.0, v231
v_mfma_f32_16x16x32_bf16 v[200:203], a[156:159], v[108:111], v[200:203]
ds_read_b64_tr_b16 a[178:179], v243 offset:10240
v_cvt_pk_bf16_f32 v128, v254, v253
v_mfma_f32_16x16x32_bf16 v[192:195], a[156:159], v[100:103], v[192:195]
ds_read_b64_tr_b16 a[180:181], v243 offset:12288
v_exp_f32 v254, v61
v_mfma_f32_16x16x32_bf16 v[192:195], a[152:155], v[96:99], v[192:195]
s_waitcnt lgkmcnt(7)
ds_read_b64_tr_b16 a[182:183], v243 offset:14336
v_mul_f32 v236, v236, v22
v_mfma_f32_16x16x32_bf16 v[192:195], a[160:163], v[112:115], v[192:195]
s_mul_i32 s54, s70, 576
ds_read_b64_tr_b16 a[184:185], v243 offset:16384
v_rcp_f32 v231, v231
v_mfma_f32_16x16x32_bf16 v[192:195], a[164:167], v[116:119], v[192:195]
s_add_u32 s54, s54, s74
ds_read_b64_tr_b16 a[186:187], v243 offset:18432
v_add_f32 v230, 1.0, v230
v_mfma_f32_16x16x32_bf16 v[200:203], a[164:167], v[124:127], v[200:203]
s_addk_i32 m0, 0x2000
ds_read_b64_tr_b16 a[188:189], v243 offset:20480
v_exp_f32 v253, v62
v_mfma_f32_16x16x32_bf16 v[200:203], a[160:163], v[120:123], v[200:203]
s_waitcnt lgkmcnt(7)
ds_read_b64_tr_b16 a[190:191], v243 offset:22528
buffer_load_dwordx4 v238, s[12:15], s54 offen  lds
v_mfma_f32_16x16x32_bf16 v[204:207], a[168:171], v[80:83], v[204:207]
ds_read_b64_tr_b16 a[144:145], v250 offset:24576
v_mul_f32 v231, v231, v23
v_mfma_f32_16x16x32_bf16 v[204:207], a[172:175], v[84:87], v[204:207]
ds_read_b64_tr_b16 a[146:147], v250 offset:26624
v_rcp_f32 v230, v230
v_mfma_f32_16x16x32_bf16 v[208:211], a[172:175], v[92:95], v[208:211]
ds_read_b64_tr_b16 a[148:149], v250 offset:28672
v_add_f32 v254, 1.0, v254
v_mfma_f32_16x16x32_bf16 v[208:211], a[168:171], v[88:91], v[208:211]
s_waitcnt lgkmcnt(7)
ds_read_b64_tr_b16 a[150:151], v250 offset:30720
v_cvt_pk_bf16_f32 v129, v236, v231
v_mfma_f32_16x16x32_bf16 v[208:211], a[176:179], v[104:107], v[208:211]
ds_read_b64_tr_b16 a[152:153], v250 offset:32768
v_exp_f32 v236, v63
v_mfma_f32_16x16x32_bf16 v[208:211], a[180:183], v[108:111], v[208:211]
ds_read_b64_tr_b16 a[154:155], v250 offset:34816
v_mul_f32 v230, v230, v60
v_mfma_f32_16x16x32_bf16 v[204:207], a[180:183], v[100:103], v[204:207]
ds_read_b64_tr_b16 a[156:157], v250 offset:36864
v_rcp_f32 v254, v254
v_mfma_f32_16x16x32_bf16 v[204:207], a[176:179], v[96:99], v[204:207]
s_waitcnt lgkmcnt(7)
ds_read_b64_tr_b16 a[158:159], v250 offset:38912
buffer_load_dwordx4 v237, s[12:15], s54 offen offset:1024  lds
v_mfma_f32_16x16x32_bf16 v[204:207], a[184:187], v[112:115], v[204:207]
ds_read_b64_tr_b16 a[160:161], v250 offset:40960
v_add_f32 v253, 1.0, v253
v_mfma_f32_16x16x32_bf16 v[204:207], a[188:191], v[116:119], v[204:207]
ds_read_b64_tr_b16 a[162:163], v250 offset:43008
v_exp_f32 v231, v136
v_mfma_f32_16x16x32_bf16 v[208:211], a[188:191], v[124:127], v[208:211]
ds_read_b64_tr_b16 a[164:165], v250 offset:45056
v_mul_f32 v254, v254, v61
v_mfma_f32_16x16x32_bf16 v[208:211], a[184:187], v[120:123], v[208:211]
s_waitcnt lgkmcnt(7)
ds_read_b64_tr_b16 a[166:167], v250 offset:47104
v_rcp_f32 v253, v253
v_mfma_f32_16x16x32_bf16 v[20:23], a[144:147], a[0:3], 0
s_mul_i32 s55, s71, 576
ds_read_b64_tr_b16 a[168:169], v245 offset:24576
v_add_f32 v236, 1.0, v236
v_mfma_f32_16x16x32_bf16 v[20:23], a[148:151], a[8:11], v[20:23]
s_add_u32 s55, s55, s74
ds_read_b64_tr_b16 a[170:171], v245 offset:26624
v_cvt_pk_bf16_f32 v132, v230, v254
v_mfma_f32_16x16x32_bf16 v[144:147], a[148:151], a[12:15], 0
s_addk_i32 m0, 0x2000
ds_read_b64_tr_b16 a[172:173], v245 offset:28672
v_exp_f32 v254, v137
v_mfma_f32_16x16x32_bf16 v[144:147], a[144:147], a[4:7], v[144:147]
s_waitcnt lgkmcnt(7)
ds_read_b64_tr_b16 a[174:175], v245 offset:30720
buffer_load_dwordx4 v238, s[12:15], s55 offen  lds
v_mfma_f32_16x16x32_bf16 v[144:147], a[152:155], a[20:23], v[144:147]
ds_read_b64_tr_b16 a[176:177], v245 offset:32768
v_mul_f32 v253, v253, v62
v_mfma_f32_16x16x32_bf16 v[144:147], a[156:159], a[28:31], v[144:147]
ds_read_b64_tr_b16 a[178:179], v245 offset:34816
v_rcp_f32 v236, v236
v_mfma_f32_16x16x32_bf16 v[20:23], a[156:159], a[24:27], v[20:23]
ds_read_b64_tr_b16 a[180:181], v245 offset:36864
v_add_f32 v231, 1.0, v231
v_mfma_f32_16x16x32_bf16 v[20:23], a[152:155], a[16:19], v[20:23]
s_waitcnt lgkmcnt(7)
ds_read_b64_tr_b16 a[182:183], v245 offset:38912
v_exp_f32 v230, v138
v_mfma_f32_16x16x32_bf16 v[20:23], a[160:163], a[32:35], v[20:23]
ds_read_b64_tr_b16 a[184:185], v245 offset:40960
v_mul_f32 v236, v236, v63
v_mfma_f32_16x16x32_bf16 v[20:23], a[164:167], a[40:43], v[20:23]
ds_read_b64_tr_b16 a[186:187], v245 offset:43008
v_rcp_f32 v231, v231
v_mfma_f32_16x16x32_bf16 v[144:147], a[164:167], a[44:47], v[144:147]
ds_read_b64_tr_b16 a[188:189], v245 offset:45056
v_add_f32 v254, 1.0, v254
v_mfma_f32_16x16x32_bf16 v[144:147], a[160:163], a[36:39], v[144:147]
s_waitcnt lgkmcnt(7)
ds_read_b64_tr_b16 a[190:191], v245 offset:47104
buffer_load_dwordx4 v237, s[12:15], s55 offen offset:1024  lds
v_mfma_f32_16x16x32_bf16 v[60:63], a[168:171], a[0:3], 0
ds_read_b64_tr_b16 a[144:145], v244 offset:24576
v_cvt_pk_bf16_f32 v133, v253, v236
v_mfma_f32_16x16x32_bf16 v[60:63], a[172:175], a[8:11], v[60:63]
ds_read_b64_tr_b16 a[146:147], v244 offset:26624
v_exp_f32 v253, v139
v_mfma_f32_16x16x32_bf16 v[152:155], a[172:175], a[12:15], 0
ds_read_b64_tr_b16 a[148:149], v244 offset:28672
v_mul_f32 v231, v231, v136
v_mfma_f32_16x16x32_bf16 v[152:155], a[168:171], a[4:7], v[152:155]
s_waitcnt lgkmcnt(7)
ds_read_b64_tr_b16 a[150:151], v244 offset:30720
v_rcp_f32 v254, v254
v_mfma_f32_16x16x32_bf16 v[152:155], a[176:179], a[20:23], v[152:155]
s_mul_i32 s54, s72, 576
ds_read_b64_tr_b16 a[152:153], v244 offset:32768
v_add_f32 v230, 1.0, v230
v_mfma_f32_16x16x32_bf16 v[152:155], a[180:183], a[28:31], v[152:155]
s_add_u32 s54, s54, s74
ds_read_b64_tr_b16 a[154:155], v244 offset:34816
v_exp_f32 v236, v168
v_mfma_f32_16x16x32_bf16 v[60:63], a[180:183], a[24:27], v[60:63]
s_addk_i32 m0, 0x2000
ds_read_b64_tr_b16 a[156:157], v244 offset:36864
v_mul_f32 v254, v254, v137
v_mfma_f32_16x16x32_bf16 v[60:63], a[176:179], a[16:19], v[60:63]
s_waitcnt lgkmcnt(7)
ds_read_b64_tr_b16 a[158:159], v244 offset:38912
buffer_load_dwordx4 v238, s[12:15], s54 offen  lds
v_mfma_f32_16x16x32_bf16 v[60:63], a[184:187], a[32:35], v[60:63]
ds_read_b64_tr_b16 a[160:161], v244 offset:40960
v_rcp_f32 v230, v230
v_mfma_f32_16x16x32_bf16 v[60:63], a[188:191], a[40:43], v[60:63]
ds_read_b64_tr_b16 a[162:163], v244 offset:43008
v_add_f32 v253, 1.0, v253
v_mfma_f32_16x16x32_bf16 v[152:155], a[188:191], a[44:47], v[152:155]
ds_read_b64_tr_b16 a[164:165], v244 offset:45056
v_cvt_pk_bf16_f32 v130, v231, v254
v_mfma_f32_16x16x32_bf16 v[152:155], a[184:187], a[36:39], v[152:155]
s_waitcnt lgkmcnt(7)
ds_read_b64_tr_b16 a[166:167], v244 offset:47104
v_exp_f32 v254, v169
v_mul_f32 v230, v230, v138
v_mfma_f32_16x16x32_bf16 v[160:163], a[144:147], a[0:3], 0
ds_read_b64_tr_b16 a[168:169], v243 offset:24576
v_rcp_f32 v253, v253
v_mfma_f32_16x16x32_bf16 v[160:163], a[148:151], a[8:11], v[160:163]
ds_read_b64_tr_b16 a[170:171], v243 offset:26624
v_add_f32 v236, 1.0, v236
v_mfma_f32_16x16x32_bf16 v[164:167], a[148:151], a[12:15], 0
ds_read_b64_tr_b16 a[172:173], v243 offset:28672
v_exp_f32 v231, v170
v_mfma_f32_16x16x32_bf16 v[164:167], a[144:147], a[4:7], v[164:167]
s_waitcnt lgkmcnt(7)
ds_read_b64_tr_b16 a[174:175], v243 offset:30720
buffer_load_dwordx4 v237, s[12:15], s54 offen offset:1024  lds
v_mfma_f32_16x16x32_bf16 v[164:167], a[152:155], a[20:23], v[164:167]
ds_read_b64_tr_b16 a[176:177], v243 offset:32768
v_mul_f32 v253, v253, v139
v_mfma_f32_16x16x32_bf16 v[164:167], a[156:159], a[28:31], v[164:167]
ds_read_b64_tr_b16 a[178:179], v243 offset:34816
v_rcp_f32 v236, v236
v_mfma_f32_16x16x32_bf16 v[160:163], a[156:159], a[24:27], v[160:163]
ds_read_b64_tr_b16 a[180:181], v243 offset:36864
v_add_f32 v254, 1.0, v254
v_mfma_f32_16x16x32_bf16 v[160:163], a[152:155], a[16:19], v[160:163]
s_waitcnt lgkmcnt(7)
ds_read_b64_tr_b16 a[182:183], v243 offset:38912
v_cvt_pk_bf16_f32 v131, v230, v253
v_mfma_f32_16x16x32_bf16 v[160:163], a[160:163], a[32:35], v[160:163]
s_mul_i32 s55, s73, 576
LF_p6:
s_cbranch_execz LF_v105
ds_read_b64_tr_b16 a[184:185], v243 offset:40960
v_exp_f32 v253, v171
v_mfma_f32_16x16x32_bf16 v[160:163], a[164:167], a[40:43], v[160:163]
s_add_u32 s55, s55, s74
ds_read_b64_tr_b16 a[186:187], v243 offset:43008
v_mul_f32 v236, v236, v168
v_mfma_f32_16x16x32_bf16 v[164:167], a[164:167], a[44:47], v[164:167]
s_waitcnt vmcnt(10)
ds_read_b64_tr_b16 a[188:189], v243 offset:45056
v_rcp_f32 v254, v254
v_mfma_f32_16x16x32_bf16 v[164:167], a[160:163], a[36:39], v[164:167]
s_waitcnt lgkmcnt(7)
ds_read_b64_tr_b16 a[190:191], v243 offset:47104
v_add_f32 v231, 1.0, v231
v_mfma_f32_16x16x32_bf16 v[136:139], a[168:171], a[0:3], 0
s_barrier
ds_read_b64_tr_b16 a[144:145], v242 offset:0
v_exp_f32 v230, v192
v_mfma_f32_16x16x32_bf16 v[136:139], a[172:175], a[8:11], v[136:139]
s_addk_i32 m0, 0x2000
ds_read_b64_tr_b16 a[146:147], v242 offset:2048
v_mul_f32 v254, v254, v169
v_mfma_f32_16x16x32_bf16 v[172:175], a[172:175], a[12:15], 0
ds_read_b64_tr_b16 a[148:149], v242 offset:4096
buffer_load_dwordx4 v238, s[12:15], s55 offen  lds
v_mfma_f32_16x16x32_bf16 v[172:175], a[168:171], a[4:7], v[172:175]
s_waitcnt lgkmcnt(7)
ds_read_b64_tr_b16 a[150:151], v242 offset:6144
v_rcp_f32 v231, v231
v_mfma_f32_16x16x32_bf16 v[172:175], a[176:179], a[20:23], v[172:175]
ds_read_b64_tr_b16 a[152:153], v242 offset:8192
v_add_f32 v253, 1.0, v253
v_mfma_f32_16x16x32_bf16 v[172:175], a[180:183], a[28:31], v[172:175]
ds_read_b64_tr_b16 a[154:155], v242 offset:10240
v_cvt_pk_bf16_f32 v134, v236, v254
v_mfma_f32_16x16x32_bf16 v[136:139], a[180:183], a[24:27], v[136:139]
ds_read_b64_tr_b16 a[156:157], v242 offset:12288
v_exp_f32 v254, v193
v_mfma_f32_16x16x32_bf16 v[136:139], a[176:179], a[16:19], v[136:139]
s_waitcnt lgkmcnt(7)
ds_read_b64_tr_b16 a[158:159], v242 offset:14336
v_mul_f32 v231, v231, v170
v_mfma_f32_16x16x32_bf16 v[136:139], a[184:187], a[32:35], v[136:139]
ds_read_b64_tr_b16 a[160:161], v242 offset:16384
v_rcp_f32 v253, v253
v_mfma_f32_16x16x32_bf16 v[136:139], a[188:191], a[40:43], v[136:139]
ds_read_b64_tr_b16 a[162:163], v242 offset:18432
v_add_f32 v230, 1.0, v230
v_mfma_f32_16x16x32_bf16 v[172:175], a[188:191], a[44:47], v[172:175]
ds_read_b64_tr_b16 a[164:165], v242 offset:20480
buffer_load_dwordx4 v237, s[12:15], s55 offen offset:1024  lds
v_mfma_f32_16x16x32_bf16 v[172:175], a[184:187], a[36:39], v[172:175]
s_waitcnt lgkmcnt(7)
ds_read_b64_tr_b16 a[166:167], v242 offset:22528
v_exp_f32 v236, v194
v_mfma_f32_16x16x32_bf16 v[20:23], a[144:147], a[48:51], v[20:23]
s_mul_i32 s54, s68, 576
ds_read_b64_tr_b16 a[168:169], v242 offset:24576
v_mul_f32 v253, v253, v171
v_mfma_f32_16x16x32_bf16 v[20:23], a[148:151], a[56:59], v[20:23]
s_add_u32 s54, s54, s75
ds_read_b64_tr_b16 a[170:171], v242 offset:26624
v_rcp_f32 v230, v230
v_mfma_f32_16x16x32_bf16 v[144:147], a[148:151], a[60:63], v[144:147]
s_addk_i32 m0, 0x2000
ds_read_b64_tr_b16 a[172:173], v242 offset:28672
v_add_f32 v254, 1.0, v254
v_mfma_f32_16x16x32_bf16 v[144:147], a[144:147], a[52:55], v[144:147]
s_waitcnt lgkmcnt(7)
ds_read_b64_tr_b16 a[174:175], v242 offset:30720
buffer_load_dwordx4 v238, s[12:15], s54 offen  lds
v_mfma_f32_16x16x32_bf16 v[144:147], a[152:155], a[68:71], v[144:147]
ds_read_b64_tr_b16 a[176:177], v242 offset:32768
v_cvt_pk_bf16_f32 v135, v231, v253
v_mfma_f32_16x16x32_bf16 v[144:147], a[156:159], a[76:79], v[144:147]
ds_read_b64_tr_b16 a[178:179], v242 offset:34816
v_exp_f32 v253, v195
v_mfma_f32_16x16x32_bf16 v[20:23], a[156:159], a[72:75], v[20:23]
ds_read_b64_tr_b16 a[180:181], v242 offset:36864
v_mul_f32 v230, v230, v192
v_mfma_f32_16x16x32_bf16 v[20:23], a[152:155], a[64:67], v[20:23]
s_waitcnt lgkmcnt(7)
ds_read_b64_tr_b16 a[182:183], v242 offset:38912
v_rcp_f32 v254, v254
v_mfma_f32_16x16x32_bf16 v[20:23], a[160:163], v[64:67], v[20:23]
ds_read_b64_tr_b16 a[184:185], v242 offset:40960
v_add_f32 v236, 1.0, v236
v_mfma_f32_16x16x32_bf16 v[20:23], a[164:167], v[68:71], v[20:23]
ds_read_b64_tr_b16 a[186:187], v242 offset:43008
v_exp_f32 v231, v200
v_mfma_f32_16x16x32_bf16 v[144:147], a[164:167], v[76:79], v[144:147]
ds_read_b64_tr_b16 a[188:189], v242 offset:45056
v_mul_f32 v254, v254, v193
v_mfma_f32_16x16x32_bf16 v[144:147], a[160:163], v[72:75], v[144:147]
s_waitcnt lgkmcnt(7)
ds_read_b64_tr_b16 a[190:191], v242 offset:47104
buffer_load_dwordx4 v237, s[12:15], s54 offen offset:1024  lds
v_mfma_f32_16x16x32_bf16 v[144:147], a[168:171], v[88:91], v[144:147]
ds_read_b64_tr_b16 a[144:145], v241 offset:0
v_rcp_f32 v236, v236
v_mfma_f32_16x16x32_bf16 v[144:147], a[172:175], v[92:95], v[144:147]
ds_read_b64_tr_b16 a[146:147], v241 offset:2048
v_add_f32 v253, 1.0, v253
v_mfma_f32_16x16x32_bf16 v[20:23], a[172:175], v[84:87], v[20:23]
ds_read_b64_tr_b16 a[148:149], v241 offset:4096
v_cvt_pk_bf16_f32 v168, v230, v254
v_mfma_f32_16x16x32_bf16 v[20:23], a[168:171], v[80:83], v[20:23]
s_waitcnt lgkmcnt(7)
ds_read_b64_tr_b16 a[150:151], v241 offset:6144
v_exp_f32 v254, v201
v_mfma_f32_16x16x32_bf16 v[20:23], a[176:179], v[96:99], v[20:23]
s_mul_i32 s55, s69, 576
ds_read_b64_tr_b16 a[152:153], v241 offset:8192
v_mul_f32 v236, v236, v194
v_mfma_f32_16x16x32_bf16 v[20:23], a[180:183], v[100:103], v[20:23]
s_add_u32 s55, s55, s75
ds_read_b64_tr_b16 a[154:155], v241 offset:10240
v_rcp_f32 v253, v253
v_mfma_f32_16x16x32_bf16 v[144:147], a[180:183], v[108:111], v[144:147]
s_addk_i32 m0, 0x2000
ds_read_b64_tr_b16 a[156:157], v241 offset:12288
v_add_f32 v231, 1.0, v231
v_mfma_f32_16x16x32_bf16 v[144:147], a[176:179], v[104:107], v[144:147]
s_waitcnt lgkmcnt(7)
ds_read_b64_tr_b16 a[158:159], v241 offset:14336
buffer_load_dwordx4 v238, s[12:15], s55 offen  lds
v_mfma_f32_16x16x32_bf16 v[144:147], a[184:187], v[120:123], v[144:147]
ds_read_b64_tr_b16 a[160:161], v241 offset:16384
v_exp_f32 v230, v202
v_mfma_f32_16x16x32_bf16 v[144:147], a[188:191], v[124:127], v[144:147]
ds_read_b64_tr_b16 a[162:163], v241 offset:18432
v_mul_f32 v253, v253, v195
v_mfma_f32_16x16x32_bf16 v[20:23], a[188:191], v[116:119], v[20:23]
ds_read_b64_tr_b16 a[164:165], v241 offset:20480
v_rcp_f32 v231, v231
v_mfma_f32_16x16x32_bf16 v[20:23], a[184:187], v[112:115], v[20:23]
s_waitcnt lgkmcnt(7)
ds_read_b64_tr_b16 a[166:167], v241 offset:22528
v_add_f32 v254, 1.0, v254
v_mfma_f32_16x16x32_bf16 v[60:63], a[144:147], a[48:51], v[60:63]
ds_read_b64_tr_b16 a[168:169], v241 offset:24576
v_cvt_pk_bf16_f32 v169, v236, v253
v_mfma_f32_16x16x32_bf16 v[60:63], a[148:151], a[56:59], v[60:63]
ds_read_b64_tr_b16 a[170:171], v241 offset:26624
v_exp_f32 v253, v203
v_mfma_f32_16x16x32_bf16 v[152:155], a[148:151], a[60:63], v[152:155]
ds_read_b64_tr_b16 a[172:173], v241 offset:28672
v_mul_f32 v231, v231, v200
v_mfma_f32_16x16x32_bf16 v[152:155], a[144:147], a[52:55], v[152:155]
s_waitcnt lgkmcnt(7)
ds_read_b64_tr_b16 a[174:175], v241 offset:30720
buffer_load_dwordx4 v237, s[12:15], s55 offen offset:1024  lds
v_mfma_f32_16x16x32_bf16 v[152:155], a[152:155], a[68:71], v[152:155]
ds_read_b64_tr_b16 a[176:177], v241 offset:32768
v_rcp_f32 v254, v254
v_mfma_f32_16x16x32_bf16 v[152:155], a[156:159], a[76:79], v[152:155]
ds_read_b64_tr_b16 a[178:179], v241 offset:34816
v_add_f32 v230, 1.0, v230
v_mfma_f32_16x16x32_bf16 v[60:63], a[156:159], a[72:75], v[60:63]
ds_read_b64_tr_b16 a[180:181], v241 offset:36864
v_exp_f32 v236, v204
v_mfma_f32_16x16x32_bf16 v[60:63], a[152:155], a[64:67], v[60:63]
s_waitcnt lgkmcnt(7)
ds_read_b64_tr_b16 a[182:183], v241 offset:38912
v_mul_f32 v254, v254, v201
v_rcp_f32 v230, v230
v_mfma_f32_16x16x32_bf16 v[60:63], a[160:163], v[64:67], v[60:63]
s_mul_i32 s54, s70, 576
ds_read_b64_tr_b16 a[184:185], v241 offset:40960
v_add_f32 v253, 1.0, v253
v_mfma_f32_16x16x32_bf16 v[60:63], a[164:167], v[68:71], v[60:63]
s_add_u32 s54, s54, s75
ds_read_b64_tr_b16 a[186:187], v241 offset:43008
v_cvt_pk_bf16_f32 v176, v231, v254
v_mfma_f32_16x16x32_bf16 v[152:155], a[164:167], v[76:79], v[152:155]
s_addk_i32 m0, 0x2000
ds_read_b64_tr_b16 a[188:189], v241 offset:45056
v_exp_f32 v254, v205
v_mfma_f32_16x16x32_bf16 v[152:155], a[160:163], v[72:75], v[152:155]
s_waitcnt lgkmcnt(7)
ds_read_b64_tr_b16 a[190:191], v241 offset:47104
buffer_load_dwordx4 v238, s[12:15], s54 offen  lds
v_mfma_f32_16x16x32_bf16 v[152:155], a[168:171], v[88:91], v[152:155]
s_lshl_b32 s86, s49, 2
ds_read_b64_tr_b16 a[144:145], v240 offset:0
v_mul_f32 v230, v230, v202
v_mfma_f32_16x16x32_bf16 v[152:155], a[172:175], v[92:95], v[152:155]
s_add_u32 s86, s86, 128
ds_read_b64_tr_b16 a[146:147], v240 offset:2048
v_mov_b32 v231, s86
v_mfma_f32_16x16x32_bf16 v[60:63], a[172:175], v[84:87], v[60:63]
buffer_load_dword v229, v231, s[36:39], 0 offen
ds_read_b64_tr_b16 a[148:149], v240 offset:4096
v_mfma_f32_16x16x32_bf16 v[60:63], a[168:171], v[80:83], v[60:63]
s_waitcnt lgkmcnt(7)
ds_read_b64_tr_b16 a[150:151], v240 offset:6144
v_rcp_f32 v253, v253
v_mfma_f32_16x16x32_bf16 v[60:63], a[176:179], v[96:99], v[60:63]
ds_read_b64_tr_b16 a[152:153], v240 offset:8192
v_add_f32 v236, 1.0, v236
v_mfma_f32_16x16x32_bf16 v[60:63], a[180:183], v[100:103], v[60:63]
ds_read_b64_tr_b16 a[154:155], v240 offset:10240
v_exp_f32 v228, v206
v_mfma_f32_16x16x32_bf16 v[152:155], a[180:183], v[108:111], v[152:155]
ds_read_b64_tr_b16 a[156:157], v240 offset:12288
v_mul_f32 v253, v253, v203
v_mfma_f32_16x16x32_bf16 v[152:155], a[176:179], v[104:107], v[152:155]
s_waitcnt lgkmcnt(7)
ds_read_b64_tr_b16 a[158:159], v240 offset:14336
buffer_load_dwordx4 v237, s[12:15], s54 offen offset:1024  lds
v_mfma_f32_16x16x32_bf16 v[152:155], a[184:187], v[120:123], v[152:155]
ds_read_b64_tr_b16 a[160:161], v240 offset:16384
v_rcp_f32 v236, v236
v_mfma_f32_16x16x32_bf16 v[152:155], a[188:191], v[124:127], v[152:155]
ds_read_b64_tr_b16 a[162:163], v240 offset:18432
v_add_f32 v254, 1.0, v254
v_mfma_f32_16x16x32_bf16 v[60:63], a[188:191], v[116:119], v[60:63]
ds_read_b64_tr_b16 a[164:165], v240 offset:20480
v_cvt_pk_bf16_f32 v177, v230, v253
v_mfma_f32_16x16x32_bf16 v[60:63], a[184:187], v[112:115], v[60:63]
s_waitcnt lgkmcnt(7)
ds_read_b64_tr_b16 a[166:167], v240 offset:22528
v_exp_f32 v253, v207
v_mfma_f32_16x16x32_bf16 v[160:163], a[144:147], a[48:51], v[160:163]
s_mul_i32 s55, s71, 576
ds_read_b64_tr_b16 a[168:169], v240 offset:24576
v_mul_f32 v236, v236, v204
v_mfma_f32_16x16x32_bf16 v[160:163], a[148:151], a[56:59], v[160:163]
s_add_u32 s55, s55, s75
ds_read_b64_tr_b16 a[170:171], v240 offset:26624
v_rcp_f32 v254, v254
v_mfma_f32_16x16x32_bf16 v[164:167], a[148:151], a[60:63], v[164:167]
s_addk_i32 m0, 0x2000
ds_read_b64_tr_b16 a[172:173], v240 offset:28672
v_add_f32 v228, 1.0, v228
v_mfma_f32_16x16x32_bf16 v[164:167], a[144:147], a[52:55], v[164:167]
s_waitcnt lgkmcnt(7)
ds_read_b64_tr_b16 a[174:175], v240 offset:30720
buffer_load_dwordx4 v238, s[12:15], s55 offen  lds
v_mfma_f32_16x16x32_bf16 v[164:167], a[152:155], a[68:71], v[164:167]
ds_read_b64_tr_b16 a[176:177], v240 offset:32768
v_exp_f32 v230, v208
v_mfma_f32_16x16x32_bf16 v[164:167], a[156:159], a[76:79], v[164:167]
ds_read_b64_tr_b16 a[178:179], v240 offset:34816
v_mul_f32 v254, v254, v205
v_mfma_f32_16x16x32_bf16 v[160:163], a[156:159], a[72:75], v[160:163]
ds_read_b64_tr_b16 a[180:181], v240 offset:36864
v_rcp_f32 v228, v228
v_mfma_f32_16x16x32_bf16 v[160:163], a[152:155], a[64:67], v[160:163]
s_waitcnt lgkmcnt(7)
ds_read_b64_tr_b16 a[182:183], v240 offset:38912
v_add_f32 v253, 1.0, v253
v_mfma_f32_16x16x32_bf16 v[160:163], a[160:163], v[64:67], v[160:163]
ds_read_b64_tr_b16 a[184:185], v240 offset:40960
v_cvt_pk_bf16_f32 v170, v236, v254
v_mfma_f32_16x16x32_bf16 v[160:163], a[164:167], v[68:71], v[160:163]
ds_read_b64_tr_b16 a[186:187], v240 offset:43008
v_exp_f32 v254, v209
v_mfma_f32_16x16x32_bf16 v[164:167], a[164:167], v[76:79], v[164:167]
ds_read_b64_tr_b16 a[188:189], v240 offset:45056
v_mul_f32 v228, v228, v206
v_mfma_f32_16x16x32_bf16 v[164:167], a[160:163], v[72:75], v[164:167]
s_waitcnt lgkmcnt(7)
ds_read_b64_tr_b16 a[190:191], v240 offset:47104
buffer_load_dwordx4 v237, s[12:15], s55 offen offset:1024  lds
v_mfma_f32_16x16x32_bf16 v[164:167], a[168:171], v[88:91], v[164:167]
ds_read_b64_tr_b16 a[144:145], v239 offset:0
v_rcp_f32 v253, v253
v_mfma_f32_16x16x32_bf16 v[164:167], a[172:175], v[92:95], v[164:167]
ds_read_b64_tr_b16 a[146:147], v239 offset:2048
v_add_f32 v230, 1.0, v230
v_mfma_f32_16x16x32_bf16 v[160:163], a[172:175], v[84:87], v[160:163]
ds_read_b64_tr_b16 a[148:149], v239 offset:4096
v_exp_f32 v236, v210
v_mfma_f32_16x16x32_bf16 v[160:163], a[168:171], v[80:83], v[160:163]
s_waitcnt lgkmcnt(7)
ds_read_b64_tr_b16 a[150:151], v239 offset:6144
v_mul_f32 v253, v253, v207
v_mfma_f32_16x16x32_bf16 v[160:163], a[176:179], v[96:99], v[160:163]
s_mul_i32 s54, s72, 576
ds_read_b64_tr_b16 a[152:153], v239 offset:8192
v_rcp_f32 v230, v230
v_mfma_f32_16x16x32_bf16 v[160:163], a[180:183], v[100:103], v[160:163]
s_add_u32 s54, s54, s75
ds_read_b64_tr_b16 a[154:155], v239 offset:10240
v_add_f32 v254, 1.0, v254
v_mfma_f32_16x16x32_bf16 v[164:167], a[180:183], v[108:111], v[164:167]
s_addk_i32 m0, 0x2000
ds_read_b64_tr_b16 a[156:157], v239 offset:12288
v_cvt_pk_bf16_f32 v171, v228, v253
v_mfma_f32_16x16x32_bf16 v[164:167], a[176:179], v[104:107], v[164:167]
s_waitcnt lgkmcnt(7)
ds_read_b64_tr_b16 a[158:159], v239 offset:14336
buffer_load_dwordx4 v238, s[12:15], s54 offen  lds
v_mfma_f32_16x16x32_bf16 v[164:167], a[184:187], v[120:123], v[164:167]
ds_read_b64_tr_b16 a[160:161], v239 offset:16384
v_exp_f32 v253, v211
v_mfma_f32_16x16x32_bf16 v[164:167], a[188:191], v[124:127], v[164:167]
ds_read_b64_tr_b16 a[162:163], v239 offset:18432
v_mul_f32 v230, v230, v208
v_mfma_f32_16x16x32_bf16 v[160:163], a[188:191], v[116:119], v[160:163]
ds_read_b64_tr_b16 a[164:165], v239 offset:20480
v_rcp_f32 v254, v254
v_mfma_f32_16x16x32_bf16 v[160:163], a[184:187], v[112:115], v[160:163]
s_waitcnt lgkmcnt(7)
ds_read_b64_tr_b16 a[166:167], v239 offset:22528
v_add_f32 v236, 1.0, v236
v_mfma_f32_16x16x32_bf16 v[136:139], a[144:147], a[48:51], v[136:139]
ds_read_b64_tr_b16 a[168:169], v239 offset:24576
v_mul_f32 v254, v254, v209
v_mfma_f32_16x16x32_bf16 v[136:139], a[148:151], a[56:59], v[136:139]
ds_read_b64_tr_b16 a[170:171], v239 offset:26624
v_rcp_f32 v236, v236
v_mfma_f32_16x16x32_bf16 v[172:175], a[148:151], a[60:63], v[172:175]
ds_read_b64_tr_b16 a[172:173], v239 offset:28672
v_add_f32 v253, 1.0, v253
v_mfma_f32_16x16x32_bf16 v[172:175], a[144:147], a[52:55], v[172:175]
s_waitcnt lgkmcnt(7)
ds_read_b64_tr_b16 a[174:175], v239 offset:30720
buffer_load_dwordx4 v237, s[12:15], s54 offen offset:1024  lds
v_mfma_f32_16x16x32_bf16 v[172:175], a[152:155], a[68:71], v[172:175]
ds_read_b64_tr_b16 a[176:177], v239 offset:32768
v_cvt_pk_bf16_f32 v178, v230, v254
v_mfma_f32_16x16x32_bf16 v[172:175], a[156:159], a[76:79], v[172:175]
ds_read_b64_tr_b16 a[178:179], v239 offset:34816
v_mul_f32 v236, v236, v210
v_mfma_f32_16x16x32_bf16 v[136:139], a[156:159], a[72:75], v[136:139]
ds_read_b64_tr_b16 a[180:181], v239 offset:36864
v_rcp_f32 v253, v253
v_mfma_f32_16x16x32_bf16 v[136:139], a[152:155], a[64:67], v[136:139]
s_waitcnt lgkmcnt(7)
ds_read_b64_tr_b16 a[182:183], v239 offset:38912
v_mul_f32 v253, v253, v211
v_mfma_f32_16x16x32_bf16 v[136:139], a[160:163], v[64:67], v[136:139]
s_mul_i32 s55, s73, 576
ds_read_b64_tr_b16 a[184:185], v239 offset:40960
v_cvt_pk_bf16_f32 v179, v236, v253
v_mfma_f32_16x16x32_bf16 v[136:139], a[164:167], v[68:71], v[136:139]
s_add_u32 s55, s55, s75
ds_read_b64_tr_b16 a[186:187], v239 offset:43008
v_mov_b32 v226, 1.0
v_mfma_f32_16x16x32_bf16 v[172:175], a[164:167], v[76:79], v[172:175]
s_waitcnt vmcnt(11)
ds_read_b64_tr_b16 a[188:189], v239 offset:45056
v_exp_f32 v64, v144
v_mfma_f32_16x16x32_bf16 v[172:175], a[160:163], v[72:75], v[172:175]
s_waitcnt lgkmcnt(7)
ds_read_b64_tr_b16 a[190:191], v239 offset:47104
v_exp_f32 v65, v145
v_mfma_f32_16x16x32_bf16 v[172:175], a[168:171], v[88:91], v[172:175]
s_barrier
ds_read_b64_tr_b16 a[144:145], v235 offset:0
v_exp_f32 v66, v146
v_mfma_f32_16x16x32_bf16 v[172:175], a[172:175], v[92:95], v[172:175]
s_addk_i32 m0, 0x2000
ds_read_b64_tr_b16 a[146:147], v235 offset:2048
v_exp_f32 v67, v147
v_mfma_f32_16x16x32_bf16 v[136:139], a[172:175], v[84:87], v[136:139]
ds_read_b64_tr_b16 a[148:149], v235 offset:4096
buffer_load_dwordx4 v238, s[12:15], s55 offen  lds
v_mfma_f32_16x16x32_bf16 v[136:139], a[168:171], v[80:83], v[136:139]
s_waitcnt lgkmcnt(7)
ds_read_b64_tr_b16 a[150:151], v235 offset:6144
v_exp_f32 v68, v20
v_mfma_f32_16x16x32_bf16 v[136:139], a[176:179], v[96:99], v[136:139]
ds_read_b64_tr_b16 a[152:153], v248 offset:0
v_exp_f32 v69, v21
v_exp_f32 v70, v22
v_mfma_f32_16x16x32_bf16 v[136:139], a[180:183], v[100:103], v[136:139]
ds_read_b64_tr_b16 a[154:155], v248 offset:2048
v_exp_f32 v71, v23
v_mfma_f32_16x16x32_bf16 v[172:175], a[180:183], v[108:111], v[172:175]
ds_read_b64_tr_b16 a[156:157], v248 offset:4096
v_exp_f32 v72, v152
v_mfma_f32_16x16x32_bf16 v[172:175], a[176:179], v[104:107], v[172:175]
s_waitcnt lgkmcnt(7)
ds_read_b64_tr_b16 a[158:159], v248 offset:6144
v_exp_f32 v73, v153
v_mfma_f32_16x16x32_bf16 v[172:175], a[184:187], v[120:123], v[172:175]
ds_read_b64_tr_b16 a[160:161], v234 offset:0
v_exp_f32 v74, v154
v_mfma_f32_16x16x32_bf16 v[172:175], a[188:191], v[124:127], v[172:175]
ds_read_b64_tr_b16 a[162:163], v234 offset:2048
v_exp_f32 v75, v155
v_mfma_f32_16x16x32_bf16 v[136:139], a[188:191], v[116:119], v[136:139]
ds_read_b64_tr_b16 a[164:165], v234 offset:4096
buffer_load_dwordx4 v237, s[12:15], s55 offen offset:1024  lds
v_mfma_f32_16x16x32_bf16 v[136:139], a[184:187], v[112:115], v[136:139]
s_waitcnt lgkmcnt(7)
ds_read_b64_tr_b16 a[166:167], v234 offset:6144
v_exp_f32 v76, v60
v_mfma_f32_16x16x32_bf16 v[80:83], a[144:147], v[4:7], 0
s_mul_i32 s54, s68, 576
ds_read_b64_tr_b16 a[168:169], v233 offset:0
v_exp_f32 v77, v61
v_mfma_f32_16x16x32_bf16 v[80:83], a[148:151], v[44:47], v[80:83]
s_add_u32 s54, s54, s76
ds_read_b64_tr_b16 a[170:171], v233 offset:2048
v_exp_f32 v78, v62
v_mfma_f32_16x16x32_bf16 v[84:87], a[148:151], v[48:51], 0
s_addk_i32 m0, 0x2000
ds_read_b64_tr_b16 a[172:173], v233 offset:4096
s_waitcnt vmcnt(7)
v_cmp_gt_u32 vcc, 1, v229
v_mfma_f32_16x16x32_bf16 v[84:87], a[144:147], v[12:15], v[84:87]
s_waitcnt lgkmcnt(7)
ds_read_b64_tr_b16 a[174:175], v233 offset:6144
buffer_load_dwordx4 v238, s[12:15], s54 offen  lds
v_mfma_f32_16x16x32_bf16 v[88:91], a[152:155], v[4:7], 0
s_cbranch_vccnz LF_go2
LF_go2_b:
ds_read_b64_tr_b16 a[176:177], v235 offset:8192
v_readfirstlane_b32 s100, v229
v_mfma_f32_16x16x32_bf16 v[88:91], a[156:159], v[44:47], v[88:91]
s_add_u32 s86, s51, 1
ds_read_b64_tr_b16 a[178:179], v235 offset:10240
v_exp_f32 v79, v63
v_mfma_f32_16x16x32_bf16 v[92:95], a[156:159], v[48:51], 0
s_lshr_b32 s86, s100, s86
ds_read_b64_tr_b16 a[180:181], v235 offset:12288
v_exp_f32 v96, v164
v_mfma_f32_16x16x32_bf16 v[92:95], a[152:155], v[12:15], v[92:95]
s_waitcnt lgkmcnt(7)
ds_read_b64_tr_b16 a[182:183], v235 offset:14336
v_exp_f32 v97, v165
v_mfma_f32_16x16x32_bf16 v[100:103], a[160:163], v[4:7], 0
s_and_b32 s86, s86, 0x2000
ds_read_b64_tr_b16 a[184:185], v248 offset:8192
v_exp_f32 v98, v166
v_mfma_f32_16x16x32_bf16 v[100:103], a[164:167], v[44:47], v[100:103]
s_lshl_b32 s87, s52, 14
ds_read_b64_tr_b16 a[186:187], v248 offset:10240
v_exp_f32 v99, v167
v_mfma_f32_16x16x32_bf16 v[104:107], a[164:167], v[48:51], 0
s_add_u32 s94, s86, 229376
ds_read_b64_tr_b16 a[188:189], v248 offset:12288
v_exp_f32 v108, v160
v_mfma_f32_16x16x32_bf16 v[104:107], a[160:163], v[12:15], v[104:107]
s_waitcnt lgkmcnt(7)
ds_read_b64_tr_b16 a[190:191], v248 offset:14336
buffer_load_dwordx4 v237, s[12:15], s54 offen offset:1024  lds
v_mfma_f32_16x16x32_bf16 v[112:115], a[168:171], v[4:7], 0
s_add_u32 s95, s86, 245760
ds_read_b64_tr_b16 a[144:145], v234 offset:8192
v_exp_f32 v109, v161
v_mfma_f32_16x16x32_bf16 v[112:115], a[172:175], v[44:47], v[112:115]
s_add_u32 s94, s94, s87
ds_read_b64_tr_b16 a[146:147], v234 offset:10240
v_exp_f32 v110, v162
v_mfma_f32_16x16x32_bf16 v[116:119], a[172:175], v[48:51], 0
s_sub_u32 s95, s95, s87
ds_read_b64_tr_b16 a[148:149], v234 offset:12288
v_exp_f32 v111, v163
v_mfma_f32_16x16x32_bf16 v[116:119], a[168:171], v[12:15], v[116:119]
s_waitcnt lgkmcnt(7)
ds_read_b64_tr_b16 a[150:151], v234 offset:14336
v_exp_f32 v120, v172
v_mfma_f32_16x16x32_bf16 v[80:83], a[176:179], v[16:19], v[80:83]
s_mul_i32 s55, s69, 576
ds_read_b64_tr_b16 a[152:153], v233 offset:8192
v_exp_f32 v121, v173
v_mfma_f32_16x16x32_bf16 v[80:83], a[180:183], v[32:35], v[80:83]
s_add_u32 s55, s55, s76
ds_read_b64_tr_b16 a[154:155], v233 offset:10240
v_exp_f32 v122, v174
v_mfma_f32_16x16x32_bf16 v[84:87], a[180:183], v[140:143], v[84:87]
s_addk_i32 m0, 0x2000
ds_read_b64_tr_b16 a[156:157], v233 offset:12288
v_exp_f32 v123, v175
v_mfma_f32_16x16x32_bf16 v[84:87], a[176:179], v[52:55], v[84:87]
s_waitcnt lgkmcnt(7)
ds_read_b64_tr_b16 a[158:159], v233 offset:14336
buffer_load_dwordx4 v238, s[12:15], s55 offen  lds
v_mfma_f32_16x16x32_bf16 v[88:91], a[184:187], v[16:19], v[88:91]
s_mul_i32 s2, s49, 6291456
ds_read_b64_tr_b16 a[160:161], v235 offset:16384
v_exp_f32 v124, v136
v_mfma_f32_16x16x32_bf16 v[88:91], a[188:191], v[32:35], v[88:91]
s_lshr_b32 s86, s100, 8
ds_read_b64_tr_b16 a[162:163], v235 offset:18432
v_exp_f32 v125, v137
v_mfma_f32_16x16x32_bf16 v[92:95], a[188:191], v[140:143], v[92:95]
s_and_b32 s86, s86, 0x2000
ds_read_b64_tr_b16 a[164:165], v235 offset:20480
v_exp_f32 v126, v138
v_mfma_f32_16x16x32_bf16 v[92:95], a[184:187], v[52:55], v[92:95]
s_waitcnt lgkmcnt(7)
ds_read_b64_tr_b16 a[166:167], v235 offset:22528
v_exp_f32 v127, v139
v_mfma_f32_16x16x32_bf16 v[100:103], a[144:147], v[16:19], v[100:103]
s_add_u32 s2, s2, s86
ds_read_b64_tr_b16 a[168:169], v248 offset:16384
s_nop 0
v_pk_add_f32 v[64:65], v[64:65], v[226:227] op_sel_hi:[1,0]
v_pk_add_f32 v[66:67], v[66:67], v[226:227] op_sel_hi:[1,0]
v_pk_add_f32 v[68:69], v[68:69], v[226:227] op_sel_hi:[1,0]
v_pk_add_f32 v[70:71], v[70:71], v[226:227] op_sel_hi:[1,0]
v_pk_add_f32 v[72:73], v[72:73], v[226:227] op_sel_hi:[1,0]
v_pk_add_f32 v[74:75], v[74:75], v[226:227] op_sel_hi:[1,0]
v_pk_add_f32 v[76:77], v[76:77], v[226:227] op_sel_hi:[1,0]
v_pk_add_f32 v[78:79], v[78:79], v[226:227] op_sel_hi:[1,0]
v_pk_add_f32 v[96:97], v[96:97], v[226:227] op_sel_hi:[1,0]
v_pk_add_f32 v[98:99], v[98:99], v[226:227] op_sel_hi:[1,0]
v_pk_add_f32 v[108:109], v[108:109], v[226:227] op_sel_hi:[1,0]
v_pk_add_f32 v[110:111], v[110:111], v[226:227] op_sel_hi:[1,0]
v_pk_add_f32 v[120:121], v[120:121], v[226:227] op_sel_hi:[1,0]
v_pk_add_f32 v[122:123], v[122:123], v[226:227] op_sel_hi:[1,0]
v_pk_add_f32 v[124:125], v[124:125], v[226:227] op_sel_hi:[1,0]
v_pk_add_f32 v[126:127], v[126:127], v[226:227] op_sel_hi:[1,0]
v_mfma_f32_16x16x32_bf16 v[100:103], a[148:151], v[32:35], v[100:103]
s_add_u32 s2, s2, s53
ds_read_b64_tr_b16 a[170:171], v248 offset:18432
v_rcp_f32 v64, v64
v_mfma_f32_16x16x32_bf16 v[104:107], a[148:151], v[140:143], v[104:107]
s_add_u32 s2, s2, 6815744
ds_read_b64_tr_b16 a[172:173], v248 offset:20480
v_rcp_f32 v65, v65
v_mfma_f32_16x16x32_bf16 v[104:107], a[144:147], v[52:55], v[104:107]
s_waitcnt lgkmcnt(7)
ds_read_b64_tr_b16 a[174:175], v248 offset:22528
buffer_load_dwordx4 v237, s[12:15], s55 offen offset:1024  lds
v_mfma_f32_16x16x32_bf16 v[112:115], a[152:155], v[16:19], v[112:115]
ds_read_b64_tr_b16 a[176:177], v234 offset:16384
v_rcp_f32 v66, v66
v_mfma_f32_16x16x32_bf16 v[112:115], a[156:159], v[32:35], v[112:115]
ds_read_b64_tr_b16 a[178:179], v234 offset:18432
v_rcp_f32 v67, v67
v_mfma_f32_16x16x32_bf16 v[116:119], a[156:159], v[140:143], v[116:119]
ds_read_b64_tr_b16 a[180:181], v234 offset:20480
v_rcp_f32 v68, v68
v_mfma_f32_16x16x32_bf16 v[116:119], a[152:155], v[52:55], v[116:119]
s_waitcnt lgkmcnt(7)
ds_read_b64_tr_b16 a[182:183], v234 offset:22528
v_rcp_f32 v69, v69
v_mfma_f32_16x16x32_bf16 v[80:83], a[160:163], v[148:151], v[80:83]
s_mul_i32 s54, s70, 576
ds_read_b64_tr_b16 a[184:185], v233 offset:16384
v_rcp_f32 v70, v70
v_mfma_f32_16x16x32_bf16 v[80:83], a[164:167], v[8:11], v[80:83]
s_add_u32 s54, s54, s76
ds_read_b64_tr_b16 a[186:187], v233 offset:18432
v_rcp_f32 v71, v71
v_mfma_f32_16x16x32_bf16 v[84:87], a[164:167], v[24:27], v[84:87]
s_addk_i32 m0, 0x2000
ds_read_b64_tr_b16 a[188:189], v233 offset:20480
v_rcp_f32 v72, v72
v_mfma_f32_16x16x32_bf16 v[84:87], a[160:163], v[156:159], v[84:87]
s_waitcnt lgkmcnt(7)
ds_read_b64_tr_b16 a[190:191], v233 offset:22528
buffer_load_dwordx4 v238, s[12:15], s54 offen  lds
v_mfma_f32_16x16x32_bf16 v[88:91], a[168:171], v[148:151], v[88:91]
ds_read_b64_tr_b16 a[144:145], v235 offset:24576
v_rcp_f32 v73, v73
v_mfma_f32_16x16x32_bf16 v[88:91], a[172:175], v[8:11], v[88:91]
ds_read_b64_tr_b16 a[146:147], v235 offset:26624
v_rcp_f32 v74, v74
v_mfma_f32_16x16x32_bf16 v[92:95], a[172:175], v[24:27], v[92:95]
ds_read_b64_tr_b16 a[148:149], v235 offset:28672
v_rcp_f32 v75, v75
v_mfma_f32_16x16x32_bf16 v[92:95], a[168:171], v[156:159], v[92:95]
s_waitcnt lgkmcnt(7)
ds_read_b64_tr_b16 a[150:151], v235 offset:30720
v_rcp_f32 v76, v76
v_mfma_f32_16x16x32_bf16 v[100:103], a[176:179], v[148:151], v[100:103]
ds_read_b64_tr_b16 a[152:153], v248 offset:24576
v_rcp_f32 v77, v77
v_mfma_f32_16x16x32_bf16 v[100:103], a[180:183], v[8:11], v[100:103]
ds_read_b64_tr_b16 a[154:155], v248 offset:26624
v_rcp_f32 v78, v78
v_mfma_f32_16x16x32_bf16 v[104:107], a[180:183], v[24:27], v[104:107]
ds_read_b64_tr_b16 a[156:157], v248 offset:28672
v_rcp_f32 v79, v79
v_mfma_f32_16x16x32_bf16 v[104:107], a[176:179], v[156:159], v[104:107]
s_waitcnt lgkmcnt(7)
ds_read_b64_tr_b16 a[158:159], v248 offset:30720
buffer_load_dwordx4 v237, s[12:15], s54 offen offset:1024  lds
v_mfma_f32_16x16x32_bf16 v[112:115], a[184:187], v[148:151], v[112:115]
ds_read_b64_tr_b16 a[160:161], v234 offset:24576
v_rcp_f32 v96, v96
v_mfma_f32_16x16x32_bf16 v[112:115], a[188:191], v[8:11], v[112:115]
ds_read_b64_tr_b16 a[162:163], v234 offset:26624
v_rcp_f32 v97, v97
v_mfma_f32_16x16x32_bf16 v[116:119], a[188:191], v[24:27], v[116:119]
ds_read_b64_tr_b16 a[164:165], v234 offset:28672
v_rcp_f32 v98, v98
v_mfma_f32_16x16x32_bf16 v[116:119], a[184:187], v[156:159], v[116:119]
s_waitcnt lgkmcnt(7)
ds_read_b64_tr_b16 a[166:167], v234 offset:30720
v_rcp_f32 v99, v99
v_mfma_f32_16x16x32_bf16 v[80:83], a[144:147], v[36:39], v[80:83]
s_mul_i32 s55, s71, 576
ds_read_b64_tr_b16 a[168:169], v233 offset:24576
v_rcp_f32 v108, v108
v_rcp_f32 v109, v109
v_mfma_f32_16x16x32_bf16 v[80:83], a[148:151], v[56:59], v[80:83]
s_add_u32 s55, s55, s76
ds_read_b64_tr_b16 a[170:171], v233 offset:26624
v_rcp_f32 v110, v110
v_mfma_f32_16x16x32_bf16 v[84:87], a[148:151], v[40:43], v[84:87]
s_addk_i32 m0, 0x2000
ds_read_b64_tr_b16 a[172:173], v233 offset:28672
v_rcp_f32 v111, v111
v_mfma_f32_16x16x32_bf16 v[84:87], a[144:147], v[28:31], v[84:87]
s_waitcnt lgkmcnt(7)
ds_read_b64_tr_b16 a[174:175], v233 offset:30720
buffer_load_dwordx4 v238, s[12:15], s55 offen  lds
v_mfma_f32_16x16x32_bf16 v[88:91], a[152:155], v[36:39], v[88:91]
ds_read_b64_tr_b16 a[176:177], v235 offset:32768
v_rcp_f32 v120, v120
v_mfma_f32_16x16x32_bf16 v[88:91], a[156:159], v[56:59], v[88:91]
ds_read_b64_tr_b16 a[178:179], v235 offset:34816
v_rcp_f32 v121, v121
v_mfma_f32_16x16x32_bf16 v[92:95], a[156:159], v[40:43], v[92:95]
ds_read_b64_tr_b16 a[180:181], v235 offset:36864
v_rcp_f32 v122, v122
v_mfma_f32_16x16x32_bf16 v[92:95], a[152:155], v[28:31], v[92:95]
s_waitcnt lgkmcnt(7)
ds_read_b64_tr_b16 a[182:183], v235 offset:38912
v_rcp_f32 v123, v123
v_mfma_f32_16x16x32_bf16 v[100:103], a[160:163], v[36:39], v[100:103]
ds_read_b64_tr_b16 a[184:185], v248 offset:32768
v_rcp_f32 v124, v124
v_mfma_f32_16x16x32_bf16 v[100:103], a[164:167], v[56:59], v[100:103]
LF_p7:
s_cbranch_execz LF_v105
ds_read_b64_tr_b16 a[186:187], v248 offset:34816
v_rcp_f32 v125, v125
v_mfma_f32_16x16x32_bf16 v[104:107], a[164:167], v[40:43], v[104:107]
ds_read_b64_tr_b16 a[188:189], v248 offset:36864
v_rcp_f32 v126, v126
v_mfma_f32_16x16x32_bf16 v[104:107], a[160:163], v[28:31], v[104:107]
s_waitcnt lgkmcnt(7)
ds_read_b64_tr_b16 a[190:191], v248 offset:38912
buffer_load_dwordx4 v237, s[12:15], s55 offen offset:1024  lds
v_mfma_f32_16x16x32_bf16 v[112:115], a[168:171], v[36:39], v[112:115]
ds_read_b64_tr_b16 a[144:145], v234 offset:32768
v_rcp_f32 v127, v127
v_mfma_f32_16x16x32_bf16 v[112:115], a[172:175], v[56:59], v[112:115]
ds_read_b64_tr_b16 a[146:147], v234 offset:34816
s_nop 0
v_pk_mul_f32 v[64:65], v[64:65], v[144:145]
v_pk_mul_f32 v[66:67], v[66:67], v[146:147]
v_pk_mul_f32 v[68:69], v[68:69], v[20:21]
v_pk_mul_f32 v[70:71], v[70:71], v[22:23]
v_pk_mul_f32 v[72:73], v[72:73], v[152:153]
v_pk_mul_f32 v[74:75], v[74:75], v[154:155]
v_pk_mul_f32 v[76:77], v[76:77], v[60:61]
v_pk_mul_f32 v[78:79], v[78:79], v[62:63]
v_pk_mul_f32 v[96:97], v[96:97], v[164:165]
v_pk_mul_f32 v[98:99], v[98:99], v[166:167]
v_pk_mul_f32 v[108:109], v[108:109], v[160:161]
v_pk_mul_f32 v[110:111], v[110:111], v[162:163]
v_pk_mul_f32 v[120:121], v[120:121], v[172:173]
v_pk_mul_f32 v[122:123], v[122:123], v[174:175]
v_pk_mul_f32 v[124:125], v[124:125], v[136:137]
v_pk_mul_f32 v[126:127], v[126:127], v[138:139]
v_mfma_f32_16x16x32_bf16 v[116:119], a[172:175], v[40:43], v[116:119]
ds_read_b64_tr_b16 a[148:149], v234 offset:36864
v_cvt_pk_bf16_f32 v20, v64, v65
v_mfma_f32_16x16x32_bf16 v[116:119], a[168:171], v[28:31], v[116:119]
s_waitcnt lgkmcnt(7)
ds_read_b64_tr_b16 a[150:151], v234 offset:38912
v_cvt_pk_bf16_f32 v21, v66, v67
v_mfma_f32_16x16x32_bf16 v[80:83], a[176:179], v[128:131], v[80:83]
s_mul_i32 s54, s72, 576
ds_read_b64_tr_b16 a[152:153], v233 offset:32768
v_cvt_pk_bf16_f32 v60, v68, v69
v_mfma_f32_16x16x32_bf16 v[80:83], a[180:183], v[168:171], v[80:83]
s_add_u32 s54, s54, s76
ds_read_b64_tr_b16 a[154:155], v233 offset:34816
v_cvt_pk_bf16_f32 v61, v70, v71
v_mfma_f32_16x16x32_bf16 v[84:87], a[180:183], v[176:179], v[84:87]
s_addk_i32 m0, 0x2000
ds_read_b64_tr_b16 a[156:157], v233 offset:36864
v_cvt_pk_bf16_f32 v22, v72, v73
v_mfma_f32_16x16x32_bf16 v[84:87], a[176:179], v[132:135], v[84:87]
s_waitcnt lgkmcnt(7)
ds_read_b64_tr_b16 a[158:159], v233 offset:38912
buffer_load_dwordx4 v238, s[12:15], s54 offen  lds
v_mfma_f32_16x16x32_bf16 v[88:91], a[184:187], v[128:131], v[88:91]
ds_read_b64_tr_b16 a[160:161], v235 offset:40960
v_cvt_pk_bf16_f32 v23, v74, v75
v_mfma_f32_16x16x32_bf16 v[88:91], a[188:191], v[168:171], v[88:91]
ds_read_b64_tr_b16 a[162:163], v235 offset:43008
v_cvt_pk_bf16_f32 v62, v76, v77
v_mfma_f32_16x16x32_bf16 v[92:95], a[188:191], v[176:179], v[92:95]
ds_read_b64_tr_b16 a[164:165], v235 offset:45056
v_cvt_pk_bf16_f32 v63, v78, v79
v_mfma_f32_16x16x32_bf16 v[92:95], a[184:187], v[132:135], v[92:95]
s_waitcnt lgkmcnt(7)
ds_read_b64_tr_b16 a[166:167], v235 offset:47104
v_cvt_pk_bf16_f32 v64, v96, v97
v_mfma_f32_16x16x32_bf16 v[100:103], a[144:147], v[128:131], v[100:103]
ds_read_b64_tr_b16 a[168:169], v248 offset:40960
v_cvt_pk_bf16_f32 v65, v98, v99
v_mfma_f32_16x16x32_bf16 v[100:103], a[148:151], v[168:171], v[100:103]
ds_read_b64_tr_b16 a[170:171], v248 offset:43008
v_cvt_pk_bf16_f32 v68, v108, v109
v_mfma_f32_16x16x32_bf16 v[104:107], a[148:151], v[176:179], v[104:107]
ds_read_b64_tr_b16 a[172:173], v248 offset:45056
v_cvt_pk_bf16_f32 v69, v110, v111
v_mfma_f32_16x16x32_bf16 v[104:107], a[144:147], v[132:135], v[104:107]
s_waitcnt lgkmcnt(7)
ds_read_b64_tr_b16 a[174:175], v248 offset:47104
buffer_load_dwordx4 v237, s[12:15], s54 offen offset:1024  lds
v_mfma_f32_16x16x32_bf16 v[112:115], a[152:155], v[128:131], v[112:115]
ds_read_b64_tr_b16 a[176:177], v234 offset:40960
v_cvt_pk_bf16_f32 v66, v120, v121
v_mfma_f32_16x16x32_bf16 v[112:115], a[156:159], v[168:171], v[112:115]
ds_read_b64_tr_b16 a[178:179], v234 offset:43008
v_cvt_pk_bf16_f32 v67, v122, v123
v_mfma_f32_16x16x32_bf16 v[116:119], a[156:159], v[176:179], v[116:119]
ds_read_b64_tr_b16 a[180:181], v234 offset:45056
v_cvt_pk_bf16_f32 v70, v124, v125
v_mfma_f32_16x16x32_bf16 v[116:119], a[152:155], v[132:135], v[116:119]
s_waitcnt lgkmcnt(7)
ds_read_b64_tr_b16 a[182:183], v234 offset:47104
v_cvt_pk_bf16_f32 v71, v126, v127
v_mfma_f32_16x16x32_bf16 v[80:83], a[160:163], v[60:63], v[80:83]
s_mul_i32 s55, s73, 576
ds_read_b64_tr_b16 a[184:185], v233 offset:40960
v_lshl_add_u32 v254, v255, 4, s53
v_mfma_f32_16x16x32_bf16 v[80:83], a[164:167], v[68:71], v[80:83]
s_add_u32 s55, s55, s76
ds_read_b64_tr_b16 a[186:187], v233 offset:43008
v_mfma_f32_16x16x32_bf16 v[84:87], a[164:167], v[64:67], v[84:87]
s_waitcnt vmcnt(10)
ds_read_b64_tr_b16 a[188:189], v233 offset:45056
v_mfma_f32_16x16x32_bf16 v[84:87], a[160:163], v[20:23], v[84:87]
s_waitcnt lgkmcnt(7)
ds_read_b64_tr_b16 a[190:191], v233 offset:47104
v_mfma_f32_16x16x32_bf16 v[88:91], a[168:171], v[60:63], v[88:91]
s_barrier
ds_read_b64_tr_b16 a[144:145], v250 offset:0
v_cvt_pk_bf16_f32 v72, v80, v81
v_mfma_f32_16x16x32_bf16 v[88:91], a[172:175], v[68:71], v[88:91]
s_addk_i32 m0, 0x2000
ds_read_b64_tr_b16 a[146:147], v250 offset:2048
v_cvt_pk_bf16_f32 v73, v82, v83
v_mfma_f32_16x16x32_bf16 v[92:95], a[172:175], v[64:67], v[92:95]
s_lshl_b32 s86, s3, 18
ds_read_b64_tr_b16 a[148:149], v250 offset:4096
buffer_load_dwordx4 v238, s[12:15], s55 offen  lds
v_mfma_f32_16x16x32_bf16 v[92:95], a[168:171], v[20:23], v[92:95]
s_waitcnt lgkmcnt(7)
ds_read_b64_tr_b16 a[150:151], v250 offset:6144
v_add_u32 v253, s86, v254
v_mfma_f32_16x16x32_bf16 v[100:103], a[176:179], v[60:63], v[100:103]
ds_read_b64_tr_b16 a[152:153], v250 offset:8192
v_cvt_pk_bf16_f32 v74, v88, v89
v_mfma_f32_16x16x32_bf16 v[100:103], a[180:183], v[68:71], v[100:103]
ds_read_b64_tr_b16 a[154:155], v250 offset:10240
v_cvt_pk_bf16_f32 v75, v90, v91
v_mfma_f32_16x16x32_bf16 v[104:107], a[180:183], v[64:67], v[104:107]
ds_read_b64_tr_b16 a[156:157], v250 offset:12288
v_cvt_pk_bf16_f32 v76, v84, v85
v_mfma_f32_16x16x32_bf16 v[104:107], a[176:179], v[20:23], v[104:107]
s_waitcnt lgkmcnt(7)
ds_read_b64_tr_b16 a[158:159], v250 offset:14336
v_cvt_pk_bf16_f32 v77, v86, v87
v_mfma_f32_16x16x32_bf16 v[112:115], a[184:187], v[60:63], v[112:115]
ds_read_b64_tr_b16 a[160:161], v250 offset:16384
v_cvt_pk_bf16_f32 v78, v92, v93
v_mfma_f32_16x16x32_bf16 v[112:115], a[188:191], v[68:71], v[112:115]
ds_read_b64_tr_b16 a[162:163], v250 offset:18432
v_cvt_pk_bf16_f32 v79, v94, v95
v_mfma_f32_16x16x32_bf16 v[116:119], a[188:191], v[64:67], v[116:119]
ds_read_b64_tr_b16 a[164:165], v250 offset:20480
buffer_load_dwordx4 v237, s[12:15], s55 offen offset:1024  lds
v_mfma_f32_16x16x32_bf16 v[116:119], a[184:187], v[20:23], v[116:119]
s_waitcnt lgkmcnt(7)
ds_read_b64_tr_b16 a[166:167], v250 offset:22528
v_xor_b32 v236, 0x40000, v253
v_mfma_f32_16x16x32_bf16 v[80:83], a[144:147], v[4:7], 0
s_mul_i32 s54, s68, 576
ds_read_b64_tr_b16 a[168:169], v250 offset:24576
v_cvt_pk_bf16_f32 v84, v112, v113
v_mfma_f32_16x16x32_bf16 v[80:83], a[148:151], v[44:47], v[80:83]
s_add_u32 s54, s54, s77
ds_read_b64_tr_b16 a[170:171], v250 offset:26624
v_cvt_pk_bf16_f32 v85, v114, v115
v_mfma_f32_16x16x32_bf16 v[88:91], a[148:151], v[48:51], 0
s_mov_b32 m0, s53
ds_read_b64_tr_b16 a[172:173], v250 offset:28672
v_cvt_pk_bf16_f32 v86, v100, v101
v_mfma_f32_16x16x32_bf16 v[88:91], a[144:147], v[12:15], v[88:91]
s_waitcnt lgkmcnt(7)
ds_read_b64_tr_b16 a[174:175], v250 offset:30720
buffer_load_dwordx4 v238, s[12:15], s54 offen  lds
v_mfma_f32_16x16x32_bf16 v[88:91], a[152:155], v[52:55], v[88:91]
s_and_b32 s86, s100, 0x2000
ds_read_b64_tr_b16 a[176:177], v250 offset:32768
v_cvt_pk_bf16_f32 v87, v102, v103
v_mfma_f32_16x16x32_bf16 v[88:91], a[156:159], v[140:143], v[88:91]
s_add_u32 s56, s83, s86
ds_read_b64_tr_b16 a[178:179], v250 offset:34816
v_cvt_pk_bf16_f32 v92, v116, v117
v_mfma_f32_16x16x32_bf16 v[80:83], a[156:159], v[32:35], v[80:83]
ds_read_b64_tr_b16 a[180:181], v250 offset:36864
v_cvt_pk_bf16_f32 v93, v118, v119
v_mfma_f32_16x16x32_bf16 v[80:83], a[152:155], v[16:19], v[80:83]
s_waitcnt lgkmcnt(7)
ds_read_b64_tr_b16 a[182:183], v250 offset:38912
v_cvt_pk_bf16_f32 v94, v104, v105
v_mfma_f32_16x16x32_bf16 v[80:83], a[160:163], v[148:151], v[80:83]
ds_read_b64_tr_b16 a[184:185], v250 offset:40960
v_cvt_pk_bf16_f32 v95, v106, v107
v_mfma_f32_16x16x32_bf16 v[80:83], a[164:167], v[8:11], v[80:83]
ds_read_b64_tr_b16 a[186:187], v250 offset:43008
v_mfma_f32_16x16x32_bf16 v[88:91], a[164:167], v[24:27], v[88:91]
s_lshr_b32 s101, s82, 1
buffer_store_dwordx4 v[72:75], v253, s[32:35], s56 offen offset:0 sc1
ds_read_b64_tr_b16 a[188:189], v250 offset:45056
v_mfma_f32_16x16x32_bf16 v[88:91], a[160:163], v[156:159], v[88:91]
s_waitcnt lgkmcnt(7)
ds_read_b64_tr_b16 a[190:191], v250 offset:47104
buffer_load_dwordx4 v237, s[12:15], s54 offen offset:1024  lds
v_mfma_f32_16x16x32_bf16 v[88:91], a[168:171], v[28:31], v[88:91]
s_lshl_b32 s67, s52, 5
ds_read_b64_tr_b16 a[144:145], v245 offset:0
v_accvgpr_write_b32 a0, 0
v_mfma_f32_16x16x32_bf16 v[88:91], a[172:175], v[40:43], v[88:91]
s_add_u32 s101, s101, s67
ds_read_b64_tr_b16 a[146:147], v245 offset:2048
v_lshl_add_u32 v231, v255, 4, s53
v_mfma_f32_16x16x32_bf16 v[80:83], a[172:175], v[56:59], v[80:83]
ds_read_b64_tr_b16 a[148:149], v245 offset:4096
v_lshrrev_b32 v230, 1, v255
v_mfma_f32_16x16x32_bf16 v[80:83], a[168:171], v[36:39], v[80:83]
s_waitcnt lgkmcnt(7)
ds_read_b64_tr_b16 a[150:151], v245 offset:6144
v_sub_u32 v230, s51, v230
v_mfma_f32_16x16x32_bf16 v[80:83], a[176:179], v[128:131], v[80:83]
s_mul_i32 s55, s69, 576
buffer_store_dwordx4 v[76:79], v253, s[32:35], s56 offen offset:1024 sc1
ds_read_b64_tr_b16 a[152:153], v245 offset:8192
v_mfma_f32_16x16x32_bf16 v[80:83], a[180:183], v[168:171], v[80:83]
s_add_u32 s55, s55, s77
ds_read_b64_tr_b16 a[154:155], v245 offset:10240
v_add_u32 v230, 7, v230
v_mfma_f32_16x16x32_bf16 v[88:91], a[180:183], v[176:179], v[88:91]
s_addk_i32 m0, 0x2000
ds_read_b64_tr_b16 a[156:157], v245 offset:12288
v_and_b32 v230, 7, v230
v_mfma_f32_16x16x32_bf16 v[88:91], a[176:179], v[132:135], v[88:91]
s_waitcnt lgkmcnt(7)
ds_read_b64_tr_b16 a[158:159], v245 offset:14336
buffer_load_dwordx4 v238, s[12:15], s55 offen  lds
v_mfma_f32_16x16x32_bf16 v[88:91], a[184:187], v[20:23], v[88:91]
s_xor_b32 s67, s52, 1
buffer_store_dwordx4 v[84:87], v236, s[32:35], s56 offen offset:0 sc1
ds_read_b64_tr_b16 a[160:161], v245 offset:16384
v_mfma_f32_16x16x32_bf16 v[88:91], a[188:191], v[64:67], v[88:91]
ds_read_b64_tr_b16 a[162:163], v245 offset:18432
v_xor_b32 v229, s67, v255
v_mfma_f32_16x16x32_bf16 v[80:83], a[188:191], v[68:71], v[80:83]
ds_read_b64_tr_b16 a[164:165], v245 offset:20480
v_and_b32 v229, 1, v229
v_mfma_f32_16x16x32_bf16 v[80:83], a[184:187], v[60:63], v[80:83]
s_waitcnt lgkmcnt(7)
ds_read_b64_tr_b16 a[166:167], v245 offset:22528
v_lshl_add_u32 v229, v230, 1, v229
v_mfma_f32_16x16x32_bf16 v[72:75], a[144:147], v[4:7], 0
buffer_store_dwordx4 v[92:95], v236, s[32:35], s56 offen offset:1024 sc1
ds_read_b64_tr_b16 a[168:169], v245 offset:24576
v_mfma_f32_16x16x32_bf16 v[72:75], a[148:151], v[44:47], v[72:75]
s_add_u32 s56, s51, 1
ds_read_b64_tr_b16 a[170:171], v245 offset:26624
v_cmp_gt_u32 s[92:93], 0, v255
v_mfma_f32_16x16x32_bf16 v[76:79], a[148:151], v[48:51], 0
s_and_b32 s56, s56, 7
ds_read_b64_tr_b16 a[172:173], v245 offset:28672
v_cvt_pk_bf16_f32 v84, v80, v81
v_mfma_f32_16x16x32_bf16 v[76:79], a[144:147], v[12:15], v[76:79]
s_waitcnt lgkmcnt(7)
ds_read_b64_tr_b16 a[174:175], v245 offset:30720
buffer_load_dwordx4 v237, s[12:15], s55 offen offset:1024  lds
v_mfma_f32_16x16x32_bf16 v[76:79], a[152:155], v[52:55], v[76:79]
s_add_u32 s56, s56, 1
ds_read_b64_tr_b16 a[176:177], v245 offset:32768
v_cvt_pk_bf16_f32 v85, v82, v83
v_mfma_f32_16x16x32_bf16 v[76:79], a[156:159], v[140:143], v[76:79]
s_lshr_b32 s86, s100, s56
ds_read_b64_tr_b16 a[178:179], v245 offset:34816
v_cvt_pk_bf16_f32 v80, v88, v89
v_mfma_f32_16x16x32_bf16 v[72:75], a[156:159], v[32:35], v[72:75]
s_and_b32 s86, s86, 0x2000
ds_read_b64_tr_b16 a[180:181], v245 offset:36864
v_cvt_pk_bf16_f32 v81, v90, v91
v_mfma_f32_16x16x32_bf16 v[72:75], a[152:155], v[16:19], v[72:75]
s_waitcnt lgkmcnt(7)
ds_read_b64_tr_b16 a[182:183], v245 offset:38912
v_cndmask_b32 v230, 3, 1, s[92:93]
v_mfma_f32_16x16x32_bf16 v[72:75], a[160:163], v[148:151], v[72:75]
s_mul_i32 s54, s70, 576
ds_read_b64_tr_b16 a[184:185], v245 offset:40960
v_cmp_eq_u32 s[92:93], 0, v229
v_mfma_f32_16x16x32_bf16 v[72:75], a[164:167], v[8:11], v[72:75]
s_add_u32 s54, s54, s77
ds_read_b64_tr_b16 a[186:187], v245 offset:43008
v_add_u32 v230, v230, v255
v_mfma_f32_16x16x32_bf16 v[76:79], a[164:167], v[24:27], v[76:79]
s_addk_i32 m0, 0x2000
ds_read_b64_tr_b16 a[188:189], v245 offset:45056
v_cndmask_b32 v230, v230, 0, s[92:93]
v_mfma_f32_16x16x32_bf16 v[76:79], a[160:163], v[156:159], v[76:79]
s_waitcnt lgkmcnt(7)
ds_read_b64_tr_b16 a[190:191], v245 offset:47104
buffer_load_dwordx4 v238, s[12:15], s54 offen  lds
v_mfma_f32_16x16x32_bf16 v[76:79], a[168:171], v[28:31], v[76:79]
s_lshl_b32 s56, s56, 19
ds_read_b64_tr_b16 a[144:145], v244 offset:0
v_cndmask_b32 v229, v229, 16, s[92:93]
v_mfma_f32_16x16x32_bf16 v[76:79], a[172:175], v[40:43], v[76:79]
s_add_u32 s56, s56, s83
ds_read_b64_tr_b16 a[146:147], v244 offset:2048
v_accvgpr_write_b32 a1, 0
v_mfma_f32_16x16x32_bf16 v[72:75], a[172:175], v[56:59], v[72:75]
s_add_u32 s56, s56, s86
ds_read_b64_tr_b16 a[148:149], v244 offset:4096
v_accvgpr_write_b32 a62, 0
v_mfma_f32_16x16x32_bf16 v[72:75], a[168:171], v[36:39], v[72:75]
s_waitcnt lgkmcnt(7)
ds_read_b64_tr_b16 a[150:151], v244 offset:6144
v_accvgpr_write_b32 a63, 0
v_mfma_f32_16x16x32_bf16 v[72:75], a[176:179], v[128:131], v[72:75]
s_sub_u32 s67, s2, 128
ds_read_b64_tr_b16 a[152:153], v244 offset:8192
v_lshl_add_u32 v229, v229, 7, s67
v_mfma_f32_16x16x32_bf16 v[72:75], a[180:183], v[168:171], v[72:75]
s_lshl_b32 s67, s50, 12
ds_read_b64_tr_b16 a[154:155], v244 offset:10240
v_accvgpr_write_b32 a64, 0
v_mfma_f32_16x16x32_bf16 v[76:79], a[180:183], v[176:179], v[76:79]
s_add_u32 s67, s67, 147456
ds_read_b64_tr_b16 a[156:157], v244 offset:12288
v_and_b32 v228, 12, v252
v_mfma_f32_16x16x32_bf16 v[76:79], a[176:179], v[132:135], v[76:79]
s_waitcnt lgkmcnt(7)
ds_read_b64_tr_b16 a[158:159], v244 offset:14336
buffer_load_dwordx4 v237, s[12:15], s54 offen offset:1024  lds
v_mfma_f32_16x16x32_bf16 v[76:79], a[184:187], v[20:23], v[76:79]
ds_read_b64_tr_b16 a[160:161], v244 offset:16384
v_add_u32 v228, v252, v228
v_mfma_f32_16x16x32_bf16 v[76:79], a[188:191], v[64:67], v[76:79]
ds_read_b64_tr_b16 a[162:163], v244 offset:18432
v_lshl_add_u32 v228, v228, 7, s67
v_mfma_f32_16x16x32_bf16 v[72:75], a[188:191], v[68:71], v[72:75]
ds_read_b64_tr_b16 a[164:165], v244 offset:20480
v_and_b32 v227, 7, v255
v_mfma_f32_16x16x32_bf16 v[72:75], a[184:187], v[60:63], v[72:75]
s_waitcnt lgkmcnt(7)
ds_read_b64_tr_b16 a[166:167], v244 offset:22528
v_xor_b32 v227, v227, v251
v_mfma_f32_16x16x32_bf16 v[88:91], a[144:147], v[4:7], 0
s_mul_i32 s55, s71, 576
ds_read_b64_tr_b16 a[168:169], v244 offset:24576
v_lshl_add_u32 v226, v227, 4, v228
v_mfma_f32_16x16x32_bf16 v[88:91], a[148:151], v[44:47], v[88:91]
s_add_u32 s55, s55, s77
ds_read_b64_tr_b16 a[170:171], v244 offset:26624
v_xor_b32 v225, 64, v226
v_mfma_f32_16x16x32_bf16 v[92:95], a[148:151], v[48:51], 0
s_addk_i32 m0, 0x2000
ds_read_b64_tr_b16 a[172:173], v244 offset:28672
v_cvt_pk_bf16_f32 v86, v72, v73
v_mfma_f32_16x16x32_bf16 v[92:95], a[144:147], v[12:15], v[92:95]
s_waitcnt lgkmcnt(7)
ds_read_b64_tr_b16 a[174:175], v244 offset:30720
buffer_load_dwordx4 v238, s[12:15], s55 offen  lds
v_mfma_f32_16x16x32_bf16 v[92:95], a[152:155], v[52:55], v[92:95]
ds_read_b64_tr_b16 a[176:177], v244 offset:32768
v_cvt_pk_bf16_f32 v87, v74, v75
v_mfma_f32_16x16x32_bf16 v[92:95], a[156:159], v[140:143], v[92:95]
ds_read_b64_tr_b16 a[178:179], v244 offset:34816
v_cvt_pk_bf16_f32 v82, v76, v77
v_mfma_f32_16x16x32_bf16 v[88:91], a[156:159], v[32:35], v[88:91]
ds_read_b64_tr_b16 a[180:181], v244 offset:36864
v_cvt_pk_bf16_f32 v83, v78, v79
v_mfma_f32_16x16x32_bf16 v[88:91], a[152:155], v[16:19], v[88:91]
s_waitcnt lgkmcnt(7)
buffer_store_dwordx4 v[84:87], v253, s[32:35], s56 offen offset:0 sc1
ds_read_b64_tr_b16 a[182:183], v244 offset:38912
v_mfma_f32_16x16x32_bf16 v[88:91], a[160:163], v[148:151], v[88:91]
ds_read_b64_tr_b16 a[184:185], v244 offset:40960
v_bfe_u32 v228, v255, 3, 2
v_mfma_f32_16x16x32_bf16 v[88:91], a[164:167], v[8:11], v[88:91]
ds_read_b64_tr_b16 a[186:187], v244 offset:43008
v_xor_b32 v228, v228, v255
v_mfma_f32_16x16x32_bf16 v[92:95], a[164:167], v[24:27], v[92:95]
buffer_store_dwordx4 v[80:83], v253, s[32:35], s56 offen offset:1024 sc1
ds_read_b64_tr_b16 a[188:189], v244 offset:45056
v_mfma_f32_16x16x32_bf16 v[92:95], a[160:163], v[156:159], v[92:95]
s_waitcnt lgkmcnt(7)
ds_read_b64_tr_b16 a[190:191], v244 offset:47104
buffer_load_dwordx4 v237, s[12:15], s55 offen offset:1024  lds
v_mfma_f32_16x16x32_bf16 v[92:95], a[168:171], v[28:31], v[92:95]
s_lshl_b32 s86, s48, 7
ds_read_b64_tr_b16 a[144:145], v243 offset:0
v_lshl_add_u32 v224, v228, 4, s67
v_mfma_f32_16x16x32_bf16 v[92:95], a[172:175], v[40:43], v[92:95]
s_add_u32 s86, s86, s2
ds_read_b64_tr_b16 a[146:147], v243 offset:2048
v_lshrrev_b32 v223, 5, v255
v_mfma_f32_16x16x32_bf16 v[88:91], a[172:175], v[56:59], v[88:91]
ds_read_b64_tr_b16 a[148:149], v243 offset:4096
v_lshl_add_u32 v223, v223, 27, s86
v_mfma_f32_16x16x32_bf16 v[88:91], a[168:171], v[36:39], v[88:91]
s_waitcnt lgkmcnt(7)
ds_read_b64_tr_b16 a[150:151], v243 offset:6144
v_lshl_add_u32 v223, v255, 2, v223
v_mfma_f32_16x16x32_bf16 v[88:91], a[176:179], v[128:131], v[88:91]
s_mul_i32 s54, s72, 576
ds_read_b64_tr_b16 a[152:153], v243 offset:8192
v_mov_b32 v254, 2
v_mfma_f32_16x16x32_bf16 v[88:91], a[180:183], v[168:171], v[88:91]
s_add_u32 s54, s54, s77
ds_read_b64_tr_b16 a[154:155], v243 offset:10240
v_xor_b32 v222, 64, v224
v_mfma_f32_16x16x32_bf16 v[92:95], a[180:183], v[176:179], v[92:95]
s_addk_i32 m0, 0x2000
ds_read_b64_tr_b16 a[156:157], v243 offset:12288
v_accvgpr_write_b32 a65, 0
v_mfma_f32_16x16x32_bf16 v[92:95], a[176:179], v[132:135], v[92:95]
s_waitcnt lgkmcnt(7)
ds_read_b64_tr_b16 a[158:159], v243 offset:14336
buffer_load_dwordx4 v238, s[12:15], s54 offen  lds
v_mfma_f32_16x16x32_bf16 v[92:95], a[184:187], v[20:23], v[92:95]
s_waitcnt vmcnt(8)
buffer_store_dword v254, v223, s[32:35], 0 offen sc1
ds_read_b64_tr_b16 a[160:161], v243 offset:16384
v_mfma_f32_16x16x32_bf16 v[92:95], a[188:191], v[64:67], v[92:95]
s_lshl_b32 s67, s49, 2
ds_read_b64_tr_b16 a[162:163], v243 offset:18432
v_accvgpr_write_b32 a126, 0
v_mfma_f32_16x16x32_bf16 v[88:91], a[188:191], v[68:71], v[88:91]
s_add_u32 s67, s67, s50
ds_read_b64_tr_b16 a[164:165], v243 offset:20480
v_accvgpr_write_b32 a127, 0
v_mfma_f32_16x16x32_bf16 v[88:91], a[184:187], v[60:63], v[88:91]
s_waitcnt lgkmcnt(7)
ds_read_b64_tr_b16 a[166:167], v243 offset:22528
v_lshrrev_b32 v221, 2, v252
v_mfma_f32_16x16x32_bf16 v[72:75], a[144:147], v[4:7], 0
s_lshl_b32 s67, s67, 5
ds_read_b64_tr_b16 a[168:169], v243 offset:24576
v_lshrrev_b32 v228, 3, v255
v_mfma_f32_16x16x32_bf16 v[72:75], a[148:151], v[44:47], v[72:75]
ds_read_b64_tr_b16 a[170:171], v243 offset:26624
v_add_u32 v228, s67, v228
v_mfma_f32_16x16x32_bf16 v[76:79], a[148:151], v[48:51], 0
ds_read_b64_tr_b16 a[172:173], v243 offset:28672
v_cvt_pk_bf16_f32 v82, v88, v89
v_mfma_f32_16x16x32_bf16 v[76:79], a[144:147], v[12:15], v[76:79]
s_waitcnt lgkmcnt(7)
ds_read_b64_tr_b16 a[174:175], v243 offset:30720
buffer_load_dwordx4 v237, s[12:15], s54 offen offset:1024  lds
v_mfma_f32_16x16x32_bf16 v[76:79], a[152:155], v[52:55], v[76:79]
ds_read_b64_tr_b16 a[176:177], v243 offset:32768
v_cvt_pk_bf16_f32 v83, v90, v91
v_mfma_f32_16x16x32_bf16 v[76:79], a[156:159], v[140:143], v[76:79]
ds_read_b64_tr_b16 a[178:179], v243 offset:34816
v_cvt_pk_bf16_f32 v86, v92, v93
v_mfma_f32_16x16x32_bf16 v[72:75], a[156:159], v[32:35], v[72:75]
ds_read_b64_tr_b16 a[180:181], v243 offset:36864
v_cvt_pk_bf16_f32 v87, v94, v95
v_mfma_f32_16x16x32_bf16 v[72:75], a[152:155], v[16:19], v[72:75]
s_waitcnt lgkmcnt(7)
ds_read_b64_tr_b16 a[182:183], v243 offset:38912
v_mul_u32_u24 v228, 2304, v228
v_mfma_f32_16x16x32_bf16 v[72:75], a[160:163], v[148:151], v[72:75]
s_mul_i32 s55, s73, 576
ds_read_b64_tr_b16 a[184:185], v243 offset:40960
v_and_b32 v227, 7, v255
v_mfma_f32_16x16x32_bf16 v[72:75], a[164:167], v[8:11], v[72:75]
s_add_u32 s55, s55, s77
ds_read_b64_tr_b16 a[186:187], v243 offset:43008
v_lshl_add_u32 v228, v227, 4, v228
v_mfma_f32_16x16x32_bf16 v[76:79], a[164:167], v[24:27], v[76:79]
ds_read_b64_tr_b16 a[188:189], v243 offset:45056
v_cmp_eq_u32 s[90:91], v221, v251
v_mfma_f32_16x16x32_bf16 v[76:79], a[160:163], v[156:159], v[76:79]
s_waitcnt lgkmcnt(7)
ds_read_b64_tr_b16 a[190:191], v243 offset:47104
v_and_b32 v252, 1, v255
v_mfma_f32_16x16x32_bf16 v[76:79], a[168:171], v[28:31], v[76:79]
s_barrier
ds_read_b64_tr_b16 a[144:145], v242 offset:0
v_lshlrev_b32 v252, 4, v252
v_mfma_f32_16x16x32_bf16 v[76:79], a[172:175], v[40:43], v[76:79]
s_addk_i32 m0, 0x2000
ds_read_b64_tr_b16 a[146:147], v242 offset:2048
v_mov_b32 v251, 0x3f80
v_mfma_f32_16x16x32_bf16 v[72:75], a[172:175], v[56:59], v[72:75]
s_lshl_b32 s67, s101, 2
ds_read_b64_tr_b16 a[148:149], v242 offset:4096
buffer_load_dwordx4 v238, s[12:15], s55 offen  lds
v_mfma_f32_16x16x32_bf16 v[72:75], a[168:171], v[36:39], v[72:75]
s_waitcnt lgkmcnt(7)
ds_read_b64_tr_b16 a[150:151], v242 offset:6144
v_add_u32 v227, s67, v228
v_mfma_f32_16x16x32_bf16 v[72:75], a[176:179], v[128:131], v[72:75]
s_sub_u32 s87, s51, 1
ds_read_b64_tr_b16 a[152:153], v242 offset:8192
v_lshlrev_b32 v251, v252, v251
v_mfma_f32_16x16x32_bf16 v[72:75], a[180:183], v[168:171], v[72:75]
s_and_b32 s87, s87, 7
ds_read_b64_tr_b16 a[154:155], v242 offset:10240
v_cndmask_b32 v251, 0, v251, s[90:91]
v_mfma_f32_16x16x32_bf16 v[76:79], a[180:183], v[176:179], v[76:79]
s_lshl_b32 s87, s87, 15
ds_read_b64_tr_b16 a[156:157], v242 offset:12288
v_and_b32 v252, 2, v255
v_mfma_f32_16x16x32_bf16 v[76:79], a[176:179], v[132:135], v[76:79]
s_waitcnt lgkmcnt(7)
ds_read_b64_tr_b16 a[158:159], v242 offset:14336
v_cmp_eq_u32 s[90:91], 0, v252
v_mfma_f32_16x16x32_bf16 v[76:79], a[184:187], v[20:23], v[76:79]
s_sub_u32 s60, s94, s87
ds_read_b64_tr_b16 a[160:161], v242 offset:16384
v_cndmask_b32 v252, 0, v251, s[90:91]
v_mfma_f32_16x16x32_bf16 v[76:79], a[188:191], v[64:67], v[76:79]
s_sub_u32 s61, s95, s87
ds_read_b64_tr_b16 a[162:163], v242 offset:18432
v_cndmask_b32 v251, v251, 0, s[90:91]
v_mfma_f32_16x16x32_bf16 v[72:75], a[188:191], v[68:71], v[72:75]
s_sub_u32 s87, s51, 2
ds_read_b64_tr_b16 a[164:165], v242 offset:20480
buffer_load_dwordx4 v237, s[12:15], s55 offen offset:1024  lds
v_mfma_f32_16x16x32_bf16 v[72:75], a[184:187], v[60:63], v[72:75]
s_waitcnt lgkmcnt(7)
ds_read_b64_tr_b16 a[166:167], v242 offset:22528
v_accvgpr_write_b32 a224, v252
v_mfma_f32_16x16x32_bf16 v[88:91], a[144:147], v[4:7], 0
s_mul_i32 s54, s68, 576
ds_read_b64_tr_b16 a[168:169], v242 offset:24576
v_accvgpr_write_b32 a225, v251
v_mfma_f32_16x16x32_bf16 v[88:91], a[148:151], v[44:47], v[88:91]
s_add_u32 s54, s54, s78
ds_read_b64_tr_b16 a[170:171], v242 offset:26624
v_accvgpr_write_b32 a226, v252
v_mfma_f32_16x16x32_bf16 v[92:95], a[148:151], v[48:51], 0
s_addk_i32 m0, 0x2000
ds_read_b64_tr_b16 a[172:173], v242 offset:28672
v_cvt_pk_bf16_f32 v80, v72, v73
v_mfma_f32_16x16x32_bf16 v[92:95], a[144:147], v[12:15], v[92:95]
s_waitcnt lgkmcnt(7)
ds_read_b64_tr_b16 a[174:175], v242 offset:30720
buffer_load_dwordx4 v238, s[12:15], s54 offen  lds
v_mfma_f32_16x16x32_bf16 v[92:95], a[152:155], v[52:55], v[92:95]
s_and_b32 s87, s87, 7
ds_read_b64_tr_b16 a[176:177], v242 offset:32768
v_cvt_pk_bf16_f32 v81, v74, v75
v_mfma_f32_16x16x32_bf16 v[92:95], a[156:159], v[140:143], v[92:95]
s_lshl_b32 s87, s87, 15
ds_read_b64_tr_b16 a[178:179], v242 offset:34816
v_cvt_pk_bf16_f32 v84, v76, v77
v_mfma_f32_16x16x32_bf16 v[88:91], a[156:159], v[32:35], v[88:91]
s_sub_u32 s62, s94, s87
ds_read_b64_tr_b16 a[180:181], v242 offset:36864
v_cvt_pk_bf16_f32 v85, v78, v79
v_mfma_f32_16x16x32_bf16 v[88:91], a[152:155], v[16:19], v[88:91]
s_waitcnt lgkmcnt(7)
buffer_store_dwordx4 v[80:83], v236, s[32:35], s56 offen offset:0 sc1
ds_read_b64_tr_b16 a[182:183], v242 offset:38912
v_mfma_f32_16x16x32_bf16 v[88:91], a[160:163], v[148:151], v[88:91]
s_sub_u32 s63, s95, s87
ds_read_b64_tr_b16 a[184:185], v242 offset:40960
v_accvgpr_write_b32 a227, v251
v_mfma_f32_16x16x32_bf16 v[88:91], a[164:167], v[8:11], v[88:91]
s_sub_u32 s87, s51, 3
ds_read_b64_tr_b16 a[186:187], v242 offset:43008
v_accvgpr_read_b32 v73, a240
v_mfma_f32_16x16x32_bf16 v[92:95], a[164:167], v[24:27], v[92:95]
s_and_b32 s87, s87, 7
buffer_store_dwordx4 v[84:87], v236, s[32:35], s56 offen offset:1024 sc1
ds_read_b64_tr_b16 a[188:189], v242 offset:45056
v_mfma_f32_16x16x32_bf16 v[92:95], a[160:163], v[156:159], v[92:95]
s_waitcnt lgkmcnt(7)
ds_read_b64_tr_b16 a[190:191], v242 offset:47104
buffer_load_dwordx4 v237, s[12:15], s54 offen offset:1024  lds
v_mfma_f32_16x16x32_bf16 v[92:95], a[168:171], v[28:31], v[92:95]
s_add_u32 s56, s51, 2
ds_read_b64_tr_b16 a[144:145], v241 offset:0
v_lshlrev_b32 v72, 16, v73
v_mfma_f32_16x16x32_bf16 v[92:95], a[172:175], v[40:43], v[92:95]
s_and_b32 s56, s56, 7
ds_read_b64_tr_b16 a[146:147], v241 offset:2048
v_and_b32 v73, s97, v73
v_mfma_f32_16x16x32_bf16 v[88:91], a[172:175], v[56:59], v[88:91]
s_add_u32 s56, s56, 1
ds_read_b64_tr_b16 a[148:149], v241 offset:4096
v_accvgpr_read_b32 v75, a241
v_mfma_f32_16x16x32_bf16 v[88:91], a[168:171], v[36:39], v[88:91]
s_waitcnt lgkmcnt(7)
ds_read_b64_tr_b16 a[150:151], v241 offset:6144
v_lshlrev_b32 v74, 16, v75
v_mfma_f32_16x16x32_bf16 v[88:91], a[176:179], v[128:131], v[88:91]
s_mul_i32 s55, s69, 576
ds_read_b64_tr_b16 a[152:153], v241 offset:8192
LF_p8:
s_cbranch_execz LF_v0
v_and_b32 v75, s97, v75
v_mfma_f32_16x16x32_bf16 v[88:91], a[180:183], v[168:171], v[88:91]
s_add_u32 s55, s55, s78
ds_read_b64_tr_b16 a[154:155], v241 offset:10240
v_accvgpr_read_b32 v77, a232
v_mfma_f32_16x16x32_bf16 v[92:95], a[180:183], v[176:179], v[92:95]
s_addk_i32 m0, 0x2000
ds_read_b64_tr_b16 a[156:157], v241 offset:12288
v_lshlrev_b32 v76, 16, v77
v_mfma_f32_16x16x32_bf16 v[92:95], a[176:179], v[132:135], v[92:95]
s_waitcnt lgkmcnt(7)
ds_read_b64_tr_b16 a[158:159], v241 offset:14336
buffer_load_dwordx4 v238, s[12:15], s55 offen  lds
v_mfma_f32_16x16x32_bf16 v[92:95], a[184:187], v[20:23], v[92:95]
s_lshr_b32 s86, s100, s56
ds_read_b64_tr_b16 a[160:161], v241 offset:16384
v_and_b32 v77, s97, v77
v_mfma_f32_16x16x32_bf16 v[92:95], a[188:191], v[64:67], v[92:95]
s_and_b32 s86, s86, 0x2000
ds_read_b64_tr_b16 a[162:163], v241 offset:18432
v_accvgpr_read_b32 v79, a233
v_mfma_f32_16x16x32_bf16 v[88:91], a[188:191], v[68:71], v[88:91]
s_lshl_b32 s56, s56, 19
ds_read_b64_tr_b16 a[164:165], v241 offset:20480
v_lshlrev_b32 v78, 16, v79
v_mfma_f32_16x16x32_bf16 v[88:91], a[184:187], v[60:63], v[88:91]
s_waitcnt lgkmcnt(7)
ds_read_b64_tr_b16 a[166:167], v241 offset:22528
v_and_b32 v79, s97, v79
v_mfma_f32_16x16x32_bf16 v[80:83], a[144:147], v[4:7], 0
s_add_u32 s56, s56, s83
ds_read_b64_tr_b16 a[168:169], v241 offset:24576
v_sub_f32 v255, v76, v247
v_mfma_f32_16x16x32_bf16 v[80:83], a[148:151], v[44:47], v[80:83]
s_add_u32 s56, s56, s86
ds_read_b64_tr_b16 a[170:171], v241 offset:26624
v_mul_f32 v255, v255, v249
v_mfma_f32_16x16x32_bf16 v[84:87], a[148:151], v[48:51], 0
s_lshl_b32 s87, s87, 15
ds_read_b64_tr_b16 a[172:173], v241 offset:28672
v_cvt_pk_bf16_f32 v96, v88, v89
v_mfma_f32_16x16x32_bf16 v[84:87], a[144:147], v[12:15], v[84:87]
s_waitcnt lgkmcnt(7)
ds_read_b64_tr_b16 a[174:175], v241 offset:30720
buffer_load_dwordx4 v237, s[12:15], s55 offen offset:1024  lds
v_mfma_f32_16x16x32_bf16 v[84:87], a[152:155], v[52:55], v[84:87]
s_sub_u32 s64, s94, s87
ds_read_b64_tr_b16 a[176:177], v241 offset:32768
v_cvt_pk_bf16_f32 v97, v90, v91
v_mfma_f32_16x16x32_bf16 v[84:87], a[156:159], v[140:143], v[84:87]
s_sub_u32 s65, s95, s87
ds_read_b64_tr_b16 a[178:179], v241 offset:34816
v_cvt_pk_bf16_f32 v88, v92, v93
v_mfma_f32_16x16x32_bf16 v[80:83], a[156:159], v[32:35], v[80:83]
s_sub_u32 s87, s51, 4
ds_read_b64_tr_b16 a[180:181], v241 offset:36864
v_cvt_pk_bf16_f32 v89, v94, v95
v_mfma_f32_16x16x32_bf16 v[80:83], a[152:155], v[16:19], v[80:83]
s_waitcnt lgkmcnt(7)
ds_read_b64_tr_b16 a[182:183], v241 offset:38912
v_fmac_f32 v76, v255, v72
v_mfma_f32_16x16x32_bf16 v[80:83], a[160:163], v[148:151], v[80:83]
s_mul_i32 s54, s70, 576
ds_read_b64_tr_b16 a[184:185], v241 offset:40960
v_sub_f32 v255, v77, v247
v_mfma_f32_16x16x32_bf16 v[80:83], a[164:167], v[8:11], v[80:83]
s_add_u32 s54, s54, s78
ds_read_b64_tr_b16 a[186:187], v241 offset:43008
v_mul_f32 v255, v255, v249
v_mfma_f32_16x16x32_bf16 v[84:87], a[164:167], v[24:27], v[84:87]
s_addk_i32 m0, 0x2000
ds_read_b64_tr_b16 a[188:189], v241 offset:45056
v_fmac_f32 v77, v255, v73
v_mfma_f32_16x16x32_bf16 v[84:87], a[160:163], v[156:159], v[84:87]
s_waitcnt lgkmcnt(7)
ds_read_b64_tr_b16 a[190:191], v241 offset:47104
buffer_load_dwordx4 v238, s[12:15], s54 offen  lds
v_mfma_f32_16x16x32_bf16 v[84:87], a[168:171], v[28:31], v[84:87]
s_and_b32 s87, s87, 7
ds_read_b64_tr_b16 a[144:145], v240 offset:0
v_sub_f32 v255, v78, v247
v_mfma_f32_16x16x32_bf16 v[84:87], a[172:175], v[40:43], v[84:87]
s_lshl_b32 s87, s87, 15
ds_read_b64_tr_b16 a[146:147], v240 offset:2048
v_mul_f32 v255, v255, v249
v_mfma_f32_16x16x32_bf16 v[80:83], a[172:175], v[56:59], v[80:83]
s_sub_u32 s66, s94, s87
ds_read_b64_tr_b16 a[148:149], v240 offset:4096
v_fmac_f32 v78, v255, v74
v_mfma_f32_16x16x32_bf16 v[80:83], a[168:171], v[36:39], v[80:83]
s_waitcnt lgkmcnt(7)
ds_read_b64_tr_b16 a[150:151], v240 offset:6144
v_sub_f32 v255, v79, v247
v_mfma_f32_16x16x32_bf16 v[80:83], a[176:179], v[128:131], v[80:83]
s_sub_u32 s4, s95, s87
ds_read_b64_tr_b16 a[152:153], v240 offset:8192
v_mul_f32 v255, v255, v249
v_mfma_f32_16x16x32_bf16 v[80:83], a[180:183], v[168:171], v[80:83]
s_sub_u32 s87, s51, 5
ds_read_b64_tr_b16 a[154:155], v240 offset:10240
v_fmac_f32 v79, v255, v75
v_mfma_f32_16x16x32_bf16 v[84:87], a[180:183], v[176:179], v[84:87]
s_and_b32 s87, s87, 7
ds_read_b64_tr_b16 a[156:157], v240 offset:12288
v_accvgpr_read_b32 v93, a234
v_mfma_f32_16x16x32_bf16 v[84:87], a[176:179], v[132:135], v[84:87]
s_waitcnt lgkmcnt(7)
ds_read_b64_tr_b16 a[158:159], v240 offset:14336
buffer_load_dwordx4 v237, s[12:15], s54 offen offset:1024  lds
v_mfma_f32_16x16x32_bf16 v[84:87], a[184:187], v[20:23], v[84:87]
s_lshl_b32 s87, s87, 15
ds_read_b64_tr_b16 a[160:161], v240 offset:16384
v_lshlrev_b32 v92, 16, v93
v_mfma_f32_16x16x32_bf16 v[84:87], a[188:191], v[64:67], v[84:87]
s_sub_u32 s5, s94, s87
ds_read_b64_tr_b16 a[162:163], v240 offset:18432
v_and_b32 v93, s97, v93
v_mfma_f32_16x16x32_bf16 v[80:83], a[188:191], v[68:71], v[80:83]
s_sub_u32 s6, s95, s87
ds_read_b64_tr_b16 a[164:165], v240 offset:20480
v_accvgpr_read_b32 v95, a235
v_mfma_f32_16x16x32_bf16 v[80:83], a[184:187], v[60:63], v[80:83]
s_waitcnt lgkmcnt(7)
ds_read_b64_tr_b16 a[166:167], v240 offset:22528
v_lshlrev_b32 v94, 16, v95
v_mfma_f32_16x16x32_bf16 v[100:103], a[144:147], v[4:7], 0
s_mul_i32 s55, s71, 576
ds_read_b64_tr_b16 a[168:169], v240 offset:24576
v_and_b32 v95, s97, v95
v_mfma_f32_16x16x32_bf16 v[100:103], a[148:151], v[44:47], v[100:103]
s_add_u32 s55, s55, s78
ds_read_b64_tr_b16 a[170:171], v240 offset:26624
v_sub_f32 v255, v92, v232
v_mfma_f32_16x16x32_bf16 v[104:107], a[148:151], v[48:51], 0
s_addk_i32 m0, 0x2000
ds_read_b64_tr_b16 a[172:173], v240 offset:28672
v_cvt_pk_bf16_f32 v98, v80, v81
v_mfma_f32_16x16x32_bf16 v[104:107], a[144:147], v[12:15], v[104:107]
s_waitcnt lgkmcnt(7)
ds_read_b64_tr_b16 a[174:175], v240 offset:30720
buffer_load_dwordx4 v238, s[12:15], s55 offen  lds
v_mfma_f32_16x16x32_bf16 v[104:107], a[152:155], v[52:55], v[104:107]
s_sub_u32 s87, s51, 6
ds_read_b64_tr_b16 a[176:177], v240 offset:32768
v_cvt_pk_bf16_f32 v99, v82, v83
v_mfma_f32_16x16x32_bf16 v[104:107], a[156:159], v[140:143], v[104:107]
s_and_b32 s87, s87, 7
ds_read_b64_tr_b16 a[178:179], v240 offset:34816
v_cvt_pk_bf16_f32 v90, v84, v85
v_mfma_f32_16x16x32_bf16 v[100:103], a[156:159], v[32:35], v[100:103]
s_lshl_b32 s87, s87, 15
ds_read_b64_tr_b16 a[180:181], v240 offset:36864
v_cvt_pk_bf16_f32 v91, v86, v87
v_mfma_f32_16x16x32_bf16 v[100:103], a[152:155], v[16:19], v[100:103]
s_waitcnt lgkmcnt(7)
buffer_store_dwordx4 v[96:99], v253, s[32:35], s56 offen offset:0 sc1
ds_read_b64_tr_b16 a[182:183], v240 offset:38912
v_mfma_f32_16x16x32_bf16 v[100:103], a[160:163], v[148:151], v[100:103]
s_sub_u32 s7, s94, s87
ds_read_b64_tr_b16 a[184:185], v240 offset:40960
v_mul_f32 v255, v255, v246
v_mfma_f32_16x16x32_bf16 v[100:103], a[164:167], v[8:11], v[100:103]
s_sub_u32 s8, s95, s87
ds_read_b64_tr_b16 a[186:187], v240 offset:43008
v_fmac_f32 v92, v255, v72
v_mfma_f32_16x16x32_bf16 v[104:107], a[164:167], v[24:27], v[104:107]
s_sub_u32 s87, s51, 7
buffer_store_dwordx4 v[88:91], v253, s[32:35], s56 offen offset:1024 sc1
ds_read_b64_tr_b16 a[188:189], v240 offset:45056
v_mfma_f32_16x16x32_bf16 v[104:107], a[160:163], v[156:159], v[104:107]
s_waitcnt lgkmcnt(7)
ds_read_b64_tr_b16 a[190:191], v240 offset:47104
buffer_load_dwordx4 v237, s[12:15], s55 offen offset:1024  lds
v_mfma_f32_16x16x32_bf16 v[104:107], a[168:171], v[28:31], v[104:107]
s_and_b32 s87, s87, 7
ds_read_b64_tr_b16 a[144:145], v239 offset:0
v_sub_f32 v255, v93, v232
v_mfma_f32_16x16x32_bf16 v[104:107], a[172:175], v[40:43], v[104:107]
s_lshl_b32 s87, s87, 15
ds_read_b64_tr_b16 a[146:147], v239 offset:2048
v_mul_f32 v255, v255, v246
v_mfma_f32_16x16x32_bf16 v[100:103], a[172:175], v[56:59], v[100:103]
s_sub_u32 s9, s94, s87
ds_read_b64_tr_b16 a[148:149], v239 offset:4096
v_fmac_f32 v93, v255, v73
v_mfma_f32_16x16x32_bf16 v[100:103], a[168:171], v[36:39], v[100:103]
s_waitcnt lgkmcnt(7)
ds_read_b64_tr_b16 a[150:151], v239 offset:6144
v_sub_f32 v255, v94, v232
v_mfma_f32_16x16x32_bf16 v[100:103], a[176:179], v[128:131], v[100:103]
s_mul_i32 s54, s72, 576
ds_read_b64_tr_b16 a[152:153], v239 offset:8192
v_mul_f32 v255, v255, v246
v_mfma_f32_16x16x32_bf16 v[100:103], a[180:183], v[168:171], v[100:103]
s_add_u32 s54, s54, s78
ds_read_b64_tr_b16 a[154:155], v239 offset:10240
v_fmac_f32 v94, v255, v74
v_mfma_f32_16x16x32_bf16 v[104:107], a[180:183], v[176:179], v[104:107]
s_addk_i32 m0, 0x2000
ds_read_b64_tr_b16 a[156:157], v239 offset:12288
v_sub_f32 v255, v95, v232
v_mfma_f32_16x16x32_bf16 v[104:107], a[176:179], v[132:135], v[104:107]
s_waitcnt lgkmcnt(7)
ds_read_b64_tr_b16 a[158:159], v239 offset:14336
buffer_load_dwordx4 v238, s[12:15], s54 offen  lds
v_mfma_f32_16x16x32_bf16 v[104:107], a[184:187], v[20:23], v[104:107]
s_sub_u32 s10, s95, s87
ds_read_b64_tr_b16 a[160:161], v239 offset:16384
v_mul_f32 v255, v255, v246
v_mfma_f32_16x16x32_bf16 v[104:107], a[188:191], v[64:67], v[104:107]
s_sub_u32 s87, s51, 8
ds_read_b64_tr_b16 a[162:163], v239 offset:18432
v_fmac_f32 v95, v255, v75
v_mfma_f32_16x16x32_bf16 v[100:103], a[188:191], v[68:71], v[100:103]
s_and_b32 s87, s87, 7
ds_read_b64_tr_b16 a[164:165], v239 offset:20480
v_accvgpr_read_b32 v73, a242
v_mfma_f32_16x16x32_bf16 v[100:103], a[184:187], v[60:63], v[100:103]
s_waitcnt lgkmcnt(7)
ds_read_b64_tr_b16 a[166:167], v239 offset:22528
v_lshlrev_b32 v72, 16, v73
v_mfma_f32_16x16x32_bf16 v[80:83], a[144:147], v[4:7], 0
s_lshl_b32 s87, s87, 15
ds_read_b64_tr_b16 a[168:169], v239 offset:24576
v_and_b32 v73, s97, v73
v_mfma_f32_16x16x32_bf16 v[80:83], a[148:151], v[44:47], v[80:83]
s_sub_u32 s11, s94, s87
ds_read_b64_tr_b16 a[170:171], v239 offset:26624
v_mov_b32 v255, 0
v_mfma_f32_16x16x32_bf16 v[84:87], a[148:151], v[48:51], 0
ds_read_b64_tr_b16 a[172:173], v239 offset:28672
v_cvt_pk_bf16_f32 v90, v100, v101
v_mfma_f32_16x16x32_bf16 v[84:87], a[144:147], v[12:15], v[84:87]
s_waitcnt lgkmcnt(7)
ds_read_b64_tr_b16 a[174:175], v239 offset:30720
buffer_load_dwordx4 v237, s[12:15], s54 offen offset:1024  lds
v_mfma_f32_16x16x32_bf16 v[84:87], a[152:155], v[52:55], v[84:87]
ds_read_b64_tr_b16 a[176:177], v239 offset:32768
v_cvt_pk_bf16_f32 v91, v102, v103
v_mfma_f32_16x16x32_bf16 v[84:87], a[156:159], v[140:143], v[84:87]
ds_read_b64_tr_b16 a[178:179], v239 offset:34816
v_cvt_pk_bf16_f32 v98, v104, v105
v_mfma_f32_16x16x32_bf16 v[80:83], a[156:159], v[32:35], v[80:83]
ds_read_b64_tr_b16 a[180:181], v239 offset:36864
v_cvt_pk_bf16_f32 v99, v106, v107
v_mfma_f32_16x16x32_bf16 v[80:83], a[152:155], v[16:19], v[80:83]
s_waitcnt lgkmcnt(7)
ds_read_b64_tr_b16 a[182:183], v239 offset:38912
v_accvgpr_read_b32 v75, a243
v_mfma_f32_16x16x32_bf16 v[80:83], a[160:163], v[148:151], v[80:83]
s_mul_i32 s55, s73, 576
ds_read_b64_tr_b16 a[184:185], v239 offset:40960
v_lshlrev_b32 v74, 16, v75
v_mfma_f32_16x16x32_bf16 v[80:83], a[164:167], v[8:11], v[80:83]
s_add_u32 s55, s55, s78
ds_read_b64_tr_b16 a[186:187], v239 offset:43008
v_and_b32 v75, s97, v75
v_mfma_f32_16x16x32_bf16 v[84:87], a[164:167], v[24:27], v[84:87]
s_waitcnt vmcnt(14)
ds_read_b64_tr_b16 a[188:189], v239 offset:45056
v_accvgpr_read_b32 v101, a236
v_mfma_f32_16x16x32_bf16 v[84:87], a[160:163], v[156:159], v[84:87]
s_waitcnt lgkmcnt(7)
ds_read_b64_tr_b16 a[190:191], v239 offset:47104
v_lshlrev_b32 v100, 16, v101
v_mfma_f32_16x16x32_bf16 v[84:87], a[168:171], v[28:31], v[84:87]
s_barrier
ds_read_b64_tr_b16 a[144:145], v235 offset:0
v_and_b32 v101, s97, v101
v_mfma_f32_16x16x32_bf16 v[84:87], a[172:175], v[40:43], v[84:87]
s_addk_i32 m0, 0x2000
ds_read_b64_tr_b16 a[146:147], v235 offset:2048
v_accvgpr_read_b32 v103, a237
v_mfma_f32_16x16x32_bf16 v[80:83], a[172:175], v[56:59], v[80:83]
ds_read_b64_tr_b16 a[148:149], v235 offset:4096
buffer_load_dwordx4 v238, s[12:15], s55 offen  lds
v_mfma_f32_16x16x32_bf16 v[80:83], a[168:171], v[36:39], v[80:83]
s_waitcnt lgkmcnt(7)
ds_read_b64_tr_b16 a[150:151], v235 offset:6144
v_lshlrev_b32 v102, 16, v103
v_mfma_f32_16x16x32_bf16 v[80:83], a[176:179], v[128:131], v[80:83]
ds_read_b64_tr_b16 a[152:153], v235 offset:8192
v_and_b32 v103, s97, v103
v_mfma_f32_16x16x32_bf16 v[80:83], a[180:183], v[168:171], v[80:83]
ds_read_b64_tr_b16 a[154:155], v235 offset:10240
v_sub_f32 v252, v100, v247
v_mfma_f32_16x16x32_bf16 v[84:87], a[180:183], v[176:179], v[84:87]
ds_read_b64_tr_b16 a[156:157], v235 offset:12288
v_mul_f32 v252, v252, v249
v_mfma_f32_16x16x32_bf16 v[84:87], a[176:179], v[132:135], v[84:87]
s_waitcnt lgkmcnt(7)
ds_read_b64_tr_b16 a[158:159], v235 offset:14336
v_fmac_f32 v100, v252, v72
v_mfma_f32_16x16x32_bf16 v[84:87], a[184:187], v[20:23], v[84:87]
ds_read_b64_tr_b16 a[160:161], v235 offset:16384
v_sub_f32 v252, v101, v247
v_mfma_f32_16x16x32_bf16 v[84:87], a[188:191], v[64:67], v[84:87]
ds_read_b64_tr_b16 a[162:163], v235 offset:18432
v_mul_f32 v252, v252, v249
v_mfma_f32_16x16x32_bf16 v[80:83], a[188:191], v[68:71], v[80:83]
ds_read_b64_tr_b16 a[164:165], v235 offset:20480
buffer_load_dwordx4 v237, s[12:15], s55 offen offset:1024  lds
v_mfma_f32_16x16x32_bf16 v[80:83], a[184:187], v[60:63], v[80:83]
s_waitcnt lgkmcnt(7)
ds_read_b64_tr_b16 a[166:167], v235 offset:22528
v_fmac_f32 v101, v252, v73
v_mfma_f32_16x16x32_bf16 v[104:107], a[144:147], v[4:7], 0
s_mul_i32 s54, s68, 576
ds_read_b64_tr_b16 a[168:169], v235 offset:24576
v_sub_f32 v252, v102, v247
v_mfma_f32_16x16x32_bf16 v[104:107], a[148:151], v[44:47], v[104:107]
s_add_u32 s54, s54, s79
ds_read_b64_tr_b16 a[170:171], v235 offset:26624
v_mul_f32 v252, v252, v249
v_mfma_f32_16x16x32_bf16 v[108:111], a[148:151], v[48:51], 0
s_addk_i32 m0, 0x2000
ds_read_b64_tr_b16 a[172:173], v235 offset:28672
v_cvt_pk_bf16_f32 v88, v80, v81
v_mfma_f32_16x16x32_bf16 v[108:111], a[144:147], v[12:15], v[108:111]
s_waitcnt lgkmcnt(7)
ds_read_b64_tr_b16 a[174:175], v235 offset:30720
buffer_load_dwordx4 v238, s[12:15], s54 offen  lds
v_mfma_f32_16x16x32_bf16 v[108:111], a[152:155], v[52:55], v[108:111]
ds_read_b64_tr_b16 a[176:177], v235 offset:32768
v_cvt_pk_bf16_f32 v89, v82, v83
v_mfma_f32_16x16x32_bf16 v[108:111], a[156:159], v[140:143], v[108:111]
ds_read_b64_tr_b16 a[178:179], v235 offset:34816
v_cvt_pk_bf16_f32 v96, v84, v85
v_mfma_f32_16x16x32_bf16 v[104:107], a[156:159], v[32:35], v[104:107]
ds_read_b64_tr_b16 a[180:181], v235 offset:36864
v_cvt_pk_bf16_f32 v97, v86, v87
v_mfma_f32_16x16x32_bf16 v[104:107], a[152:155], v[16:19], v[104:107]
s_waitcnt lgkmcnt(7)
buffer_store_dwordx4 v[88:91], v236, s[32:35], s56 offen offset:0 sc1
ds_read_b64_tr_b16 a[182:183], v235 offset:38912
v_mfma_f32_16x16x32_bf16 v[104:107], a[160:163], v[148:151], v[104:107]
ds_read_b64_tr_b16 a[184:185], v235 offset:40960
v_fmac_f32 v102, v252, v74
v_mfma_f32_16x16x32_bf16 v[104:107], a[164:167], v[8:11], v[104:107]
ds_read_b64_tr_b16 a[186:187], v235 offset:43008
v_sub_f32 v252, v103, v247
v_mfma_f32_16x16x32_bf16 v[108:111], a[164:167], v[24:27], v[108:111]
buffer_store_dwordx4 v[96:99], v236, s[32:35], s56 offen offset:1024 sc1
ds_read_b64_tr_b16 a[188:189], v235 offset:45056
v_mfma_f32_16x16x32_bf16 v[108:111], a[160:163], v[156:159], v[108:111]
s_waitcnt lgkmcnt(7)
ds_read_b64_tr_b16 a[190:191], v235 offset:47104
buffer_load_dwordx4 v237, s[12:15], s54 offen offset:1024  lds
v_mfma_f32_16x16x32_bf16 v[108:111], a[168:171], v[28:31], v[108:111]
s_add_u32 s56, s51, 3
ds_read_b64_tr_b16 a[144:145], v248 offset:0
v_mul_f32 v252, v252, v249
v_mfma_f32_16x16x32_bf16 v[108:111], a[172:175], v[40:43], v[108:111]
s_and_b32 s56, s56, 7
ds_read_b64_tr_b16 a[146:147], v248 offset:2048
v_fmac_f32 v103, v252, v75
v_mfma_f32_16x16x32_bf16 v[104:107], a[172:175], v[56:59], v[104:107]
s_add_u32 s56, s56, 1
ds_read_b64_tr_b16 a[148:149], v248 offset:4096
v_accvgpr_read_b32 v81, a238
v_mfma_f32_16x16x32_bf16 v[104:107], a[168:171], v[36:39], v[104:107]
s_waitcnt lgkmcnt(7)
ds_read_b64_tr_b16 a[150:151], v248 offset:6144
v_lshlrev_b32 v80, 16, v81
v_mfma_f32_16x16x32_bf16 v[104:107], a[176:179], v[128:131], v[104:107]
s_mul_i32 s55, s69, 576
ds_read_b64_tr_b16 a[152:153], v248 offset:8192
v_and_b32 v81, s97, v81
v_mfma_f32_16x16x32_bf16 v[104:107], a[180:183], v[168:171], v[104:107]
s_add_u32 s55, s55, s79
ds_read_b64_tr_b16 a[154:155], v248 offset:10240
v_accvgpr_read_b32 v83, a239
v_mfma_f32_16x16x32_bf16 v[108:111], a[180:183], v[176:179], v[108:111]
s_addk_i32 m0, 0x2000
ds_read_b64_tr_b16 a[156:157], v248 offset:12288
v_lshlrev_b32 v82, 16, v83
v_mfma_f32_16x16x32_bf16 v[108:111], a[176:179], v[132:135], v[108:111]
s_waitcnt lgkmcnt(7)
ds_read_b64_tr_b16 a[158:159], v248 offset:14336
buffer_load_dwordx4 v238, s[12:15], s55 offen  lds
v_mfma_f32_16x16x32_bf16 v[108:111], a[184:187], v[20:23], v[108:111]
s_lshr_b32 s86, s100, s56
ds_read_b64_tr_b16 a[160:161], v248 offset:16384
v_and_b32 v83, s97, v83
v_mfma_f32_16x16x32_bf16 v[108:111], a[188:191], v[64:67], v[108:111]
s_and_b32 s86, s86, 0x2000
ds_read_b64_tr_b16 a[162:163], v248 offset:18432
v_sub_f32 v252, v80, v232
v_mfma_f32_16x16x32_bf16 v[104:107], a[188:191], v[68:71], v[104:107]
s_lshl_b32 s56, s56, 19
ds_read_b64_tr_b16 a[164:165], v248 offset:20480
v_mul_f32 v252, v252, v246
v_mfma_f32_16x16x32_bf16 v[104:107], a[184:187], v[60:63], v[104:107]
s_waitcnt lgkmcnt(7)
ds_read_b64_tr_b16 a[166:167], v248 offset:22528
v_fmac_f32 v80, v252, v72
v_mfma_f32_16x16x32_bf16 v[84:87], a[144:147], v[4:7], 0
s_add_u32 s56, s56, s83
ds_read_b64_tr_b16 a[168:169], v248 offset:24576
v_sub_f32 v252, v81, v232
v_mfma_f32_16x16x32_bf16 v[84:87], a[148:151], v[44:47], v[84:87]
s_add_u32 s56, s56, s86
ds_read_b64_tr_b16 a[170:171], v248 offset:26624
v_mov_b32 v254, 6
v_mfma_f32_16x16x32_bf16 v[88:91], a[148:151], v[48:51], 0
ds_read_b64_tr_b16 a[172:173], v248 offset:28672
v_cvt_pk_bf16_f32 v96, v104, v105
v_mfma_f32_16x16x32_bf16 v[88:91], a[144:147], v[12:15], v[88:91]
s_waitcnt lgkmcnt(7)
ds_read_b64_tr_b16 a[174:175], v248 offset:30720
buffer_load_dwordx4 v237, s[12:15], s55 offen offset:1024  lds
v_mfma_f32_16x16x32_bf16 v[88:91], a[152:155], v[52:55], v[88:91]
ds_read_b64_tr_b16 a[176:177], v248 offset:32768
v_cvt_pk_bf16_f32 v97, v106, v107
v_mfma_f32_16x16x32_bf16 v[88:91], a[156:159], v[140:143], v[88:91]
ds_read_b64_tr_b16 a[178:179], v248 offset:34816
v_cvt_pk_bf16_f32 v104, v108, v109
v_mfma_f32_16x16x32_bf16 v[84:87], a[156:159], v[32:35], v[84:87]
ds_read_b64_tr_b16 a[180:181], v248 offset:36864
v_cvt_pk_bf16_f32 v105, v110, v111
v_mfma_f32_16x16x32_bf16 v[84:87], a[152:155], v[16:19], v[84:87]
s_waitcnt lgkmcnt(7)
ds_read_b64_tr_b16 a[182:183], v248 offset:38912
v_mul_f32 v252, v252, v246
v_mfma_f32_16x16x32_bf16 v[84:87], a[160:163], v[148:151], v[84:87]
s_mul_i32 s54, s70, 576
ds_read_b64_tr_b16 a[184:185], v248 offset:40960
v_fmac_f32 v81, v252, v73
v_mfma_f32_16x16x32_bf16 v[84:87], a[164:167], v[8:11], v[84:87]
s_add_u32 s54, s54, s79
ds_read_b64_tr_b16 a[186:187], v248 offset:43008
v_sub_f32 v252, v82, v232
v_mfma_f32_16x16x32_bf16 v[88:91], a[164:167], v[24:27], v[88:91]
s_addk_i32 m0, 0x2000
ds_read_b64_tr_b16 a[188:189], v248 offset:45056
v_mul_f32 v252, v252, v246
v_mfma_f32_16x16x32_bf16 v[88:91], a[160:163], v[156:159], v[88:91]
s_waitcnt lgkmcnt(7)
ds_read_b64_tr_b16 a[190:191], v248 offset:47104
buffer_load_dwordx4 v238, s[12:15], s54 offen  lds
v_mfma_f32_16x16x32_bf16 v[88:91], a[168:171], v[28:31], v[88:91]
ds_read_b64_tr_b16 a[144:145], v234 offset:0
v_fmac_f32 v82, v252, v74
v_mfma_f32_16x16x32_bf16 v[88:91], a[172:175], v[40:43], v[88:91]
ds_read_b64_tr_b16 a[146:147], v234 offset:2048
v_sub_f32 v252, v83, v232
v_mfma_f32_16x16x32_bf16 v[84:87], a[172:175], v[56:59], v[84:87]
ds_read_b64_tr_b16 a[148:149], v234 offset:4096
v_mul_f32 v252, v252, v246
v_mfma_f32_16x16x32_bf16 v[84:87], a[168:171], v[36:39], v[84:87]
s_waitcnt lgkmcnt(7)
ds_read_b64_tr_b16 a[150:151], v234 offset:6144
v_fmac_f32 v83, v252, v75
v_mfma_f32_16x16x32_bf16 v[84:87], a[176:179], v[128:131], v[84:87]
ds_read_b64_tr_b16 a[152:153], v234 offset:8192
v_mfma_f32_16x16x32_bf16 v[84:87], a[180:183], v[168:171], v[84:87]
ds_read_b64_tr_b16 a[154:155], v234 offset:10240
v_mfma_f32_16x16x32_bf16 v[88:91], a[180:183], v[176:179], v[88:91]
ds_read_b64_tr_b16 a[156:157], v234 offset:12288
v_mfma_f32_16x16x32_bf16 v[88:91], a[176:179], v[132:135], v[88:91]
s_waitcnt lgkmcnt(7)
ds_read_b64_tr_b16 a[158:159], v234 offset:14336
buffer_load_dwordx4 v237, s[12:15], s54 offen offset:1024  lds
v_mfma_f32_16x16x32_bf16 v[88:91], a[184:187], v[20:23], v[88:91]
ds_read_b64_tr_b16 a[160:161], v234 offset:16384
v_mfma_f32_16x16x32_bf16 v[88:91], a[188:191], v[64:67], v[88:91]
ds_read_b64_tr_b16 a[162:163], v234 offset:18432
v_mfma_f32_16x16x32_bf16 v[84:87], a[188:191], v[68:71], v[84:87]
ds_read_b64_tr_b16 a[164:165], v234 offset:20480
v_mfma_f32_16x16x32_bf16 v[84:87], a[184:187], v[60:63], v[84:87]
s_waitcnt lgkmcnt(7)
ds_read_b64_tr_b16 a[166:167], v234 offset:22528
v_mfma_f32_16x16x32_bf16 v[72:75], a[144:147], v[4:7], 0
s_mul_i32 s55, s71, 576
ds_read_b64_tr_b16 a[168:169], v234 offset:24576
v_mfma_f32_16x16x32_bf16 v[72:75], a[148:151], v[44:47], v[72:75]
s_add_u32 s55, s55, s79
ds_read_b64_tr_b16 a[170:171], v234 offset:26624
v_mfma_f32_16x16x32_bf16 v[108:111], a[148:151], v[48:51], 0
s_addk_i32 m0, 0x2000
ds_read_b64_tr_b16 a[172:173], v234 offset:28672
v_cvt_pk_bf16_f32 v98, v84, v85
v_mfma_f32_16x16x32_bf16 v[108:111], a[144:147], v[12:15], v[108:111]
s_waitcnt lgkmcnt(7)
ds_read_b64_tr_b16 a[174:175], v234 offset:30720
buffer_load_dwordx4 v238, s[12:15], s55 offen  lds
v_mfma_f32_16x16x32_bf16 v[108:111], a[152:155], v[52:55], v[108:111]
s_waitcnt vmcnt(6)
ds_read_b64_tr_b16 a[176:177], v234 offset:32768
v_cvt_pk_bf16_f32 v99, v86, v87
v_mfma_f32_16x16x32_bf16 v[108:111], a[156:159], v[140:143], v[108:111]
ds_read_b64_tr_b16 a[178:179], v234 offset:34816
v_cvt_pk_bf16_f32 v106, v88, v89
v_mfma_f32_16x16x32_bf16 v[72:75], a[156:159], v[32:35], v[72:75]
ds_read_b64_tr_b16 a[180:181], v234 offset:36864
v_cvt_pk_bf16_f32 v107, v90, v91
v_mfma_f32_16x16x32_bf16 v[72:75], a[152:155], v[16:19], v[72:75]
s_waitcnt lgkmcnt(7)
buffer_store_dword v254, v223, s[32:35], 0 offen sc1
ds_read_b64_tr_b16 a[182:183], v234 offset:38912
v_mfma_f32_16x16x32_bf16 v[72:75], a[160:163], v[148:151], v[72:75]
buffer_store_dwordx4 v[96:99], v253, s[32:35], s56 offen offset:0 sc1
ds_read_b64_tr_b16 a[184:185], v234 offset:40960
v_mfma_f32_16x16x32_bf16 v[72:75], a[164:167], v[8:11], v[72:75]
ds_read_b64_tr_b16 a[186:187], v234 offset:43008
v_mfma_f32_16x16x32_bf16 v[108:111], a[164:167], v[24:27], v[108:111]
buffer_store_dwordx4 v[104:107], v253, s[32:35], s56 offen offset:1024 sc1
ds_read_b64_tr_b16 a[188:189], v234 offset:45056
v_mfma_f32_16x16x32_bf16 v[108:111], a[160:163], v[156:159], v[108:111]
s_waitcnt lgkmcnt(7)
ds_read_b64_tr_b16 a[190:191], v234 offset:47104
buffer_load_dwordx4 v237, s[12:15], s55 offen offset:1024  lds
v_mfma_f32_16x16x32_bf16 v[108:111], a[168:171], v[28:31], v[108:111]
ds_read_b64_tr_b16 a[144:145], v233 offset:0
v_mfma_f32_16x16x32_bf16 v[108:111], a[172:175], v[40:43], v[108:111]
ds_read_b64_tr_b16 a[146:147], v233 offset:2048
v_mfma_f32_16x16x32_bf16 v[72:75], a[172:175], v[56:59], v[72:75]
ds_read_b64_tr_b16 a[148:149], v233 offset:4096
v_mfma_f32_16x16x32_bf16 v[72:75], a[168:171], v[36:39], v[72:75]
s_waitcnt lgkmcnt(7)
ds_read_b64_tr_b16 a[150:151], v233 offset:6144
v_mfma_f32_16x16x32_bf16 v[72:75], a[176:179], v[128:131], v[72:75]
s_mul_i32 s54, s72, 576
ds_read_b64_tr_b16 a[152:153], v233 offset:8192
v_mfma_f32_16x16x32_bf16 v[72:75], a[180:183], v[168:171], v[72:75]
s_add_u32 s54, s54, s79
ds_read_b64_tr_b16 a[154:155], v233 offset:10240
v_mfma_f32_16x16x32_bf16 v[108:111], a[180:183], v[176:179], v[108:111]
s_addk_i32 m0, 0x2000
ds_read_b64_tr_b16 a[156:157], v233 offset:12288
v_mfma_f32_16x16x32_bf16 v[108:111], a[176:179], v[132:135], v[108:111]
s_waitcnt lgkmcnt(7)
ds_read_b64_tr_b16 a[158:159], v233 offset:14336
buffer_load_dwordx4 v238, s[12:15], s54 offen  lds
v_mfma_f32_16x16x32_bf16 v[108:111], a[184:187], v[20:23], v[108:111]
ds_read_b64_tr_b16 a[160:161], v233 offset:16384
v_mfma_f32_16x16x32_bf16 v[108:111], a[188:191], v[64:67], v[108:111]
ds_read_b64_tr_b16 a[162:163], v233 offset:18432
v_mfma_f32_16x16x32_bf16 v[72:75], a[188:191], v[68:71], v[72:75]
ds_read_b64_tr_b16 a[164:165], v233 offset:20480
v_mfma_f32_16x16x32_bf16 v[72:75], a[184:187], v[60:63], v[72:75]
s_waitcnt lgkmcnt(7)
ds_read_b64_tr_b16 a[166:167], v233 offset:22528
v_mfma_f32_16x16x32_bf16 v[84:87], a[144:147], v[4:7], 0
ds_read_b64_tr_b16 a[168:169], v233 offset:24576
v_mfma_f32_16x16x32_bf16 v[84:87], a[148:151], v[44:47], v[84:87]
ds_read_b64_tr_b16 a[170:171], v233 offset:26624
v_mfma_f32_16x16x32_bf16 v[88:91], a[148:151], v[48:51], 0
ds_read_b64_tr_b16 a[172:173], v233 offset:28672
v_cvt_pk_bf16_f32 v98, v72, v73
v_mfma_f32_16x16x32_bf16 v[88:91], a[144:147], v[12:15], v[88:91]
s_waitcnt lgkmcnt(7)
ds_read_b64_tr_b16 a[174:175], v233 offset:30720
buffer_load_dwordx4 v237, s[12:15], s54 offen offset:1024  lds
v_mfma_f32_16x16x32_bf16 v[88:91], a[152:155], v[52:55], v[88:91]
ds_read_b64_tr_b16 a[176:177], v233 offset:32768
v_cvt_pk_bf16_f32 v99, v74, v75
v_mfma_f32_16x16x32_bf16 v[88:91], a[156:159], v[140:143], v[88:91]
ds_read_b64_tr_b16 a[178:179], v233 offset:34816
v_cvt_pk_bf16_f32 v74, v108, v109
v_mfma_f32_16x16x32_bf16 v[84:87], a[156:159], v[32:35], v[84:87]
ds_read_b64_tr_b16 a[180:181], v233 offset:36864
v_cvt_pk_bf16_f32 v75, v110, v111
v_mfma_f32_16x16x32_bf16 v[84:87], a[152:155], v[16:19], v[84:87]
s_waitcnt lgkmcnt(7)
ds_read_b64_tr_b16 a[182:183], v233 offset:38912
v_mfma_f32_16x16x32_bf16 v[84:87], a[160:163], v[148:151], v[84:87]
s_mul_i32 s55, s73, 576
ds_read_b64_tr_b16 a[184:185], v233 offset:40960
v_mfma_f32_16x16x32_bf16 v[84:87], a[164:167], v[8:11], v[84:87]
s_add_u32 s55, s55, s79
ds_read_b64_tr_b16 a[186:187], v233 offset:43008
v_mfma_f32_16x16x32_bf16 v[88:91], a[164:167], v[24:27], v[88:91]
ds_read_b64_tr_b16 a[188:189], v233 offset:45056
v_mfma_f32_16x16x32_bf16 v[88:91], a[160:163], v[156:159], v[88:91]
s_waitcnt lgkmcnt(7)
ds_read_b64_tr_b16 a[190:191], v233 offset:47104
v_mfma_f32_16x16x32_bf16 v[88:91], a[168:171], v[28:31], v[88:91]
s_barrier
ds_read_b64_tr_b16 a[144:145], v250 offset:0
v_mfma_f32_16x16x32_bf16 v[88:91], a[172:175], v[40:43], v[88:91]
s_addk_i32 m0, 0x2000
ds_read_b64_tr_b16 a[146:147], v250 offset:2048
v_mfma_f32_16x16x32_bf16 v[84:87], a[172:175], v[56:59], v[84:87]
ds_read_b64_tr_b16 a[148:149], v250 offset:4096
buffer_load_dwordx4 v238, s[12:15], s55 offen  lds
v_mfma_f32_16x16x32_bf16 v[84:87], a[168:171], v[36:39], v[84:87]
s_waitcnt lgkmcnt(7)
ds_read_b64_tr_b16 a[150:151], v250 offset:6144
v_mfma_f32_16x16x32_bf16 v[84:87], a[176:179], v[128:131], v[84:87]
ds_read_b64_tr_b16 a[152:153], v250 offset:8192
v_mfma_f32_16x16x32_bf16 v[84:87], a[180:183], v[168:171], v[84:87]
ds_read_b64_tr_b16 a[154:155], v250 offset:10240
v_mfma_f32_16x16x32_bf16 v[88:91], a[180:183], v[176:179], v[88:91]
ds_read_b64_tr_b16 a[156:157], v250 offset:12288
v_mfma_f32_16x16x32_bf16 v[88:91], a[176:179], v[132:135], v[88:91]
s_waitcnt lgkmcnt(7)
ds_read_b64_tr_b16 a[158:159], v250 offset:14336
v_mfma_f32_16x16x32_bf16 v[88:91], a[184:187], v[20:23], v[88:91]
ds_read_b64_tr_b16 a[160:161], v250 offset:16384
v_mfma_f32_16x16x32_bf16 v[88:91], a[188:191], v[64:67], v[88:91]
LF_p9:
s_cbranch_execz LF_v0
ds_read_b64_tr_b16 a[162:163], v250 offset:18432
v_mfma_f32_16x16x32_bf16 v[84:87], a[188:191], v[68:71], v[84:87]
ds_read_b64_tr_b16 a[164:165], v250 offset:20480
buffer_load_dwordx4 v237, s[12:15], s55 offen offset:1024  lds
v_mfma_f32_16x16x32_bf16 v[84:87], a[184:187], v[60:63], v[84:87]
s_waitcnt lgkmcnt(7)
ds_read_b64_tr_b16 a[166:167], v250 offset:22528
v_mfma_f32_16x16x32_bf16 v[104:107], a[144:147], v[4:7], 0
s_mul_i32 s54, s68, 576
ds_read_b64_tr_b16 a[168:169], v250 offset:24576
v_mfma_f32_16x16x32_bf16 v[104:107], a[148:151], v[44:47], v[104:107]
s_add_u32 s54, s54, s80
ds_read_b64_tr_b16 a[170:171], v250 offset:26624
v_mfma_f32_16x16x32_bf16 v[108:111], a[148:151], v[48:51], 0
s_mov_b32 m0, s53
ds_read_b64_tr_b16 a[172:173], v250 offset:28672
v_cvt_pk_bf16_f32 v96, v84, v85
v_mfma_f32_16x16x32_bf16 v[108:111], a[144:147], v[12:15], v[108:111]
s_waitcnt lgkmcnt(7)
ds_read_b64_tr_b16 a[174:175], v250 offset:30720
buffer_load_dwordx4 v238, s[12:15], s54 offen  lds
v_mfma_f32_16x16x32_bf16 v[108:111], a[152:155], v[52:55], v[108:111]
ds_read_b64_tr_b16 a[176:177], v250 offset:32768
v_cvt_pk_bf16_f32 v97, v86, v87
v_mfma_f32_16x16x32_bf16 v[108:111], a[156:159], v[140:143], v[108:111]
ds_read_b64_tr_b16 a[178:179], v250 offset:34816
v_cvt_pk_bf16_f32 v72, v88, v89
v_mfma_f32_16x16x32_bf16 v[104:107], a[156:159], v[32:35], v[104:107]
ds_read_b64_tr_b16 a[180:181], v250 offset:36864
v_cvt_pk_bf16_f32 v73, v90, v91
v_mfma_f32_16x16x32_bf16 v[104:107], a[152:155], v[16:19], v[104:107]
s_waitcnt lgkmcnt(7)
buffer_store_dwordx4 v[96:99], v236, s[32:35], s56 offen offset:0 sc1
ds_read_b64_tr_b16 a[182:183], v250 offset:38912
v_mfma_f32_16x16x32_bf16 v[104:107], a[160:163], v[148:151], v[104:107]
ds_read_b64_tr_b16 a[184:185], v250 offset:40960
v_mfma_f32_16x16x32_bf16 v[104:107], a[164:167], v[8:11], v[104:107]
ds_read_b64_tr_b16 a[186:187], v250 offset:43008
v_mfma_f32_16x16x32_bf16 v[108:111], a[164:167], v[24:27], v[108:111]
buffer_store_dwordx4 v[72:75], v236, s[32:35], s56 offen offset:1024 sc1
ds_read_b64_tr_b16 a[188:189], v250 offset:45056
v_mfma_f32_16x16x32_bf16 v[108:111], a[160:163], v[156:159], v[108:111]
s_waitcnt lgkmcnt(7)
ds_read_b64_tr_b16 a[190:191], v250 offset:47104
buffer_load_dwordx4 v237, s[12:15], s54 offen offset:1024  lds
v_mfma_f32_16x16x32_bf16 v[108:111], a[168:171], v[28:31], v[108:111]
s_add_u32 s56, s51, 4
ds_read_b64_tr_b16 a[144:145], v245 offset:0
v_mfma_f32_16x16x32_bf16 v[108:111], a[172:175], v[40:43], v[108:111]
s_and_b32 s56, s56, 7
ds_read_b64_tr_b16 a[146:147], v245 offset:2048
v_mfma_f32_16x16x32_bf16 v[104:107], a[172:175], v[56:59], v[104:107]
s_add_u32 s56, s56, 1
ds_read_b64_tr_b16 a[148:149], v245 offset:4096
v_mfma_f32_16x16x32_bf16 v[104:107], a[168:171], v[36:39], v[104:107]
s_waitcnt lgkmcnt(7)
ds_read_b64_tr_b16 a[150:151], v245 offset:6144
v_mfma_f32_16x16x32_bf16 v[104:107], a[176:179], v[128:131], v[104:107]
s_mul_i32 s55, s69, 576
ds_read_b64_tr_b16 a[152:153], v245 offset:8192
v_mfma_f32_16x16x32_bf16 v[104:107], a[180:183], v[168:171], v[104:107]
s_add_u32 s55, s55, s80
ds_read_b64_tr_b16 a[154:155], v245 offset:10240
v_mfma_f32_16x16x32_bf16 v[108:111], a[180:183], v[176:179], v[108:111]
s_addk_i32 m0, 0x2000
ds_read_b64_tr_b16 a[156:157], v245 offset:12288
v_mfma_f32_16x16x32_bf16 v[108:111], a[176:179], v[132:135], v[108:111]
s_waitcnt lgkmcnt(7)
ds_read_b64_tr_b16 a[158:159], v245 offset:14336
buffer_load_dwordx4 v238, s[12:15], s55 offen  lds
v_mfma_f32_16x16x32_bf16 v[108:111], a[184:187], v[20:23], v[108:111]
s_lshr_b32 s86, s100, s56
ds_read_b64_tr_b16 a[160:161], v245 offset:16384
v_mfma_f32_16x16x32_bf16 v[108:111], a[188:191], v[64:67], v[108:111]
s_and_b32 s86, s86, 0x2000
ds_read_b64_tr_b16 a[162:163], v245 offset:18432
v_mfma_f32_16x16x32_bf16 v[104:107], a[188:191], v[68:71], v[104:107]
s_lshl_b32 s56, s56, 19
ds_read_b64_tr_b16 a[164:165], v245 offset:20480
v_mfma_f32_16x16x32_bf16 v[104:107], a[184:187], v[60:63], v[104:107]
s_waitcnt lgkmcnt(7)
ds_read_b64_tr_b16 a[166:167], v245 offset:22528
v_mfma_f32_16x16x32_bf16 v[72:75], a[144:147], v[4:7], 0
s_add_u32 s56, s56, s83
ds_read_b64_tr_b16 a[168:169], v245 offset:24576
v_mfma_f32_16x16x32_bf16 v[72:75], a[148:151], v[44:47], v[72:75]
s_add_u32 s56, s56, s86
ds_read_b64_tr_b16 a[170:171], v245 offset:26624
v_mfma_f32_16x16x32_bf16 v[84:87], a[148:151], v[48:51], 0
ds_read_b64_tr_b16 a[172:173], v245 offset:28672
v_cvt_pk_bf16_f32 v88, v104, v105
v_mfma_f32_16x16x32_bf16 v[84:87], a[144:147], v[12:15], v[84:87]
s_waitcnt lgkmcnt(7)
ds_read_b64_tr_b16 a[174:175], v245 offset:30720
buffer_load_dwordx4 v237, s[12:15], s55 offen offset:1024  lds
v_mfma_f32_16x16x32_bf16 v[84:87], a[152:155], v[52:55], v[84:87]
ds_read_b64_tr_b16 a[176:177], v245 offset:32768
v_cvt_pk_bf16_f32 v89, v106, v107
v_mfma_f32_16x16x32_bf16 v[84:87], a[156:159], v[140:143], v[84:87]
ds_read_b64_tr_b16 a[178:179], v245 offset:34816
v_cvt_pk_bf16_f32 v96, v108, v109
v_mfma_f32_16x16x32_bf16 v[72:75], a[156:159], v[32:35], v[72:75]
ds_read_b64_tr_b16 a[180:181], v245 offset:36864
v_cvt_pk_bf16_f32 v97, v110, v111
v_mfma_f32_16x16x32_bf16 v[72:75], a[152:155], v[16:19], v[72:75]
s_waitcnt lgkmcnt(7)
ds_read_b64_tr_b16 a[182:183], v245 offset:38912
v_mfma_f32_16x16x32_bf16 v[72:75], a[160:163], v[148:151], v[72:75]
s_mul_i32 s54, s70, 576
ds_read_b64_tr_b16 a[184:185], v245 offset:40960
v_mfma_f32_16x16x32_bf16 v[72:75], a[164:167], v[8:11], v[72:75]
s_add_u32 s54, s54, s80
ds_read_b64_tr_b16 a[186:187], v245 offset:43008
s_mov_b64 exec, 0xf
buffer_atomic_add v255, v229, s[32:35], 0 offen sc0 sc1
s_mov_b64 exec, -1
v_mfma_f32_16x16x32_bf16 v[84:87], a[164:167], v[24:27], v[84:87]
s_addk_i32 m0, 0x2000
ds_read_b64_tr_b16 a[188:189], v245 offset:45056
v_mfma_f32_16x16x32_bf16 v[84:87], a[160:163], v[156:159], v[84:87]
s_waitcnt lgkmcnt(7)
ds_read_b64_tr_b16 a[190:191], v245 offset:47104
buffer_load_dwordx4 v238, s[12:15], s54 offen  lds
v_mfma_f32_16x16x32_bf16 v[84:87], a[168:171], v[28:31], v[84:87]
ds_read_b64_tr_b16 a[144:145], v244 offset:0
v_mfma_f32_16x16x32_bf16 v[84:87], a[172:175], v[40:43], v[84:87]
ds_read_b64_tr_b16 a[146:147], v244 offset:2048
v_mfma_f32_16x16x32_bf16 v[72:75], a[172:175], v[56:59], v[72:75]
ds_read_b64_tr_b16 a[148:149], v244 offset:4096
v_mfma_f32_16x16x32_bf16 v[72:75], a[168:171], v[36:39], v[72:75]
s_waitcnt lgkmcnt(7)
ds_read_b64_tr_b16 a[150:151], v244 offset:6144
v_mfma_f32_16x16x32_bf16 v[72:75], a[176:179], v[128:131], v[72:75]
ds_read_b64_tr_b16 a[152:153], v244 offset:8192
v_mfma_f32_16x16x32_bf16 v[72:75], a[180:183], v[168:171], v[72:75]
ds_read_b64_tr_b16 a[154:155], v244 offset:10240
v_mfma_f32_16x16x32_bf16 v[84:87], a[180:183], v[176:179], v[84:87]
ds_read_b64_tr_b16 a[156:157], v244 offset:12288
v_mfma_f32_16x16x32_bf16 v[84:87], a[176:179], v[132:135], v[84:87]
s_waitcnt lgkmcnt(7)
ds_read_b64_tr_b16 a[158:159], v244 offset:14336
buffer_load_dwordx4 v237, s[12:15], s54 offen offset:1024  lds
v_mfma_f32_16x16x32_bf16 v[84:87], a[184:187], v[20:23], v[84:87]
ds_read_b64_tr_b16 a[160:161], v244 offset:16384
v_mfma_f32_16x16x32_bf16 v[84:87], a[188:191], v[64:67], v[84:87]
ds_read_b64_tr_b16 a[162:163], v244 offset:18432
v_mfma_f32_16x16x32_bf16 v[72:75], a[188:191], v[68:71], v[72:75]
ds_read_b64_tr_b16 a[164:165], v244 offset:20480
v_mfma_f32_16x16x32_bf16 v[72:75], a[184:187], v[60:63], v[72:75]
s_waitcnt lgkmcnt(7)
ds_read_b64_tr_b16 a[166:167], v244 offset:22528
v_mfma_f32_16x16x32_bf16 v[104:107], a[144:147], v[4:7], 0
s_mul_i32 s55, s71, 576
ds_read_b64_tr_b16 a[168:169], v244 offset:24576
v_mfma_f32_16x16x32_bf16 v[104:107], a[148:151], v[44:47], v[104:107]
s_add_u32 s55, s55, s80
ds_read_b64_tr_b16 a[170:171], v244 offset:26624
v_mfma_f32_16x16x32_bf16 v[108:111], a[148:151], v[48:51], 0
s_addk_i32 m0, 0x2000
ds_read_b64_tr_b16 a[172:173], v244 offset:28672
v_cvt_pk_bf16_f32 v90, v72, v73
v_mfma_f32_16x16x32_bf16 v[108:111], a[144:147], v[12:15], v[108:111]
s_waitcnt lgkmcnt(7)
ds_read_b64_tr_b16 a[174:175], v244 offset:30720
buffer_load_dwordx4 v238, s[12:15], s55 offen  lds
v_mfma_f32_16x16x32_bf16 v[108:111], a[152:155], v[52:55], v[108:111]
ds_read_b64_tr_b16 a[176:177], v244 offset:32768
v_cvt_pk_bf16_f32 v91, v74, v75
v_mfma_f32_16x16x32_bf16 v[108:111], a[156:159], v[140:143], v[108:111]
ds_read_b64_tr_b16 a[178:179], v244 offset:34816
v_cvt_pk_bf16_f32 v98, v84, v85
v_mfma_f32_16x16x32_bf16 v[104:107], a[156:159], v[32:35], v[104:107]
ds_read_b64_tr_b16 a[180:181], v244 offset:36864
v_cvt_pk_bf16_f32 v99, v86, v87
v_mfma_f32_16x16x32_bf16 v[104:107], a[152:155], v[16:19], v[104:107]
s_waitcnt lgkmcnt(7)
buffer_store_dwordx4 v[88:91], v253, s[32:35], s56 offen offset:0 sc1
ds_read_b64_tr_b16 a[182:183], v244 offset:38912
v_mfma_f32_16x16x32_bf16 v[104:107], a[160:163], v[148:151], v[104:107]
ds_read_b64_tr_b16 a[184:185], v244 offset:40960
v_mfma_f32_16x16x32_bf16 v[104:107], a[164:167], v[8:11], v[104:107]
ds_read_b64_tr_b16 a[186:187], v244 offset:43008
v_mfma_f32_16x16x32_bf16 v[108:111], a[164:167], v[24:27], v[108:111]
buffer_store_dwordx4 v[96:99], v253, s[32:35], s56 offen offset:1024 sc1
ds_read_b64_tr_b16 a[188:189], v244 offset:45056
v_mfma_f32_16x16x32_bf16 v[108:111], a[160:163], v[156:159], v[108:111]
s_waitcnt lgkmcnt(7)
ds_read_b64_tr_b16 a[190:191], v244 offset:47104
buffer_load_dwordx4 v237, s[12:15], s55 offen offset:1024  lds
v_mfma_f32_16x16x32_bf16 v[108:111], a[168:171], v[28:31], v[108:111]
ds_read_b64_tr_b16 a[144:145], v243 offset:0
v_mfma_f32_16x16x32_bf16 v[108:111], a[172:175], v[40:43], v[108:111]
ds_read_b64_tr_b16 a[146:147], v243 offset:2048
v_mfma_f32_16x16x32_bf16 v[104:107], a[172:175], v[56:59], v[104:107]
ds_read_b64_tr_b16 a[148:149], v243 offset:4096
v_mfma_f32_16x16x32_bf16 v[104:107], a[168:171], v[36:39], v[104:107]
s_waitcnt lgkmcnt(7)
ds_read_b64_tr_b16 a[150:151], v243 offset:6144
v_mfma_f32_16x16x32_bf16 v[104:107], a[176:179], v[128:131], v[104:107]
s_mul_i32 s54, s72, 576
ds_read_b64_tr_b16 a[152:153], v243 offset:8192
v_mfma_f32_16x16x32_bf16 v[104:107], a[180:183], v[168:171], v[104:107]
s_add_u32 s54, s54, s80
ds_read_b64_tr_b16 a[154:155], v243 offset:10240
v_mfma_f32_16x16x32_bf16 v[108:111], a[180:183], v[176:179], v[108:111]
s_addk_i32 m0, 0x2000
ds_read_b64_tr_b16 a[156:157], v243 offset:12288
v_mfma_f32_16x16x32_bf16 v[108:111], a[176:179], v[132:135], v[108:111]
s_waitcnt lgkmcnt(7)
ds_read_b64_tr_b16 a[158:159], v243 offset:14336
buffer_load_dwordx4 v238, s[12:15], s54 offen  lds
v_mfma_f32_16x16x32_bf16 v[108:111], a[184:187], v[20:23], v[108:111]
ds_read_b64_tr_b16 a[160:161], v243 offset:16384
v_mfma_f32_16x16x32_bf16 v[108:111], a[188:191], v[64:67], v[108:111]
ds_read_b64_tr_b16 a[162:163], v243 offset:18432
v_mfma_f32_16x16x32_bf16 v[104:107], a[188:191], v[68:71], v[104:107]
ds_read_b64_tr_b16 a[164:165], v243 offset:20480
v_mfma_f32_16x16x32_bf16 v[104:107], a[184:187], v[60:63], v[104:107]
s_waitcnt lgkmcnt(7)
ds_read_b64_tr_b16 a[166:167], v243 offset:22528
v_mfma_f32_16x16x32_bf16 v[72:75], a[144:147], v[4:7], 0
ds_read_b64_tr_b16 a[168:169], v243 offset:24576
v_mfma_f32_16x16x32_bf16 v[72:75], a[148:151], v[44:47], v[72:75]
ds_read_b64_tr_b16 a[170:171], v243 offset:26624
v_mfma_f32_16x16x32_bf16 v[84:87], a[148:151], v[48:51], 0
ds_read_b64_tr_b16 a[172:173], v243 offset:28672
s_waitcnt vmcnt(7)
v_cmp_le_u32 vcc, v230, v255
v_mfma_f32_16x16x32_bf16 v[84:87], a[144:147], v[12:15], v[84:87]
s_waitcnt lgkmcnt(7)
ds_read_b64_tr_b16 a[174:175], v243 offset:30720
buffer_load_dwordx4 v237, s[12:15], s54 offen offset:1024  lds
v_mfma_f32_16x16x32_bf16 v[84:87], a[152:155], v[52:55], v[84:87]
s_and_b32 s99, vcc_lo, 0xf
ds_read_b64_tr_b16 a[176:177], v243 offset:32768
v_cvt_pk_bf16_f32 v90, v104, v105
v_mfma_f32_16x16x32_bf16 v[84:87], a[156:159], v[140:143], v[84:87]
s_andn2_b32 s98, s98, s99
ds_read_b64_tr_b16 a[178:179], v243 offset:34816
v_cvt_pk_bf16_f32 v91, v106, v107
v_mfma_f32_16x16x32_bf16 v[72:75], a[156:159], v[32:35], v[72:75]
s_lshl_b32 s57, s98, 20
ds_read_b64_tr_b16 a[180:181], v243 offset:36864
v_cvt_pk_bf16_f32 v98, v108, v109
v_mfma_f32_16x16x32_bf16 v[72:75], a[152:155], v[16:19], v[72:75]
s_waitcnt lgkmcnt(7)
ds_read_b64_tr_b16 a[182:183], v243 offset:38912
v_cvt_pk_bf16_f32 v99, v110, v111
v_mfma_f32_16x16x32_bf16 v[72:75], a[160:163], v[148:151], v[72:75]
s_mul_i32 s55, s73, 576
ds_read_b64_tr_b16 a[184:185], v243 offset:40960
v_mfma_f32_16x16x32_bf16 v[72:75], a[164:167], v[8:11], v[72:75]
s_add_u32 s55, s55, s80
ds_read_b64_tr_b16 a[186:187], v243 offset:43008
v_mfma_f32_16x16x32_bf16 v[84:87], a[164:167], v[24:27], v[84:87]
ds_read_b64_tr_b16 a[188:189], v243 offset:45056
v_mfma_f32_16x16x32_bf16 v[84:87], a[160:163], v[156:159], v[84:87]
s_waitcnt lgkmcnt(7)
ds_read_b64_tr_b16 a[190:191], v243 offset:47104
v_mfma_f32_16x16x32_bf16 v[84:87], a[168:171], v[28:31], v[84:87]
s_barrier
ds_read_b64_tr_b16 a[144:145], v242 offset:0
v_mfma_f32_16x16x32_bf16 v[84:87], a[172:175], v[40:43], v[84:87]
s_addk_i32 m0, 0x2000
ds_read_b64_tr_b16 a[146:147], v242 offset:2048
v_mfma_f32_16x16x32_bf16 v[72:75], a[172:175], v[56:59], v[72:75]
s_and_b32 s57, s57, 0x100000
s_or_b32 s57, s57, s60
ds_read_b64_tr_b16 a[148:149], v242 offset:4096
buffer_load_dwordx4 v238, s[12:15], s55 offen  lds
buffer_load_dwordx4 a[2:5], v231, s[44:47], s57 offen offset:0 sc1
v_mfma_f32_16x16x32_bf16 v[72:75], a[168:171], v[36:39], v[72:75]
s_waitcnt lgkmcnt(7)
ds_read_b64_tr_b16 a[150:151], v242 offset:6144
v_mfma_f32_16x16x32_bf16 v[72:75], a[176:179], v[128:131], v[72:75]
ds_read_b64_tr_b16 a[152:153], v242 offset:8192
v_mfma_f32_16x16x32_bf16 v[72:75], a[180:183], v[168:171], v[72:75]
ds_read_b64_tr_b16 a[154:155], v242 offset:10240
v_mfma_f32_16x16x32_bf16 v[84:87], a[180:183], v[176:179], v[84:87]
ds_read_b64_tr_b16 a[156:157], v242 offset:12288
v_mfma_f32_16x16x32_bf16 v[84:87], a[176:179], v[132:135], v[84:87]
s_waitcnt lgkmcnt(7)
ds_read_b64_tr_b16 a[158:159], v242 offset:14336
v_mfma_f32_16x16x32_bf16 v[84:87], a[184:187], v[20:23], v[84:87]
ds_read_b64_tr_b16 a[160:161], v242 offset:16384
v_mfma_f32_16x16x32_bf16 v[84:87], a[188:191], v[64:67], v[84:87]
ds_read_b64_tr_b16 a[162:163], v242 offset:18432
v_mfma_f32_16x16x32_bf16 v[72:75], a[188:191], v[68:71], v[72:75]
ds_read_b64_tr_b16 a[164:165], v242 offset:20480
buffer_load_dwordx4 v237, s[12:15], s55 offen offset:1024  lds
v_mfma_f32_16x16x32_bf16 v[72:75], a[184:187], v[60:63], v[72:75]
s_waitcnt lgkmcnt(7)
ds_read_b64_tr_b16 a[166:167], v242 offset:22528
v_mfma_f32_16x16x32_bf16 v[104:107], a[144:147], v[4:7], 0
s_mul_i32 s54, s68, 576
ds_read_b64_tr_b16 a[168:169], v242 offset:24576
v_mfma_f32_16x16x32_bf16 v[104:107], a[148:151], v[44:47], v[104:107]
s_add_u32 s54, s54, s81
ds_read_b64_tr_b16 a[170:171], v242 offset:26624
v_mfma_f32_16x16x32_bf16 v[108:111], a[148:151], v[48:51], 0
s_addk_i32 m0, 0x2000
ds_read_b64_tr_b16 a[172:173], v242 offset:28672
v_cvt_pk_bf16_f32 v88, v72, v73
v_mfma_f32_16x16x32_bf16 v[108:111], a[144:147], v[12:15], v[108:111]
s_waitcnt lgkmcnt(7)
ds_read_b64_tr_b16 a[174:175], v242 offset:30720
buffer_load_dwordx4 v238, s[12:15], s54 offen  lds
v_mfma_f32_16x16x32_bf16 v[108:111], a[152:155], v[52:55], v[108:111]
ds_read_b64_tr_b16 a[176:177], v242 offset:32768
v_cvt_pk_bf16_f32 v89, v74, v75
v_mfma_f32_16x16x32_bf16 v[108:111], a[156:159], v[140:143], v[108:111]
ds_read_b64_tr_b16 a[178:179], v242 offset:34816
v_cvt_pk_bf16_f32 v96, v84, v85
v_mfma_f32_16x16x32_bf16 v[104:107], a[156:159], v[32:35], v[104:107]
ds_read_b64_tr_b16 a[180:181], v242 offset:36864
v_cvt_pk_bf16_f32 v97, v86, v87
v_mfma_f32_16x16x32_bf16 v[104:107], a[152:155], v[16:19], v[104:107]
s_waitcnt lgkmcnt(7)
buffer_store_dwordx4 v[88:91], v236, s[32:35], s56 offen offset:0 sc1
ds_read_b64_tr_b16 a[182:183], v242 offset:38912
v_mfma_f32_16x16x32_bf16 v[104:107], a[160:163], v[148:151], v[104:107]
buffer_load_dwordx4 a[66:69], v231, s[44:47], s57 offen offset:1024 sc1
ds_read_b64_tr_b16 a[184:185], v242 offset:40960
v_mfma_f32_16x16x32_bf16 v[104:107], a[164:167], v[8:11], v[104:107]
s_lshl_b32 s57, s98, 19
ds_read_b64_tr_b16 a[186:187], v242 offset:43008
v_mfma_f32_16x16x32_bf16 v[108:111], a[164:167], v[24:27], v[108:111]
s_and_b32 s57, s57, 0x100000
buffer_store_dwordx4 v[96:99], v236, s[32:35], s56 offen offset:1024 sc1
ds_read_b64_tr_b16 a[188:189], v242 offset:45056
v_mfma_f32_16x16x32_bf16 v[108:111], a[160:163], v[156:159], v[108:111]
s_waitcnt lgkmcnt(7)
ds_read_b64_tr_b16 a[190:191], v242 offset:47104
buffer_load_dwordx4 v237, s[12:15], s54 offen offset:1024  lds
v_mfma_f32_16x16x32_bf16 v[108:111], a[168:171], v[28:31], v[108:111]
s_or_b32 s57, s57, s61
ds_read_b64_tr_b16 a[144:145], v241 offset:0
v_mfma_f32_16x16x32_bf16 v[108:111], a[172:175], v[40:43], v[108:111]
s_add_u32 s56, s51, 5
ds_read_b64_tr_b16 a[146:147], v241 offset:2048
v_mfma_f32_16x16x32_bf16 v[104:107], a[172:175], v[56:59], v[104:107]
s_and_b32 s56, s56, 7
ds_read_b64_tr_b16 a[148:149], v241 offset:4096
v_mfma_f32_16x16x32_bf16 v[104:107], a[168:171], v[36:39], v[104:107]
s_waitcnt lgkmcnt(7)
ds_read_b64_tr_b16 a[150:151], v241 offset:6144
v_mfma_f32_16x16x32_bf16 v[104:107], a[176:179], v[128:131], v[104:107]
s_mul_i32 s55, s69, 576
ds_read_b64_tr_b16 a[152:153], v241 offset:8192
v_mfma_f32_16x16x32_bf16 v[104:107], a[180:183], v[168:171], v[104:107]
s_add_u32 s55, s55, s81
ds_read_b64_tr_b16 a[154:155], v241 offset:10240
v_mfma_f32_16x16x32_bf16 v[108:111], a[180:183], v[176:179], v[108:111]
s_addk_i32 m0, 0x2000
ds_read_b64_tr_b16 a[156:157], v241 offset:12288
v_mfma_f32_16x16x32_bf16 v[108:111], a[176:179], v[132:135], v[108:111]
s_waitcnt lgkmcnt(7)
ds_read_b64_tr_b16 a[158:159], v241 offset:14336
buffer_load_dwordx4 v238, s[12:15], s55 offen  lds
v_mfma_f32_16x16x32_bf16 v[108:111], a[184:187], v[20:23], v[108:111]
s_add_u32 s56, s56, 1
ds_read_b64_tr_b16 a[160:161], v241 offset:16384
v_mfma_f32_16x16x32_bf16 v[108:111], a[188:191], v[64:67], v[108:111]
s_lshr_b32 s86, s100, s56
ds_read_b64_tr_b16 a[162:163], v241 offset:18432
v_mfma_f32_16x16x32_bf16 v[104:107], a[188:191], v[68:71], v[104:107]
s_and_b32 s86, s86, 0x2000
ds_read_b64_tr_b16 a[164:165], v241 offset:20480
v_mfma_f32_16x16x32_bf16 v[104:107], a[184:187], v[60:63], v[104:107]
s_waitcnt lgkmcnt(7)
ds_read_b64_tr_b16 a[166:167], v241 offset:22528
v_mfma_f32_16x16x32_bf16 v[72:75], a[144:147], v[4:7], 0
s_lshl_b32 s56, s56, 19
ds_read_b64_tr_b16 a[168:169], v241 offset:24576
v_mfma_f32_16x16x32_bf16 v[72:75], a[148:151], v[44:47], v[72:75]
s_add_u32 s56, s56, s83
ds_read_b64_tr_b16 a[170:171], v241 offset:26624
v_mfma_f32_16x16x32_bf16 v[84:87], a[148:151], v[48:51], 0
s_add_u32 s56, s56, s86
ds_read_b64_tr_b16 a[172:173], v241 offset:28672
v_cvt_pk_bf16_f32 v88, v104, v105
v_mfma_f32_16x16x32_bf16 v[84:87], a[144:147], v[12:15], v[84:87]
s_waitcnt lgkmcnt(7)
ds_read_b64_tr_b16 a[174:175], v241 offset:30720
buffer_load_dwordx4 v237, s[12:15], s55 offen offset:1024  lds
v_mfma_f32_16x16x32_bf16 v[84:87], a[152:155], v[52:55], v[84:87]
ds_read_b64_tr_b16 a[176:177], v241 offset:32768
v_cvt_pk_bf16_f32 v89, v106, v107
v_mfma_f32_16x16x32_bf16 v[84:87], a[156:159], v[140:143], v[84:87]
ds_read_b64_tr_b16 a[178:179], v241 offset:34816
v_cvt_pk_bf16_f32 v96, v108, v109
v_mfma_f32_16x16x32_bf16 v[72:75], a[156:159], v[32:35], v[72:75]
buffer_load_dwordx4 a[6:9], v231, s[44:47], s57 offen offset:0 sc1
ds_read_b64_tr_b16 a[180:181], v241 offset:36864
v_mfma_f32_16x16x32_bf16 v[72:75], a[152:155], v[16:19], v[72:75]
s_waitcnt lgkmcnt(7)
ds_read_b64_tr_b16 a[182:183], v241 offset:38912
v_cvt_pk_bf16_f32 v97, v110, v111
v_mfma_f32_16x16x32_bf16 v[72:75], a[160:163], v[148:151], v[72:75]
s_mul_i32 s54, s70, 576
ds_read_b64_tr_b16 a[184:185], v241 offset:40960
v_mov_b32 v254, 10
v_mfma_f32_16x16x32_bf16 v[72:75], a[164:167], v[8:11], v[72:75]
s_add_u32 s54, s54, s81
ds_read_b64_tr_b16 a[186:187], v241 offset:43008
v_mfma_f32_16x16x32_bf16 v[84:87], a[164:167], v[24:27], v[84:87]
s_addk_i32 m0, 0x2000
ds_read_b64_tr_b16 a[188:189], v241 offset:45056
v_mfma_f32_16x16x32_bf16 v[84:87], a[160:163], v[156:159], v[84:87]
s_waitcnt lgkmcnt(7)
ds_read_b64_tr_b16 a[190:191], v241 offset:47104
buffer_load_dwordx4 v238, s[12:15], s54 offen  lds
v_mfma_f32_16x16x32_bf16 v[84:87], a[168:171], v[28:31], v[84:87]
ds_read_b64_tr_b16 a[144:145], v240 offset:0
v_mfma_f32_16x16x32_bf16 v[84:87], a[172:175], v[40:43], v[84:87]
ds_read_b64_tr_b16 a[146:147], v240 offset:2048
v_mfma_f32_16x16x32_bf16 v[72:75], a[172:175], v[56:59], v[72:75]
ds_read_b64_tr_b16 a[148:149], v240 offset:4096
v_mfma_f32_16x16x32_bf16 v[72:75], a[168:171], v[36:39], v[72:75]
s_waitcnt lgkmcnt(7)
ds_read_b64_tr_b16 a[150:151], v240 offset:6144
v_mfma_f32_16x16x32_bf16 v[72:75], a[176:179], v[128:131], v[72:75]
ds_read_b64_tr_b16 a[152:153], v240 offset:8192
v_mfma_f32_16x16x32_bf16 v[72:75], a[180:183], v[168:171], v[72:75]
ds_read_b64_tr_b16 a[154:155], v240 offset:10240
v_mfma_f32_16x16x32_bf16 v[84:87], a[180:183], v[176:179], v[84:87]
ds_read_b64_tr_b16 a[156:157], v240 offset:12288
v_mfma_f32_16x16x32_bf16 v[84:87], a[176:179], v[132:135], v[84:87]
s_waitcnt lgkmcnt(7)
ds_read_b64_tr_b16 a[158:159], v240 offset:14336
buffer_load_dwordx4 v237, s[12:15], s54 offen offset:1024  lds
v_mfma_f32_16x16x32_bf16 v[84:87], a[184:187], v[20:23], v[84:87]
ds_read_b64_tr_b16 a[160:161], v240 offset:16384
v_mfma_f32_16x16x32_bf16 v[84:87], a[188:191], v[64:67], v[84:87]
ds_read_b64_tr_b16 a[162:163], v240 offset:18432
v_mfma_f32_16x16x32_bf16 v[72:75], a[188:191], v[68:71], v[72:75]
ds_read_b64_tr_b16 a[164:165], v240 offset:20480
v_mfma_f32_16x16x32_bf16 v[72:75], a[184:187], v[60:63], v[72:75]
s_waitcnt lgkmcnt(7)
ds_read_b64_tr_b16 a[166:167], v240 offset:22528
v_mfma_f32_16x16x32_bf16 v[104:107], a[144:147], v[4:7], 0
s_mul_i32 s55, s71, 576
ds_read_b64_tr_b16 a[168:169], v240 offset:24576
v_mfma_f32_16x16x32_bf16 v[104:107], a[148:151], v[44:47], v[104:107]
s_add_u32 s55, s55, s81
ds_read_b64_tr_b16 a[170:171], v240 offset:26624
v_mfma_f32_16x16x32_bf16 v[108:111], a[148:151], v[48:51], 0
s_addk_i32 m0, 0x2000
ds_read_b64_tr_b16 a[172:173], v240 offset:28672
v_cvt_pk_bf16_f32 v90, v72, v73
v_mfma_f32_16x16x32_bf16 v[108:111], a[144:147], v[12:15], v[108:111]
s_waitcnt lgkmcnt(7)
ds_read_b64_tr_b16 a[174:175], v240 offset:30720
buffer_load_dwordx4 v238, s[12:15], s55 offen  lds
v_mfma_f32_16x16x32_bf16 v[108:111], a[152:155], v[52:55], v[108:111]
s_waitcnt vmcnt(7)
ds_read_b64_tr_b16 a[176:177], v240 offset:32768
v_cvt_pk_bf16_f32 v91, v74, v75
v_mfma_f32_16x16x32_bf16 v[108:111], a[156:159], v[140:143], v[108:111]
ds_read_b64_tr_b16 a[178:179], v240 offset:34816
v_cvt_pk_bf16_f32 v98, v84, v85
v_mfma_f32_16x16x32_bf16 v[104:107], a[156:159], v[32:35], v[104:107]
ds_read_b64_tr_b16 a[180:181], v240 offset:36864
v_cvt_pk_bf16_f32 v99, v86, v87
v_mfma_f32_16x16x32_bf16 v[104:107], a[152:155], v[16:19], v[104:107]
s_waitcnt lgkmcnt(7)
buffer_load_dwordx4 a[70:73], v231, s[44:47], s57 offen offset:1024 sc1
ds_read_b64_tr_b16 a[182:183], v240 offset:38912
v_mfma_f32_16x16x32_bf16 v[104:107], a[160:163], v[148:151], v[104:107]
s_lshl_b32 s57, s98, 18
buffer_store_dword v254, v223, s[32:35], 0 offen sc1
ds_read_b64_tr_b16 a[184:185], v240 offset:40960
v_mfma_f32_16x16x32_bf16 v[104:107], a[164:167], v[8:11], v[104:107]
s_and_b32 s57, s57, 0x100000
buffer_store_dwordx4 v[88:91], v253, s[32:35], s56 offen offset:0 sc1
ds_read_b64_tr_b16 a[186:187], v240 offset:43008
v_mfma_f32_16x16x32_bf16 v[108:111], a[164:167], v[24:27], v[108:111]
s_or_b32 s57, s57, s62
buffer_store_dwordx4 v[96:99], v253, s[32:35], s56 offen offset:1024 sc1
ds_read_b64_tr_b16 a[188:189], v240 offset:45056
v_mfma_f32_16x16x32_bf16 v[108:111], a[160:163], v[156:159], v[108:111]
s_waitcnt lgkmcnt(7)
ds_read_b64_tr_b16 a[190:191], v240 offset:47104
buffer_load_dwordx4 v237, s[12:15], s55 offen offset:1024  lds
v_mfma_f32_16x16x32_bf16 v[108:111], a[168:171], v[28:31], v[108:111]
ds_read_b64_tr_b16 a[144:145], v239 offset:0
v_mfma_f32_16x16x32_bf16 v[108:111], a[172:175], v[40:43], v[108:111]
ds_read_b64_tr_b16 a[146:147], v239 offset:2048
v_mfma_f32_16x16x32_bf16 v[104:107], a[172:175], v[56:59], v[104:107]
ds_read_b64_tr_b16 a[148:149], v239 offset:4096
v_mfma_f32_16x16x32_bf16 v[104:107], a[168:171], v[36:39], v[104:107]
s_waitcnt lgkmcnt(7)
ds_read_b64_tr_b16 a[150:151], v239 offset:6144
v_mfma_f32_16x16x32_bf16 v[104:107], a[176:179], v[128:131], v[104:107]
s_mul_i32 s54, s72, 576
ds_read_b64_tr_b16 a[152:153], v239 offset:8192
v_mfma_f32_16x16x32_bf16 v[104:107], a[180:183], v[168:171], v[104:107]
s_add_u32 s54, s54, s81
ds_read_b64_tr_b16 a[154:155], v239 offset:10240
v_mfma_f32_16x16x32_bf16 v[108:111], a[180:183], v[176:179], v[108:111]
s_addk_i32 m0, 0x2000
ds_read_b64_tr_b16 a[156:157], v239 offset:12288
v_mfma_f32_16x16x32_bf16 v[108:111], a[176:179], v[132:135], v[108:111]
s_waitcnt lgkmcnt(7)
ds_read_b64_tr_b16 a[158:159], v239 offset:14336
buffer_load_dwordx4 v238, s[12:15], s54 offen  lds
v_mfma_f32_16x16x32_bf16 v[108:111], a[184:187], v[20:23], v[108:111]
ds_read_b64_tr_b16 a[160:161], v239 offset:16384
v_mfma_f32_16x16x32_bf16 v[108:111], a[188:191], v[64:67], v[108:111]
ds_read_b64_tr_b16 a[162:163], v239 offset:18432
v_mfma_f32_16x16x32_bf16 v[104:107], a[188:191], v[68:71], v[104:107]
ds_read_b64_tr_b16 a[164:165], v239 offset:20480
v_mfma_f32_16x16x32_bf16 v[104:107], a[184:187], v[60:63], v[104:107]
s_waitcnt lgkmcnt(7)
ds_read_b64_tr_b16 a[166:167], v239 offset:22528
v_mfma_f32_16x16x32_bf16 v[72:75], a[144:147], v[4:7], 0
ds_read_b64_tr_b16 a[168:169], v239 offset:24576
v_mfma_f32_16x16x32_bf16 v[72:75], a[148:151], v[44:47], v[72:75]
ds_read_b64_tr_b16 a[170:171], v239 offset:26624
v_mfma_f32_16x16x32_bf16 v[84:87], a[148:151], v[48:51], 0
buffer_load_dwordx4 a[10:13], v231, s[44:47], s57 offen offset:0 sc1
ds_read_b64_tr_b16 a[172:173], v239 offset:28672
v_mfma_f32_16x16x32_bf16 v[84:87], a[144:147], v[12:15], v[84:87]
s_waitcnt lgkmcnt(7)
ds_read_b64_tr_b16 a[174:175], v239 offset:30720
buffer_load_dwordx4 v237, s[12:15], s54 offen offset:1024  lds
v_mfma_f32_16x16x32_bf16 v[84:87], a[152:155], v[52:55], v[84:87]
ds_read_b64_tr_b16 a[176:177], v239 offset:32768
v_cvt_pk_bf16_f32 v90, v104, v105
v_mfma_f32_16x16x32_bf16 v[84:87], a[156:159], v[140:143], v[84:87]
ds_read_b64_tr_b16 a[178:179], v239 offset:34816
v_cvt_pk_bf16_f32 v91, v106, v107
v_mfma_f32_16x16x32_bf16 v[72:75], a[156:159], v[32:35], v[72:75]
ds_read_b64_tr_b16 a[180:181], v239 offset:36864
v_cvt_pk_bf16_f32 v98, v108, v109
v_mfma_f32_16x16x32_bf16 v[72:75], a[152:155], v[16:19], v[72:75]
s_waitcnt lgkmcnt(7)
ds_read_b64_tr_b16 a[182:183], v239 offset:38912
v_cvt_pk_bf16_f32 v99, v110, v111
v_mfma_f32_16x16x32_bf16 v[72:75], a[160:163], v[148:151], v[72:75]
s_mul_i32 s55, s73, 576
ds_read_b64_tr_b16 a[184:185], v239 offset:40960
v_mfma_f32_16x16x32_bf16 v[72:75], a[164:167], v[8:11], v[72:75]
s_add_u32 s55, s55, s81
ds_read_b64_tr_b16 a[186:187], v239 offset:43008
v_mfma_f32_16x16x32_bf16 v[84:87], a[164:167], v[24:27], v[84:87]
ds_read_b64_tr_b16 a[188:189], v239 offset:45056
v_mfma_f32_16x16x32_bf16 v[84:87], a[160:163], v[156:159], v[84:87]
s_waitcnt lgkmcnt(7)
ds_read_b64_tr_b16 a[190:191], v239 offset:47104
v_mfma_f32_16x16x32_bf16 v[84:87], a[168:171], v[28:31], v[84:87]
s_barrier
ds_read_b64_tr_b16 a[144:145], v235 offset:0
v_mfma_f32_16x16x32_bf16 v[84:87], a[172:175], v[40:43], v[84:87]
s_addk_i32 m0, 0x2000
ds_read_b64_tr_b16 a[146:147], v235 offset:2048
v_mfma_f32_16x16x32_bf16 v[72:75], a[172:175], v[56:59], v[72:75]
ds_read_b64_tr_b16 a[148:149], v235 offset:4096
buffer_load_dwordx4 v238, s[12:15], s55 offen  lds
v_mfma_f32_16x16x32_bf16 v[72:75], a[168:171], v[36:39], v[72:75]
s_waitcnt lgkmcnt(7)
ds_read_b64_tr_b16 a[150:151], v235 offset:6144
v_mfma_f32_16x16x32_bf16 v[72:75], a[176:179], v[128:131], v[72:75]
LF_p10:
s_cbranch_execz LF_v0
ds_read_b64_tr_b16 a[152:153], v235 offset:8192
v_mfma_f32_16x16x32_bf16 v[72:75], a[180:183], v[168:171], v[72:75]
ds_read_b64_tr_b16 a[154:155], v235 offset:10240
v_mfma_f32_16x16x32_bf16 v[84:87], a[180:183], v[176:179], v[84:87]
ds_read_b64_tr_b16 a[156:157], v235 offset:12288
v_mfma_f32_16x16x32_bf16 v[84:87], a[176:179], v[132:135], v[84:87]
s_waitcnt lgkmcnt(7)
ds_read_b64_tr_b16 a[158:159], v235 offset:14336
v_mfma_f32_16x16x32_bf16 v[84:87], a[184:187], v[20:23], v[84:87]
ds_read_b64_tr_b16 a[160:161], v235 offset:16384
v_mfma_f32_16x16x32_bf16 v[84:87], a[188:191], v[64:67], v[84:87]
ds_read_b64_tr_b16 a[162:163], v235 offset:18432
v_mfma_f32_16x16x32_bf16 v[72:75], a[188:191], v[68:71], v[72:75]
ds_read_b64_tr_b16 a[164:165], v235 offset:20480
buffer_load_dwordx4 v237, s[12:15], s55 offen offset:1024  lds
v_mfma_f32_16x16x32_bf16 v[72:75], a[184:187], v[60:63], v[72:75]
s_waitcnt lgkmcnt(7)
ds_read_b64_tr_b16 a[166:167], v235 offset:22528
v_mfma_f32_16x16x32_bf16 v[104:107], a[144:147], v[4:7], 0
s_mul_i32 s54, s68, 576
buffer_load_dwordx4 a[74:77], v231, s[44:47], s57 offen offset:1024 sc1
ds_read_b64_tr_b16 a[168:169], v235 offset:24576
v_mfma_f32_16x16x32_bf16 v[104:107], a[148:151], v[44:47], v[104:107]
s_add_u32 s54, s54, s82
ds_read_b64_tr_b16 a[170:171], v235 offset:26624
v_mfma_f32_16x16x32_bf16 v[108:111], a[148:151], v[48:51], 0
s_addk_i32 m0, 0x2000
ds_read_b64_tr_b16 a[172:173], v235 offset:28672
v_cvt_pk_bf16_f32 v88, v72, v73
v_mfma_f32_16x16x32_bf16 v[108:111], a[144:147], v[12:15], v[108:111]
s_waitcnt lgkmcnt(7)
ds_read_b64_tr_b16 a[174:175], v235 offset:30720
buffer_load_dwordx4 v238, s[12:15], s54 offen  lds
v_mfma_f32_16x16x32_bf16 v[108:111], a[152:155], v[52:55], v[108:111]
s_lshl_b32 s57, s98, 17
ds_read_b64_tr_b16 a[176:177], v235 offset:32768
v_cvt_pk_bf16_f32 v89, v74, v75
v_mfma_f32_16x16x32_bf16 v[108:111], a[156:159], v[140:143], v[108:111]
s_and_b32 s57, s57, 0x100000
ds_read_b64_tr_b16 a[178:179], v235 offset:34816
v_cvt_pk_bf16_f32 v96, v84, v85
v_mfma_f32_16x16x32_bf16 v[104:107], a[156:159], v[32:35], v[104:107]
s_or_b32 s57, s57, s63
ds_read_b64_tr_b16 a[180:181], v235 offset:36864
v_cvt_pk_bf16_f32 v97, v86, v87
v_mfma_f32_16x16x32_bf16 v[104:107], a[152:155], v[16:19], v[104:107]
s_waitcnt lgkmcnt(7)
buffer_store_dwordx4 v[88:91], v236, s[32:35], s56 offen offset:0 sc1
ds_read_b64_tr_b16 a[182:183], v235 offset:38912
v_mfma_f32_16x16x32_bf16 v[104:107], a[160:163], v[148:151], v[104:107]
ds_read_b64_tr_b16 a[184:185], v235 offset:40960
v_mfma_f32_16x16x32_bf16 v[104:107], a[164:167], v[8:11], v[104:107]
ds_read_b64_tr_b16 a[186:187], v235 offset:43008
v_mfma_f32_16x16x32_bf16 v[108:111], a[164:167], v[24:27], v[108:111]
buffer_store_dwordx4 v[96:99], v236, s[32:35], s56 offen offset:1024 sc1
ds_read_b64_tr_b16 a[188:189], v235 offset:45056
v_mfma_f32_16x16x32_bf16 v[108:111], a[160:163], v[156:159], v[108:111]
s_waitcnt lgkmcnt(7)
ds_read_b64_tr_b16 a[190:191], v235 offset:47104
buffer_load_dwordx4 v237, s[12:15], s54 offen offset:1024  lds
v_mfma_f32_16x16x32_bf16 v[108:111], a[168:171], v[28:31], v[108:111]
s_add_u32 s56, s51, 6
ds_read_b64_tr_b16 a[144:145], v248 offset:0
v_mfma_f32_16x16x32_bf16 v[108:111], a[172:175], v[40:43], v[108:111]
s_and_b32 s56, s56, 7
ds_read_b64_tr_b16 a[146:147], v248 offset:2048
v_mfma_f32_16x16x32_bf16 v[104:107], a[172:175], v[56:59], v[104:107]
s_add_u32 s56, s56, 1
ds_read_b64_tr_b16 a[148:149], v248 offset:4096
v_mfma_f32_16x16x32_bf16 v[104:107], a[168:171], v[36:39], v[104:107]
s_waitcnt lgkmcnt(7)
ds_read_b64_tr_b16 a[150:151], v248 offset:6144
v_mfma_f32_16x16x32_bf16 v[104:107], a[176:179], v[128:131], v[104:107]
s_mul_i32 s55, s69, 576
ds_read_b64_tr_b16 a[152:153], v248 offset:8192
v_mfma_f32_16x16x32_bf16 v[104:107], a[180:183], v[168:171], v[104:107]
s_add_u32 s55, s55, s82
ds_read_b64_tr_b16 a[154:155], v248 offset:10240
v_mfma_f32_16x16x32_bf16 v[108:111], a[180:183], v[176:179], v[108:111]
s_addk_i32 m0, 0x2000
ds_read_b64_tr_b16 a[156:157], v248 offset:12288
v_mfma_f32_16x16x32_bf16 v[108:111], a[176:179], v[132:135], v[108:111]
s_waitcnt lgkmcnt(7)
ds_read_b64_tr_b16 a[158:159], v248 offset:14336
buffer_load_dwordx4 v238, s[12:15], s55 offen  lds
v_mfma_f32_16x16x32_bf16 v[108:111], a[184:187], v[20:23], v[108:111]
s_lshr_b32 s86, s100, s56
ds_read_b64_tr_b16 a[160:161], v248 offset:16384
v_mfma_f32_16x16x32_bf16 v[108:111], a[188:191], v[64:67], v[108:111]
s_and_b32 s86, s86, 0x2000
ds_read_b64_tr_b16 a[162:163], v248 offset:18432
v_mfma_f32_16x16x32_bf16 v[104:107], a[188:191], v[68:71], v[104:107]
s_lshl_b32 s56, s56, 19
buffer_load_dwordx4 a[14:17], v231, s[44:47], s57 offen offset:0 sc1
ds_read_b64_tr_b16 a[164:165], v248 offset:20480
v_mfma_f32_16x16x32_bf16 v[104:107], a[184:187], v[60:63], v[104:107]
s_waitcnt lgkmcnt(7)
ds_read_b64_tr_b16 a[166:167], v248 offset:22528
v_mov_b32 v255, 0
v_mfma_f32_16x16x32_bf16 v[72:75], a[144:147], v[4:7], 0
s_add_u32 s56, s56, s83
ds_read_b64_tr_b16 a[168:169], v248 offset:24576
v_mfma_f32_16x16x32_bf16 v[72:75], a[148:151], v[44:47], v[72:75]
s_add_u32 s56, s56, s86
ds_read_b64_tr_b16 a[170:171], v248 offset:26624
v_mov_b32 v254, 12
v_mfma_f32_16x16x32_bf16 v[84:87], a[148:151], v[48:51], 0
ds_read_b64_tr_b16 a[172:173], v248 offset:28672
v_cvt_pk_bf16_f32 v88, v104, v105
v_mfma_f32_16x16x32_bf16 v[84:87], a[144:147], v[12:15], v[84:87]
s_waitcnt lgkmcnt(7)
ds_read_b64_tr_b16 a[174:175], v248 offset:30720
buffer_load_dwordx4 v237, s[12:15], s55 offen offset:1024  lds
v_mfma_f32_16x16x32_bf16 v[84:87], a[152:155], v[52:55], v[84:87]
ds_read_b64_tr_b16 a[176:177], v248 offset:32768
v_cvt_pk_bf16_f32 v89, v106, v107
v_mfma_f32_16x16x32_bf16 v[84:87], a[156:159], v[140:143], v[84:87]
ds_read_b64_tr_b16 a[178:179], v248 offset:34816
v_cvt_pk_bf16_f32 v96, v108, v109
v_mfma_f32_16x16x32_bf16 v[72:75], a[156:159], v[32:35], v[72:75]
ds_read_b64_tr_b16 a[180:181], v248 offset:36864
v_cvt_pk_bf16_f32 v97, v110, v111
v_mfma_f32_16x16x32_bf16 v[72:75], a[152:155], v[16:19], v[72:75]
s_waitcnt lgkmcnt(7)
ds_read_b64_tr_b16 a[182:183], v248 offset:38912
v_mfma_f32_16x16x32_bf16 v[72:75], a[160:163], v[148:151], v[72:75]
s_mul_i32 s54, s70, 576
ds_read_b64_tr_b16 a[184:185], v248 offset:40960
v_mfma_f32_16x16x32_bf16 v[72:75], a[164:167], v[8:11], v[72:75]
s_add_u32 s54, s54, s82
ds_read_b64_tr_b16 a[186:187], v248 offset:43008
s_mov_b64 exec, 0xf0
buffer_atomic_add v255, v229, s[32:35], 0 offen sc0 sc1
s_mov_b64 exec, -1
v_mfma_f32_16x16x32_bf16 v[84:87], a[164:167], v[24:27], v[84:87]
s_addk_i32 m0, 0x2000
ds_read_b64_tr_b16 a[188:189], v248 offset:45056
v_mfma_f32_16x16x32_bf16 v[84:87], a[160:163], v[156:159], v[84:87]
s_waitcnt lgkmcnt(7)
ds_read_b64_tr_b16 a[190:191], v248 offset:47104
buffer_load_dwordx4 v238, s[12:15], s54 offen  lds
v_mfma_f32_16x16x32_bf16 v[84:87], a[168:171], v[28:31], v[84:87]
ds_read_b64_tr_b16 a[144:145], v234 offset:0
v_mfma_f32_16x16x32_bf16 v[84:87], a[172:175], v[40:43], v[84:87]
ds_read_b64_tr_b16 a[146:147], v234 offset:2048
v_mfma_f32_16x16x32_bf16 v[72:75], a[172:175], v[56:59], v[72:75]
ds_read_b64_tr_b16 a[148:149], v234 offset:4096
v_mfma_f32_16x16x32_bf16 v[72:75], a[168:171], v[36:39], v[72:75]
s_waitcnt lgkmcnt(7)
ds_read_b64_tr_b16 a[150:151], v234 offset:6144
v_mfma_f32_16x16x32_bf16 v[72:75], a[176:179], v[128:131], v[72:75]
ds_read_b64_tr_b16 a[152:153], v234 offset:8192
v_mfma_f32_16x16x32_bf16 v[72:75], a[180:183], v[168:171], v[72:75]
ds_read_b64_tr_b16 a[154:155], v234 offset:10240
v_mfma_f32_16x16x32_bf16 v[84:87], a[180:183], v[176:179], v[84:87]
ds_read_b64_tr_b16 a[156:157], v234 offset:12288
v_mfma_f32_16x16x32_bf16 v[84:87], a[176:179], v[132:135], v[84:87]
s_waitcnt lgkmcnt(7)
ds_read_b64_tr_b16 a[158:159], v234 offset:14336
buffer_load_dwordx4 v237, s[12:15], s54 offen offset:1024  lds
v_mfma_f32_16x16x32_bf16 v[84:87], a[184:187], v[20:23], v[84:87]
buffer_load_dwordx4 a[78:81], v231, s[44:47], s57 offen offset:1024 sc1
ds_read_b64_tr_b16 a[160:161], v234 offset:16384
v_mfma_f32_16x16x32_bf16 v[84:87], a[188:191], v[64:67], v[84:87]
ds_read_b64_tr_b16 a[162:163], v234 offset:18432
v_mfma_f32_16x16x32_bf16 v[72:75], a[188:191], v[68:71], v[72:75]
ds_read_b64_tr_b16 a[164:165], v234 offset:20480
v_mfma_f32_16x16x32_bf16 v[72:75], a[184:187], v[60:63], v[72:75]
s_waitcnt lgkmcnt(7)
ds_read_b64_tr_b16 a[166:167], v234 offset:22528
v_mfma_f32_16x16x32_bf16 v[104:107], a[144:147], v[4:7], 0
s_mul_i32 s55, s71, 576
ds_read_b64_tr_b16 a[168:169], v234 offset:24576
v_mfma_f32_16x16x32_bf16 v[104:107], a[148:151], v[44:47], v[104:107]
s_add_u32 s55, s55, s82
ds_read_b64_tr_b16 a[170:171], v234 offset:26624
v_mfma_f32_16x16x32_bf16 v[108:111], a[148:151], v[48:51], 0
s_addk_i32 m0, 0x2000
ds_read_b64_tr_b16 a[172:173], v234 offset:28672
v_cvt_pk_bf16_f32 v90, v72, v73
v_mfma_f32_16x16x32_bf16 v[108:111], a[144:147], v[12:15], v[108:111]
s_waitcnt lgkmcnt(7)
ds_read_b64_tr_b16 a[174:175], v234 offset:30720
buffer_load_dwordx4 v238, s[12:15], s55 offen  lds
v_mfma_f32_16x16x32_bf16 v[108:111], a[152:155], v[52:55], v[108:111]
s_waitcnt vmcnt(9)
ds_read_b64_tr_b16 a[176:177], v234 offset:32768
v_cvt_pk_bf16_f32 v91, v74, v75
v_mfma_f32_16x16x32_bf16 v[108:111], a[156:159], v[140:143], v[108:111]
ds_read_b64_tr_b16 a[178:179], v234 offset:34816
v_cvt_pk_bf16_f32 v98, v84, v85
v_mfma_f32_16x16x32_bf16 v[104:107], a[156:159], v[32:35], v[104:107]
ds_read_b64_tr_b16 a[180:181], v234 offset:36864
v_cvt_pk_bf16_f32 v99, v86, v87
v_mfma_f32_16x16x32_bf16 v[104:107], a[152:155], v[16:19], v[104:107]
s_waitcnt lgkmcnt(7)
buffer_store_dword v254, v223, s[32:35], 0 offen sc1
ds_read_b64_tr_b16 a[182:183], v234 offset:38912
v_mfma_f32_16x16x32_bf16 v[104:107], a[160:163], v[148:151], v[104:107]
buffer_store_dwordx4 v[88:91], v253, s[32:35], s56 offen offset:0 sc1
ds_read_b64_tr_b16 a[184:185], v234 offset:40960
v_mfma_f32_16x16x32_bf16 v[104:107], a[164:167], v[8:11], v[104:107]
ds_read_b64_tr_b16 a[186:187], v234 offset:43008
v_mfma_f32_16x16x32_bf16 v[108:111], a[164:167], v[24:27], v[108:111]
buffer_store_dwordx4 v[96:99], v253, s[32:35], s56 offen offset:1024 sc1
ds_read_b64_tr_b16 a[188:189], v234 offset:45056
v_mfma_f32_16x16x32_bf16 v[108:111], a[160:163], v[156:159], v[108:111]
s_waitcnt lgkmcnt(7)
ds_read_b64_tr_b16 a[190:191], v234 offset:47104
buffer_load_dwordx4 v237, s[12:15], s55 offen offset:1024  lds
v_mfma_f32_16x16x32_bf16 v[108:111], a[168:171], v[28:31], v[108:111]
ds_read_b64_tr_b16 a[144:145], v233 offset:0
v_mfma_f32_16x16x32_bf16 v[108:111], a[172:175], v[40:43], v[108:111]
ds_read_b64_tr_b16 a[146:147], v233 offset:2048
v_mfma_f32_16x16x32_bf16 v[104:107], a[172:175], v[56:59], v[104:107]
ds_read_b64_tr_b16 a[148:149], v233 offset:4096
v_mfma_f32_16x16x32_bf16 v[104:107], a[168:171], v[36:39], v[104:107]
s_waitcnt lgkmcnt(7)
ds_read_b64_tr_b16 a[150:151], v233 offset:6144
v_mfma_f32_16x16x32_bf16 v[104:107], a[176:179], v[128:131], v[104:107]
s_mul_i32 s54, s72, 576
ds_read_b64_tr_b16 a[152:153], v233 offset:8192
v_mfma_f32_16x16x32_bf16 v[104:107], a[180:183], v[168:171], v[104:107]
s_add_u32 s54, s54, s82
ds_read_b64_tr_b16 a[154:155], v233 offset:10240
v_mfma_f32_16x16x32_bf16 v[108:111], a[180:183], v[176:179], v[108:111]
s_addk_i32 m0, 0x2000
ds_read_b64_tr_b16 a[156:157], v233 offset:12288
v_mfma_f32_16x16x32_bf16 v[108:111], a[176:179], v[132:135], v[108:111]
s_waitcnt lgkmcnt(7)
ds_read_b64_tr_b16 a[158:159], v233 offset:14336
buffer_load_dwordx4 v238, s[12:15], s54 offen  lds
v_mfma_f32_16x16x32_bf16 v[108:111], a[184:187], v[20:23], v[108:111]
ds_read_b64_tr_b16 a[160:161], v233 offset:16384
v_mfma_f32_16x16x32_bf16 v[108:111], a[188:191], v[64:67], v[108:111]
ds_read_b64_tr_b16 a[162:163], v233 offset:18432
v_mfma_f32_16x16x32_bf16 v[104:107], a[188:191], v[68:71], v[104:107]
ds_read_b64_tr_b16 a[164:165], v233 offset:20480
v_mfma_f32_16x16x32_bf16 v[104:107], a[184:187], v[60:63], v[104:107]
s_waitcnt lgkmcnt(7)
ds_read_b64_tr_b16 a[166:167], v233 offset:22528
v_mfma_f32_16x16x32_bf16 v[72:75], a[144:147], v[4:7], 0
ds_read_b64_tr_b16 a[168:169], v233 offset:24576
s_waitcnt vmcnt(9)
v_cmp_le_u32 vcc, v230, v255
v_mfma_f32_16x16x32_bf16 v[72:75], a[148:151], v[44:47], v[72:75]
s_and_b32 s99, vcc_lo, 0xf0
ds_read_b64_tr_b16 a[170:171], v233 offset:26624
v_mfma_f32_16x16x32_bf16 v[84:87], a[148:151], v[48:51], 0
s_andn2_b32 s98, s98, s99
ds_read_b64_tr_b16 a[172:173], v233 offset:28672
v_cvt_pk_bf16_f32 v90, v104, v105
v_mfma_f32_16x16x32_bf16 v[84:87], a[144:147], v[12:15], v[84:87]
s_waitcnt lgkmcnt(7)
ds_read_b64_tr_b16 a[174:175], v233 offset:30720
buffer_load_dwordx4 v237, s[12:15], s54 offen offset:1024  lds
v_mfma_f32_16x16x32_bf16 v[84:87], a[152:155], v[52:55], v[84:87]
s_lshl_b32 s57, s98, 16
ds_read_b64_tr_b16 a[176:177], v233 offset:32768
v_cvt_pk_bf16_f32 v91, v106, v107
v_mfma_f32_16x16x32_bf16 v[84:87], a[156:159], v[140:143], v[84:87]
s_and_b32 s57, s57, 0x100000
ds_read_b64_tr_b16 a[178:179], v233 offset:34816
v_cvt_pk_bf16_f32 v98, v108, v109
v_mfma_f32_16x16x32_bf16 v[72:75], a[156:159], v[32:35], v[72:75]
s_or_b32 s57, s57, s64
ds_read_b64_tr_b16 a[180:181], v233 offset:36864
v_cvt_pk_bf16_f32 v99, v110, v111
v_mfma_f32_16x16x32_bf16 v[72:75], a[152:155], v[16:19], v[72:75]
s_waitcnt lgkmcnt(7)
ds_read_b64_tr_b16 a[182:183], v233 offset:38912
v_mfma_f32_16x16x32_bf16 v[72:75], a[160:163], v[148:151], v[72:75]
s_mul_i32 s55, s73, 576
buffer_load_dwordx4 a[18:21], v231, s[44:47], s57 offen offset:0 sc1
ds_read_b64_tr_b16 a[184:185], v233 offset:40960
v_mfma_f32_16x16x32_bf16 v[72:75], a[164:167], v[8:11], v[72:75]
s_add_u32 s55, s55, s82
ds_read_b64_tr_b16 a[186:187], v233 offset:43008
v_mfma_f32_16x16x32_bf16 v[84:87], a[164:167], v[24:27], v[84:87]
ds_read_b64_tr_b16 a[188:189], v233 offset:45056
v_mfma_f32_16x16x32_bf16 v[84:87], a[160:163], v[156:159], v[84:87]
s_waitcnt lgkmcnt(7)
ds_read_b64_tr_b16 a[190:191], v233 offset:47104
v_mfma_f32_16x16x32_bf16 v[84:87], a[168:171], v[28:31], v[84:87]
s_barrier
ds_read_b64_tr_b16 a[144:145], v250 offset:0
v_mfma_f32_16x16x32_bf16 v[84:87], a[172:175], v[40:43], v[84:87]
s_addk_i32 m0, 0x2000
ds_read_b64_tr_b16 a[146:147], v250 offset:2048
v_mfma_f32_16x16x32_bf16 v[72:75], a[172:175], v[56:59], v[72:75]
ds_read_b64_tr_b16 a[148:149], v250 offset:4096
buffer_load_dwordx4 v238, s[12:15], s55 offen  lds
v_mfma_f32_16x16x32_bf16 v[72:75], a[168:171], v[36:39], v[72:75]
s_waitcnt lgkmcnt(7)
ds_read_b64_tr_b16 a[150:151], v250 offset:6144
v_mfma_f32_16x16x32_bf16 v[72:75], a[176:179], v[128:131], v[72:75]
ds_read_b64_tr_b16 a[152:153], v250 offset:8192
v_mfma_f32_16x16x32_bf16 v[72:75], a[180:183], v[168:171], v[72:75]
ds_read_b64_tr_b16 a[154:155], v250 offset:10240
v_mfma_f32_16x16x32_bf16 v[84:87], a[180:183], v[176:179], v[84:87]
ds_read_b64_tr_b16 a[156:157], v250 offset:12288
v_mfma_f32_16x16x32_bf16 v[84:87], a[176:179], v[132:135], v[84:87]
s_waitcnt lgkmcnt(7)
ds_read_b64_tr_b16 a[158:159], v250 offset:14336
v_mfma_f32_16x16x32_bf16 v[84:87], a[184:187], v[20:23], v[84:87]
ds_read_b64_tr_b16 a[160:161], v250 offset:16384
v_mfma_f32_16x16x32_bf16 v[84:87], a[188:191], v[64:67], v[84:87]
ds_read_b64_tr_b16 a[162:163], v250 offset:18432
v_mfma_f32_16x16x32_bf16 v[72:75], a[188:191], v[68:71], v[72:75]
ds_read_b64_tr_b16 a[164:165], v250 offset:20480
buffer_load_dwordx4 v237, s[12:15], s55 offen offset:1024  lds
v_mfma_f32_16x16x32_bf16 v[72:75], a[184:187], v[60:63], v[72:75]
s_waitcnt lgkmcnt(7)
ds_read_b64_tr_b16 a[166:167], v250 offset:22528
v_mfma_f32_16x16x32_bf16 v[104:107], a[144:147], v[4:7], 0
buffer_load_dwordx4 a[82:85], v231, s[44:47], s57 offen offset:1024 sc1
ds_read_b64_tr_b16 a[168:169], v250 offset:24576
v_mfma_f32_16x16x32_bf16 v[104:107], a[148:151], v[44:47], v[104:107]
s_lshl_b32 s57, s98, 15
ds_read_b64_tr_b16 a[170:171], v250 offset:26624
v_mfma_f32_16x16x32_bf16 v[108:111], a[148:151], v[48:51], 0
s_and_b32 s57, s57, 0x100000
ds_read_b64_tr_b16 a[172:173], v250 offset:28672
v_cvt_pk_bf16_f32 v88, v72, v73
v_mfma_f32_16x16x32_bf16 v[108:111], a[144:147], v[12:15], v[108:111]
s_waitcnt lgkmcnt(7)
ds_read_b64_tr_b16 a[174:175], v250 offset:30720
v_cvt_pk_bf16_f32 v89, v74, v75
v_mfma_f32_16x16x32_bf16 v[108:111], a[152:155], v[52:55], v[108:111]
s_or_b32 s57, s57, s65
ds_read_b64_tr_b16 a[176:177], v250 offset:32768
v_cvt_pk_bf16_f32 v96, v84, v85
v_mfma_f32_16x16x32_bf16 v[108:111], a[156:159], v[140:143], v[108:111]
ds_read_b64_tr_b16 a[178:179], v250 offset:34816
v_cvt_pk_bf16_f32 v97, v86, v87
v_mfma_f32_16x16x32_bf16 v[104:107], a[156:159], v[32:35], v[104:107]
buffer_store_dwordx4 v[88:91], v236, s[32:35], s56 offen offset:0 sc1
ds_read_b64_tr_b16 a[180:181], v250 offset:36864
v_mfma_f32_16x16x32_bf16 v[104:107], a[152:155], v[16:19], v[104:107]
s_waitcnt lgkmcnt(7)
ds_read_b64_tr_b16 a[182:183], v250 offset:38912
v_mfma_f32_16x16x32_bf16 v[104:107], a[160:163], v[148:151], v[104:107]
ds_read_b64_tr_b16 a[184:185], v250 offset:40960
v_mfma_f32_16x16x32_bf16 v[104:107], a[164:167], v[8:11], v[104:107]
ds_read_b64_tr_b16 a[186:187], v250 offset:43008
v_mfma_f32_16x16x32_bf16 v[108:111], a[164:167], v[24:27], v[108:111]
buffer_store_dwordx4 v[96:99], v236, s[32:35], s56 offen offset:1024 sc1
ds_read_b64_tr_b16 a[188:189], v250 offset:45056
v_mfma_f32_16x16x32_bf16 v[108:111], a[160:163], v[156:159], v[108:111]
s_waitcnt lgkmcnt(7)
ds_read_b64_tr_b16 a[190:191], v250 offset:47104
v_mfma_f32_16x16x32_bf16 v[108:111], a[168:171], v[28:31], v[108:111]
s_add_u32 s56, s51, 7
ds_read_b64_tr_b16 a[144:145], v245 offset:0
v_mfma_f32_16x16x32_bf16 v[108:111], a[172:175], v[40:43], v[108:111]
s_and_b32 s56, s56, 7
ds_read_b64_tr_b16 a[146:147], v245 offset:2048
v_mfma_f32_16x16x32_bf16 v[104:107], a[172:175], v[56:59], v[104:107]
s_add_u32 s56, s56, 1
ds_read_b64_tr_b16 a[148:149], v245 offset:4096
v_mfma_f32_16x16x32_bf16 v[104:107], a[168:171], v[36:39], v[104:107]
s_waitcnt lgkmcnt(7)
ds_read_b64_tr_b16 a[150:151], v245 offset:6144
v_mfma_f32_16x16x32_bf16 v[104:107], a[176:179], v[128:131], v[104:107]
s_lshr_b32 s86, s100, s56
buffer_load_dwordx4 a[22:25], v231, s[44:47], s57 offen offset:0 sc1
ds_read_b64_tr_b16 a[152:153], v245 offset:8192
v_mfma_f32_16x16x32_bf16 v[104:107], a[180:183], v[168:171], v[104:107]
s_and_b32 s86, s86, 0x2000
ds_read_b64_tr_b16 a[154:155], v245 offset:10240
v_mfma_f32_16x16x32_bf16 v[108:111], a[180:183], v[176:179], v[108:111]
s_lshl_b32 s56, s56, 19
ds_read_b64_tr_b16 a[156:157], v245 offset:12288
v_mfma_f32_16x16x32_bf16 v[108:111], a[176:179], v[132:135], v[108:111]
s_waitcnt lgkmcnt(7)
ds_read_b64_tr_b16 a[158:159], v245 offset:14336
v_mfma_f32_16x16x32_bf16 v[108:111], a[184:187], v[20:23], v[108:111]
s_add_u32 s56, s56, s83
ds_read_b64_tr_b16 a[160:161], v245 offset:16384
v_mfma_f32_16x16x32_bf16 v[108:111], a[188:191], v[64:67], v[108:111]
s_add_u32 s56, s56, s86
ds_read_b64_tr_b16 a[162:163], v245 offset:18432
v_mov_b32 v254, 14
v_mfma_f32_16x16x32_bf16 v[104:107], a[188:191], v[68:71], v[104:107]
ds_read_b64_tr_b16 a[164:165], v245 offset:20480
v_mfma_f32_16x16x32_bf16 v[104:107], a[184:187], v[60:63], v[104:107]
s_waitcnt lgkmcnt(7)
ds_read_b64_tr_b16 a[166:167], v245 offset:22528
v_mfma_f32_16x16x32_bf16 v[72:75], a[144:147], v[4:7], 0
ds_read_b64_tr_b16 a[168:169], v245 offset:24576
v_mfma_f32_16x16x32_bf16 v[72:75], a[148:151], v[44:47], v[72:75]
ds_read_b64_tr_b16 a[170:171], v245 offset:26624
v_mfma_f32_16x16x32_bf16 v[84:87], a[148:151], v[48:51], 0
ds_read_b64_tr_b16 a[172:173], v245 offset:28672
v_cvt_pk_bf16_f32 v88, v104, v105
v_mfma_f32_16x16x32_bf16 v[84:87], a[144:147], v[12:15], v[84:87]
s_waitcnt lgkmcnt(7)
ds_read_b64_tr_b16 a[174:175], v245 offset:30720
v_cvt_pk_bf16_f32 v89, v106, v107
v_mfma_f32_16x16x32_bf16 v[84:87], a[152:155], v[52:55], v[84:87]
ds_read_b64_tr_b16 a[176:177], v245 offset:32768
v_cvt_pk_bf16_f32 v96, v108, v109
v_mfma_f32_16x16x32_bf16 v[84:87], a[156:159], v[140:143], v[84:87]
ds_read_b64_tr_b16 a[178:179], v245 offset:34816
v_cvt_pk_bf16_f32 v97, v110, v111
v_mfma_f32_16x16x32_bf16 v[72:75], a[156:159], v[32:35], v[72:75]
ds_read_b64_tr_b16 a[180:181], v245 offset:36864
v_mfma_f32_16x16x32_bf16 v[72:75], a[152:155], v[16:19], v[72:75]
s_waitcnt lgkmcnt(7)
ds_read_b64_tr_b16 a[182:183], v245 offset:38912
v_mfma_f32_16x16x32_bf16 v[72:75], a[160:163], v[148:151], v[72:75]
buffer_load_dwordx4 a[86:89], v231, s[44:47], s57 offen offset:1024 sc1
ds_read_b64_tr_b16 a[184:185], v245 offset:40960
v_mfma_f32_16x16x32_bf16 v[72:75], a[164:167], v[8:11], v[72:75]
s_lshl_b32 s57, s98, 14
ds_read_b64_tr_b16 a[186:187], v245 offset:43008
v_mfma_f32_16x16x32_bf16 v[84:87], a[164:167], v[24:27], v[84:87]
s_and_b32 s57, s57, 0x100000
ds_read_b64_tr_b16 a[188:189], v245 offset:45056
v_mfma_f32_16x16x32_bf16 v[84:87], a[160:163], v[156:159], v[84:87]
s_waitcnt lgkmcnt(7)
ds_read_b64_tr_b16 a[190:191], v245 offset:47104
v_mfma_f32_16x16x32_bf16 v[84:87], a[168:171], v[28:31], v[84:87]
s_or_b32 s57, s57, s66
ds_read_b64_tr_b16 a[144:145], v244 offset:0
v_mfma_f32_16x16x32_bf16 v[84:87], a[172:175], v[40:43], v[84:87]
ds_read_b64_tr_b16 a[146:147], v244 offset:2048
v_mfma_f32_16x16x32_bf16 v[72:75], a[172:175], v[56:59], v[72:75]
ds_read_b64_tr_b16 a[148:149], v244 offset:4096
v_mfma_f32_16x16x32_bf16 v[72:75], a[168:171], v[36:39], v[72:75]
s_waitcnt lgkmcnt(7)
ds_read_b64_tr_b16 a[150:151], v244 offset:6144
v_mfma_f32_16x16x32_bf16 v[72:75], a[176:179], v[128:131], v[72:75]
ds_read_b64_tr_b16 a[152:153], v244 offset:8192
v_mfma_f32_16x16x32_bf16 v[72:75], a[180:183], v[168:171], v[72:75]
ds_read_b64_tr_b16 a[154:155], v244 offset:10240
v_mfma_f32_16x16x32_bf16 v[84:87], a[180:183], v[176:179], v[84:87]
ds_read_b64_tr_b16 a[156:157], v244 offset:12288
v_mfma_f32_16x16x32_bf16 v[84:87], a[176:179], v[132:135], v[84:87]
s_waitcnt lgkmcnt(7)
ds_read_b64_tr_b16 a[158:159], v244 offset:14336
v_mfma_f32_16x16x32_bf16 v[84:87], a[184:187], v[20:23], v[84:87]
ds_read_b64_tr_b16 a[160:161], v244 offset:16384
v_mfma_f32_16x16x32_bf16 v[84:87], a[188:191], v[64:67], v[84:87]
ds_read_b64_tr_b16 a[162:163], v244 offset:18432
v_mfma_f32_16x16x32_bf16 v[72:75], a[188:191], v[68:71], v[72:75]
ds_read_b64_tr_b16 a[164:165], v244 offset:20480
v_mfma_f32_16x16x32_bf16 v[72:75], a[184:187], v[60:63], v[72:75]
s_waitcnt lgkmcnt(7)
ds_read_b64_tr_b16 a[166:167], v244 offset:22528
v_mfma_f32_16x16x32_bf16 v[104:107], a[144:147], v[4:7], 0
buffer_load_dwordx4 a[26:29], v231, s[44:47], s57 offen offset:0 sc1
ds_read_b64_tr_b16 a[168:169], v244 offset:24576
v_mfma_f32_16x16x32_bf16 v[104:107], a[148:151], v[44:47], v[104:107]
ds_read_b64_tr_b16 a[170:171], v244 offset:26624
v_mfma_f32_16x16x32_bf16 v[108:111], a[148:151], v[48:51], 0
s_waitcnt vmcnt(3)
ds_read_b64_tr_b16 a[172:173], v244 offset:28672
v_cvt_pk_bf16_f32 v90, v72, v73
v_mfma_f32_16x16x32_bf16 v[108:111], a[144:147], v[12:15], v[108:111]
s_waitcnt lgkmcnt(7)
ds_read_b64_tr_b16 a[174:175], v244 offset:30720
v_cvt_pk_bf16_f32 v91, v74, v75
v_mfma_f32_16x16x32_bf16 v[108:111], a[152:155], v[52:55], v[108:111]
ds_read_b64_tr_b16 a[176:177], v244 offset:32768
v_cvt_pk_bf16_f32 v98, v84, v85
v_mfma_f32_16x16x32_bf16 v[108:111], a[156:159], v[140:143], v[108:111]
ds_read_b64_tr_b16 a[178:179], v244 offset:34816
v_cvt_pk_bf16_f32 v99, v86, v87
v_mfma_f32_16x16x32_bf16 v[104:107], a[156:159], v[32:35], v[104:107]
buffer_store_dword v254, v223, s[32:35], 0 offen sc1
ds_read_b64_tr_b16 a[180:181], v244 offset:36864
v_mfma_f32_16x16x32_bf16 v[104:107], a[152:155], v[16:19], v[104:107]
s_waitcnt lgkmcnt(7)
buffer_store_dwordx4 v[88:91], v253, s[32:35], s56 offen offset:0 sc1
ds_read_b64_tr_b16 a[182:183], v244 offset:38912
v_mfma_f32_16x16x32_bf16 v[104:107], a[160:163], v[148:151], v[104:107]
ds_read_b64_tr_b16 a[184:185], v244 offset:40960
v_mfma_f32_16x16x32_bf16 v[104:107], a[164:167], v[8:11], v[104:107]
ds_read_b64_tr_b16 a[186:187], v244 offset:43008
v_mfma_f32_16x16x32_bf16 v[108:111], a[164:167], v[24:27], v[108:111]
buffer_store_dwordx4 v[96:99], v253, s[32:35], s56 offen offset:1024 sc1
ds_read_b64_tr_b16 a[188:189], v244 offset:45056
v_mfma_f32_16x16x32_bf16 v[108:111], a[160:163], v[156:159], v[108:111]
s_waitcnt lgkmcnt(7)
ds_read_b64_tr_b16 a[190:191], v244 offset:47104
v_mfma_f32_16x16x32_bf16 v[108:111], a[168:171], v[28:31], v[108:111]
ds_read_b64_tr_b16 a[144:145], v243 offset:0
v_mfma_f32_16x16x32_bf16 v[108:111], a[172:175], v[40:43], v[108:111]
ds_read_b64_tr_b16 a[146:147], v243 offset:2048
v_mfma_f32_16x16x32_bf16 v[104:107], a[172:175], v[56:59], v[104:107]
ds_read_b64_tr_b16 a[148:149], v243 offset:4096
v_mfma_f32_16x16x32_bf16 v[104:107], a[168:171], v[36:39], v[104:107]
s_waitcnt lgkmcnt(7)
ds_read_b64_tr_b16 a[150:151], v243 offset:6144
v_mfma_f32_16x16x32_bf16 v[104:107], a[176:179], v[128:131], v[104:107]
buffer_load_dwordx4 a[90:93], v231, s[44:47], s57 offen offset:1024 sc1
ds_read_b64_tr_b16 a[152:153], v243 offset:8192
v_mfma_f32_16x16x32_bf16 v[104:107], a[180:183], v[168:171], v[104:107]
ds_read_b64_tr_b16 a[154:155], v243 offset:10240
v_mov_b32 v255, 0
v_mfma_f32_16x16x32_bf16 v[108:111], a[180:183], v[176:179], v[108:111]
ds_read_b64_tr_b16 a[156:157], v243 offset:12288
v_mfma_f32_16x16x32_bf16 v[108:111], a[176:179], v[132:135], v[108:111]
s_waitcnt lgkmcnt(7)
ds_read_b64_tr_b16 a[158:159], v243 offset:14336
v_mfma_f32_16x16x32_bf16 v[108:111], a[184:187], v[20:23], v[108:111]
ds_read_b64_tr_b16 a[160:161], v243 offset:16384
v_mfma_f32_16x16x32_bf16 v[108:111], a[188:191], v[64:67], v[108:111]
ds_read_b64_tr_b16 a[162:163], v243 offset:18432
v_mfma_f32_16x16x32_bf16 v[104:107], a[188:191], v[68:71], v[104:107]
ds_read_b64_tr_b16 a[164:165], v243 offset:20480
v_mfma_f32_16x16x32_bf16 v[104:107], a[184:187], v[60:63], v[104:107]
s_waitcnt lgkmcnt(7)
ds_read_b64_tr_b16 a[166:167], v243 offset:22528
v_mfma_f32_16x16x32_bf16 v[72:75], a[144:147], v[4:7], 0
ds_read_b64_tr_b16 a[168:169], v243 offset:24576
v_mfma_f32_16x16x32_bf16 v[72:75], a[148:151], v[44:47], v[72:75]
ds_read_b64_tr_b16 a[170:171], v243 offset:26624
v_mfma_f32_16x16x32_bf16 v[84:87], a[148:151], v[48:51], 0
ds_read_b64_tr_b16 a[172:173], v243 offset:28672
s_mov_b64 exec, 0x300
buffer_atomic_add v255, v229, s[32:35], 0 offen sc0 sc1
s_mov_b64 exec, -1
v_mfma_f32_16x16x32_bf16 v[84:87], a[144:147], v[12:15], v[84:87]
s_waitcnt lgkmcnt(7)
ds_read_b64_tr_b16 a[174:175], v243 offset:30720
v_cvt_pk_bf16_f32 v90, v104, v105
v_mfma_f32_16x16x32_bf16 v[84:87], a[152:155], v[52:55], v[84:87]
s_lshl_b32 s57, s98, 13
ds_read_b64_tr_b16 a[176:177], v243 offset:32768
v_cvt_pk_bf16_f32 v91, v106, v107
v_mfma_f32_16x16x32_bf16 v[84:87], a[156:159], v[140:143], v[84:87]
s_and_b32 s57, s57, 0x100000
ds_read_b64_tr_b16 a[178:179], v243 offset:34816
v_cvt_pk_bf16_f32 v98, v108, v109
v_mfma_f32_16x16x32_bf16 v[72:75], a[156:159], v[32:35], v[72:75]
s_or_b32 s57, s57, s4
ds_read_b64_tr_b16 a[180:181], v243 offset:36864
v_cvt_pk_bf16_f32 v99, v110, v111
v_mfma_f32_16x16x32_bf16 v[72:75], a[152:155], v[16:19], v[72:75]
s_waitcnt lgkmcnt(7)
ds_read_b64_tr_b16 a[182:183], v243 offset:38912
v_mfma_f32_16x16x32_bf16 v[72:75], a[160:163], v[148:151], v[72:75]
buffer_load_dwordx4 a[30:33], v231, s[44:47], s57 offen offset:0 sc1
ds_read_b64_tr_b16 a[184:185], v243 offset:40960
v_mfma_f32_16x16x32_bf16 v[72:75], a[164:167], v[8:11], v[72:75]
ds_read_b64_tr_b16 a[186:187], v243 offset:43008
v_mfma_f32_16x16x32_bf16 v[84:87], a[164:167], v[24:27], v[84:87]
ds_read_b64_tr_b16 a[188:189], v243 offset:45056
v_mfma_f32_16x16x32_bf16 v[84:87], a[160:163], v[156:159], v[84:87]
s_waitcnt lgkmcnt(7)
ds_read_b64_tr_b16 a[190:191], v243 offset:47104
v_mfma_f32_16x16x32_bf16 v[84:87], a[168:171], v[28:31], v[84:87]
s_barrier
ds_read_b64_tr_b16 a[144:145], v242 offset:0
v_mfma_f32_16x16x32_bf16 v[84:87], a[172:175], v[40:43], v[84:87]
ds_read_b64_tr_b16 a[146:147], v242 offset:2048
v_mfma_f32_16x16x32_bf16 v[72:75], a[172:175], v[56:59], v[72:75]
LF_p11:
s_cbranch_execz LF_v0
ds_read_b64_tr_b16 a[148:149], v242 offset:4096
v_mfma_f32_16x16x32_bf16 v[72:75], a[168:171], v[36:39], v[72:75]
s_waitcnt lgkmcnt(7)
ds_read_b64_tr_b16 a[150:151], v242 offset:6144
v_mfma_f32_16x16x32_bf16 v[72:75], a[176:179], v[128:131], v[72:75]
ds_read_b64_tr_b16 a[152:153], v242 offset:8192
v_mfma_f32_16x16x32_bf16 v[72:75], a[180:183], v[168:171], v[72:75]
ds_read_b64_tr_b16 a[154:155], v242 offset:10240
v_mfma_f32_16x16x32_bf16 v[84:87], a[180:183], v[176:179], v[84:87]
ds_read_b64_tr_b16 a[156:157], v242 offset:12288
v_mfma_f32_16x16x32_bf16 v[84:87], a[176:179], v[132:135], v[84:87]
s_waitcnt lgkmcnt(7)
ds_read_b64_tr_b16 a[158:159], v242 offset:14336
v_mfma_f32_16x16x32_bf16 v[84:87], a[184:187], v[20:23], v[84:87]
ds_read_b64_tr_b16 a[160:161], v242 offset:16384
v_mfma_f32_16x16x32_bf16 v[84:87], a[188:191], v[64:67], v[84:87]
ds_read_b64_tr_b16 a[162:163], v242 offset:18432
v_mfma_f32_16x16x32_bf16 v[72:75], a[188:191], v[68:71], v[72:75]
ds_read_b64_tr_b16 a[164:165], v242 offset:20480
v_mfma_f32_16x16x32_bf16 v[72:75], a[184:187], v[60:63], v[72:75]
s_waitcnt lgkmcnt(7)
ds_read_b64_tr_b16 a[166:167], v242 offset:22528
v_mfma_f32_16x16x32_bf16 v[104:107], a[144:147], v[4:7], 0
buffer_load_dwordx4 a[94:97], v231, s[44:47], s57 offen offset:1024 sc1
ds_read_b64_tr_b16 a[168:169], v242 offset:24576
v_mfma_f32_16x16x32_bf16 v[104:107], a[148:151], v[44:47], v[104:107]
ds_read_b64_tr_b16 a[170:171], v242 offset:26624
v_mfma_f32_16x16x32_bf16 v[108:111], a[148:151], v[48:51], 0
ds_read_b64_tr_b16 a[172:173], v242 offset:28672
v_cvt_pk_bf16_f32 v88, v72, v73
v_mfma_f32_16x16x32_bf16 v[108:111], a[144:147], v[12:15], v[108:111]
s_waitcnt lgkmcnt(7)
ds_read_b64_tr_b16 a[174:175], v242 offset:30720
v_cvt_pk_bf16_f32 v89, v74, v75
v_mfma_f32_16x16x32_bf16 v[108:111], a[152:155], v[52:55], v[108:111]
ds_read_b64_tr_b16 a[176:177], v242 offset:32768
v_cvt_pk_bf16_f32 v96, v84, v85
v_mfma_f32_16x16x32_bf16 v[108:111], a[156:159], v[140:143], v[108:111]
ds_read_b64_tr_b16 a[178:179], v242 offset:34816
v_cvt_pk_bf16_f32 v97, v86, v87
v_mfma_f32_16x16x32_bf16 v[104:107], a[156:159], v[32:35], v[104:107]
buffer_store_dwordx4 v[88:91], v236, s[32:35], s56 offen offset:0 sc1
ds_read_b64_tr_b16 a[180:181], v242 offset:36864
v_mfma_f32_16x16x32_bf16 v[104:107], a[152:155], v[16:19], v[104:107]
s_waitcnt lgkmcnt(7)
ds_read_b64_tr_b16 a[182:183], v242 offset:38912
v_mfma_f32_16x16x32_bf16 v[104:107], a[160:163], v[148:151], v[104:107]
ds_read_b64_tr_b16 a[184:185], v242 offset:40960
v_mfma_f32_16x16x32_bf16 v[104:107], a[164:167], v[8:11], v[104:107]
ds_read_b64_tr_b16 a[186:187], v242 offset:43008
v_mfma_f32_16x16x32_bf16 v[108:111], a[164:167], v[24:27], v[108:111]
buffer_store_dwordx4 v[96:99], v236, s[32:35], s56 offen offset:1024 sc1
ds_read_b64_tr_b16 a[188:189], v242 offset:45056
v_mfma_f32_16x16x32_bf16 v[108:111], a[160:163], v[156:159], v[108:111]
s_waitcnt lgkmcnt(7)
ds_read_b64_tr_b16 a[190:191], v242 offset:47104
v_mfma_f32_16x16x32_bf16 v[108:111], a[168:171], v[28:31], v[108:111]
s_add_u32 s56, s51, 8
ds_read_b64_tr_b16 a[144:145], v241 offset:0
v_mfma_f32_16x16x32_bf16 v[108:111], a[172:175], v[40:43], v[108:111]
s_and_b32 s56, s56, 7
ds_read_b64_tr_b16 a[146:147], v241 offset:2048
v_mfma_f32_16x16x32_bf16 v[104:107], a[172:175], v[56:59], v[104:107]
s_add_u32 s56, s56, 1
ds_read_b64_tr_b16 a[148:149], v241 offset:4096
v_mfma_f32_16x16x32_bf16 v[104:107], a[168:171], v[36:39], v[104:107]
s_waitcnt lgkmcnt(7)
ds_read_b64_tr_b16 a[150:151], v241 offset:6144
s_waitcnt vmcnt(4)
v_cmp_le_u32 vcc, v230, v255
v_mfma_f32_16x16x32_bf16 v[104:107], a[176:179], v[128:131], v[104:107]
s_and_b32 s99, vcc_lo, 0x300
ds_read_b64_tr_b16 a[152:153], v241 offset:8192
v_mfma_f32_16x16x32_bf16 v[104:107], a[180:183], v[168:171], v[104:107]
s_andn2_b32 s98, s98, s99
ds_read_b64_tr_b16 a[154:155], v241 offset:10240
v_mfma_f32_16x16x32_bf16 v[108:111], a[180:183], v[176:179], v[108:111]
s_lshl_b32 s57, s98, 12
ds_read_b64_tr_b16 a[156:157], v241 offset:12288
v_mfma_f32_16x16x32_bf16 v[108:111], a[176:179], v[132:135], v[108:111]
s_waitcnt lgkmcnt(7)
ds_read_b64_tr_b16 a[158:159], v241 offset:14336
v_mfma_f32_16x16x32_bf16 v[108:111], a[184:187], v[20:23], v[108:111]
s_and_b32 s57, s57, 0x100000
ds_read_b64_tr_b16 a[160:161], v241 offset:16384
v_mfma_f32_16x16x32_bf16 v[108:111], a[188:191], v[64:67], v[108:111]
s_or_b32 s57, s57, s5
ds_read_b64_tr_b16 a[162:163], v241 offset:18432
v_mfma_f32_16x16x32_bf16 v[104:107], a[188:191], v[68:71], v[104:107]
s_lshr_b32 s86, s100, s56
ds_read_b64_tr_b16 a[164:165], v241 offset:20480
v_mfma_f32_16x16x32_bf16 v[104:107], a[184:187], v[60:63], v[104:107]
s_waitcnt lgkmcnt(7)
buffer_load_dwordx4 a[34:37], v231, s[44:47], s57 offen offset:0 sc1
ds_read_b64_tr_b16 a[166:167], v241 offset:22528
v_mfma_f32_16x16x32_bf16 v[72:75], a[144:147], v[4:7], 0
s_and_b32 s86, s86, 0x2000
ds_read_b64_tr_b16 a[168:169], v241 offset:24576
v_mfma_f32_16x16x32_bf16 v[72:75], a[148:151], v[44:47], v[72:75]
s_lshl_b32 s56, s56, 19
ds_read_b64_tr_b16 a[170:171], v241 offset:26624
v_mfma_f32_16x16x32_bf16 v[84:87], a[148:151], v[48:51], 0
s_add_u32 s56, s56, s83
ds_read_b64_tr_b16 a[172:173], v241 offset:28672
v_cvt_pk_bf16_f32 v88, v104, v105
v_mfma_f32_16x16x32_bf16 v[84:87], a[144:147], v[12:15], v[84:87]
s_waitcnt lgkmcnt(7)
ds_read_b64_tr_b16 a[174:175], v241 offset:30720
v_cvt_pk_bf16_f32 v89, v106, v107
v_mfma_f32_16x16x32_bf16 v[84:87], a[152:155], v[52:55], v[84:87]
s_add_u32 s56, s56, s86
ds_read_b64_tr_b16 a[176:177], v241 offset:32768
v_cvt_pk_bf16_f32 v96, v108, v109
v_mfma_f32_16x16x32_bf16 v[84:87], a[156:159], v[140:143], v[84:87]
ds_read_b64_tr_b16 a[178:179], v241 offset:34816
v_cvt_pk_bf16_f32 v97, v110, v111
v_mfma_f32_16x16x32_bf16 v[72:75], a[156:159], v[32:35], v[72:75]
ds_read_b64_tr_b16 a[180:181], v241 offset:36864
v_mov_b32 v254, 16
v_mfma_f32_16x16x32_bf16 v[72:75], a[152:155], v[16:19], v[72:75]
s_waitcnt lgkmcnt(7)
ds_read_b64_tr_b16 a[182:183], v241 offset:38912
v_mfma_f32_16x16x32_bf16 v[72:75], a[160:163], v[148:151], v[72:75]
ds_read_b64_tr_b16 a[184:185], v241 offset:40960
v_mfma_f32_16x16x32_bf16 v[72:75], a[164:167], v[8:11], v[72:75]
buffer_load_dwordx4 a[98:101], v231, s[44:47], s57 offen offset:1024 sc1
ds_read_b64_tr_b16 a[186:187], v241 offset:43008
v_mfma_f32_16x16x32_bf16 v[84:87], a[164:167], v[24:27], v[84:87]
ds_read_b64_tr_b16 a[188:189], v241 offset:45056
v_mov_b32 v255, 0
v_mfma_f32_16x16x32_bf16 v[84:87], a[160:163], v[156:159], v[84:87]
s_waitcnt lgkmcnt(7)
ds_read_b64_tr_b16 a[190:191], v241 offset:47104
s_mov_b64 exec, 0xc00
buffer_atomic_add v255, v229, s[32:35], 0 offen sc0 sc1
s_mov_b64 exec, -1
v_mfma_f32_16x16x32_bf16 v[84:87], a[168:171], v[28:31], v[84:87]
s_lshl_b32 s57, s98, 11
ds_read_b64_tr_b16 a[144:145], v240 offset:0
v_mfma_f32_16x16x32_bf16 v[84:87], a[172:175], v[40:43], v[84:87]
s_and_b32 s57, s57, 0x100000
ds_read_b64_tr_b16 a[146:147], v240 offset:2048
v_mfma_f32_16x16x32_bf16 v[72:75], a[172:175], v[56:59], v[72:75]
s_or_b32 s57, s57, s6
ds_read_b64_tr_b16 a[148:149], v240 offset:4096
v_mfma_f32_16x16x32_bf16 v[72:75], a[168:171], v[36:39], v[72:75]
s_waitcnt lgkmcnt(7)
ds_read_b64_tr_b16 a[150:151], v240 offset:6144
v_mfma_f32_16x16x32_bf16 v[72:75], a[176:179], v[128:131], v[72:75]
ds_read_b64_tr_b16 a[152:153], v240 offset:8192
v_mfma_f32_16x16x32_bf16 v[72:75], a[180:183], v[168:171], v[72:75]
ds_read_b64_tr_b16 a[154:155], v240 offset:10240
v_mfma_f32_16x16x32_bf16 v[84:87], a[180:183], v[176:179], v[84:87]
ds_read_b64_tr_b16 a[156:157], v240 offset:12288
v_mfma_f32_16x16x32_bf16 v[84:87], a[176:179], v[132:135], v[84:87]
s_waitcnt lgkmcnt(7)
buffer_load_dwordx4 a[38:41], v231, s[44:47], s57 offen offset:0 sc1
ds_read_b64_tr_b16 a[158:159], v240 offset:14336
v_mfma_f32_16x16x32_bf16 v[84:87], a[184:187], v[20:23], v[84:87]
ds_read_b64_tr_b16 a[160:161], v240 offset:16384
v_mfma_f32_16x16x32_bf16 v[84:87], a[188:191], v[64:67], v[84:87]
ds_read_b64_tr_b16 a[162:163], v240 offset:18432
v_mfma_f32_16x16x32_bf16 v[72:75], a[188:191], v[68:71], v[72:75]
ds_read_b64_tr_b16 a[164:165], v240 offset:20480
v_mfma_f32_16x16x32_bf16 v[72:75], a[184:187], v[60:63], v[72:75]
s_waitcnt lgkmcnt(7)
ds_read_b64_tr_b16 a[166:167], v240 offset:22528
v_mfma_f32_16x16x32_bf16 v[104:107], a[144:147], v[4:7], 0
ds_read_b64_tr_b16 a[168:169], v240 offset:24576
v_mfma_f32_16x16x32_bf16 v[104:107], a[148:151], v[44:47], v[104:107]
ds_read_b64_tr_b16 a[170:171], v240 offset:26624
v_mfma_f32_16x16x32_bf16 v[108:111], a[148:151], v[48:51], 0
s_waitcnt vmcnt(4)
ds_read_b64_tr_b16 a[172:173], v240 offset:28672
v_cvt_pk_bf16_f32 v90, v72, v73
v_mfma_f32_16x16x32_bf16 v[108:111], a[144:147], v[12:15], v[108:111]
s_waitcnt lgkmcnt(7)
ds_read_b64_tr_b16 a[174:175], v240 offset:30720
v_cvt_pk_bf16_f32 v91, v74, v75
v_mfma_f32_16x16x32_bf16 v[108:111], a[152:155], v[52:55], v[108:111]
ds_read_b64_tr_b16 a[176:177], v240 offset:32768
v_cvt_pk_bf16_f32 v98, v84, v85
v_mfma_f32_16x16x32_bf16 v[108:111], a[156:159], v[140:143], v[108:111]
ds_read_b64_tr_b16 a[178:179], v240 offset:34816
v_cvt_pk_bf16_f32 v99, v86, v87
v_mfma_f32_16x16x32_bf16 v[104:107], a[156:159], v[32:35], v[104:107]
buffer_load_dwordx4 a[102:105], v231, s[44:47], s57 offen offset:1024 sc1
ds_read_b64_tr_b16 a[180:181], v240 offset:36864
v_mfma_f32_16x16x32_bf16 v[104:107], a[152:155], v[16:19], v[104:107]
s_waitcnt lgkmcnt(7)
buffer_store_dword v254, v223, s[32:35], 0 offen sc1
ds_read_b64_tr_b16 a[182:183], v240 offset:38912
v_mfma_f32_16x16x32_bf16 v[104:107], a[160:163], v[148:151], v[104:107]
buffer_store_dwordx4 v[88:91], v253, s[32:35], s56 offen offset:0 sc1
ds_read_b64_tr_b16 a[184:185], v240 offset:40960
v_mfma_f32_16x16x32_bf16 v[104:107], a[164:167], v[8:11], v[104:107]
ds_read_b64_tr_b16 a[186:187], v240 offset:43008
v_mfma_f32_16x16x32_bf16 v[108:111], a[164:167], v[24:27], v[108:111]
buffer_store_dwordx4 v[96:99], v253, s[32:35], s56 offen offset:1024 sc1
ds_read_b64_tr_b16 a[188:189], v240 offset:45056
v_mfma_f32_16x16x32_bf16 v[108:111], a[160:163], v[156:159], v[108:111]
s_waitcnt lgkmcnt(7)
ds_read_b64_tr_b16 a[190:191], v240 offset:47104
v_mov_b32 v254, 17
v_mfma_f32_16x16x32_bf16 v[108:111], a[168:171], v[28:31], v[108:111]
ds_read_b64_tr_b16 a[144:145], v239 offset:0
v_mfma_f32_16x16x32_bf16 v[108:111], a[172:175], v[40:43], v[108:111]
ds_read_b64_tr_b16 a[146:147], v239 offset:2048
v_mfma_f32_16x16x32_bf16 v[104:107], a[172:175], v[56:59], v[104:107]
ds_read_b64_tr_b16 a[148:149], v239 offset:4096
v_mfma_f32_16x16x32_bf16 v[104:107], a[168:171], v[36:39], v[104:107]
s_waitcnt lgkmcnt(7)
ds_read_b64_tr_b16 a[150:151], v239 offset:6144
v_mfma_f32_16x16x32_bf16 v[104:107], a[176:179], v[128:131], v[104:107]
ds_read_b64_tr_b16 a[152:153], v239 offset:8192
v_mfma_f32_16x16x32_bf16 v[104:107], a[180:183], v[168:171], v[104:107]
ds_read_b64_tr_b16 a[154:155], v239 offset:10240
s_waitcnt vmcnt(5)
v_cmp_le_u32 vcc, v230, v255
v_mfma_f32_16x16x32_bf16 v[108:111], a[180:183], v[176:179], v[108:111]
s_and_b32 s99, vcc_lo, 0xc00
ds_read_b64_tr_b16 a[156:157], v239 offset:12288
v_mfma_f32_16x16x32_bf16 v[108:111], a[176:179], v[132:135], v[108:111]
s_waitcnt lgkmcnt(7)
ds_read_b64_tr_b16 a[158:159], v239 offset:14336
v_mfma_f32_16x16x32_bf16 v[108:111], a[184:187], v[20:23], v[108:111]
s_andn2_b32 s98, s98, s99
ds_read_b64_tr_b16 a[160:161], v239 offset:16384
v_mfma_f32_16x16x32_bf16 v[108:111], a[188:191], v[64:67], v[108:111]
s_lshl_b32 s57, s98, 10
ds_read_b64_tr_b16 a[162:163], v239 offset:18432
v_mfma_f32_16x16x32_bf16 v[104:107], a[188:191], v[68:71], v[104:107]
s_and_b32 s57, s57, 0x100000
ds_read_b64_tr_b16 a[164:165], v239 offset:20480
v_mfma_f32_16x16x32_bf16 v[104:107], a[184:187], v[60:63], v[104:107]
s_waitcnt lgkmcnt(7)
ds_read_b64_tr_b16 a[166:167], v239 offset:22528
v_mfma_f32_16x16x32_bf16 v[72:75], a[144:147], v[4:7], 0
s_or_b32 s57, s57, s7
ds_read_b64_tr_b16 a[168:169], v239 offset:24576
v_mfma_f32_16x16x32_bf16 v[72:75], a[148:151], v[44:47], v[72:75]
buffer_load_dwordx4 a[42:45], v231, s[44:47], s57 offen offset:0 sc1
ds_read_b64_tr_b16 a[170:171], v239 offset:26624
v_mfma_f32_16x16x32_bf16 v[4:7], a[148:151], v[48:51], 0
ds_read_b64_tr_b16 a[172:173], v239 offset:28672
v_mfma_f32_16x16x32_bf16 v[4:7], a[144:147], v[12:15], v[4:7]
s_waitcnt lgkmcnt(7)
ds_read_b64_tr_b16 a[174:175], v239 offset:30720
v_mfma_f32_16x16x32_bf16 v[4:7], a[152:155], v[52:55], v[4:7]
ds_read_b64_tr_b16 a[176:177], v239 offset:32768
v_mfma_f32_16x16x32_bf16 v[4:7], a[156:159], v[140:143], v[4:7]
ds_read_b64_tr_b16 a[178:179], v239 offset:34816
v_mfma_f32_16x16x32_bf16 v[72:75], a[156:159], v[32:35], v[72:75]
buffer_load_dwordx4 a[106:109], v231, s[44:47], s57 offen offset:1024 sc1
ds_read_b64_tr_b16 a[180:181], v239 offset:36864
v_mfma_f32_16x16x32_bf16 v[72:75], a[152:155], v[16:19], v[72:75]
s_waitcnt lgkmcnt(7)
ds_read_b64_tr_b16 a[182:183], v239 offset:38912
v_mfma_f32_16x16x32_bf16 v[72:75], a[160:163], v[148:151], v[72:75]
s_lshl_b32 s57, s98, 9
ds_read_b64_tr_b16 a[184:185], v239 offset:40960
v_mfma_f32_16x16x32_bf16 v[72:75], a[164:167], v[8:11], v[72:75]
s_and_b32 s57, s57, 0x100000
ds_read_b64_tr_b16 a[186:187], v239 offset:43008
v_mfma_f32_16x16x32_bf16 v[4:7], a[164:167], v[24:27], v[4:7]
s_or_b32 s57, s57, s8
ds_read_b64_tr_b16 a[188:189], v239 offset:45056
v_mfma_f32_16x16x32_bf16 v[4:7], a[160:163], v[156:159], v[4:7]
s_waitcnt lgkmcnt(7)
buffer_load_dwordx4 a[46:49], v231, s[44:47], s57 offen offset:0 sc1
ds_read_b64_tr_b16 a[190:191], v239 offset:47104
v_mfma_f32_16x16x32_bf16 v[4:7], a[168:171], v[28:31], v[4:7]
v_mfma_f32_16x16x32_bf16 v[4:7], a[172:175], v[40:43], v[4:7]
v_mfma_f32_16x16x32_bf16 v[72:75], a[172:175], v[56:59], v[72:75]
v_mfma_f32_16x16x32_bf16 v[72:75], a[168:171], v[36:39], v[72:75]
s_waitcnt lgkmcnt(4)
v_mfma_f32_16x16x32_bf16 v[72:75], a[176:179], v[128:131], v[72:75]
s_waitcnt vmcnt(3)
buffer_load_dwordx4 a[110:113], v231, s[44:47], s57 offen offset:1024 sc1
buffer_store_dword v254, v223, s[32:35], 0 offen sc1
v_mfma_f32_16x16x32_bf16 v[72:75], a[180:183], v[168:171], v[72:75]
v_mfma_f32_16x16x32_bf16 v[4:7], a[180:183], v[176:179], v[4:7]
v_mfma_f32_16x16x32_bf16 v[4:7], a[176:179], v[132:135], v[4:7]
s_waitcnt lgkmcnt(0)
v_mfma_f32_16x16x32_bf16 v[4:7], a[184:187], v[20:23], v[4:7]
v_mfma_f32_16x16x32_bf16 v[4:7], a[188:191], v[64:67], v[4:7]
v_mfma_f32_16x16x32_bf16 v[72:75], a[188:191], v[68:71], v[72:75]
v_mfma_f32_16x16x32_bf16 v[72:75], a[184:187], v[60:63], v[72:75]
v_mov_b32 v255, 0
s_mov_b64 exec, 0x7000
buffer_atomic_add v255, v229, s[32:35], 0 offen sc0 sc1
s_mov_b64 exec, -1
s_waitcnt vmcnt(0)
v_cmp_le_u32 vcc, v230, v255
s_nop 0
s_and_b32 s99, vcc_lo, 0x7000
s_andn2_b32 s98, s98, s99
s_lshl_b32 s57, s98, 8
s_and_b32 s57, s57, 0x100000
s_or_b32 s57, s57, s9
buffer_load_dwordx4 a[50:53], v231, s[44:47], s57 offen offset:0 sc1
buffer_load_dwordx4 a[114:117], v231, s[44:47], s57 offen offset:1024 sc1
s_lshl_b32 s57, s98, 7
s_and_b32 s57, s57, 0x100000
s_or_b32 s57, s57, s10
buffer_load_dwordx4 a[54:57], v231, s[44:47], s57 offen offset:0 sc1
buffer_load_dwordx4 a[118:121], v231, s[44:47], s57 offen offset:1024 sc1
s_lshl_b32 s57, s98, 6
s_and_b32 s57, s57, 0x100000
s_or_b32 s57, s57, s11
buffer_load_dwordx4 a[58:61], v231, s[44:47], s57 offen offset:0 sc1
buffer_load_dwordx4 a[122:125], v231, s[44:47], s57 offen offset:1024 sc1
s_mov_b32 s96, 0
s_mov_b32 s59, 0
s_mov_b32 s58, s98
s_branch LF_tl_n
LF_t:
v_mov_b32 v255, 0
s_mov_b32 exec_hi, 0
s_mov_b32 exec_lo, s98
buffer_atomic_add v255, v229, s[32:35], 0 offen sc0 sc1
s_mov_b64 exec, -1
s_mov_b32 s58, s98
s_waitcnt vmcnt(0)
v_cmp_le_u32 vcc, v230, v255
s_nop 0
s_and_b32 s99, vcc_lo, s98
s_andn2_b32 s98, s98, s99
s_cmp_eq_u32 s99, 0
s_cbranch_scc1 LF_tl_n
s_and_b32 s67, s99, 0xf
s_cbranch_scc0 LF_tl_g0
s_bitcmp1_b32 s99, 0
s_cbranch_scc0 LF_tl_0
buffer_load_dwordx4 a[2:5], v231, s[44:47], s60 offen offset:0 sc1
buffer_load_dwordx4 a[66:69], v231, s[44:47], s60 offen offset:1024 sc1
LF_tl_0:
s_bitcmp1_b32 s99, 1
s_cbranch_scc0 LF_tl_1
buffer_load_dwordx4 a[6:9], v231, s[44:47], s61 offen offset:0 sc1
buffer_load_dwordx4 a[70:73], v231, s[44:47], s61 offen offset:1024 sc1
LF_tl_1:
s_bitcmp1_b32 s99, 2
s_cbranch_scc0 LF_tl_2
buffer_load_dwordx4 a[10:13], v231, s[44:47], s62 offen offset:0 sc1
buffer_load_dwordx4 a[74:77], v231, s[44:47], s62 offen offset:1024 sc1
LF_tl_2:
s_bitcmp1_b32 s99, 3
s_cbranch_scc0 LF_tl_3
buffer_load_dwordx4 a[14:17], v231, s[44:47], s63 offen offset:0 sc1
buffer_load_dwordx4 a[78:81], v231, s[44:47], s63 offen offset:1024 sc1
LF_tl_3:
LF_tl_g0:
s_and_b32 s67, s99, 0xf0
s_cbranch_scc0 LF_tl_g4
s_bitcmp1_b32 s99, 4
s_cbranch_scc0 LF_tl_4
buffer_load_dwordx4 a[18:21], v231, s[44:47], s64 offen offset:0 sc1
buffer_load_dwordx4 a[82:85], v231, s[44:47], s64 offen offset:1024 sc1
LF_tl_4:
s_bitcmp1_b32 s99, 5
s_cbranch_scc0 LF_tl_5
buffer_load_dwordx4 a[22:25], v231, s[44:47], s65 offen offset:0 sc1
buffer_load_dwordx4 a[86:89], v231, s[44:47], s65 offen offset:1024 sc1
LF_tl_5:
s_bitcmp1_b32 s99, 6
s_cbranch_scc0 LF_tl_6
buffer_load_dwordx4 a[26:29], v231, s[44:47], s66 offen offset:0 sc1
buffer_load_dwordx4 a[90:93], v231, s[44:47], s66 offen offset:1024 sc1
LF_tl_6:
s_bitcmp1_b32 s99, 7
s_cbranch_scc0 LF_tl_7
buffer_load_dwordx4 a[30:33], v231, s[44:47], s4 offen offset:0 sc1
buffer_load_dwordx4 a[94:97], v231, s[44:47], s4 offen offset:1024 sc1
LF_tl_7:
LF_tl_g4:
s_and_b32 s67, s99, 0xf00
s_cbranch_scc0 LF_tl_g8
s_bitcmp1_b32 s99, 8
s_cbranch_scc0 LF_tl_8
buffer_load_dwordx4 a[34:37], v231, s[44:47], s5 offen offset:0 sc1
buffer_load_dwordx4 a[98:101], v231, s[44:47], s5 offen offset:1024 sc1
LF_tl_8:
s_bitcmp1_b32 s99, 9
s_cbranch_scc0 LF_tl_9
buffer_load_dwordx4 a[38:41], v231, s[44:47], s6 offen offset:0 sc1
buffer_load_dwordx4 a[102:105], v231, s[44:47], s6 offen offset:1024 sc1
LF_tl_9:
s_bitcmp1_b32 s99, 10
s_cbranch_scc0 LF_tl_10
buffer_load_dwordx4 a[42:45], v231, s[44:47], s7 offen offset:0 sc1
buffer_load_dwordx4 a[106:109], v231, s[44:47], s7 offen offset:1024 sc1
LF_tl_10:
s_bitcmp1_b32 s99, 11
s_cbranch_scc0 LF_tl_11
buffer_load_dwordx4 a[46:49], v231, s[44:47], s8 offen offset:0 sc1
buffer_load_dwordx4 a[110:113], v231, s[44:47], s8 offen offset:1024 sc1
LF_tl_11:
LF_tl_g8:
s_and_b32 s67, s99, 0xf000
s_cbranch_scc0 LF_tl_g12
s_bitcmp1_b32 s99, 12
s_cbranch_scc0 LF_tl_12
buffer_load_dwordx4 a[50:53], v231, s[44:47], s9 offen offset:0 sc1
buffer_load_dwordx4 a[114:117], v231, s[44:47], s9 offen offset:1024 sc1
LF_tl_12:
s_bitcmp1_b32 s99, 13
s_cbranch_scc0 LF_tl_13
buffer_load_dwordx4 a[54:57], v231, s[44:47], s10 offen offset:0 sc1
buffer_load_dwordx4 a[118:121], v231, s[44:47], s10 offen offset:1024 sc1
LF_tl_13:
s_bitcmp1_b32 s99, 14
s_cbranch_scc0 LF_tl_14
buffer_load_dwordx4 a[58:61], v231, s[44:47], s11 offen offset:0 sc1
buffer_load_dwordx4 a[122:125], v231, s[44:47], s11 offen offset:1024 sc1
LF_tl_14:
LF_tl_g12:
LF_tl_n:
s_and_b32 s67, s58, 0xfff
s_or_b32 s67, s67, s59
s_cbranch_scc1 LF_t_s
v_mfma_f32_16x16x32_bf16 v[104:107], a[224:227], a[0:3], v[104:107]
v_mfma_f32_16x16x32_bf16 v[108:111], a[224:227], a[64:67], v[108:111]
v_mfma_f32_16x16x32_bf16 v[72:75], a[224:227], a[4:7], v[72:75]
v_mfma_f32_16x16x32_bf16 v[4:7], a[224:227], a[68:71], v[4:7]
v_mfma_f32_16x16x32_bf16 v[104:107], a[224:227], a[8:11], v[104:107]
v_mfma_f32_16x16x32_bf16 v[108:111], a[224:227], a[72:75], v[108:111]
v_mfma_f32_16x16x32_bf16 v[72:75], a[224:227], a[12:15], v[72:75]
v_mfma_f32_16x16x32_bf16 v[4:7], a[224:227], a[76:79], v[4:7]
v_mfma_f32_16x16x32_bf16 v[104:107], a[224:227], a[16:19], v[104:107]
v_mfma_f32_16x16x32_bf16 v[108:111], a[224:227], a[80:83], v[108:111]
v_mfma_f32_16x16x32_bf16 v[72:75], a[224:227], a[20:23], v[72:75]
v_mfma_f32_16x16x32_bf16 v[4:7], a[224:227], a[84:87], v[4:7]
v_mfma_f32_16x16x32_bf16 v[104:107], a[224:227], a[24:27], v[104:107]
v_mfma_f32_16x16x32_bf16 v[108:111], a[224:227], a[88:91], v[108:111]
v_mfma_f32_16x16x32_bf16 v[72:75], a[224:227], a[28:31], v[72:75]
v_mfma_f32_16x16x32_bf16 v[4:7], a[224:227], a[92:95], v[4:7]
v_mfma_f32_16x16x32_bf16 v[104:107], a[224:227], a[32:35], v[104:107]
v_mfma_f32_16x16x32_bf16 v[108:111], a[224:227], a[96:99], v[108:111]
v_mfma_f32_16x16x32_bf16 v[72:75], a[224:227], a[36:39], v[72:75]
v_mfma_f32_16x16x32_bf16 v[4:7], a[224:227], a[100:103], v[4:7]
v_mfma_f32_16x16x32_bf16 v[104:107], a[224:227], a[40:43], v[104:107]
v_mfma_f32_16x16x32_bf16 v[108:111], a[224:227], a[104:107], v[108:111]
v_mfma_f32_16x16x32_bf16 v[72:75], a[224:227], a[44:47], v[72:75]
v_mfma_f32_16x16x32_bf16 v[4:7], a[224:227], a[108:111], v[4:7]
s_mov_b32 s59, 1
LF_t_s:
s_add_u32 s96, s96, 1
s_cmp_lt_u32 s96, 20000
s_cselect_b32 s67, s98, 0
s_cmp_lg_u32 s67, 0
s_cbranch_scc1 LF_t
LF_t_x:
s_cmp_lg_u32 s59, 0
s_waitcnt vmcnt(0)
s_cbranch_scc1 LF_t_h
v_mfma_f32_16x16x32_bf16 v[104:107], a[224:227], a[0:3], v[104:107]
v_mfma_f32_16x16x32_bf16 v[108:111], a[224:227], a[64:67], v[108:111]
v_mfma_f32_16x16x32_bf16 v[72:75], a[224:227], a[4:7], v[72:75]
v_mfma_f32_16x16x32_bf16 v[4:7], a[224:227], a[68:71], v[4:7]
v_mfma_f32_16x16x32_bf16 v[104:107], a[224:227], a[8:11], v[104:107]
v_mfma_f32_16x16x32_bf16 v[108:111], a[224:227], a[72:75], v[108:111]
v_mfma_f32_16x16x32_bf16 v[72:75], a[224:227], a[12:15], v[72:75]
v_mfma_f32_16x16x32_bf16 v[4:7], a[224:227], a[76:79], v[4:7]
v_mfma_f32_16x16x32_bf16 v[104:107], a[224:227], a[16:19], v[104:107]
v_mfma_f32_16x16x32_bf16 v[108:111], a[224:227], a[80:83], v[108:111]
v_mfma_f32_16x16x32_bf16 v[72:75], a[224:227], a[20:23], v[72:75]
v_mfma_f32_16x16x32_bf16 v[4:7], a[224:227], a[84:87], v[4:7]
v_mfma_f32_16x16x32_bf16 v[104:107], a[224:227], a[24:27], v[104:107]
v_mfma_f32_16x16x32_bf16 v[108:111], a[224:227], a[88:91], v[108:111]
v_mfma_f32_16x16x32_bf16 v[72:75], a[224:227], a[28:31], v[72:75]
v_mfma_f32_16x16x32_bf16 v[4:7], a[224:227], a[92:95], v[4:7]
v_mfma_f32_16x16x32_bf16 v[104:107], a[224:227], a[32:35], v[104:107]
v_mfma_f32_16x16x32_bf16 v[108:111], a[224:227], a[96:99], v[108:111]
v_mfma_f32_16x16x32_bf16 v[72:75], a[224:227], a[36:39], v[72:75]
v_mfma_f32_16x16x32_bf16 v[4:7], a[224:227], a[100:103], v[4:7]
v_mfma_f32_16x16x32_bf16 v[104:107], a[224:227], a[40:43], v[104:107]
v_mfma_f32_16x16x32_bf16 v[108:111], a[224:227], a[104:107], v[108:111]
v_mfma_f32_16x16x32_bf16 v[72:75], a[224:227], a[44:47], v[72:75]
v_mfma_f32_16x16x32_bf16 v[4:7], a[224:227], a[108:111], v[4:7]
LF_t_h:
v_mfma_f32_16x16x32_bf16 v[104:107], a[224:227], a[48:51], v[104:107]
v_mfma_f32_16x16x32_bf16 v[108:111], a[224:227], a[112:115], v[108:111]
v_mfma_f32_16x16x32_bf16 v[72:75], a[224:227], a[52:55], v[72:75]
v_mfma_f32_16x16x32_bf16 v[4:7], a[224:227], a[116:119], v[4:7]
v_mfma_f32_16x16x32_bf16 v[104:107], a[224:227], a[56:59], v[104:107]
v_mfma_f32_16x16x32_bf16 v[108:111], a[224:227], a[120:123], v[108:111]
v_mfma_f32_16x16x32_bf16 v[72:75], a[224:227], a[60:63], v[72:75]
v_mfma_f32_16x16x32_bf16 v[4:7], a[224:227], a[124:127], v[4:7]
s_nop 4
v_fmac_f32 v76, 0xbf317218, v104
v_fmac_f32 v77, 0xbf317218, v105
v_fmac_f32 v78, 0xbf317218, v106
v_fmac_f32 v79, 0xbf317218, v107
ds_write_b128 v226, v[76:79] offset:0
v_fmac_f32 v100, 0xbf317218, v72
v_fmac_f32 v101, 0xbf317218, v73
v_fmac_f32 v102, 0xbf317218, v74
v_fmac_f32 v103, 0xbf317218, v75
ds_write_b128 v225, v[100:103] offset:0
v_fmac_f32 v92, 0xbf317218, v108
v_fmac_f32 v93, 0xbf317218, v109
v_fmac_f32 v94, 0xbf317218, v110
v_fmac_f32 v95, 0xbf317218, v111
ds_write_b128 v226, v[92:95] offset:512
v_fmac_f32 v80, 0xbf317218, v4
v_fmac_f32 v81, 0xbf317218, v5
v_fmac_f32 v82, 0xbf317218, v6
v_fmac_f32 v83, 0xbf317218, v7
ds_write_b128 v225, v[80:83] offset:512
ds_read_b128 v[4:7], v224 offset:0
ds_read_b128 v[8:11], v222 offset:1024
ds_read_b128 v[12:15], v224 offset:2048
ds_read_b128 v[16:19], v222 offset:3072
s_mov_b32 s67, 0
s_waitcnt lgkmcnt(3)
buffer_store_dwordx4 v[4:7], v227, s[28:31], s67 offen sc1
s_mov_b32 s67, 18432
s_waitcnt lgkmcnt(2)
buffer_store_dwordx4 v[8:11], v227, s[28:31], s67 offen sc1
s_mov_b32 s67, 36864
s_waitcnt lgkmcnt(1)
buffer_store_dwordx4 v[12:15], v227, s[28:31], s67 offen sc1
s_mov_b32 s67, 55296
s_waitcnt lgkmcnt(0)
buffer_store_dwordx4 v[16:19], v227, s[28:31], s67 offen sc1
s_endpgm
LF_go2:
s_nop 7
s_mov_b32 s96, 0
LF_go2_l:
s_sleep 2
buffer_load_dword v229, v231, s[36:39], 0 offen sc1
s_waitcnt vmcnt(0)
v_cmp_gt_u32 vcc, 1, v229
s_nop 1
s_cbranch_vccz LF_go2_b
s_add_u32 s96, s96, 1
s_cmp_lt_u32 s96, 20000
s_cbranch_scc1 LF_go2_l
s_branch LF_go2_b
.p2align 12
LH:
s_mov_b64 exec, -1
s_mul_i32 s67, s48, 1
s_add_u32 s67, s67, s49
s_mul_i32 s86, s67, 7282
s_lshr_b32 s86, s86, 16
s_mul_i32 s86, s86, 9
s_sub_u32 s67, s67, s86
s_mul_i32 s67, s67, 128
s_mul_i32 s100, s49, 147456
s_cmp_ge_u32 s48, 9
s_cselect_b32 s86, 4608, 0
s_add_u32 s100, s100, s86
s_lshl_b32 s53, s50, 11
v_and_b32 v255, 63, v0
v_lshrrev_b32 v254, 3, v255
v_and_b32 v253, 7, v255
v_lshrrev_b32 v248, 1, v254
v_xor_b32 v248, v253, v248
v_lshlrev_b32 v252, 4, v248
v_xor_b32 v251, 64, v252
v_and_b32 v248, 4, v254
v_add_u32 v248, v254, v248
s_lshl_b32 s86, s50, 5
v_add_u32 v248, s86, v248
v_mul_u32_u24 v248, 1152, v248
v_add_u32 v250, v248, v252
v_add_u32 v248, 17408, v248
v_add_u32 v249, v248, v251
s_add_u32 s86, s67, 0
s_sub_u32 s87, s86, 1152
s_min_u32 s58, s86, s87
s_add_u32 s86, s67, 128
s_sub_u32 s87, s86, 1152
s_min_u32 s59, s86, s87
s_add_u32 s86, s67, 256
s_sub_u32 s87, s86, 1152
s_min_u32 s60, s86, s87
s_add_u32 s86, s67, 384
s_sub_u32 s87, s86, 1152
s_min_u32 s61, s86, s87
s_add_u32 s86, s67, 512
s_sub_u32 s87, s86, 1152
s_min_u32 s62, s86, s87
s_add_u32 s86, s67, 640
s_sub_u32 s87, s86, 1152
s_min_u32 s63, s86, s87
s_add_u32 s86, s67, 768
s_sub_u32 s87, s86, 1152
s_min_u32 s64, s86, s87
s_add_u32 s86, s67, 896
s_sub_u32 s87, s86, 1152
s_min_u32 s65, s86, s87
s_add_u32 s86, s67, 1024
s_sub_u32 s87, s86, 1152
s_min_u32 s66, s86, s87
s_mov_b32 s6, 2359296
s_mov_b32 s7, 0x20000
s_waitcnt lgkmcnt(0)
s_mov_b32 s4, s68
s_mov_b32 s5, s69
v_and_b32 v254, 15, v255
v_lshrrev_b32 v253, 4, v255
v_lshrrev_b32 v248, 1, v254
v_xor_b32 v248, v253, v248
v_lshlrev_b32 v248, 4, v248
v_lshl_add_u32 v248, v254, 7, v248
v_add_u32 v252, s53, v248
v_xor_b32 v251, 64, v252
v_add_u32 v243, 49152, v252
v_add_u32 v242, 49152, v251
v_add_u32 v241, 98304, v252
v_add_u32 v240, 98304, v251
v_mov_b32 v248, 0x3f803f80
v_accvgpr_write_b32 a244, v248
v_accvgpr_write_b32 a245, v248
v_accvgpr_write_b32 a246, v248
v_accvgpr_write_b32 a247, v248
s_mov_b64 s[8:9], s[88:89]
s_mov_b32 s10, 5308416
s_mov_b32 s11, 0x20000
s_mov_b64 s[12:13], s[90:91]
s_mov_b32 s14, 5308416
s_mov_b32 s15, 0x20000
s_mov_b64 s[20:21], s[78:79]
s_mov_b32 s22, 663552
s_mov_b32 s23, 0x20000
s_mov_b64 s[24:25], s[80:81]
s_mov_b32 s26, 663552
s_mov_b32 s27, 0x20000
s_bitcmp1_b32 s50, 0
s_cselect_b64 s[16:17], s[76:77], s[74:75]
s_mov_b32 s18, 663552
s_mov_b32 s19, 0x20000
s_mov_b64 s[28:29], s[92:93]
s_mov_b32 s30, 4718592
s_mov_b32 s31, 0x20000
s_mov_b64 s[36:37], s[94:95]
s_mov_b32 s38, 256
s_mov_b32 s39, 0x20000
s_mov_b64 s[32:33], s[96:97]
s_mov_b32 s34, 134217728
s_mov_b32 s35, 0x20000
s_mov_b32 s97, 0xffff0000
s_mov_b32 s46, 245760
s_mov_b32 s47, 0x20000
s_mov_b32 s98, 0x7fff
s_mov_b32 s99, 0
s_mov_b32 s51, 0
s_mov_b32 s52, 0
s_mov_b64 s[44:45], s[32:33]
s_sub_u32 s86, s49, 9
s_min_u32 s101, s49, s86
v_lshrrev_b32 v248, 2, v254
v_lshl_add_u32 v239, v248, 4, v254
v_lshlrev_b32 v239, 2, v239
v_and_b32 v248, 3, v255
v_cmp_eq_u32 s[88:89], 1, v248
v_cmp_eq_u32 s[90:91], 2, v248
v_cmp_eq_u32 s[92:93], 3, v248
s_and_b32 s86, s49, 6
s_lshl_b32 s86, s86, 1
s_lshr_b32 s87, s49, 3
s_lshl_b32 s87, s87, 1
s_add_u32 s86, s86, s87
s_and_b32 s87, s49, 1
s_add_u32 s86, s86, s87
s_min_u32 s86, s86, 14
s_mov_b32 s78, s86
s_cmp_ge_u32 s78, 9
s_cbranch_scc1 LH_f1
v_and_b32 v248, 63, v0
s_lshr_b32 s67, s50, 1
s_lshl_b32 s67, s67, 13
v_lshl_add_u32 v248, v248, 7, s67
s_mul_i32 s67, s78, 73728
s_add_u32 s67, s67, 32768
buffer_load_ubyte v247, v248, s[16:19], s67 offen
s_add_u32 s67, s67, 16384
buffer_load_ubyte v247, v248, s[16:19], s67 offen
s_add_u32 s67, s67, 16384
buffer_load_ubyte v247, v248, s[16:19], s67 offen
s_add_u32 s67, s67, 16384
s_branch LH_f2
LH_f1:
v_mul_u32_u24 v248, 9216, v0
s_mul_i32 s67, s78, 768
s_sub_u32 s67, s67, 2304
s_add_u32 s86, s67, 128
buffer_load_ubyte v247, v248, s[8:11], s86 offen
s_add_u32 s86, s67, 2359424
buffer_load_ubyte v247, v248, s[8:11], s86 offen
s_add_u32 s86, s67, 4718720
buffer_load_ubyte v247, v248, s[8:11], s86 offen
LH_f2:
v_mov_b32 v236, 0x7f817f81
v_mov_b32 v237, 0x7f817f81
v_lshlrev_b32 v248, 3, v255
s_lshl_b32 s67, s49, 9
s_sub_u32 s67, 7680, s67
s_lshl_b32 s86, s50, 13
s_add_u32 s67, s67, s86
buffer_store_dwordx2 v[236:237], v248, s[32:35], s67 offen sc1
s_add_u32 s67, s67, 32768
buffer_store_dwordx2 v[236:237], v248, s[32:35], s67 offen sc1
s_add_u32 s67, s67, 32768
buffer_store_dwordx2 v[236:237], v248, s[32:35], s67 offen sc1
s_add_u32 s67, s67, 32768
s_mul_i32 s79, s49, 6291456
s_add_u32 s79, s79, 2342912
s_lshl_b32 s86, s50, 8
s_add_u32 s79, s79, s86
v_lshrrev_b32 v238, 1, v255
v_lshlrev_b32 v238, 21, v238
v_and_b32 v237, 1, v255
v_lshl_add_u32 v238, v237, 13, v238
v_mov_b32 v236, 0
s_mov_b64 exec, 63
buffer_store_dword v236, v238, s[32:35], s79 offen sc1
s_mov_b64 exec, -1
s_lshl_b32 s67, s49, 2
v_lshl_add_u32 v235, v0, 8, s67
v_mov_b32 v234, 1
s_waitcnt vmcnt(0)
s_barrier
buffer_store_dword v234, v235, s[36:39], 0 offen sc1
s_mov_b64 exec, 63
buffer_atomic_add v236, v238, s[32:35], s79 offen sc0 sc1
s_mov_b64 exec, -1
s_barrier
s_waitcnt vmcnt(0)
s_barrier
s_cmp_lg_u32 s50, 0
s_cbranch_scc1 LH_k9
s_mov_b32 s96, 2
s_mov_b32 s68, -1
s_mov_b32 s69, -1
s_mov_b32 s70, -1
s_mov_b32 s71, -1
s_mov_b32 s72, -1
s_mov_b32 s73, -1
s_waitcnt vmcnt(0)
LH_k1:
s_mov_b64 exec, 1
s_memtime s[74:75]
s_waitcnt lgkmcnt(0)
buffer_atomic_add v236, v238, s[32:35], s79 offen sc0 sc1
s_waitcnt vmcnt(0)
s_memtime s[76:77]
s_waitcnt lgkmcnt(0)
s_sub_u32 s86, s76, s74
s_min_u32 s68, s68, s86
s_mov_b64 exec, 2
s_memtime s[74:75]
s_waitcnt lgkmcnt(0)
buffer_atomic_add v236, v238, s[32:35], s79 offen sc0 sc1
s_waitcnt vmcnt(0)
s_memtime s[76:77]
s_waitcnt lgkmcnt(0)
s_sub_u32 s86, s76, s74
s_min_u32 s69, s69, s86
s_mov_b64 exec, 4
s_memtime s[74:75]
s_waitcnt lgkmcnt(0)
buffer_atomic_add v236, v238, s[32:35], s79 offen sc0 sc1
s_waitcnt vmcnt(0)
s_memtime s[76:77]
s_waitcnt lgkmcnt(0)
s_sub_u32 s86, s76, s74
s_min_u32 s70, s70, s86
s_mov_b64 exec, 8
s_memtime s[74:75]
s_waitcnt lgkmcnt(0)
buffer_atomic_add v236, v238, s[32:35], s79 offen sc0 sc1
s_waitcnt vmcnt(0)
s_memtime s[76:77]
s_waitcnt lgkmcnt(0)
s_sub_u32 s86, s76, s74
s_min_u32 s71, s71, s86
s_mov_b64 exec, 16
s_memtime s[74:75]
s_waitcnt lgkmcnt(0)
buffer_atomic_add v236, v238, s[32:35], s79 offen sc0 sc1
s_waitcnt vmcnt(0)
s_memtime s[76:77]
s_waitcnt lgkmcnt(0)
s_sub_u32 s86, s76, s74
s_min_u32 s72, s72, s86
s_mov_b64 exec, 32
s_memtime s[74:75]
s_waitcnt lgkmcnt(0)
buffer_atomic_add v236, v238, s[32:35], s79 offen sc0 sc1
s_waitcnt vmcnt(0)
s_memtime s[76:77]
s_waitcnt lgkmcnt(0)
s_sub_u32 s86, s76, s74
s_min_u32 s73, s73, s86
s_sub_u32 s96, s96, 1
s_cmp_lg_u32 s96, 0
s_cbranch_scc1 LH_k1
s_mov_b64 exec, -1
s_mov_b32 s83, 1
s_cmp_lt_u32 s69, s68
s_cselect_b32 s86, 0x1e000, 0
s_or_b32 s83, s83, s86
s_cmp_lt_u32 s71, s70
s_cselect_b32 s86, 0x1e0000, 0
s_or_b32 s83, s83, s86
s_cmp_lt_u32 s73, s72
s_cselect_b32 s86, 0x200000, 0
s_or_b32 s83, s83, s86
v_mov_b32 v236, s83
v_mov_b32 v237, 147456
ds_write_b32 v237, v236
s_waitcnt lgkmcnt(0)
LH_k9:
s_barrier
v_mov_b32 v237, 147456
ds_read_b32 v236, v237
s_waitcnt lgkmcnt(0)
v_readfirstlane_b32 s83, v236
s_mul_i32 s2, s49, 6291456
s_lshr_b32 s86, s83, 8
s_and_b32 s86, s86, 0x2000
s_add_u32 s2, s2, s86
s_add_u32 s2, s2, s53
s_add_u32 s2, s2, 6815744
v_lshlrev_b32 v248, 4, v255
v_mov_b32 v4, 0
v_mov_b32 v5, 0
v_mov_b32 v6, 0
v_mov_b32 v7, 0
buffer_store_dwordx4 v[4:7], v248, s[32:35], s2 offen sc1
buffer_store_dwordx4 v[4:7], v248, s[32:35], s2 offen offset:1024 sc1
v_mov_b32 v234, s83
s_waitcnt vmcnt(0)
s_barrier
buffer_store_dword v234, v235, s[36:39], 0 offen offset:128 sc1
s_barrier
v_lshlrev_b32 v248, 7, v0
v_add_u32 v248, 24576, v248
v_min_u32 v248, v246, v248
v_add_co_u32 v236, vcc, v244, v248
s_nop 1
v_addc_co_u32 v237, vcc, 0, v245, vcc
global_load_ubyte v247, v[236:237], off
s_waitcnt vmcnt(0)
s_mov_b32 m0, s53
s_add_u32 s54, s100, s58
buffer_load_dwordx4 v250, s[4:7], s54 offen  lds
buffer_load_dwordx4 v249, s[4:7], s54 offen offset:1024  lds
s_addk_i32 m0, 0x2000
s_add_u32 s54, s100, s59
buffer_load_dwordx4 v250, s[4:7], s54 offen  lds
buffer_load_dwordx4 v249, s[4:7], s54 offen offset:1024  lds
s_addk_i32 m0, 0x2000
s_add_u32 s54, s100, s60
buffer_load_dwordx4 v250, s[4:7], s54 offen  lds
buffer_load_dwordx4 v249, s[4:7], s54 offen offset:1024  lds
s_addk_i32 m0, 0x2000
s_add_u32 s54, s100, s61
buffer_load_dwordx4 v250, s[4:7], s54 offen  lds
buffer_load_dwordx4 v249, s[4:7], s54 offen offset:1024  lds
s_addk_i32 m0, 0x2000
s_add_u32 s54, s100, s62
buffer_load_dwordx4 v250, s[4:7], s54 offen  lds
buffer_load_dwordx4 v249, s[4:7], s54 offen offset:1024  lds
s_waitcnt vmcnt(8)
ds_read_b128 v[4:7], v252 offset:0
ds_read_b128 v[8:11], v251 offset:0
s_addk_i32 m0, 0x2000
s_add_u32 s54, s100, s63
buffer_load_dwordx4 v250, s[4:7], s54 offen  lds
buffer_load_dwordx4 v249, s[4:7], s54 offen offset:1024  lds
s_waitcnt vmcnt(8)
ds_read_b128 v[12:15], v252 offset:8192
ds_read_b128 v[16:19], v251 offset:8192
s_waitcnt lgkmcnt(2)
v_mfma_f32_16x16x32_bf16 a[252:255], a[244:247], v[4:7], 0
v_mfma_f32_16x16x32_bf16 v[20:23], v[4:7], v[4:7], 0
v_mfma_f32_16x16x32_bf16 a[252:255], a[244:247], v[8:11], a[252:255]
v_mfma_f32_16x16x32_bf16 v[20:23], v[8:11], v[8:11], v[20:23]
s_addk_i32 m0, 0x2000
s_add_u32 s54, s100, s64
buffer_load_dwordx4 v250, s[4:7], s54 offen  lds
buffer_load_dwordx4 v249, s[4:7], s54 offen offset:1024  lds
s_waitcnt vmcnt(8)
ds_read_b128 v[4:7], v252 offset:16384
ds_read_b128 v[8:11], v251 offset:16384
s_waitcnt lgkmcnt(2)
v_mfma_f32_16x16x32_bf16 a[252:255], a[244:247], v[12:15], a[252:255]
v_mfma_f32_16x16x32_bf16 v[20:23], v[12:15], v[12:15], v[20:23]
v_mfma_f32_16x16x32_bf16 a[252:255], a[244:247], v[16:19], a[252:255]
v_mfma_f32_16x16x32_bf16 v[20:23], v[16:19], v[16:19], v[20:23]
s_addk_i32 m0, 0x2000
s_add_u32 s54, s100, s65
buffer_load_dwordx4 v250, s[4:7], s54 offen  lds
buffer_load_dwordx4 v249, s[4:7], s54 offen offset:1024  lds
s_waitcnt vmcnt(8)
ds_read_b128 v[12:15], v252 offset:24576
ds_read_b128 v[16:19], v251 offset:24576
s_waitcnt lgkmcnt(2)
v_mfma_f32_16x16x32_bf16 a[252:255], a[244:247], v[4:7], a[252:255]
v_mfma_f32_16x16x32_bf16 v[20:23], v[4:7], v[4:7], v[20:23]
v_mfma_f32_16x16x32_bf16 a[252:255], a[244:247], v[8:11], a[252:255]
v_mfma_f32_16x16x32_bf16 v[20:23], v[8:11], v[8:11], v[20:23]
s_addk_i32 m0, 0x2000
s_add_u32 s54, s100, s66
buffer_load_dwordx4 v250, s[4:7], s54 offen  lds
buffer_load_dwordx4 v249, s[4:7], s54 offen offset:1024  lds
s_waitcnt vmcnt(8)
ds_read_b128 v[4:7], v252 offset:32768
ds_read_b128 v[8:11], v251 offset:32768
s_waitcnt lgkmcnt(2)
v_mfma_f32_16x16x32_bf16 a[252:255], a[244:247], v[12:15], a[252:255]
v_mfma_f32_16x16x32_bf16 v[20:23], v[12:15], v[12:15], v[20:23]
v_mfma_f32_16x16x32_bf16 a[252:255], a[244:247], v[16:19], a[252:255]
v_mfma_f32_16x16x32_bf16 v[20:23], v[16:19], v[16:19], v[20:23]
s_addk_i32 m0, 0x2000
s_sub_u32 s100, s100, 4608
s_add_u32 s54, s100, s58
buffer_load_dwordx4 v250, s[4:7], s54 offen  lds
buffer_load_dwordx4 v249, s[4:7], s54 offen offset:1024  lds
s_waitcnt vmcnt(8)
ds_read_b128 v[12:15], v252 offset:40960
ds_read_b128 v[16:19], v251 offset:40960
s_waitcnt lgkmcnt(2)
v_mfma_f32_16x16x32_bf16 a[252:255], a[244:247], v[4:7], a[252:255]
v_mfma_f32_16x16x32_bf16 v[20:23], v[4:7], v[4:7], v[20:23]
v_mfma_f32_16x16x32_bf16 a[252:255], a[244:247], v[8:11], a[252:255]
v_mfma_f32_16x16x32_bf16 v[20:23], v[8:11], v[8:11], v[20:23]
s_addk_i32 m0, 0x2000
s_add_u32 s54, s100, s59
buffer_load_dwordx4 v250, s[4:7], s54 offen  lds
buffer_load_dwordx4 v249, s[4:7], s54 offen offset:1024  lds
s_waitcnt vmcnt(8)
ds_read_b128 v[4:7], v243 offset:0
ds_read_b128 v[8:11], v242 offset:0
s_waitcnt lgkmcnt(2)
v_mfma_f32_16x16x32_bf16 a[252:255], a[244:247], v[12:15], a[252:255]
v_mfma_f32_16x16x32_bf16 v[20:23], v[12:15], v[12:15], v[20:23]
v_mfma_f32_16x16x32_bf16 a[252:255], a[244:247], v[16:19], a[252:255]
v_mfma_f32_16x16x32_bf16 v[20:23], v[16:19], v[16:19], v[20:23]
s_addk_i32 m0, 0x2000
s_add_u32 s54, s100, s60
buffer_load_dwordx4 v250, s[4:7], s54 offen  lds
buffer_load_dwordx4 v249, s[4:7], s54 offen offset:1024  lds
s_waitcnt vmcnt(8)
ds_read_b128 v[12:15], v243 offset:8192
ds_read_b128 v[16:19], v242 offset:8192
s_waitcnt lgkmcnt(2)
v_mfma_f32_16x16x32_bf16 a[252:255], a[244:247], v[4:7], a[252:255]
v_mfma_f32_16x16x32_bf16 v[20:23], v[4:7], v[4:7], v[20:23]
v_mfma_f32_16x16x32_bf16 a[252:255], a[244:247], v[8:11], a[252:255]
v_mfma_f32_16x16x32_bf16 v[20:23], v[8:11], v[8:11], v[20:23]
s_addk_i32 m0, 0x2000
s_add_u32 s54, s100, s61
buffer_load_dwordx4 v250, s[4:7], s54 offen  lds
buffer_load_dwordx4 v249, s[4:7], s54 offen offset:1024  lds
s_waitcnt vmcnt(8)
ds_read_b128 v[4:7], v243 offset:16384
ds_read_b128 v[8:11], v242 offset:16384
s_waitcnt lgkmcnt(2)
v_mfma_f32_16x16x32_bf16 a[252:255], a[244:247], v[12:15], a[252:255]
v_mfma_f32_16x16x32_bf16 v[20:23], v[12:15], v[12:15], v[20:23]
v_mfma_f32_16x16x32_bf16 a[252:255], a[244:247], v[16:19], a[252:255]
v_mfma_f32_16x16x32_bf16 v[20:23], v[16:19], v[16:19], v[20:23]
s_addk_i32 m0, 0x2000
s_add_u32 s54, s100, s62
buffer_load_dwordx4 v250, s[4:7], s54 offen  lds
buffer_load_dwordx4 v249, s[4:7], s54 offen offset:1024  lds
s_waitcnt vmcnt(8)
ds_read_b128 v[12:15], v243 offset:24576
ds_read_b128 v[16:19], v242 offset:24576
s_waitcnt lgkmcnt(2)
v_mfma_f32_16x16x32_bf16 a[252:255], a[244:247], v[4:7], a[252:255]
v_mfma_f32_16x16x32_bf16 v[20:23], v[4:7], v[4:7], v[20:23]
v_mfma_f32_16x16x32_bf16 a[252:255], a[244:247], v[8:11], a[252:255]
v_mfma_f32_16x16x32_bf16 v[20:23], v[8:11], v[8:11], v[20:23]
s_nop 7
v_cndmask_b32 v252, v20, v21, s[88:89]
v_cndmask_b32 v252, v252, v22, s[90:91]
v_cndmask_b32 v252, v252, v23, s[92:93]
ds_bpermute_b32 v252, v239, v252
v_accvgpr_read_b32 v251, a252
v_mul_f32 v251, 0x3ae38e39, v251
v_cvt_pk_bf16_f32 v248, 0, v251
v_mul_f32 v251, v251, v251
s_addk_i32 m0, 0x2000
s_add_u32 s54, s100, s63
buffer_load_dwordx4 v250, s[4:7], s54 offen  lds
buffer_load_dwordx4 v249, s[4:7], s54 offen offset:1024  lds
s_waitcnt vmcnt(8)
ds_read_b128 v[4:7], v243 offset:32768
ds_read_b128 v[8:11], v242 offset:32768
s_waitcnt lgkmcnt(3)
v_mfma_f32_16x16x32_bf16 a[248:251], a[244:247], v[12:15], 0
s_waitcnt lgkmcnt(2)
v_mul_f32 v252, 0x3ae38e39, v252
v_sub_f32 v252, v252, v251
v_mfma_f32_16x16x32_bf16 v[20:23], v[12:15], v[12:15], 0
v_max_f32 v252, 0, v252
v_cvt_pk_bf16_f32 v252, 0, v252
v_mfma_f32_16x16x32_bf16 a[248:251], a[244:247], v[16:19], a[248:251]
v_add_f32 v252, 0x3727c5ac, v252
v_cvt_pk_bf16_f32 v252, 0, v252
v_mfma_f32_16x16x32_bf16 v[20:23], v[16:19], v[16:19], v[20:23]
v_sqrt_f32 v252, v252
s_nop 0
v_cvt_pk_bf16_f32 v252, 0, v252
v_rcp_f32 v251, v252
s_addk_i32 m0, 0x2000
s_add_u32 s54, s100, s64
buffer_load_dwordx4 v250, s[4:7], s54 offen  lds
buffer_load_dwordx4 v249, s[4:7], s54 offen offset:1024  lds
s_waitcnt vmcnt(8)
ds_read_b128 v[12:15], v243 offset:40960
ds_read_b128 v[16:19], v242 offset:40960
s_waitcnt lgkmcnt(2)
v_mfma_f32_16x16x32_bf16 a[248:251], a[244:247], v[4:7], a[248:251]
v_mfma_f32_16x16x32_bf16 v[20:23], v[4:7], v[4:7], v[20:23]
v_mfma_f32_16x16x32_bf16 a[248:251], a[244:247], v[8:11], a[248:251]
v_mfma_f32_16x16x32_bf16 v[20:23], v[8:11], v[8:11], v[20:23]
s_addk_i32 m0, 0x2000
s_add_u32 s54, s100, s65
buffer_load_dwordx4 v250, s[4:7], s54 offen  lds
buffer_load_dwordx4 v249, s[4:7], s54 offen offset:1024  lds
s_waitcnt vmcnt(8)
ds_read_b128 v[4:7], v241 offset:0
ds_read_b128 v[8:11], v240 offset:0
s_waitcnt lgkmcnt(2)
v_mfma_f32_16x16x32_bf16 a[248:251], a[244:247], v[12:15], a[248:251]
v_mfma_f32_16x16x32_bf16 v[20:23], v[12:15], v[12:15], v[20:23]
v_mfma_f32_16x16x32_bf16 a[248:251], a[244:247], v[16:19], a[248:251]
v_mfma_f32_16x16x32_bf16 v[20:23], v[16:19], v[16:19], v[20:23]
s_addk_i32 m0, 0x2000
s_add_u32 s54, s100, s66
buffer_load_dwordx4 v250, s[4:7], s54 offen  lds
buffer_load_dwordx4 v249, s[4:7], s54 offen offset:1024  lds
s_waitcnt vmcnt(8)
ds_read_b128 v[12:15], v241 offset:8192
ds_read_b128 v[16:19], v240 offset:8192
s_waitcnt lgkmcnt(2)
v_mfma_f32_16x16x32_bf16 a[248:251], a[244:247], v[4:7], a[248:251]
v_mfma_f32_16x16x32_bf16 v[20:23], v[4:7], v[4:7], v[20:23]
v_mfma_f32_16x16x32_bf16 a[248:251], a[244:247], v[8:11], a[248:251]
v_mfma_f32_16x16x32_bf16 v[20:23], v[8:11], v[8:11], v[20:23]
s_waitcnt vmcnt(6)
ds_read_b128 v[4:7], v241 offset:16384
ds_read_b128 v[8:11], v240 offset:16384
s_waitcnt lgkmcnt(2)
v_mfma_f32_16x16x32_bf16 a[248:251], a[244:247], v[12:15], a[248:251]
v_mfma_f32_16x16x32_bf16 v[20:23], v[12:15], v[12:15], v[20:23]
v_mfma_f32_16x16x32_bf16 a[248:251], a[244:247], v[16:19], a[248:251]
v_mfma_f32_16x16x32_bf16 v[20:23], v[16:19], v[16:19], v[20:23]
s_waitcnt vmcnt(4)
ds_read_b128 v[12:15], v241 offset:24576
ds_read_b128 v[16:19], v240 offset:24576
s_waitcnt lgkmcnt(2)
v_mfma_f32_16x16x32_bf16 a[248:251], a[244:247], v[4:7], a[248:251]
v_mfma_f32_16x16x32_bf16 v[20:23], v[4:7], v[4:7], v[20:23]
v_mfma_f32_16x16x32_bf16 a[248:251], a[244:247], v[8:11], a[248:251]
v_mfma_f32_16x16x32_bf16 v[20:23], v[8:11], v[8:11], v[20:23]
s_waitcnt vmcnt(2)
ds_read_b128 v[4:7], v241 offset:32768
ds_read_b128 v[8:11], v240 offset:32768
s_waitcnt lgkmcnt(2)
v_mfma_f32_16x16x32_bf16 a[248:251], a[244:247], v[12:15], a[248:251]
v_mfma_f32_16x16x32_bf16 v[20:23], v[12:15], v[12:15], v[20:23]
v_mfma_f32_16x16x32_bf16 a[248:251], a[244:247], v[16:19], a[248:251]
v_mfma_f32_16x16x32_bf16 v[20:23], v[16:19], v[16:19], v[20:23]
s_waitcnt vmcnt(0)
ds_read_b128 v[12:15], v241 offset:40960
ds_read_b128 v[16:19], v240 offset:40960
s_waitcnt lgkmcnt(2)
v_mfma_f32_16x16x32_bf16 a[248:251], a[244:247], v[4:7], a[248:251]
v_mfma_f32_16x16x32_bf16 v[20:23], v[4:7], v[4:7], v[20:23]
v_mfma_f32_16x16x32_bf16 a[248:251], a[244:247], v[8:11], a[248:251]
v_mfma_f32_16x16x32_bf16 v[20:23], v[8:11], v[8:11], v[20:23]
s_waitcnt lgkmcnt(0)
v_mfma_f32_16x16x32_bf16 a[248:251], a[244:247], v[12:15], a[248:251]
v_mfma_f32_16x16x32_bf16 v[20:23], v[12:15], v[12:15], v[20:23]
v_mfma_f32_16x16x32_bf16 a[248:251], a[244:247], v[16:19], a[248:251]
v_mfma_f32_16x16x32_bf16 v[20:23], v[16:19], v[16:19], v[20:23]
s_nop 7
v_cndmask_b32 v252, v20, v21, s[88:89]
v_cndmask_b32 v252, v252, v22, s[90:91]
v_cndmask_b32 v252, v252, v23, s[92:93]
ds_bpermute_b32 v252, v239, v252
v_accvgpr_read_b32 v250, a248
v_mul_f32 v250, 0x3ae38e39, v250
v_cvt_pk_bf16_f32 v249, 0, v250
v_mul_f32 v250, v250, v250
s_waitcnt lgkmcnt(0)
v_mul_f32 v252, 0x3ae38e39, v252
v_sub_f32 v252, v252, v250
v_max_f32 v252, 0, v252
v_cvt_pk_bf16_f32 v252, 0, v252
v_add_f32 v252, 0x3727c5ac, v252
v_cvt_pk_bf16_f32 v252, 0, v252
v_sqrt_f32 v252, v252
s_nop 0
v_cvt_pk_bf16_f32 v252, 0, v252
v_rcp_f32 v250, v252
v_lshl_add_u32 v252, v255, 4, s53
s_mul_i32 s86, s49, 6291456
s_add_u32 s86, s86, 2097152
s_add_u32 s44, s44, s86
s_addc_u32 s45, s45, 0
s_lshl_b32 s74, s101, 6
s_add_u32 s75, s74, 32
s_add_u32 s86, s101, 1
s_sub_u32 s87, s86, 9
s_min_u32 s86, s86, s87
s_lshl_b32 s76, s86, 6
v_and_b32 v243, 12, v254
v_add_u32 v243, v254, v243
s_lshl_b32 s67, s49, 2
s_add_u32 s67, s67, s50
s_lshl_b32 s67, s67, 5
v_add_u32 v243, s67, v243
v_mul_u32_u24 v243, 1152, v243
s_lshl_b32 s67, s74, 1
v_lshl_add_u32 v242, v253, 3, s67
v_add_u32 v241, v243, v242
s_mov_b32 s67, 4608
global_load_dwordx2 v[238:239], v242, s[84:85] offset:0
buffer_load_dwordx2 v[236:237], v241, s[4:7], 0 offen offset:0
buffer_load_dwordx2 v[234:235], v241, s[4:7], s67 offen offset:0
global_load_dwordx2 v[232:233], v242, s[84:85] offset:32
buffer_load_dwordx2 v[242:243], v241, s[4:7], 0 offen offset:32
buffer_load_dwordx2 v[230:231], v241, s[4:7], s67 offen offset:32
s_waitcnt vmcnt(5)
v_lshlrev_b32 v4, 16, v238
v_and_b32 v5, s97, v238
v_lshlrev_b32 v6, 16, v239
v_and_b32 v7, s97, v239
s_waitcnt vmcnt(4)
v_lshlrev_b32 v8, 16, v236
v_sub_f32 v241, v8, v249
v_mul_f32 v241, v241, v250
v_fmac_f32 v8, v241, v4
v_and_b32 v9, s97, v236
v_sub_f32 v241, v9, v249
v_mul_f32 v241, v241, v250
v_fmac_f32 v9, v241, v5
v_lshlrev_b32 v10, 16, v237
v_sub_f32 v241, v10, v249
v_mul_f32 v241, v241, v250
v_fmac_f32 v10, v241, v6
v_and_b32 v11, s97, v237
v_sub_f32 v241, v11, v249
v_mul_f32 v241, v241, v250
v_fmac_f32 v11, v241, v7
s_waitcnt vmcnt(3)
v_lshlrev_b32 v12, 16, v234
v_sub_f32 v241, v12, v248
v_mul_f32 v241, v241, v251
v_fmac_f32 v12, v241, v4
v_and_b32 v13, s97, v234
v_sub_f32 v241, v13, v248
v_mul_f32 v241, v241, v251
v_fmac_f32 v13, v241, v5
v_lshlrev_b32 v14, 16, v235
v_sub_f32 v241, v14, v248
v_mul_f32 v241, v241, v251
v_fmac_f32 v14, v241, v6
v_and_b32 v15, s97, v235
v_sub_f32 v241, v15, v248
v_mul_f32 v241, v241, v251
v_fmac_f32 v15, v241, v7
s_waitcnt vmcnt(2)
v_lshlrev_b32 v4, 16, v232
v_and_b32 v5, s97, v232
v_lshlrev_b32 v6, 16, v233
v_and_b32 v7, s97, v233
s_waitcnt vmcnt(1)
v_lshlrev_b32 v16, 16, v242
v_sub_f32 v241, v16, v249
v_mul_f32 v241, v241, v250
v_fmac_f32 v16, v241, v4
v_and_b32 v17, s97, v242
v_sub_f32 v241, v17, v249
v_mul_f32 v241, v241, v250
v_fmac_f32 v17, v241, v5
v_lshlrev_b32 v18, 16, v243
v_sub_f32 v241, v18, v249
v_mul_f32 v241, v241, v250
v_fmac_f32 v18, v241, v6
v_and_b32 v19, s97, v243
v_sub_f32 v243, v19, v249
v_mul_f32 v243, v243, v250
v_fmac_f32 v19, v243, v7
s_waitcnt vmcnt(0)
v_lshlrev_b32 v20, 16, v230
v_sub_f32 v243, v20, v248
v_mul_f32 v243, v243, v251
v_fmac_f32 v20, v243, v4
v_and_b32 v21, s97, v230
v_sub_f32 v243, v21, v248
v_mul_f32 v243, v243, v251
v_fmac_f32 v21, v243, v5
v_lshlrev_b32 v22, 16, v231
v_sub_f32 v243, v22, v248
v_mul_f32 v243, v243, v251
v_fmac_f32 v22, v243, v6
v_and_b32 v23, s97, v231
v_sub_f32 v243, v23, v248
v_mul_f32 v243, v243, v251
v_fmac_f32 v23, v243, v7
v_and_b32 v243, 12, v254
v_add_u32 v243, v254, v243
s_lshl_b32 s67, s49, 2
s_add_u32 s67, s67, s50
s_lshl_b32 s67, s67, 5
v_add_u32 v243, s67, v243
v_mul_u32_u24 v243, 1152, v243
s_lshl_b32 s67, s75, 1
v_lshl_add_u32 v242, v253, 3, s67
v_add_u32 v241, v243, v242
s_mov_b32 s67, 4608
global_load_dwordx2 v[238:239], v242, s[84:85] offset:0
buffer_load_dwordx2 v[236:237], v241, s[4:7], 0 offen offset:0
buffer_load_dwordx2 v[234:235], v241, s[4:7], s67 offen offset:0
global_load_dwordx2 v[232:233], v242, s[84:85] offset:32
buffer_load_dwordx2 v[242:243], v241, s[4:7], 0 offen offset:32
buffer_load_dwordx2 v[230:231], v241, s[4:7], s67 offen offset:32
s_waitcnt vmcnt(5)
v_lshlrev_b32 v4, 16, v238
v_and_b32 v5, s97, v238
v_lshlrev_b32 v6, 16, v239
v_and_b32 v7, s97, v239
s_waitcnt vmcnt(4)
v_lshlrev_b32 v24, 16, v236
v_sub_f32 v241, v24, v249
v_mul_f32 v241, v241, v250
v_fmac_f32 v24, v241, v4
v_and_b32 v25, s97, v236
v_sub_f32 v241, v25, v249
v_mul_f32 v241, v241, v250
v_fmac_f32 v25, v241, v5
v_lshlrev_b32 v26, 16, v237
v_sub_f32 v241, v26, v249
v_mul_f32 v241, v241, v250
v_fmac_f32 v26, v241, v6
v_and_b32 v27, s97, v237
v_sub_f32 v241, v27, v249
v_mul_f32 v241, v241, v250
v_fmac_f32 v27, v241, v7
s_waitcnt vmcnt(3)
v_lshlrev_b32 v28, 16, v234
v_sub_f32 v241, v28, v248
v_mul_f32 v241, v241, v251
v_fmac_f32 v28, v241, v4
v_and_b32 v29, s97, v234
v_sub_f32 v241, v29, v248
v_mul_f32 v241, v241, v251
v_fmac_f32 v29, v241, v5
v_lshlrev_b32 v30, 16, v235
v_sub_f32 v241, v30, v248
v_mul_f32 v241, v241, v251
v_fmac_f32 v30, v241, v6
v_and_b32 v31, s97, v235
v_sub_f32 v241, v31, v248
v_mul_f32 v241, v241, v251
v_fmac_f32 v31, v241, v7
s_waitcnt vmcnt(2)
v_lshlrev_b32 v4, 16, v232
v_and_b32 v5, s97, v232
v_lshlrev_b32 v6, 16, v233
v_and_b32 v7, s97, v233
s_waitcnt vmcnt(1)
v_lshlrev_b32 v32, 16, v242
v_sub_f32 v241, v32, v249
v_mul_f32 v241, v241, v250
v_fmac_f32 v32, v241, v4
v_and_b32 v33, s97, v242
v_sub_f32 v241, v33, v249
v_mul_f32 v241, v241, v250
v_fmac_f32 v33, v241, v5
v_lshlrev_b32 v34, 16, v243
v_sub_f32 v241, v34, v249
v_mul_f32 v241, v241, v250
v_fmac_f32 v34, v241, v6
v_and_b32 v35, s97, v243
v_sub_f32 v243, v35, v249
v_mul_f32 v243, v243, v250
v_fmac_f32 v35, v243, v7
s_waitcnt vmcnt(0)
v_lshlrev_b32 v36, 16, v230
v_sub_f32 v243, v36, v248
v_mul_f32 v243, v243, v251
v_fmac_f32 v36, v243, v4
v_and_b32 v37, s97, v230
v_sub_f32 v243, v37, v248
v_mul_f32 v243, v243, v251
v_fmac_f32 v37, v243, v5
v_lshlrev_b32 v38, 16, v231
v_sub_f32 v243, v38, v248
v_mul_f32 v243, v243, v251
v_fmac_f32 v38, v243, v6
v_and_b32 v39, s97, v231
v_sub_f32 v243, v39, v248
v_mul_f32 v243, v243, v251
v_fmac_f32 v39, v243, v7
v_and_b32 v243, 12, v254
v_add_u32 v243, v254, v243
s_lshl_b32 s67, s49, 2
s_add_u32 s67, s67, s50
s_lshl_b32 s67, s67, 5
v_add_u32 v243, s67, v243
v_mul_u32_u24 v243, 1152, v243
s_lshl_b32 s67, s76, 1
v_lshl_add_u32 v242, v253, 3, s67
v_add_u32 v241, v243, v242
s_mov_b32 s67, 4608
global_load_dwordx2 v[238:239], v242, s[84:85] offset:0
buffer_load_dwordx2 v[236:237], v241, s[4:7], 0 offen offset:0
buffer_load_dwordx2 v[234:235], v241, s[4:7], s67 offen offset:0
global_load_dwordx2 v[232:233], v242, s[84:85] offset:32
buffer_load_dwordx2 v[242:243], v241, s[4:7], 0 offen offset:32
buffer_load_dwordx2 v[230:231], v241, s[4:7], s67 offen offset:32
s_waitcnt vmcnt(5)
v_lshlrev_b32 v4, 16, v238
v_and_b32 v5, s97, v238
v_lshlrev_b32 v6, 16, v239
v_and_b32 v7, s97, v239
s_waitcnt vmcnt(4)
v_lshlrev_b32 v40, 16, v236
v_sub_f32 v241, v40, v249
v_mul_f32 v241, v241, v250
v_fmac_f32 v40, v241, v4
v_and_b32 v41, s97, v236
v_sub_f32 v241, v41, v249
v_mul_f32 v241, v241, v250
v_fmac_f32 v41, v241, v5
v_lshlrev_b32 v42, 16, v237
v_sub_f32 v241, v42, v249
v_mul_f32 v241, v241, v250
v_fmac_f32 v42, v241, v6
v_and_b32 v43, s97, v237
v_sub_f32 v241, v43, v249
v_mul_f32 v241, v241, v250
v_fmac_f32 v43, v241, v7
s_waitcnt vmcnt(3)
v_lshlrev_b32 v44, 16, v234
v_sub_f32 v241, v44, v248
v_mul_f32 v241, v241, v251
v_fmac_f32 v44, v241, v4
v_and_b32 v45, s97, v234
v_sub_f32 v241, v45, v248
v_mul_f32 v241, v241, v251
v_fmac_f32 v45, v241, v5
v_lshlrev_b32 v46, 16, v235
v_sub_f32 v241, v46, v248
v_mul_f32 v241, v241, v251
v_fmac_f32 v46, v241, v6
v_and_b32 v47, s97, v235
v_sub_f32 v241, v47, v248
v_mul_f32 v241, v241, v251
v_fmac_f32 v47, v241, v7
s_waitcnt vmcnt(2)
v_lshlrev_b32 v4, 16, v232
v_and_b32 v5, s97, v232
v_lshlrev_b32 v6, 16, v233
v_and_b32 v7, s97, v233
s_waitcnt vmcnt(1)
v_lshlrev_b32 v48, 16, v242
v_sub_f32 v241, v48, v249
v_mul_f32 v241, v241, v250
v_fmac_f32 v48, v241, v4
v_and_b32 v49, s97, v242
v_sub_f32 v241, v49, v249
v_mul_f32 v241, v241, v250
v_fmac_f32 v49, v241, v5
v_lshlrev_b32 v50, 16, v243
v_sub_f32 v241, v50, v249
v_mul_f32 v241, v241, v250
v_fmac_f32 v50, v241, v6
v_and_b32 v51, s97, v243
v_sub_f32 v243, v51, v249
v_mul_f32 v243, v243, v250
v_fmac_f32 v51, v243, v7
s_waitcnt vmcnt(0)
v_lshlrev_b32 v52, 16, v230
v_sub_f32 v250, v52, v248
v_mul_f32 v250, v250, v251
v_fmac_f32 v52, v250, v4
v_and_b32 v53, s97, v230
v_sub_f32 v250, v53, v248
v_mul_f32 v250, v250, v251
v_fmac_f32 v53, v250, v5
v_lshlrev_b32 v54, 16, v231
v_sub_f32 v250, v54, v248
v_mul_f32 v250, v250, v251
v_fmac_f32 v54, v250, v6
v_and_b32 v55, s97, v231
v_sub_f32 v250, v55, v248
v_mul_f32 v250, v250, v251
v_fmac_f32 v55, v250, v7
v_lshlrev_b32 v251, 7, v0
v_add_u32 v251, 28672, v251
v_min_u32 v251, v246, v251
v_add_co_u32 v248, vcc, v244, v251
s_nop 1
v_addc_co_u32 v249, vcc, 0, v245, vcc
global_load_ubyte v247, v[248:249], off
s_waitcnt vmcnt(0)
v_accvgpr_write_b32 a0, 0
v_accvgpr_write_b32 a1, 0
v_accvgpr_write_b32 a66, 0
v_accvgpr_write_b32 a67, 0
v_accvgpr_write_b32 a68, 0
v_accvgpr_write_b32 a69, 0
v_accvgpr_write_b32 a134, 0
v_accvgpr_write_b32 a135, 0
v_mov_b32 v56, 0
v_mov_b32 v57, 0
v_mov_b32 v122, 0
v_mov_b32 v123, 0
v_mov_b32 v124, 0
v_mov_b32 v125, 0
v_mov_b32 v190, 0
v_mov_b32 v191, 0
v_lshrrev_b32 v251, 2, v254
v_cmp_eq_u32 s[90:91], v251, v253
v_and_b32 v251, 1, v255
v_lshlrev_b32 v251, 4, v251
v_mov_b32 v250, 0x3f80
v_lshlrev_b32 v250, v251, v250
v_cndmask_b32 v250, 0, v250, s[90:91]
v_and_b32 v251, 2, v255
v_cmp_eq_u32 s[90:91], 0, v251
s_nop 1
v_cndmask_b32 v251, 0, v250, s[90:91]
v_cndmask_b32 v250, v250, 0, s[90:91]
v_accvgpr_write_b32 a224, v251
v_accvgpr_write_b32 a225, v250
v_accvgpr_write_b32 a226, v251
v_accvgpr_write_b32 a227, v250
v_lshrrev_b32 v251, 1, v255
v_sub_u32 v251, s51, v251
v_add_u32 v251, 7, v251
v_and_b32 v251, 7, v251
s_xor_b32 s67, s52, 1
v_xor_b32 v250, s67, v255
v_and_b32 v250, 1, v250
v_lshl_add_u32 v250, v251, 1, v250
v_cmp_gt_u32 s[92:93], 0, v255
s_nop 1
v_cndmask_b32 v251, 3, 1, s[92:93]
v_cmp_eq_u32 s[92:93], 0, v250
v_add_u32 v251, v251, v255
s_nop 0
v_cndmask_b32 v251, v251, 0, s[92:93]
v_cndmask_b32 v250, v250, 16, s[92:93]
s_sub_u32 s67, s2, 128
v_lshl_add_u32 v250, v250, 7, s67
v_accvgpr_write_b32 a62, 0
v_accvgpr_write_b32 a63, 0
v_accvgpr_write_b32 a64, 0
v_accvgpr_write_b32 a65, 0
v_accvgpr_write_b32 a130, 0
v_accvgpr_write_b32 a131, 0
v_accvgpr_write_b32 a132, 0
v_accvgpr_write_b32 a133, 0
v_mov_b32 v114, 0
v_mov_b32 v115, 0
v_mov_b32 v116, 0
v_mov_b32 v117, 0
v_mov_b32 v182, 0
v_mov_b32 v183, 0
v_mov_b32 v184, 0
v_mov_b32 v185, 0
s_add_u32 s40, s44, 0x40000
s_addc_u32 s41, s45, 0
s_mov_b32 s42, s46
s_mov_b32 s43, 0x20000
s_and_b32 s67, s83, 0x2000
s_add_u32 s94, s67, 229376
s_add_u32 s95, s67, 245760
s_mov_b32 s96, 0
s_sub_u32 s87, s51, 1
s_and_b32 s87, s87, 7
s_lshl_b32 s87, s87, 15
s_sub_u32 s60, s94, s87
s_sub_u32 s61, s95, s87
s_sub_u32 s87, s51, 2
s_and_b32 s87, s87, 7
s_lshl_b32 s87, s87, 15
s_sub_u32 s62, s94, s87
s_sub_u32 s63, s95, s87
s_sub_u32 s87, s51, 3
s_and_b32 s87, s87, 7
s_lshl_b32 s87, s87, 15
s_sub_u32 s64, s94, s87
s_sub_u32 s65, s95, s87
s_sub_u32 s87, s51, 4
s_and_b32 s87, s87, 7
s_lshl_b32 s87, s87, 15
s_sub_u32 s66, s94, s87
s_sub_u32 s4, s95, s87
s_sub_u32 s87, s51, 5
s_and_b32 s87, s87, 7
s_lshl_b32 s87, s87, 15
s_sub_u32 s5, s94, s87
s_sub_u32 s6, s95, s87
s_sub_u32 s87, s51, 6
s_and_b32 s87, s87, 7
s_lshl_b32 s87, s87, 15
s_sub_u32 s7, s94, s87
s_sub_u32 s8, s95, s87
s_sub_u32 s87, s51, 7
s_and_b32 s87, s87, 7
s_lshl_b32 s87, s87, 15
s_sub_u32 s9, s94, s87
s_sub_u32 s10, s95, s87
s_sub_u32 s87, s51, 8
s_and_b32 s87, s87, 7
s_lshl_b32 s87, s87, 15
s_sub_u32 s11, s94, s87
s_mov_b64 exec, 0
s_cmp_eq_u32 s50, 0
s_cbranch_scc1 LH_p12
s_cmp_eq_u32 s50, 1
s_cbranch_scc1 LH_p13
s_cmp_eq_u32 s50, 2
s_cbranch_scc1 LH_p14
s_branch LH_p15
LH_v0:
s_mov_b64 exec, -1
LH_e:
v_mov_b32 v249, 0
s_mov_b32 exec_hi, 0
s_mov_b32 exec_lo, s98
buffer_atomic_add v249, v250, s[32:35], 0 offen sc0 sc1
s_mov_b64 exec, -1
s_waitcnt vmcnt(0)
v_cmp_le_u32 vcc, 2, v249
s_nop 0
s_and_b32 s99, vcc_lo, s98
s_andn2_b32 s98, s98, s99
s_cmp_lg_u32 s99, 0
s_cbranch_scc1 LH_e1
s_sleep 6
s_branch LH_e2
LH_e1:
s_bitcmp1_b32 s99, 0
s_cbranch_scc0 LH_e_0
buffer_load_dwordx4 a[2:5], v252, s[44:47], s60 offen offset:0 sc1
buffer_load_dwordx4 a[70:73], v252, s[44:47], s60 offen offset:1024 sc1
buffer_load_dwordx4 v[62:65], v252, s[40:43], s60 offen offset:0 sc1
buffer_load_dwordx4 v[130:133], v252, s[40:43], s60 offen offset:1024 sc1
LH_e_0:
s_bitcmp1_b32 s99, 1
s_cbranch_scc0 LH_e_1
buffer_load_dwordx4 a[6:9], v252, s[44:47], s61 offen offset:0 sc1
buffer_load_dwordx4 a[74:77], v252, s[44:47], s61 offen offset:1024 sc1
buffer_load_dwordx4 v[58:61], v252, s[40:43], s61 offen offset:0 sc1
buffer_load_dwordx4 v[126:129], v252, s[40:43], s61 offen offset:1024 sc1
LH_e_1:
s_bitcmp1_b32 s99, 2
s_cbranch_scc0 LH_e_2
buffer_load_dwordx4 a[10:13], v252, s[44:47], s62 offen offset:0 sc1
buffer_load_dwordx4 a[78:81], v252, s[44:47], s62 offen offset:1024 sc1
buffer_load_dwordx4 v[70:73], v252, s[40:43], s62 offen offset:0 sc1
buffer_load_dwordx4 v[138:141], v252, s[40:43], s62 offen offset:1024 sc1
LH_e_2:
s_bitcmp1_b32 s99, 3
s_cbranch_scc0 LH_e_3
buffer_load_dwordx4 a[14:17], v252, s[44:47], s63 offen offset:0 sc1
buffer_load_dwordx4 a[82:85], v252, s[44:47], s63 offen offset:1024 sc1
buffer_load_dwordx4 v[66:69], v252, s[40:43], s63 offen offset:0 sc1
buffer_load_dwordx4 v[134:137], v252, s[40:43], s63 offen offset:1024 sc1
LH_e_3:
s_bitcmp1_b32 s99, 4
s_cbranch_scc0 LH_e_4
buffer_load_dwordx4 a[18:21], v252, s[44:47], s64 offen offset:0 sc1
buffer_load_dwordx4 a[86:89], v252, s[44:47], s64 offen offset:1024 sc1
buffer_load_dwordx4 v[78:81], v252, s[40:43], s64 offen offset:0 sc1
buffer_load_dwordx4 v[146:149], v252, s[40:43], s64 offen offset:1024 sc1
LH_e_4:
s_bitcmp1_b32 s99, 5
s_cbranch_scc0 LH_e_5
buffer_load_dwordx4 a[22:25], v252, s[44:47], s65 offen offset:0 sc1
buffer_load_dwordx4 a[90:93], v252, s[44:47], s65 offen offset:1024 sc1
buffer_load_dwordx4 v[74:77], v252, s[40:43], s65 offen offset:0 sc1
buffer_load_dwordx4 v[142:145], v252, s[40:43], s65 offen offset:1024 sc1
LH_e_5:
s_bitcmp1_b32 s99, 6
s_cbranch_scc0 LH_e_6
buffer_load_dwordx4 a[26:29], v252, s[44:47], s66 offen offset:0 sc1
buffer_load_dwordx4 a[94:97], v252, s[44:47], s66 offen offset:1024 sc1
buffer_load_dwordx4 v[86:89], v252, s[40:43], s66 offen offset:0 sc1
buffer_load_dwordx4 v[154:157], v252, s[40:43], s66 offen offset:1024 sc1
LH_e_6:
s_bitcmp1_b32 s99, 7
s_cbranch_scc0 LH_e_7
buffer_load_dwordx4 a[30:33], v252, s[44:47], s4 offen offset:0 sc1
buffer_load_dwordx4 a[98:101], v252, s[44:47], s4 offen offset:1024 sc1
buffer_load_dwordx4 v[82:85], v252, s[40:43], s4 offen offset:0 sc1
buffer_load_dwordx4 v[150:153], v252, s[40:43], s4 offen offset:1024 sc1
LH_e_7:
s_bitcmp1_b32 s99, 8
s_cbranch_scc0 LH_e_8
buffer_load_dwordx4 a[34:37], v252, s[44:47], s5 offen offset:0 sc1
buffer_load_dwordx4 a[102:105], v252, s[44:47], s5 offen offset:1024 sc1
buffer_load_dwordx4 v[94:97], v252, s[40:43], s5 offen offset:0 sc1
buffer_load_dwordx4 v[162:165], v252, s[40:43], s5 offen offset:1024 sc1
LH_e_8:
s_bitcmp1_b32 s99, 9
s_cbranch_scc0 LH_e_9
buffer_load_dwordx4 a[38:41], v252, s[44:47], s6 offen offset:0 sc1
buffer_load_dwordx4 a[106:109], v252, s[44:47], s6 offen offset:1024 sc1
buffer_load_dwordx4 v[90:93], v252, s[40:43], s6 offen offset:0 sc1
buffer_load_dwordx4 v[158:161], v252, s[40:43], s6 offen offset:1024 sc1
LH_e_9:
s_bitcmp1_b32 s99, 10
s_cbranch_scc0 LH_e_10
buffer_load_dwordx4 a[42:45], v252, s[44:47], s7 offen offset:0 sc1
buffer_load_dwordx4 a[110:113], v252, s[44:47], s7 offen offset:1024 sc1
buffer_load_dwordx4 v[102:105], v252, s[40:43], s7 offen offset:0 sc1
buffer_load_dwordx4 v[170:173], v252, s[40:43], s7 offen offset:1024 sc1
LH_e_10:
s_bitcmp1_b32 s99, 11
s_cbranch_scc0 LH_e_11
buffer_load_dwordx4 a[46:49], v252, s[44:47], s8 offen offset:0 sc1
buffer_load_dwordx4 a[114:117], v252, s[44:47], s8 offen offset:1024 sc1
buffer_load_dwordx4 v[98:101], v252, s[40:43], s8 offen offset:0 sc1
buffer_load_dwordx4 v[166:169], v252, s[40:43], s8 offen offset:1024 sc1
LH_e_11:
s_bitcmp1_b32 s99, 12
s_cbranch_scc0 LH_e_12
buffer_load_dwordx4 a[50:53], v252, s[44:47], s9 offen offset:0 sc1
buffer_load_dwordx4 a[118:121], v252, s[44:47], s9 offen offset:1024 sc1
buffer_load_dwordx4 v[110:113], v252, s[40:43], s9 offen offset:0 sc1
buffer_load_dwordx4 v[178:181], v252, s[40:43], s9 offen offset:1024 sc1
LH_e_12:
s_bitcmp1_b32 s99, 13
s_cbranch_scc0 LH_e_13
buffer_load_dwordx4 a[54:57], v252, s[44:47], s10 offen offset:0 sc1
buffer_load_dwordx4 a[122:125], v252, s[44:47], s10 offen offset:1024 sc1
buffer_load_dwordx4 v[106:109], v252, s[40:43], s10 offen offset:0 sc1
buffer_load_dwordx4 v[174:177], v252, s[40:43], s10 offen offset:1024 sc1
LH_e_13:
s_bitcmp1_b32 s99, 14
s_cbranch_scc0 LH_e_14
buffer_load_dwordx4 a[58:61], v252, s[44:47], s11 offen offset:0 sc1
buffer_load_dwordx4 a[126:129], v252, s[44:47], s11 offen offset:1024 sc1
buffer_load_dwordx4 v[118:121], v252, s[40:43], s11 offen offset:0 sc1
buffer_load_dwordx4 v[186:189], v252, s[40:43], s11 offen offset:1024 sc1
LH_e_14:
LH_e2:
s_add_u32 s96, s96, 1
s_cmp_lt_u32 s96, 20000
s_cselect_b32 s67, s98, 0
s_cmp_lg_u32 s67, 0
s_cbranch_scc1 LH_e
s_waitcnt vmcnt(0)
v_mfma_f32_16x16x32_bf16 v[4:7], a[224:227], a[0:3], 0
v_mfma_f32_16x16x32_bf16 v[192:195], a[224:227], a[68:71], 0
v_mfma_f32_16x16x32_bf16 v[196:199], a[224:227], a[4:7], 0
v_mfma_f32_16x16x32_bf16 v[200:203], a[224:227], a[72:75], 0
v_mfma_f32_16x16x32_bf16 v[4:7], a[224:227], a[8:11], v[4:7]
v_mfma_f32_16x16x32_bf16 v[192:195], a[224:227], a[76:79], v[192:195]
v_mfma_f32_16x16x32_bf16 v[196:199], a[224:227], a[12:15], v[196:199]
LH_p12:
s_cbranch_execz LH_p16
v_mfma_f32_16x16x32_bf16 v[200:203], a[224:227], a[80:83], v[200:203]
v_mfma_f32_16x16x32_bf16 v[4:7], a[224:227], a[16:19], v[4:7]
v_mfma_f32_16x16x32_bf16 v[192:195], a[224:227], a[84:87], v[192:195]
v_mfma_f32_16x16x32_bf16 v[196:199], a[224:227], a[20:23], v[196:199]
v_mfma_f32_16x16x32_bf16 v[200:203], a[224:227], a[88:91], v[200:203]
v_mfma_f32_16x16x32_bf16 v[4:7], a[224:227], a[24:27], v[4:7]
v_mfma_f32_16x16x32_bf16 v[192:195], a[224:227], a[92:95], v[192:195]
v_mfma_f32_16x16x32_bf16 v[196:199], a[224:227], a[28:31], v[196:199]
v_mfma_f32_16x16x32_bf16 v[200:203], a[224:227], a[96:99], v[200:203]
v_mfma_f32_16x16x32_bf16 v[4:7], a[224:227], a[32:35], v[4:7]
v_mfma_f32_16x16x32_bf16 v[192:195], a[224:227], a[100:103], v[192:195]
v_mfma_f32_16x16x32_bf16 v[196:199], a[224:227], a[36:39], v[196:199]
v_mfma_f32_16x16x32_bf16 v[200:203], a[224:227], a[104:107], v[200:203]
v_mfma_f32_16x16x32_bf16 v[4:7], a[224:227], a[40:43], v[4:7]
v_mfma_f32_16x16x32_bf16 v[192:195], a[224:227], a[108:111], v[192:195]
v_mfma_f32_16x16x32_bf16 v[196:199], a[224:227], a[44:47], v[196:199]
v_mfma_f32_16x16x32_bf16 v[200:203], a[224:227], a[112:115], v[200:203]
v_mfma_f32_16x16x32_bf16 v[4:7], a[224:227], a[48:51], v[4:7]
v_mfma_f32_16x16x32_bf16 v[192:195], a[224:227], a[116:119], v[192:195]
v_mfma_f32_16x16x32_bf16 v[196:199], a[224:227], a[52:55], v[196:199]
v_mfma_f32_16x16x32_bf16 v[200:203], a[224:227], a[120:123], v[200:203]
v_mfma_f32_16x16x32_bf16 v[4:7], a[224:227], a[56:59], v[4:7]
v_mfma_f32_16x16x32_bf16 v[192:195], a[224:227], a[124:127], v[192:195]
v_mfma_f32_16x16x32_bf16 v[196:199], a[224:227], a[60:63], v[196:199]
v_mfma_f32_16x16x32_bf16 v[200:203], a[224:227], a[128:131], v[200:203]
v_mfma_f32_16x16x32_bf16 v[4:7], a[224:227], a[64:67], v[4:7]
v_mfma_f32_16x16x32_bf16 v[192:195], a[224:227], a[132:135], v[192:195]
s_lshl_b32 s67, s50, 12
s_add_u32 s67, s67, 147456
v_and_b32 v249, 12, v254
v_add_u32 v249, v254, v249
v_lshl_add_u32 v249, v249, 7, s67
v_and_b32 v248, 7, v255
v_xor_b32 v248, v248, v253
v_lshl_add_u32 v247, v248, 4, v249
v_xor_b32 v246, 64, v247
v_bfe_u32 v249, v255, 3, 2
v_xor_b32 v249, v249, v255
v_lshl_add_u32 v245, v249, 4, s67
v_xor_b32 v244, 64, v245
s_lshl_b32 s67, s49, 2
s_add_u32 s67, s67, s50
s_lshl_b32 s67, s67, 5
v_lshrrev_b32 v249, 3, v255
v_add_u32 v249, s67, v249
v_mul_u32_u24 v249, 2304, v249
v_and_b32 v248, 7, v255
v_lshl_add_u32 v249, v248, 4, v249
s_lshl_b32 s67, s74, 2
v_add_u32 v248, s67, v249
v_fmac_f32 v8, 0xbf317218, v4
v_fmac_f32 v9, 0xbf317218, v5
v_fmac_f32 v10, 0xbf317218, v6
v_fmac_f32 v11, 0xbf317218, v7
ds_write_b128 v247, v[8:11] offset:0
v_fmac_f32 v16, 0xbf317218, v196
v_fmac_f32 v17, 0xbf317218, v197
v_fmac_f32 v18, 0xbf317218, v198
v_fmac_f32 v19, 0xbf317218, v199
ds_write_b128 v246, v[16:19] offset:0
v_fmac_f32 v12, 0xbf317218, v192
v_fmac_f32 v13, 0xbf317218, v193
v_fmac_f32 v14, 0xbf317218, v194
v_fmac_f32 v15, 0xbf317218, v195
ds_write_b128 v247, v[12:15] offset:512
v_fmac_f32 v20, 0xbf317218, v200
v_fmac_f32 v21, 0xbf317218, v201
v_fmac_f32 v22, 0xbf317218, v202
v_fmac_f32 v23, 0xbf317218, v203
ds_write_b128 v246, v[20:23] offset:512
ds_read_b128 v[4:7], v245 offset:0
LH_p13:
s_cbranch_execz LH_p17
ds_read_b128 v[8:11], v244 offset:1024
ds_read_b128 v[12:15], v245 offset:2048
ds_read_b128 v[16:19], v244 offset:3072
s_mov_b32 s67, 0
s_waitcnt lgkmcnt(3)
buffer_store_dwordx4 v[4:7], v248, s[28:31], s67 offen sc1
s_mov_b32 s67, 18432
s_waitcnt lgkmcnt(2)
buffer_store_dwordx4 v[8:11], v248, s[28:31], s67 offen sc1
s_mov_b32 s67, 36864
s_waitcnt lgkmcnt(1)
buffer_store_dwordx4 v[12:15], v248, s[28:31], s67 offen sc1
s_mov_b32 s67, 55296
s_waitcnt lgkmcnt(0)
buffer_store_dwordx4 v[16:19], v248, s[28:31], s67 offen sc1
s_add_u32 s44, s44, 0x80000
s_addc_u32 s45, s45, 0
s_mov_b32 s98, 0x7fff
s_lshr_b32 s67, s83, 1
s_and_b32 s67, s67, 0x2000
s_add_u32 s94, s67, 229376
s_add_u32 s95, s67, 245760
s_sub_u32 s87, s51, 1
s_and_b32 s87, s87, 7
s_lshl_b32 s87, s87, 15
s_sub_u32 s60, s94, s87
s_sub_u32 s61, s95, s87
s_sub_u32 s87, s51, 2
s_and_b32 s87, s87, 7
s_lshl_b32 s87, s87, 15
s_sub_u32 s62, s94, s87
s_sub_u32 s63, s95, s87
s_sub_u32 s87, s51, 3
s_and_b32 s87, s87, 7
s_lshl_b32 s87, s87, 15
s_sub_u32 s64, s94, s87
s_sub_u32 s65, s95, s87
s_sub_u32 s87, s51, 4
s_and_b32 s87, s87, 7
s_lshl_b32 s87, s87, 15
s_sub_u32 s66, s94, s87
s_sub_u32 s4, s95, s87
s_sub_u32 s87, s51, 5
s_and_b32 s87, s87, 7
s_lshl_b32 s87, s87, 15
s_sub_u32 s5, s94, s87
s_sub_u32 s6, s95, s87
s_sub_u32 s87, s51, 6
s_and_b32 s87, s87, 7
s_lshl_b32 s87, s87, 15
s_sub_u32 s7, s94, s87
s_sub_u32 s8, s95, s87
s_sub_u32 s87, s51, 7
s_and_b32 s87, s87, 7
s_lshl_b32 s87, s87, 15
s_sub_u32 s9, s94, s87
s_sub_u32 s10, s95, s87
s_sub_u32 s87, s51, 8
s_and_b32 s87, s87, 7
s_lshl_b32 s87, s87, 15
s_sub_u32 s11, s94, s87
s_nop 0
v_accvgpr_write_b32 a0, 0
v_accvgpr_write_b32 a1, 0
v_accvgpr_write_b32 a62, 0
v_accvgpr_write_b32 a63, 0
v_accvgpr_write_b32 a64, 0
v_accvgpr_write_b32 a65, 0
v_accvgpr_write_b32 a126, 0
v_accvgpr_write_b32 a127, 0
s_mov_b32 s96, 0
s_mov_b32 s59, 0
v_mov_b32 v249, 0
s_mov_b32 exec_hi, 0
s_mov_b32 exec_lo, s98
buffer_atomic_add v249, v250, s[32:35], 0 offen sc0 sc1
s_mov_b64 exec, -1
s_waitcnt vmcnt(0)
v_cmp_le_u32 vcc, v251, v249
s_nop 0
s_and_b32 s99, vcc_lo, s98
s_andn2_b32 s98, s98, s99
s_cmp_eq_u32 s99, 0
s_cbranch_scc1 LH_to_n
s_and_b32 s67, s99, 0xf
s_cbranch_scc0 LH_to_g0
s_bitcmp1_b32 s99, 0
s_cbranch_scc0 LH_to_0
buffer_load_dwordx4 a[2:5], v252, s[44:47], s60 offen offset:0 sc1
buffer_load_dwordx4 a[66:69], v252, s[44:47], s60 offen offset:1024 sc1
LH_to_0:
s_bitcmp1_b32 s99, 1
s_cbranch_scc0 LH_to_1
buffer_load_dwordx4 a[6:9], v252, s[44:47], s61 offen offset:0 sc1
buffer_load_dwordx4 a[70:73], v252, s[44:47], s61 offen offset:1024 sc1
LH_to_1:
s_bitcmp1_b32 s99, 2
s_cbranch_scc0 LH_to_2
buffer_load_dwordx4 a[10:13], v252, s[44:47], s62 offen offset:0 sc1
buffer_load_dwordx4 a[74:77], v252, s[44:47], s62 offen offset:1024 sc1
LH_p14:
s_cbranch_execz LH_p18
LH_to_2:
s_bitcmp1_b32 s99, 3
s_cbranch_scc0 LH_to_3
buffer_load_dwordx4 a[14:17], v252, s[44:47], s63 offen offset:0 sc1
buffer_load_dwordx4 a[78:81], v252, s[44:47], s63 offen offset:1024 sc1
LH_to_3:
LH_to_g0:
s_and_b32 s67, s99, 0xf0
s_cbranch_scc0 LH_to_g4
s_bitcmp1_b32 s99, 4
s_cbranch_scc0 LH_to_4
buffer_load_dwordx4 a[18:21], v252, s[44:47], s64 offen offset:0 sc1
buffer_load_dwordx4 a[82:85], v252, s[44:47], s64 offen offset:1024 sc1
LH_to_4:
s_bitcmp1_b32 s99, 5
s_cbranch_scc0 LH_to_5
buffer_load_dwordx4 a[22:25], v252, s[44:47], s65 offen offset:0 sc1
buffer_load_dwordx4 a[86:89], v252, s[44:47], s65 offen offset:1024 sc1
LH_to_5:
s_bitcmp1_b32 s99, 6
s_cbranch_scc0 LH_to_6
buffer_load_dwordx4 a[26:29], v252, s[44:47], s66 offen offset:0 sc1
buffer_load_dwordx4 a[90:93], v252, s[44:47], s66 offen offset:1024 sc1
LH_to_6:
s_bitcmp1_b32 s99, 7
s_cbranch_scc0 LH_to_7
buffer_load_dwordx4 a[30:33], v252, s[44:47], s4 offen offset:0 sc1
buffer_load_dwordx4 a[94:97], v252, s[44:47], s4 offen offset:1024 sc1
LH_to_7:
LH_to_g4:
s_and_b32 s67, s99, 0xf00
s_cbranch_scc0 LH_to_g8
s_bitcmp1_b32 s99, 8
s_cbranch_scc0 LH_to_8
buffer_load_dwordx4 a[34:37], v252, s[44:47], s5 offen offset:0 sc1
buffer_load_dwordx4 a[98:101], v252, s[44:47], s5 offen offset:1024 sc1
LH_to_8:
s_bitcmp1_b32 s99, 9
s_cbranch_scc0 LH_to_9
buffer_load_dwordx4 a[38:41], v252, s[44:47], s6 offen offset:0 sc1
buffer_load_dwordx4 a[102:105], v252, s[44:47], s6 offen offset:1024 sc1
LH_to_9:
s_bitcmp1_b32 s99, 10
s_cbranch_scc0 LH_to_10
buffer_load_dwordx4 a[42:45], v252, s[44:47], s7 offen offset:0 sc1
buffer_load_dwordx4 a[106:109], v252, s[44:47], s7 offen offset:1024 sc1
LH_to_10:
s_bitcmp1_b32 s99, 11
s_cbranch_scc0 LH_to_11
buffer_load_dwordx4 a[46:49], v252, s[44:47], s8 offen offset:0 sc1
buffer_load_dwordx4 a[110:113], v252, s[44:47], s8 offen offset:1024 sc1
LH_to_11:
LH_to_g8:
s_and_b32 s67, s99, 0xf000
s_cbranch_scc0 LH_to_g12
s_bitcmp1_b32 s99, 12
s_cbranch_scc0 LH_to_12
buffer_load_dwordx4 a[50:53], v252, s[44:47], s9 offen offset:0 sc1
buffer_load_dwordx4 a[114:117], v252, s[44:47], s9 offen offset:1024 sc1
LH_to_12:
s_bitcmp1_b32 s99, 13
s_cbranch_scc0 LH_to_13
buffer_load_dwordx4 a[54:57], v252, s[44:47], s10 offen offset:0 sc1
buffer_load_dwordx4 a[118:121], v252, s[44:47], s10 offen offset:1024 sc1
LH_to_13:
s_bitcmp1_b32 s99, 14
s_cbranch_scc0 LH_to_14
buffer_load_dwordx4 a[58:61], v252, s[44:47], s11 offen offset:0 sc1
buffer_load_dwordx4 a[122:125], v252, s[44:47], s11 offen offset:1024 sc1
LH_to_14:
LH_to_g12:
LH_to_n:
v_mfma_f32_16x16x32_bf16 v[4:7], a[224:227], v[56:59], 0
v_mfma_f32_16x16x32_bf16 v[8:11], a[224:227], v[124:127], 0
v_mfma_f32_16x16x32_bf16 v[12:15], a[224:227], v[60:63], 0
v_mfma_f32_16x16x32_bf16 v[16:19], a[224:227], v[128:131], 0
v_mfma_f32_16x16x32_bf16 v[4:7], a[224:227], v[64:67], v[4:7]
v_mfma_f32_16x16x32_bf16 v[8:11], a[224:227], v[132:135], v[8:11]
v_mfma_f32_16x16x32_bf16 v[12:15], a[224:227], v[68:71], v[12:15]
v_mfma_f32_16x16x32_bf16 v[16:19], a[224:227], v[136:139], v[16:19]
v_mfma_f32_16x16x32_bf16 v[4:7], a[224:227], v[72:75], v[4:7]
v_mfma_f32_16x16x32_bf16 v[8:11], a[224:227], v[140:143], v[8:11]
v_mfma_f32_16x16x32_bf16 v[12:15], a[224:227], v[76:79], v[12:15]
v_mfma_f32_16x16x32_bf16 v[16:19], a[224:227], v[144:147], v[16:19]
v_mfma_f32_16x16x32_bf16 v[4:7], a[224:227], v[80:83], v[4:7]
v_mfma_f32_16x16x32_bf16 v[8:11], a[224:227], v[148:151], v[8:11]
v_mfma_f32_16x16x32_bf16 v[12:15], a[224:227], v[84:87], v[12:15]
v_mfma_f32_16x16x32_bf16 v[16:19], a[224:227], v[152:155], v[16:19]
v_mfma_f32_16x16x32_bf16 v[4:7], a[224:227], v[88:91], v[4:7]
v_mfma_f32_16x16x32_bf16 v[8:11], a[224:227], v[156:159], v[8:11]
v_mfma_f32_16x16x32_bf16 v[12:15], a[224:227], v[92:95], v[12:15]
v_mfma_f32_16x16x32_bf16 v[16:19], a[224:227], v[160:163], v[16:19]
v_mfma_f32_16x16x32_bf16 v[4:7], a[224:227], v[96:99], v[4:7]
v_mfma_f32_16x16x32_bf16 v[8:11], a[224:227], v[164:167], v[8:11]
v_mfma_f32_16x16x32_bf16 v[12:15], a[224:227], v[100:103], v[12:15]
LH_p15:
s_cbranch_execz LH_p19
v_mfma_f32_16x16x32_bf16 v[16:19], a[224:227], v[168:171], v[16:19]
v_mfma_f32_16x16x32_bf16 v[4:7], a[224:227], v[104:107], v[4:7]
v_mfma_f32_16x16x32_bf16 v[8:11], a[224:227], v[172:175], v[8:11]
v_mfma_f32_16x16x32_bf16 v[12:15], a[224:227], v[108:111], v[12:15]
v_mfma_f32_16x16x32_bf16 v[16:19], a[224:227], v[176:179], v[16:19]
v_mfma_f32_16x16x32_bf16 v[4:7], a[224:227], v[112:115], v[4:7]
v_mfma_f32_16x16x32_bf16 v[8:11], a[224:227], v[180:183], v[8:11]
v_mfma_f32_16x16x32_bf16 v[12:15], a[224:227], v[116:119], v[12:15]
v_mfma_f32_16x16x32_bf16 v[16:19], a[224:227], v[184:187], v[16:19]
v_mfma_f32_16x16x32_bf16 v[4:7], a[224:227], v[120:123], v[4:7]
v_mfma_f32_16x16x32_bf16 v[8:11], a[224:227], v[188:191], v[8:11]
s_lshl_b32 s67, s50, 12
s_add_u32 s67, s67, 147456
v_and_b32 v249, 12, v254
v_add_u32 v249, v254, v249
v_lshl_add_u32 v249, v249, 7, s67
v_and_b32 v248, 7, v255
v_xor_b32 v248, v248, v253
v_lshl_add_u32 v247, v248, 4, v249
v_xor_b32 v246, 64, v247
v_bfe_u32 v249, v255, 3, 2
v_xor_b32 v249, v249, v255
v_lshl_add_u32 v245, v249, 4, s67
v_xor_b32 v244, 64, v245
s_lshl_b32 s67, s49, 2
s_add_u32 s67, s67, s50
s_lshl_b32 s67, s67, 5
v_lshrrev_b32 v249, 3, v255
v_add_u32 v249, s67, v249
v_mul_u32_u24 v249, 2304, v249
v_and_b32 v248, 7, v255
v_lshl_add_u32 v249, v248, 4, v249
s_lshl_b32 s67, s75, 2
v_add_u32 v248, s67, v249
v_fmac_f32 v24, 0xbf317218, v4
v_fmac_f32 v25, 0xbf317218, v5
v_fmac_f32 v26, 0xbf317218, v6
v_fmac_f32 v27, 0xbf317218, v7
ds_write_b128 v247, v[24:27] offset:0
v_fmac_f32 v32, 0xbf317218, v12
v_fmac_f32 v33, 0xbf317218, v13
v_fmac_f32 v34, 0xbf317218, v14
v_fmac_f32 v35, 0xbf317218, v15
ds_write_b128 v246, v[32:35] offset:0
v_fmac_f32 v28, 0xbf317218, v8
v_fmac_f32 v29, 0xbf317218, v9
v_fmac_f32 v30, 0xbf317218, v10
v_fmac_f32 v31, 0xbf317218, v11
ds_write_b128 v247, v[28:31] offset:512
v_fmac_f32 v36, 0xbf317218, v16
v_fmac_f32 v37, 0xbf317218, v17
v_fmac_f32 v38, 0xbf317218, v18
v_fmac_f32 v39, 0xbf317218, v19
ds_write_b128 v246, v[36:39] offset:512
ds_read_b128 v[4:7], v245 offset:0
ds_read_b128 v[8:11], v244 offset:1024
ds_read_b128 v[12:15], v245 offset:2048
ds_read_b128 v[16:19], v244 offset:3072
s_mov_b32 s67, 0
s_waitcnt lgkmcnt(3)
buffer_store_dwordx4 v[4:7], v248, s[28:31], s67 offen sc1
s_mov_b32 s67, 18432
s_waitcnt lgkmcnt(2)
buffer_store_dwordx4 v[8:11], v248, s[28:31], s67 offen sc1
s_mov_b32 s67, 36864
s_waitcnt lgkmcnt(1)
buffer_store_dwordx4 v[12:15], v248, s[28:31], s67 offen sc1
s_mov_b32 s67, 55296
s_waitcnt lgkmcnt(0)
buffer_store_dwordx4 v[16:19], v248, s[28:31], s67 offen sc1
s_lshl_b32 s67, s50, 12
s_add_u32 s67, s67, 147456
v_and_b32 v249, 12, v254
v_add_u32 v249, v254, v249
v_lshl_add_u32 v249, v249, 7, s67
LH_p16:
s_cbranch_execz LH_v0
v_and_b32 v254, 7, v255
v_xor_b32 v254, v254, v253
v_lshl_add_u32 v253, v254, 4, v249
v_xor_b32 v248, 64, v253
v_bfe_u32 v249, v255, 3, 2
v_xor_b32 v249, v249, v255
v_lshl_add_u32 v247, v249, 4, s67
v_xor_b32 v246, 64, v247
s_lshl_b32 s67, s49, 2
s_add_u32 s67, s67, s50
s_lshl_b32 s67, s67, 5
v_lshrrev_b32 v249, 3, v255
v_add_u32 v249, s67, v249
v_mul_u32_u24 v249, 2304, v249
v_and_b32 v254, 7, v255
v_lshl_add_u32 v249, v254, 4, v249
s_lshl_b32 s67, s76, 2
v_add_u32 v255, s67, v249
s_cmp_eq_u32 s98, 0
s_cbranch_scc1 LH_t_x
LH_t:
v_mov_b32 v254, 0
s_mov_b32 exec_hi, 0
s_mov_b32 exec_lo, s98
buffer_atomic_add v254, v250, s[32:35], 0 offen sc0 sc1
s_mov_b64 exec, -1
s_mov_b32 s58, s98
s_waitcnt vmcnt(0)
v_cmp_le_u32 vcc, v251, v254
s_nop 0
s_and_b32 s99, vcc_lo, s98
s_andn2_b32 s98, s98, s99
s_cmp_eq_u32 s99, 0
s_cbranch_scc1 LH_tl_n
s_and_b32 s67, s99, 0xf
s_cbranch_scc0 LH_tl_g0
s_bitcmp1_b32 s99, 0
s_cbranch_scc0 LH_tl_0
buffer_load_dwordx4 a[2:5], v252, s[44:47], s60 offen offset:0 sc1
buffer_load_dwordx4 a[66:69], v252, s[44:47], s60 offen offset:1024 sc1
LH_tl_0:
s_bitcmp1_b32 s99, 1
s_cbranch_scc0 LH_tl_1
buffer_load_dwordx4 a[6:9], v252, s[44:47], s61 offen offset:0 sc1
buffer_load_dwordx4 a[70:73], v252, s[44:47], s61 offen offset:1024 sc1
LH_tl_1:
s_bitcmp1_b32 s99, 2
s_cbranch_scc0 LH_tl_2
buffer_load_dwordx4 a[10:13], v252, s[44:47], s62 offen offset:0 sc1
buffer_load_dwordx4 a[74:77], v252, s[44:47], s62 offen offset:1024 sc1
LH_tl_2:
s_bitcmp1_b32 s99, 3
s_cbranch_scc0 LH_tl_3
buffer_load_dwordx4 a[14:17], v252, s[44:47], s63 offen offset:0 sc1
buffer_load_dwordx4 a[78:81], v252, s[44:47], s63 offen offset:1024 sc1
LH_tl_3:
LH_tl_g0:
s_and_b32 s67, s99, 0xf0
s_cbranch_scc0 LH_tl_g4
s_bitcmp1_b32 s99, 4
s_cbranch_scc0 LH_tl_4
buffer_load_dwordx4 a[18:21], v252, s[44:47], s64 offen offset:0 sc1
buffer_load_dwordx4 a[82:85], v252, s[44:47], s64 offen offset:1024 sc1
LH_tl_4:
s_bitcmp1_b32 s99, 5
s_cbranch_scc0 LH_tl_5
buffer_load_dwordx4 a[22:25], v252, s[44:47], s65 offen offset:0 sc1
buffer_load_dwordx4 a[86:89], v252, s[44:47], s65 offen offset:1024 sc1
LH_tl_5:
s_bitcmp1_b32 s99, 6
s_cbranch_scc0 LH_tl_6
buffer_load_dwordx4 a[26:29], v252, s[44:47], s66 offen offset:0 sc1
buffer_load_dwordx4 a[90:93], v252, s[44:47], s66 offen offset:1024 sc1
LH_tl_6:
s_bitcmp1_b32 s99, 7
s_cbranch_scc0 LH_tl_7
buffer_load_dwordx4 a[30:33], v252, s[44:47], s4 offen offset:0 sc1
buffer_load_dwordx4 a[94:97], v252, s[44:47], s4 offen offset:1024 sc1
LH_tl_7:
LH_tl_g4:
s_and_b32 s67, s99, 0xf00
s_cbranch_scc0 LH_tl_g8
s_bitcmp1_b32 s99, 8
s_cbranch_scc0 LH_tl_8
buffer_load_dwordx4 a[34:37], v252, s[44:47], s5 offen offset:0 sc1
buffer_load_dwordx4 a[98:101], v252, s[44:47], s5 offen offset:1024 sc1
LH_tl_8:
s_bitcmp1_b32 s99, 9
s_cbranch_scc0 LH_tl_9
buffer_load_dwordx4 a[38:41], v252, s[44:47], s6 offen offset:0 sc1
buffer_load_dwordx4 a[102:105], v252, s[44:47], s6 offen offset:1024 sc1
LH_tl_9:
s_bitcmp1_b32 s99, 10
s_cbranch_scc0 LH_tl_10
buffer_load_dwordx4 a[42:45], v252, s[44:47], s7 offen offset:0 sc1
buffer_load_dwordx4 a[106:109], v252, s[44:47], s7 offen offset:1024 sc1
LH_tl_10:
s_bitcmp1_b32 s99, 11
s_cbranch_scc0 LH_tl_11
buffer_load_dwordx4 a[46:49], v252, s[44:47], s8 offen offset:0 sc1
buffer_load_dwordx4 a[110:113], v252, s[44:47], s8 offen offset:1024 sc1
LH_tl_11:
LH_tl_g8:
s_and_b32 s67, s99, 0xf000
s_cbranch_scc0 LH_tl_g12
s_bitcmp1_b32 s99, 12
s_cbranch_scc0 LH_tl_12
buffer_load_dwordx4 a[50:53], v252, s[44:47], s9 offen offset:0 sc1
buffer_load_dwordx4 a[114:117], v252, s[44:47], s9 offen offset:1024 sc1
LH_p17:
s_cbranch_execz LH_v0
LH_tl_12:
s_bitcmp1_b32 s99, 13
s_cbranch_scc0 LH_tl_13
buffer_load_dwordx4 a[54:57], v252, s[44:47], s10 offen offset:0 sc1
buffer_load_dwordx4 a[118:121], v252, s[44:47], s10 offen offset:1024 sc1
LH_tl_13:
s_bitcmp1_b32 s99, 14
s_cbranch_scc0 LH_tl_14
buffer_load_dwordx4 a[58:61], v252, s[44:47], s11 offen offset:0 sc1
buffer_load_dwordx4 a[122:125], v252, s[44:47], s11 offen offset:1024 sc1
LH_tl_14:
LH_tl_g12:
LH_tl_n:
s_and_b32 s67, s58, 0xfff
s_or_b32 s67, s67, s59
s_cbranch_scc1 LH_t_s
v_mfma_f32_16x16x32_bf16 v[4:7], a[224:227], a[0:3], 0
v_mfma_f32_16x16x32_bf16 v[8:11], a[224:227], a[64:67], 0
v_mfma_f32_16x16x32_bf16 v[12:15], a[224:227], a[4:7], 0
v_mfma_f32_16x16x32_bf16 v[16:19], a[224:227], a[68:71], 0
v_mfma_f32_16x16x32_bf16 v[4:7], a[224:227], a[8:11], v[4:7]
v_mfma_f32_16x16x32_bf16 v[8:11], a[224:227], a[72:75], v[8:11]
v_mfma_f32_16x16x32_bf16 v[12:15], a[224:227], a[12:15], v[12:15]
v_mfma_f32_16x16x32_bf16 v[16:19], a[224:227], a[76:79], v[16:19]
v_mfma_f32_16x16x32_bf16 v[4:7], a[224:227], a[16:19], v[4:7]
v_mfma_f32_16x16x32_bf16 v[8:11], a[224:227], a[80:83], v[8:11]
v_mfma_f32_16x16x32_bf16 v[12:15], a[224:227], a[20:23], v[12:15]
v_mfma_f32_16x16x32_bf16 v[16:19], a[224:227], a[84:87], v[16:19]
v_mfma_f32_16x16x32_bf16 v[4:7], a[224:227], a[24:27], v[4:7]
v_mfma_f32_16x16x32_bf16 v[8:11], a[224:227], a[88:91], v[8:11]
v_mfma_f32_16x16x32_bf16 v[12:15], a[224:227], a[28:31], v[12:15]
v_mfma_f32_16x16x32_bf16 v[16:19], a[224:227], a[92:95], v[16:19]
v_mfma_f32_16x16x32_bf16 v[4:7], a[224:227], a[32:35], v[4:7]
v_mfma_f32_16x16x32_bf16 v[8:11], a[224:227], a[96:99], v[8:11]
v_mfma_f32_16x16x32_bf16 v[12:15], a[224:227], a[36:39], v[12:15]
v_mfma_f32_16x16x32_bf16 v[16:19], a[224:227], a[100:103], v[16:19]
v_mfma_f32_16x16x32_bf16 v[4:7], a[224:227], a[40:43], v[4:7]
v_mfma_f32_16x16x32_bf16 v[8:11], a[224:227], a[104:107], v[8:11]
v_mfma_f32_16x16x32_bf16 v[12:15], a[224:227], a[44:47], v[12:15]
v_mfma_f32_16x16x32_bf16 v[16:19], a[224:227], a[108:111], v[16:19]
s_mov_b32 s59, 1
LH_t_s:
s_add_u32 s96, s96, 1
s_cmp_lt_u32 s96, 20000
s_cselect_b32 s67, s98, 0
s_cmp_lg_u32 s67, 0
s_cbranch_scc1 LH_t
LH_t_x:
s_cmp_lg_u32 s59, 0
s_waitcnt vmcnt(0)
s_cbranch_scc1 LH_t_h
v_mfma_f32_16x16x32_bf16 v[4:7], a[224:227], a[0:3], 0
v_mfma_f32_16x16x32_bf16 v[8:11], a[224:227], a[64:67], 0
v_mfma_f32_16x16x32_bf16 v[12:15], a[224:227], a[4:7], 0
v_mfma_f32_16x16x32_bf16 v[16:19], a[224:227], a[68:71], 0
v_mfma_f32_16x16x32_bf16 v[4:7], a[224:227], a[8:11], v[4:7]
v_mfma_f32_16x16x32_bf16 v[8:11], a[224:227], a[72:75], v[8:11]
v_mfma_f32_16x16x32_bf16 v[12:15], a[224:227], a[12:15], v[12:15]
v_mfma_f32_16x16x32_bf16 v[16:19], a[224:227], a[76:79], v[16:19]
v_mfma_f32_16x16x32_bf16 v[4:7], a[224:227], a[16:19], v[4:7]
v_mfma_f32_16x16x32_bf16 v[8:11], a[224:227], a[80:83], v[8:11]
v_mfma_f32_16x16x32_bf16 v[12:15], a[224:227], a[20:23], v[12:15]
v_mfma_f32_16x16x32_bf16 v[16:19], a[224:227], a[84:87], v[16:19]
v_mfma_f32_16x16x32_bf16 v[4:7], a[224:227], a[24:27], v[4:7]
v_mfma_f32_16x16x32_bf16 v[8:11], a[224:227], a[88:91], v[8:11]
v_mfma_f32_16x16x32_bf16 v[12:15], a[224:227], a[28:31], v[12:15]
v_mfma_f32_16x16x32_bf16 v[16:19], a[224:227], a[92:95], v[16:19]
v_mfma_f32_16x16x32_bf16 v[4:7], a[224:227], a[32:35], v[4:7]
v_mfma_f32_16x16x32_bf16 v[8:11], a[224:227], a[96:99], v[8:11]
v_mfma_f32_16x16x32_bf16 v[12:15], a[224:227], a[36:39], v[12:15]
v_mfma_f32_16x16x32_bf16 v[16:19], a[224:227], a[100:103], v[16:19]
v_mfma_f32_16x16x32_bf16 v[4:7], a[224:227], a[40:43], v[4:7]
v_mfma_f32_16x16x32_bf16 v[8:11], a[224:227], a[104:107], v[8:11]
v_mfma_f32_16x16x32_bf16 v[12:15], a[224:227], a[44:47], v[12:15]
v_mfma_f32_16x16x32_bf16 v[16:19], a[224:227], a[108:111], v[16:19]
LH_t_h:
v_mfma_f32_16x16x32_bf16 v[4:7], a[224:227], a[48:51], v[4:7]
v_mfma_f32_16x16x32_bf16 v[8:11], a[224:227], a[112:115], v[8:11]
LH_p18:
s_cbranch_execz LH_v0
v_mfma_f32_16x16x32_bf16 v[12:15], a[224:227], a[52:55], v[12:15]
v_mfma_f32_16x16x32_bf16 v[16:19], a[224:227], a[116:119], v[16:19]
v_mfma_f32_16x16x32_bf16 v[4:7], a[224:227], a[56:59], v[4:7]
v_mfma_f32_16x16x32_bf16 v[8:11], a[224:227], a[120:123], v[8:11]
v_mfma_f32_16x16x32_bf16 v[12:15], a[224:227], a[60:63], v[12:15]
v_mfma_f32_16x16x32_bf16 v[16:19], a[224:227], a[124:127], v[16:19]
s_nop 4
v_fmac_f32 v40, 0xbf317218, v4
v_fmac_f32 v41, 0xbf317218, v5
v_fmac_f32 v42, 0xbf317218, v6
v_fmac_f32 v43, 0xbf317218, v7
ds_write_b128 v253, v[40:43] offset:0
v_fmac_f32 v48, 0xbf317218, v12
v_fmac_f32 v49, 0xbf317218, v13
v_fmac_f32 v50, 0xbf317218, v14
v_fmac_f32 v51, 0xbf317218, v15
ds_write_b128 v248, v[48:51] offset:0
v_fmac_f32 v44, 0xbf317218, v8
v_fmac_f32 v45, 0xbf317218, v9
v_fmac_f32 v46, 0xbf317218, v10
v_fmac_f32 v47, 0xbf317218, v11
ds_write_b128 v253, v[44:47] offset:512
v_fmac_f32 v52, 0xbf317218, v16
v_fmac_f32 v53, 0xbf317218, v17
v_fmac_f32 v54, 0xbf317218, v18
v_fmac_f32 v55, 0xbf317218, v19
ds_write_b128 v248, v[52:55] offset:512
ds_read_b128 v[4:7], v247 offset:0
ds_read_b128 v[8:11], v246 offset:1024
ds_read_b128 v[12:15], v247 offset:2048
ds_read_b128 v[16:19], v246 offset:3072
s_mov_b32 s67, 0
s_waitcnt lgkmcnt(3)
buffer_store_dwordx4 v[4:7], v255, s[28:31], s67 offen sc1
s_mov_b32 s67, 18432
s_waitcnt lgkmcnt(2)
buffer_store_dwordx4 v[8:11], v255, s[28:31], s67 offen sc1
s_mov_b32 s67, 36864
s_waitcnt lgkmcnt(1)
buffer_store_dwordx4 v[12:15], v255, s[28:31], s67 offen sc1
s_mov_b32 s67, 55296
s_waitcnt lgkmcnt(0)
buffer_store_dwordx4 v[16:19], v255, s[28:31], s67 offen sc1
s_endpgm
LH_p19:
s_branch LH_v0
Lcode_end:
s_endpgm
.section .rodata,"a"
.p2align 6
.amdhsa_kernel parallel_sum__ssm_conv_s5__dense_activation_silu__prompt_kernel
  .amdhsa_next_free_vgpr 512
  .amdhsa_next_free_sgpr 102
  .amdhsa_accum_offset 256
  .amdhsa_group_segment_fixed_size 0
  .amdhsa_kernarg_size 120
  .amdhsa_user_sgpr_count 2
  .amdhsa_user_sgpr_kernarg_segment_ptr 1
  .amdhsa_system_sgpr_workgroup_id_x 1
.end_amdhsa_kernel
```
